```python
import torch

def _softmax(x, axis=-1):
    return torch.softmax(x, dim=axis)

def _gelu(x):
    return torch.nn.functional.gelu(x, approximate='tanh')

def _silu(x):
    return torch.nn.functional.silu(x)

def _sigmoid(x):
    return torch.sigmoid(x)

def _layernorm(x, axis=-1, eps=1e-05):
    m = x.mean(dim=axis, keepdim=True)
    v = x.var(dim=axis, keepdim=True, unbiased=False)
    return (x - m) / torch.sqrt(v + eps)

def _scatter_add(tgt, idx, src, axis=0):
    return tgt.clone().index_add_(axis, idx, src)

def _segment_sum(src, seg, n):
    out = torch.zeros((n,) + src.shape[1:], dtype=src.dtype)
    return out.index_add_(0, seg, src)

def _pad(x, pw):
    flat = tuple((v for pair in reversed(pw) for v in pair))
    return torch.nn.functional.pad(x, flat)
kernel_name = 'adaLN_cond__sliding_local_dilated__glu_gated_glu__prompt'

def setup_inputs():

    _w = lambda a: (lambda t: t.to(torch.bfloat16) if t.is_floating_point() else t)(torch.as_tensor(a))

    def _A_setup():
        B, S, D = (1, 2048, 576)
        return {'x': _w((lambda *s: torch.randn(*s, dtype=torch.bfloat16) * 0.05)(B, S, D)), 'wqkv': _w((lambda *s: torch.randn(*s, dtype=torch.bfloat16) * 0.05)(D, 3 * D)), 'wo': _w((lambda *s: torch.randn(*s, dtype=torch.bfloat16) * 0.05)(D, D))}
    _A_in = _A_setup()

    def _B_setup():
        B, S, D, F = (1, 2048, 576, 4608)
        return {'x': _w((lambda *s: torch.randn(*s, dtype=torch.bfloat16) * 0.05)(B, S, D)), 'w_gate': _w((lambda *s: torch.randn(*s, dtype=torch.bfloat16) * 0.05)(D, F)), 'w_up': _w((lambda *s: torch.randn(*s, dtype=torch.bfloat16) * 0.05)(D, F)), 'w_down': _w((lambda *s: torch.randn(*s, dtype=torch.bfloat16) * 0.05)(F, D))}
    _B_in = _B_setup()
    return {'A_x': _A_in['x'], 'A_wqkv': _A_in['wqkv'], 'A_wo': _A_in['wo'], 'B_x': _B_in['x'], 'B_w_gate': _B_in['w_gate'], 'B_w_up': _B_in['w_up'], 'B_w_down': _B_in['w_down'], 'c': _w((lambda *s: torch.randn(*s, dtype=torch.bfloat16) * 0.1)(1, 576) * 8.0), 'w_mod': _w((lambda *s: torch.randn(*s, dtype=torch.bfloat16) * 0.1)(576, 6 * 576) * 576 ** (-0.5) * 8.0)}

def reference(A_x, A_wqkv, A_wo, B_x, B_w_gate, B_w_up, B_w_down, c, w_mod):

    def _A_ref(x, wqkv, wo):
        B, S, D = x.shape
        H = 32
        Dh = D // H
        W, dil = (8, 2)
        qkv = (lambda x, *d: x.permute(*d))((x @ wqkv).reshape(B, S, 3, H, Dh), 2, 0, 3, 1, 4)
        q, k, v = (qkv[0], qkv[1], qkv[2])
        scale = Dh ** (-0.5)
        pos = torch.arange(S)
        off = torch.arange(W) * dil
        idx = pos[:, None] - off[None, :]
        mask = idx >= 0
        idx_c = torch.where(mask, idx, 0).reshape(-1)
        kg = k[:, :, idx_c, :].reshape(B, H, S, W, Dh)
        vg = v[:, :, idx_c, :].reshape(B, H, S, W, Dh)
        logits = torch.einsum('bhsd,bhswd->bhsw', q, kg) * scale
        logits = torch.where(mask[None, None, :, :], logits, -1000000000.0)
        attn = _softmax(logits, axis=-1)
        o = torch.einsum('bhsw,bhswd->bhsd', attn, vg)
        return (lambda x, *d: x.permute(*d))(o, 0, 2, 1, 3).reshape(B, S, D) @ wo

    def _B_ref(x, w_gate, w_up, w_down):
        g = torch.einsum('bsd,df->bsf', x, w_gate)
        u = torch.einsum('bsd,df->bsf', x, w_up)
        h = _sigmoid(g) * u
        return torch.einsum('bsf,fd->bsd', h, w_down)
    x = A_x
    mod = (_silu(c) @ w_mod).reshape(c.shape[0], 6, 1, -1)
    sa, ca, ga, sb, cb, gb = (mod[:, 0].clone(), mod[:, 1].clone(), mod[:, 2].clone(), mod[:, 3].clone(), mod[:, 4].clone(), mod[:, 5].clone())
    h = _layernorm(x, axis=-1) * (1 + ca) + sa
    x = x + ga * _A_ref(h, A_wqkv, A_wo)
    h = _layernorm(x, axis=-1) * (1 + cb) + sb
    x = x + gb * _B_ref(h, B_w_gate, B_w_up, B_w_down)
    return x
```

```asm
; @launch kernel=k0_kernel grid=(356,1,1) block=(256,1,1) lds=36864
; @launch kernel=k1_kernel grid=(256,1,1) block=(256,1,1) lds=163840
.amdgcn_target "amdgcn-amd-amdhsa--gfx950"
.text
.globl k0_kernel
.p2align 8
.type k0_kernel,@function
k0_kernel:
    s_cmp_ge_u32 s2, 356
    s_cbranch_scc1 L_end_k0_kernel
    s_load_dwordx16 s[64:79], s[0:1], 0
    s_load_dwordx8 s[80:87], s[0:1], 64
    v_lshrrev_b32 v2, 6, v0
    v_and_b32 v1, 63, v0
    v_readfirstlane_b32 s34, v2
    s_and_b32 s40, s2, 7
    s_lshr_b32 s32, s40, 2
    s_lshr_b32 s41, s2, 5
    s_lshl_b32 s41, s41, 1
    s_add_u32 s32, s32, s41
    s_and_b32 s33, s40, 3
    s_lshl_b32 s33, s33, 2
    s_lshr_b32 s41, s2, 3
    s_and_b32 s41, s41, 3
    s_add_u32 s33, s33, s41
    s_mov_b32 s35, 0xffff0000
    s_mov_b32 s36, 0
    s_mov_b32 s37, -1
    s_getpc_b64 s[50:51]
L_pc_1:
    s_add_u32 s50, s50, L_k0_body-L_pc_1
    s_addc_u32 s51, s51, 0
    v_lshlrev_b32 v2, 7, v1
    v_min_u32 v3, L_k0_end-L_k0_body-4, v2
    global_load_dword v127, v3, s[50:51]
L_k0_body:
    s_mov_b32 s39, s2
    s_cmp_lt_u32 s2, 84
    s_cbranch_scc1 L_rolewq_4
    s_sub_u32 s39, s2, 84
    s_cmp_lt_u32 s39, 108
    s_cbranch_scc1 L_rolemod_2
    s_sub_u32 s39, s39, 108
    s_cmp_lt_u32 s39, 64
    s_cbranch_scc1 L_rolexh_3
    s_sub_u32 s39, s2, 172
    s_cmp_lt_u32 s39, 144
    s_cbranch_scc1 L_rolewq_4
    s_sub_u32 s39, s39, 144
L_rolewo_5:
    s_lshl_b32 s40, s39, 2
    s_add_u32 s40, s40, s34
    s_lshr_b32 s41, s40, 3
    s_and_b32 s42, s40, 7
    s_mul_i32 s43, s42, 144
    s_mul_i32 s44, s34, 4864
    v_lshrrev_b32 v4, 3, v1
    v_and_b32 v5, 7, v1
    v_lshlrev_b32 v5, 4, v5
    v_mul_u32_u24 v6, 1152, v4
    v_add_u32 v6, v6, v5
    v_lshlrev_b32 v7, 2, v4
    s_mov_b32 s45, 0x76543210
    v_lshrrev_b32 v7, v7, s45
    v_and_b32 v7, 15, v7
    v_lshlrev_b32 v9, 2, v4
    s_mov_b32 s45, 0x00002211
    v_lshrrev_b32 v9, v9, s45
    v_and_b32 v9, 15, v9
    v_lshl_add_u32 v7, v9, 4, v7
    v_mul_u32_u24 v8, 1152, v7
    v_add_u32 v8, v8, v5
    s_lshl_b32 s45, s41, 2
    s_waitcnt lgkmcnt(0)
    s_mov_b32 s20, s68
    s_mov_b32 s21, s69
    s_mov_b32 s22, 663552
    s_mov_b32 s23, 0x20000
    s_add_u32 s47, s45, 0
    s_mul_i32 s48, s47, 205
    s_lshr_b32 s48, s48, 10
    s_mul_i32 s49, s48, 5
    s_sub_u32 s49, s47, s49
    s_lshr_b32 s50, s49, 1
    s_mul_i32 s50, s50, 18
    s_and_b32 s51, s49, 1
    s_lshl_b32 s51, s51, 3
    s_add_u32 s50, s50, s51
    s_mul_i32 s48, s48, 36
    s_cmp_eq_u32 s49, 4
    s_cselect_b32 s50, 0, s50
    s_cselect_b64 vcc, -1, 0
    s_add_u32 s50, s50, s48
    s_mul_i32 s50, s50, 1152
    s_add_u32 s52, s50, s43
    v_cndmask_b32 v10, v6, v8, vcc
    s_add_u32 m0, s44, 0
    s_nop 0
    buffer_load_dwordx4 v10, s[20:23], s52 offen lds
    s_add_u32 s47, s45, 1
    s_mul_i32 s48, s47, 205
    s_lshr_b32 s48, s48, 10
    s_mul_i32 s49, s48, 5
    s_sub_u32 s49, s47, s49
    s_lshr_b32 s50, s49, 1
    s_mul_i32 s50, s50, 18
    s_and_b32 s51, s49, 1
    s_lshl_b32 s51, s51, 3
    s_add_u32 s50, s50, s51
    s_mul_i32 s48, s48, 36
    s_cmp_eq_u32 s49, 4
    s_cselect_b32 s50, 0, s50
    s_cselect_b64 vcc, -1, 0
    s_add_u32 s50, s50, s48
    s_mul_i32 s50, s50, 1152
    s_add_u32 s53, s50, s43
    v_cndmask_b32 v11, v6, v8, vcc
    s_add_u32 m0, s44, 1024
    s_nop 0
    buffer_load_dwordx4 v11, s[20:23], s53 offen lds
    s_add_u32 s47, s45, 2
    s_mul_i32 s48, s47, 205
    s_lshr_b32 s48, s48, 10
    s_mul_i32 s49, s48, 5
    s_sub_u32 s49, s47, s49
    s_lshr_b32 s50, s49, 1
    s_mul_i32 s50, s50, 18
    s_and_b32 s51, s49, 1
    s_lshl_b32 s51, s51, 3
    s_add_u32 s50, s50, s51
    s_mul_i32 s48, s48, 36
    s_cmp_eq_u32 s49, 4
    s_cselect_b32 s50, 0, s50
    s_cselect_b64 vcc, -1, 0
    s_add_u32 s50, s50, s48
    s_mul_i32 s50, s50, 1152
    s_add_u32 s54, s50, s43
    v_cndmask_b32 v12, v6, v8, vcc
    s_add_u32 m0, s44, 2048
    s_nop 0
    buffer_load_dwordx4 v12, s[20:23], s54 offen lds
    s_add_u32 s47, s45, 3
    s_mul_i32 s48, s47, 205
    s_lshr_b32 s48, s48, 10
    s_mul_i32 s49, s48, 5
    s_sub_u32 s49, s47, s49
    s_lshr_b32 s50, s49, 1
    s_mul_i32 s50, s50, 18
    s_and_b32 s51, s49, 1
    s_lshl_b32 s51, s51, 3
    s_add_u32 s50, s50, s51
    s_mul_i32 s48, s48, 36
    s_cmp_eq_u32 s49, 4
    s_cselect_b32 s50, 0, s50
    s_cselect_b64 vcc, -1, 0
    s_add_u32 s50, s50, s48
    s_mul_i32 s50, s50, 1152
    s_add_u32 s55, s50, s43
    v_cndmask_b32 v13, v6, v8, vcc
    s_add_u32 m0, s44, 3072
    s_nop 0
    buffer_load_dwordx4 v13, s[20:23], s55 offen lds
    v_and_b32 v14, 7, v1
    v_lshlrev_b32 v14, 5, v14
    v_bfe_u32 v15, v1, 3, 2
    v_add_u32 v10, s52, v10
    v_add_u32 v11, s53, v11
    v_add_u32 v12, s54, v12
    v_add_u32 v13, s55, v13
    ds_bpermute_b32 v16, v14, v10
    ds_bpermute_b32 v17, v14, v11
    ds_bpermute_b32 v18, v14, v12
    ds_bpermute_b32 v19, v14, v13
    v_cmp_eq_u32 vcc, 1, v15
    s_waitcnt lgkmcnt(2)
    s_nop 0
    v_cndmask_b32 v16, v16, v17, vcc
    v_cmp_eq_u32 vcc, 2, v15
    s_waitcnt lgkmcnt(1)
    s_nop 0
    v_cndmask_b32 v16, v16, v18, vcc
    v_cmp_eq_u32 vcc, 3, v15
    s_waitcnt lgkmcnt(0)
    s_nop 0
    v_cndmask_b32 v16, v16, v19, vcc
    s_add_u32 m0, s44, 4096
    s_mov_b32 exec_hi, 0
    buffer_load_dwordx4 v16, s[20:23], 0 offen offset:128 lds
    s_mov_b32 exec_hi, -1
    s_mov_b32 s16, s86
    s_mov_b32 s17, s87
    s_mov_b32 s18, 268435456
    s_mov_b32 s19, 0x20000
    v_lshrrev_b32 v4, 4, v1
    v_bfe_u32 v5, v1, 2, 2
    v_lshl_add_u32 v4, v4, 3, v5
    v_and_b32 v5, 3, v1
    v_lshlrev_b32 v6, 7, v4
    v_lshl_add_u32 v6, v5, 3, v6
    v_add_u32 v6, s44, v6
    v_and_b32 v5, 1, v5
    v_lshlrev_b32 v7, 4, v4
    v_lshl_add_u32 v7, v5, 3, v7
    v_add_u32 v7, s44, v7
    v_lshlrev_b32 v3, 4, v1
    s_mul_i32 s46, s42, 102400
    s_mul_i32 s47, s41, 5120
    s_add_u32 s46, s46, s47
    s_add_u32 s46, s46, 5729536
    s_add_u32 s47, s46, 4096
    s_waitcnt vmcnt(0)
    ds_read_b64_tr_b16 v[32:33], v6 offset:0
    ds_read_b64_tr_b16 v[34:35], v6 offset:512
    ds_read_b64_tr_b16 v[36:37], v6 offset:32
    ds_read_b64_tr_b16 v[38:39], v6 offset:544
    ds_read_b64_tr_b16 v[40:41], v6 offset:64
    ds_read_b64_tr_b16 v[42:43], v6 offset:576
    ds_read_b64_tr_b16 v[44:45], v6 offset:96
    ds_read_b64_tr_b16 v[46:47], v6 offset:608
    ds_read_b64_tr_b16 v[48:49], v7 offset:4224
    ds_read_b64_tr_b16 v[50:51], v7 offset:4288
    s_waitcnt lgkmcnt(8)
    buffer_store_dwordx4 v[32:35], v3, s[16:19], s46 offen offset:0
    s_waitcnt lgkmcnt(6)
    buffer_store_dwordx4 v[36:39], v3, s[16:19], s46 offen offset:1024
    s_waitcnt lgkmcnt(4)
    buffer_store_dwordx4 v[40:43], v3, s[16:19], s46 offen offset:2048
    s_waitcnt lgkmcnt(2)
    buffer_store_dwordx4 v[44:47], v3, s[16:19], s46 offen offset:3072
    s_waitcnt lgkmcnt(0)
    buffer_store_dwordx4 v[48:51], v3, s[16:19], s47 offen
    s_endpgm
L_rolemod_2:
    s_and_b32 s40, s39, 7
    s_lshl_b32 s40, s40, 1
    s_bfe_u32 s41, s39, 0x10003
    s_and_b32 s42, s39, 0xfffffff0
    s_or_b32 s40, s40, s41
    s_or_b32 s40, s40, s42
    s_cmp_lt_u32 s39, 96
    s_cselect_b32 s39, s40, s39
    v_lshrrev_b32 v2, 2, v1
    v_and_b32 v3, 3, v1
    s_mul_i32 s40, s34, 144
    v_add_u32 v4, s40, v2
    s_movk_i32 s41, 6912
    v_mul_lo_u32 v5, v4, s41
    v_lshl_add_u32 v5, v3, 4, v5
    v_lshlrev_b32 v6, 1, v4
    s_lshl_b32 s41, s39, 6
    s_waitcnt lgkmcnt(0)
    s_mov_b32 s12, s78
    s_mov_b32 s13, s79
    s_mov_b32 s14, 1152
    s_mov_b32 s15, 0x20000
    s_mov_b32 s8, s80
    s_mov_b32 s9, s81
    s_mov_b32 s10, 3981312
    s_mov_b32 s11, 0x20000
    buffer_load_ushort v10, v6, s[12:15], 0 offen offset:0
    buffer_load_ushort v11, v6, s[12:15], 0 offen offset:32
    buffer_load_ushort v12, v6, s[12:15], 0 offen offset:64
    buffer_load_ushort v13, v6, s[12:15], 0 offen offset:96
    buffer_load_ushort v14, v6, s[12:15], 0 offen offset:128
    buffer_load_ushort v15, v6, s[12:15], 0 offen offset:160
    buffer_load_ushort v16, v6, s[12:15], 0 offen offset:192
    buffer_load_ushort v17, v6, s[12:15], 0 offen offset:224
    buffer_load_ushort v18, v6, s[12:15], 0 offen offset:256
    s_add_u32 s42, s41, 0
    buffer_load_dwordx4 v[20:23], v5, s[8:11], s42 offen nt
    s_add_u32 s42, s41, 110592
    buffer_load_dwordx4 v[24:27], v5, s[8:11], s42 offen nt
    s_add_u32 s42, s41, 221184
    buffer_load_dwordx4 v[28:31], v5, s[8:11], s42 offen nt
    s_add_u32 s42, s41, 331776
    buffer_load_dwordx4 v[32:35], v5, s[8:11], s42 offen nt
    s_add_u32 s42, s41, 442368
    buffer_load_dwordx4 v[36:39], v5, s[8:11], s42 offen nt
    s_add_u32 s42, s41, 552960
    buffer_load_dwordx4 v[40:43], v5, s[8:11], s42 offen nt
    s_add_u32 s42, s41, 663552
    buffer_load_dwordx4 v[44:47], v5, s[8:11], s42 offen nt
    s_add_u32 s42, s41, 774144
    buffer_load_dwordx4 v[48:51], v5, s[8:11], s42 offen nt
    s_add_u32 s42, s41, 884736
    buffer_load_dwordx4 v[52:55], v5, s[8:11], s42 offen nt
    s_mov_b32 s16, s86
    s_mov_b32 s17, s87
    s_mov_b32 s18, 268435456
    s_mov_b32 s19, 0x20000
    s_mov_b32 s43, 0xbfb8aa3b
    s_waitcnt vmcnt(17)
    v_lshlrev_b32 v10, 16, v10
    s_waitcnt vmcnt(16)
    v_lshlrev_b32 v11, 16, v11
    s_waitcnt vmcnt(15)
    v_lshlrev_b32 v12, 16, v12
    s_waitcnt vmcnt(14)
    v_lshlrev_b32 v13, 16, v13
    s_waitcnt vmcnt(13)
    v_lshlrev_b32 v14, 16, v14
    s_waitcnt vmcnt(12)
    v_lshlrev_b32 v15, 16, v15
    s_waitcnt vmcnt(11)
    v_lshlrev_b32 v16, 16, v16
    s_waitcnt vmcnt(10)
    v_lshlrev_b32 v17, 16, v17
    s_waitcnt vmcnt(9)
    v_lshlrev_b32 v18, 16, v18
    v_mul_f32 v64, s43, v10
    v_mul_f32 v65, s43, v11
    v_mul_f32 v66, s43, v12
    v_mul_f32 v67, s43, v13
    v_mul_f32 v68, s43, v14
    v_mul_f32 v69, s43, v15
    v_mul_f32 v70, s43, v16
    v_mul_f32 v71, s43, v17
    v_mul_f32 v72, s43, v18
    v_exp_f32 v64, v64
    v_exp_f32 v65, v65
    v_exp_f32 v66, v66
    v_exp_f32 v67, v67
    v_exp_f32 v68, v68
    v_exp_f32 v69, v69
    v_exp_f32 v70, v70
    v_exp_f32 v71, v71
    v_exp_f32 v72, v72
    v_add_f32 v64, 1.0, v64
    v_add_f32 v65, 1.0, v65
    v_add_f32 v66, 1.0, v66
    v_add_f32 v67, 1.0, v67
    v_add_f32 v68, 1.0, v68
    v_add_f32 v69, 1.0, v69
    v_add_f32 v70, 1.0, v70
    v_add_f32 v71, 1.0, v71
    v_add_f32 v72, 1.0, v72
    v_rcp_f32 v64, v64
    v_rcp_f32 v65, v65
    v_rcp_f32 v66, v66
    v_rcp_f32 v67, v67
    v_rcp_f32 v68, v68
    v_rcp_f32 v69, v69
    v_rcp_f32 v70, v70
    v_rcp_f32 v71, v71
    v_rcp_f32 v72, v72
    v_mul_f32 v10, v10, v64
    v_mul_f32 v11, v11, v65
    v_mul_f32 v12, v12, v66
    v_mul_f32 v13, v13, v67
    v_mul_f32 v14, v14, v68
    v_mul_f32 v15, v15, v69
    v_mul_f32 v16, v16, v70
    v_mul_f32 v17, v17, v71
    v_mul_f32 v18, v18, v72
    v_cvt_pk_bf16_f32 v10, v10, v10
    v_cvt_pk_bf16_f32 v11, v11, v11
    v_cvt_pk_bf16_f32 v12, v12, v12
    v_cvt_pk_bf16_f32 v13, v13, v13
    v_cvt_pk_bf16_f32 v14, v14, v14
    v_cvt_pk_bf16_f32 v15, v15, v15
    v_cvt_pk_bf16_f32 v16, v16, v16
    v_cvt_pk_bf16_f32 v17, v17, v17
    v_cvt_pk_bf16_f32 v18, v18, v18
    v_and_b32 v10, s35, v10
    v_and_b32 v11, s35, v11
    v_and_b32 v12, s35, v12
    v_and_b32 v13, s35, v13
    v_and_b32 v14, s35, v14
    v_and_b32 v15, s35, v15
    v_and_b32 v16, s35, v16
    v_and_b32 v17, s35, v17
    v_and_b32 v18, s35, v18
    s_waitcnt vmcnt(8)
    v_lshlrev_b32 v64, 16, v20
    v_and_b32 v65, s35, v20
    v_lshlrev_b32 v66, 16, v21
    v_and_b32 v67, s35, v21
    v_lshlrev_b32 v68, 16, v22
    v_and_b32 v69, s35, v22
    v_lshlrev_b32 v70, 16, v23
    v_and_b32 v71, s35, v23
    v_pk_mul_f32 v[56:57], v[64:65], v[10:11] op_sel_hi:[1,0]
    v_pk_mul_f32 v[58:59], v[66:67], v[10:11] op_sel_hi:[1,0]
    v_pk_mul_f32 v[60:61], v[68:69], v[10:11] op_sel_hi:[1,0]
    v_pk_mul_f32 v[62:63], v[70:71], v[10:11] op_sel_hi:[1,0]
    s_waitcnt vmcnt(7)
    v_lshlrev_b32 v64, 16, v24
    v_and_b32 v65, s35, v24
    v_lshlrev_b32 v66, 16, v25
    v_and_b32 v67, s35, v25
    v_lshlrev_b32 v68, 16, v26
    v_and_b32 v69, s35, v26
    v_lshlrev_b32 v70, 16, v27
    v_and_b32 v71, s35, v27
    v_pk_fma_f32 v[56:57], v[64:65], v[10:11], v[56:57] op_sel:[0,1,0] op_sel_hi:[1,1,1]
    v_pk_fma_f32 v[58:59], v[66:67], v[10:11], v[58:59] op_sel:[0,1,0] op_sel_hi:[1,1,1]
    v_pk_fma_f32 v[60:61], v[68:69], v[10:11], v[60:61] op_sel:[0,1,0] op_sel_hi:[1,1,1]
    v_pk_fma_f32 v[62:63], v[70:71], v[10:11], v[62:63] op_sel:[0,1,0] op_sel_hi:[1,1,1]
    s_waitcnt vmcnt(6)
    v_lshlrev_b32 v64, 16, v28
    v_and_b32 v65, s35, v28
    v_lshlrev_b32 v66, 16, v29
    v_and_b32 v67, s35, v29
    v_lshlrev_b32 v68, 16, v30
    v_and_b32 v69, s35, v30
    v_lshlrev_b32 v70, 16, v31
    v_and_b32 v71, s35, v31
    v_pk_fma_f32 v[56:57], v[64:65], v[12:13], v[56:57] op_sel_hi:[1,0,1]
    v_pk_fma_f32 v[58:59], v[66:67], v[12:13], v[58:59] op_sel_hi:[1,0,1]
    v_pk_fma_f32 v[60:61], v[68:69], v[12:13], v[60:61] op_sel_hi:[1,0,1]
    v_pk_fma_f32 v[62:63], v[70:71], v[12:13], v[62:63] op_sel_hi:[1,0,1]
    s_waitcnt vmcnt(5)
    v_lshlrev_b32 v64, 16, v32
    v_and_b32 v65, s35, v32
    v_lshlrev_b32 v66, 16, v33
    v_and_b32 v67, s35, v33
    v_lshlrev_b32 v68, 16, v34
    v_and_b32 v69, s35, v34
    v_lshlrev_b32 v70, 16, v35
    v_and_b32 v71, s35, v35
    v_pk_fma_f32 v[56:57], v[64:65], v[12:13], v[56:57] op_sel:[0,1,0] op_sel_hi:[1,1,1]
    v_pk_fma_f32 v[58:59], v[66:67], v[12:13], v[58:59] op_sel:[0,1,0] op_sel_hi:[1,1,1]
    v_pk_fma_f32 v[60:61], v[68:69], v[12:13], v[60:61] op_sel:[0,1,0] op_sel_hi:[1,1,1]
    v_pk_fma_f32 v[62:63], v[70:71], v[12:13], v[62:63] op_sel:[0,1,0] op_sel_hi:[1,1,1]
    s_waitcnt vmcnt(4)
    v_lshlrev_b32 v64, 16, v36
    v_and_b32 v65, s35, v36
    v_lshlrev_b32 v66, 16, v37
    v_and_b32 v67, s35, v37
    v_lshlrev_b32 v68, 16, v38
    v_and_b32 v69, s35, v38
    v_lshlrev_b32 v70, 16, v39
    v_and_b32 v71, s35, v39
    v_pk_fma_f32 v[56:57], v[64:65], v[14:15], v[56:57] op_sel_hi:[1,0,1]
    v_pk_fma_f32 v[58:59], v[66:67], v[14:15], v[58:59] op_sel_hi:[1,0,1]
    v_pk_fma_f32 v[60:61], v[68:69], v[14:15], v[60:61] op_sel_hi:[1,0,1]
    v_pk_fma_f32 v[62:63], v[70:71], v[14:15], v[62:63] op_sel_hi:[1,0,1]
    s_waitcnt vmcnt(3)
    v_lshlrev_b32 v64, 16, v40
    v_and_b32 v65, s35, v40
    v_lshlrev_b32 v66, 16, v41
    v_and_b32 v67, s35, v41
    v_lshlrev_b32 v68, 16, v42
    v_and_b32 v69, s35, v42
    v_lshlrev_b32 v70, 16, v43
    v_and_b32 v71, s35, v43
    v_pk_fma_f32 v[56:57], v[64:65], v[14:15], v[56:57] op_sel:[0,1,0] op_sel_hi:[1,1,1]
    v_pk_fma_f32 v[58:59], v[66:67], v[14:15], v[58:59] op_sel:[0,1,0] op_sel_hi:[1,1,1]
    v_pk_fma_f32 v[60:61], v[68:69], v[14:15], v[60:61] op_sel:[0,1,0] op_sel_hi:[1,1,1]
    v_pk_fma_f32 v[62:63], v[70:71], v[14:15], v[62:63] op_sel:[0,1,0] op_sel_hi:[1,1,1]
    s_waitcnt vmcnt(2)
    v_lshlrev_b32 v64, 16, v44
    v_and_b32 v65, s35, v44
    v_lshlrev_b32 v66, 16, v45
    v_and_b32 v67, s35, v45
    v_lshlrev_b32 v68, 16, v46
    v_and_b32 v69, s35, v46
    v_lshlrev_b32 v70, 16, v47
    v_and_b32 v71, s35, v47
    v_pk_fma_f32 v[56:57], v[64:65], v[16:17], v[56:57] op_sel_hi:[1,0,1]
    v_pk_fma_f32 v[58:59], v[66:67], v[16:17], v[58:59] op_sel_hi:[1,0,1]
    v_pk_fma_f32 v[60:61], v[68:69], v[16:17], v[60:61] op_sel_hi:[1,0,1]
    v_pk_fma_f32 v[62:63], v[70:71], v[16:17], v[62:63] op_sel_hi:[1,0,1]
    s_waitcnt vmcnt(1)
    v_lshlrev_b32 v64, 16, v48
    v_and_b32 v65, s35, v48
    v_lshlrev_b32 v66, 16, v49
    v_and_b32 v67, s35, v49
    v_lshlrev_b32 v68, 16, v50
    v_and_b32 v69, s35, v50
    v_lshlrev_b32 v70, 16, v51
    v_and_b32 v71, s35, v51
    v_pk_fma_f32 v[56:57], v[64:65], v[16:17], v[56:57] op_sel:[0,1,0] op_sel_hi:[1,1,1]
    v_pk_fma_f32 v[58:59], v[66:67], v[16:17], v[58:59] op_sel:[0,1,0] op_sel_hi:[1,1,1]
    v_pk_fma_f32 v[60:61], v[68:69], v[16:17], v[60:61] op_sel:[0,1,0] op_sel_hi:[1,1,1]
    v_pk_fma_f32 v[62:63], v[70:71], v[16:17], v[62:63] op_sel:[0,1,0] op_sel_hi:[1,1,1]
    s_waitcnt vmcnt(0)
    v_lshlrev_b32 v64, 16, v52
    v_and_b32 v65, s35, v52
    v_lshlrev_b32 v66, 16, v53
    v_and_b32 v67, s35, v53
    v_lshlrev_b32 v68, 16, v54
    v_and_b32 v69, s35, v54
    v_lshlrev_b32 v70, 16, v55
    v_and_b32 v71, s35, v55
    v_pk_fma_f32 v[56:57], v[64:65], v[18:19], v[56:57] op_sel_hi:[1,0,1]
    v_pk_fma_f32 v[58:59], v[66:67], v[18:19], v[58:59] op_sel_hi:[1,0,1]
    v_pk_fma_f32 v[60:61], v[68:69], v[18:19], v[60:61] op_sel_hi:[1,0,1]
    v_pk_fma_f32 v[62:63], v[70:71], v[18:19], v[62:63] op_sel_hi:[1,0,1]
    v_add_f32_dpp v56, v56, v56 row_ror:8 row_mask:0xf bank_mask:0xf
    v_add_f32_dpp v57, v57, v57 row_ror:8 row_mask:0xf bank_mask:0xf
    v_add_f32_dpp v58, v58, v58 row_ror:8 row_mask:0xf bank_mask:0xf
    v_add_f32_dpp v59, v59, v59 row_ror:8 row_mask:0xf bank_mask:0xf
    v_add_f32_dpp v60, v60, v60 row_ror:8 row_mask:0xf bank_mask:0xf
    v_add_f32_dpp v61, v61, v61 row_ror:8 row_mask:0xf bank_mask:0xf
    v_add_f32_dpp v62, v62, v62 row_ror:8 row_mask:0xf bank_mask:0xf
    v_add_f32_dpp v63, v63, v63 row_ror:8 row_mask:0xf bank_mask:0xf
    v_add_f32_dpp v56, v56, v56 row_ror:4 row_mask:0xf bank_mask:0xf
    v_add_f32_dpp v57, v57, v57 row_ror:4 row_mask:0xf bank_mask:0xf
    v_add_f32_dpp v58, v58, v58 row_ror:4 row_mask:0xf bank_mask:0xf
    v_add_f32_dpp v59, v59, v59 row_ror:4 row_mask:0xf bank_mask:0xf
    v_add_f32_dpp v60, v60, v60 row_ror:4 row_mask:0xf bank_mask:0xf
    v_add_f32_dpp v61, v61, v61 row_ror:4 row_mask:0xf bank_mask:0xf
    v_add_f32_dpp v62, v62, v62 row_ror:4 row_mask:0xf bank_mask:0xf
    v_add_f32_dpp v63, v63, v63 row_ror:4 row_mask:0xf bank_mask:0xf
    v_lshrrev_b32 v7, 4, v1
    s_lshl_b32 s40, s34, 2
    v_add_u32 v7, s40, v7
    v_lshlrev_b32 v7, 7, v7
    v_lshl_add_u32 v7, v3, 5, v7
    s_mov_b32 exec_lo, 0x000f000f
    s_mov_b32 exec_hi, 0x000f000f
    ds_write_b128 v7, v[56:59] offset:0
    ds_write_b128 v7, v[60:63] offset:16
    s_mov_b64 exec, -1
    s_waitcnt lgkmcnt(0)
    s_barrier
    s_cmp_lg_u32 s34, 0
    s_nop 0
    s_cbranch_scc1 L_skip_6
    v_lshrrev_b32 v7, 5, v1
    v_and_b32 v8, 31, v1
    v_lshlrev_b32 v7, 10, v7
    v_lshl_add_u32 v7, v8, 2, v7
    ds_read_b32 v56, v7 offset:0
    ds_read_b32 v57, v7 offset:128
    ds_read_b32 v58, v7 offset:256
    ds_read_b32 v59, v7 offset:384
    ds_read_b32 v60, v7 offset:512
    ds_read_b32 v61, v7 offset:640
    ds_read_b32 v62, v7 offset:768
    ds_read_b32 v63, v7 offset:896
    s_waitcnt lgkmcnt(6)
    v_add_f32 v56, v56, v57
    s_waitcnt lgkmcnt(4)
    v_add_f32 v58, v58, v59
    s_waitcnt lgkmcnt(2)
    v_add_f32 v60, v60, v61
    s_waitcnt lgkmcnt(0)
    v_add_f32 v62, v62, v63
    v_add_f32 v56, v56, v58
    v_add_f32 v60, v60, v62
    v_add_f32 v56, v56, v60
    v_mov_b32 v57, v56
    s_nop 1
    v_permlane32_swap_b32 v56, v57
    v_add_f32 v56, v56, v57
    v_cvt_pk_bf16_f32 v56, v56, v56
    v_and_b32 v56, s35, v56
    s_mul_i32 s40, s39, 57
    s_lshr_b32 s40, s40, 10
    s_cmp_eq_u32 s40, 1
    s_cselect_b32 s41, 1.0, 0
    s_cmp_eq_u32 s40, 4
    s_cselect_b32 s41, 1.0, s41
    v_add_f32 v56, s41, v56
    v_cvt_pk_bf16_f32 v56, v56, v56
    v_and_b32 v56, s35, v56
    s_lshl_b32 s40, s39, 7
    v_lshlrev_b32 v8, 2, v8
    s_mov_b32 exec_hi, 0
    buffer_store_dword v56, v8, s[16:19], s40 offen offset:0
    s_mov_b64 exec, -1
    s_waitcnt vmcnt(0)
    s_nop 0
L_skip_6:
    s_endpgm
L_rolexh_3:
    v_lshrrev_b32 v4, 3, v1
    v_and_b32 v5, 7, v1
    v_mul_u32_u24 v2, 1152, v4
    v_lshl_add_u32 v2, v5, 4, v2
    s_lshl_b32 s40, s39, 2
    s_add_u32 s40, s40, s34
    s_mul_i32 s41, s40, 9216
    s_waitcnt lgkmcnt(0)
    s_mov_b32 s8, s64
    s_mov_b32 s9, s65
    s_mov_b32 s10, 2359296
    s_mov_b32 s11, 0x20000
    buffer_load_dwordx4 v[16:19], v2, s[8:11], s41 offen offset:0
    buffer_load_dwordx4 v[20:23], v2, s[8:11], s41 offen offset:128
    buffer_load_dwordx4 v[24:27], v2, s[8:11], s41 offen offset:256
    buffer_load_dwordx4 v[28:31], v2, s[8:11], s41 offen offset:384
    buffer_load_dwordx4 v[32:35], v2, s[8:11], s41 offen offset:512
    buffer_load_dwordx4 v[36:39], v2, s[8:11], s41 offen offset:640
    buffer_load_dwordx4 v[40:43], v2, s[8:11], s41 offen offset:768
    buffer_load_dwordx4 v[44:47], v2, s[8:11], s41 offen offset:896
    buffer_load_dwordx4 v[48:51], v2, s[8:11], s41 offen offset:1024
    s_mov_b32 s16, s86
    s_mov_b32 s17, s87
    s_mov_b32 s18, 268435456
    s_mov_b32 s19, 0x20000
    s_mul_i32 s42, s34, 9216
    v_xor_b32 v6, v4, v5
    v_lshlrev_b32 v6, 4, v6
    v_add_u32 v6, s42, v6
    v_lshl_add_u32 v7, v4, 7, v6
    v_lshl_add_u32 v6, v5, 7, v6
    v_lshlrev_b32 v3, 9, v4
    v_lshl_add_u32 v3, v5, 4, v3
    s_mul_i32 s43, s39, 36864
    s_lshl_b32 s44, s34, 7
    s_add_u32 s43, s43, s44
    s_add_u32 s43, s43, 1157376
    s_lshr_b32 s46, s40, 1
    s_mul_i32 s46, s46, 18432
    s_and_b32 s47, s34, 1
    s_lshl_b32 s47, s47, 7
    s_add_u32 s46, s46, s47
    s_add_u32 s46, s46, 13888768
    v_lshlrev_b32 v15, 8, v4
    v_lshl_add_u32 v15, v5, 4, v15
    s_waitcnt vmcnt(8)
    v_lshlrev_b32 v56, 16, v16
    v_and_b32 v57, s35, v16
    v_lshlrev_b32 v58, 16, v17
    v_and_b32 v59, s35, v17
    v_lshlrev_b32 v60, 16, v18
    v_and_b32 v61, s35, v18
    v_lshlrev_b32 v62, 16, v19
    v_and_b32 v63, s35, v19
    s_waitcnt vmcnt(7)
    v_lshlrev_b32 v64, 16, v20
    v_and_b32 v65, s35, v20
    v_lshlrev_b32 v66, 16, v21
    v_and_b32 v67, s35, v21
    v_lshlrev_b32 v68, 16, v22
    v_and_b32 v69, s35, v22
    v_lshlrev_b32 v70, 16, v23
    v_and_b32 v71, s35, v23
    s_waitcnt vmcnt(6)
    v_lshlrev_b32 v72, 16, v24
    v_and_b32 v73, s35, v24
    v_lshlrev_b32 v74, 16, v25
    v_and_b32 v75, s35, v25
    v_lshlrev_b32 v76, 16, v26
    v_and_b32 v77, s35, v26
    v_lshlrev_b32 v78, 16, v27
    v_and_b32 v79, s35, v27
    s_waitcnt vmcnt(5)
    v_lshlrev_b32 v80, 16, v28
    v_and_b32 v81, s35, v28
    v_lshlrev_b32 v82, 16, v29
    v_and_b32 v83, s35, v29
    v_lshlrev_b32 v84, 16, v30
    v_and_b32 v85, s35, v30
    v_lshlrev_b32 v86, 16, v31
    v_and_b32 v87, s35, v31
    s_waitcnt vmcnt(4)
    v_lshlrev_b32 v88, 16, v32
    v_and_b32 v89, s35, v32
    v_lshlrev_b32 v90, 16, v33
    v_and_b32 v91, s35, v33
    v_lshlrev_b32 v92, 16, v34
    v_and_b32 v93, s35, v34
    v_lshlrev_b32 v94, 16, v35
    v_and_b32 v95, s35, v35
    s_waitcnt vmcnt(3)
    v_lshlrev_b32 v96, 16, v36
    v_and_b32 v97, s35, v36
    v_lshlrev_b32 v98, 16, v37
    v_and_b32 v99, s35, v37
    v_lshlrev_b32 v100, 16, v38
    v_and_b32 v101, s35, v38
    v_lshlrev_b32 v102, 16, v39
    v_and_b32 v103, s35, v39
    s_waitcnt vmcnt(2)
    v_lshlrev_b32 v104, 16, v40
    v_and_b32 v105, s35, v40
    v_lshlrev_b32 v106, 16, v41
    v_and_b32 v107, s35, v41
    v_lshlrev_b32 v108, 16, v42
    v_and_b32 v109, s35, v42
    v_lshlrev_b32 v110, 16, v43
    v_and_b32 v111, s35, v43
    s_waitcnt vmcnt(1)
    v_lshlrev_b32 v112, 16, v44
    v_and_b32 v113, s35, v44
    v_lshlrev_b32 v114, 16, v45
    v_and_b32 v115, s35, v45
    v_lshlrev_b32 v116, 16, v46
    v_and_b32 v117, s35, v46
    v_lshlrev_b32 v118, 16, v47
    v_and_b32 v119, s35, v47
    s_waitcnt vmcnt(0)
    v_lshlrev_b32 v120, 16, v48
    v_and_b32 v121, s35, v48
    v_lshlrev_b32 v122, 16, v49
    v_and_b32 v123, s35, v49
    v_lshlrev_b32 v124, 16, v50
    v_and_b32 v125, s35, v50
    v_lshlrev_b32 v126, 16, v51
    v_and_b32 v127, s35, v51
    v_pk_add_f32 v[8:9], v[56:57], v[58:59]
    v_pk_add_f32 v[10:11], v[60:61], v[62:63]
    v_pk_add_f32 v[10:11], v[10:11], v[64:65]
    v_pk_add_f32 v[8:9], v[8:9], v[66:67]
    v_pk_add_f32 v[10:11], v[10:11], v[68:69]
    v_pk_add_f32 v[8:9], v[8:9], v[70:71]
    v_pk_add_f32 v[10:11], v[10:11], v[72:73]
    v_pk_add_f32 v[8:9], v[8:9], v[74:75]
    v_pk_add_f32 v[10:11], v[10:11], v[76:77]
    v_pk_add_f32 v[8:9], v[8:9], v[78:79]
    v_pk_add_f32 v[10:11], v[10:11], v[80:81]
    v_pk_add_f32 v[8:9], v[8:9], v[82:83]
    v_pk_add_f32 v[10:11], v[10:11], v[84:85]
    v_pk_add_f32 v[8:9], v[8:9], v[86:87]
    v_pk_add_f32 v[10:11], v[10:11], v[88:89]
    v_pk_add_f32 v[8:9], v[8:9], v[90:91]
    v_pk_add_f32 v[10:11], v[10:11], v[92:93]
    v_pk_add_f32 v[8:9], v[8:9], v[94:95]
    v_pk_add_f32 v[10:11], v[10:11], v[96:97]
    v_pk_add_f32 v[8:9], v[8:9], v[98:99]
    v_pk_add_f32 v[10:11], v[10:11], v[100:101]
    v_pk_add_f32 v[8:9], v[8:9], v[102:103]
    v_pk_add_f32 v[10:11], v[10:11], v[104:105]
    v_pk_add_f32 v[8:9], v[8:9], v[106:107]
    v_pk_add_f32 v[10:11], v[10:11], v[108:109]
    v_pk_add_f32 v[8:9], v[8:9], v[110:111]
    v_pk_add_f32 v[10:11], v[10:11], v[112:113]
    v_pk_add_f32 v[8:9], v[8:9], v[114:115]
    v_pk_add_f32 v[10:11], v[10:11], v[116:117]
    v_pk_add_f32 v[8:9], v[8:9], v[118:119]
    v_pk_add_f32 v[10:11], v[10:11], v[120:121]
    v_pk_add_f32 v[8:9], v[8:9], v[122:123]
    v_pk_add_f32 v[10:11], v[10:11], v[124:125]
    v_pk_add_f32 v[8:9], v[8:9], v[126:127]
    v_pk_add_f32 v[8:9], v[8:9], v[10:11]
    v_add_f32 v8, v8, v9
    s_nop 1
    v_add_f32_dpp v8, v8, v8 quad_perm:[1,0,3,2] row_mask:0xf bank_mask:0xf
    s_nop 1
    v_add_f32_dpp v8, v8, v8 quad_perm:[2,3,0,1] row_mask:0xf bank_mask:0xf
    s_nop 1
    v_add_f32_dpp v8, v8, v8 row_half_mirror row_mask:0xf bank_mask:0xf
    s_mov_b32 s45, 0x3ae38e39
    v_mul_f32 v8, s45, v8
    v_pk_add_f32 v[56:57], v[56:57], v[8:9] op_sel_hi:[1,0] neg_lo:[0,1] neg_hi:[0,1]
    v_pk_add_f32 v[58:59], v[58:59], v[8:9] op_sel_hi:[1,0] neg_lo:[0,1] neg_hi:[0,1]
    v_pk_add_f32 v[60:61], v[60:61], v[8:9] op_sel_hi:[1,0] neg_lo:[0,1] neg_hi:[0,1]
    v_pk_add_f32 v[62:63], v[62:63], v[8:9] op_sel_hi:[1,0] neg_lo:[0,1] neg_hi:[0,1]
    v_pk_add_f32 v[64:65], v[64:65], v[8:9] op_sel_hi:[1,0] neg_lo:[0,1] neg_hi:[0,1]
    v_pk_add_f32 v[66:67], v[66:67], v[8:9] op_sel_hi:[1,0] neg_lo:[0,1] neg_hi:[0,1]
    v_pk_add_f32 v[68:69], v[68:69], v[8:9] op_sel_hi:[1,0] neg_lo:[0,1] neg_hi:[0,1]
    v_pk_add_f32 v[70:71], v[70:71], v[8:9] op_sel_hi:[1,0] neg_lo:[0,1] neg_hi:[0,1]
    v_pk_add_f32 v[72:73], v[72:73], v[8:9] op_sel_hi:[1,0] neg_lo:[0,1] neg_hi:[0,1]
    v_pk_add_f32 v[74:75], v[74:75], v[8:9] op_sel_hi:[1,0] neg_lo:[0,1] neg_hi:[0,1]
    v_pk_add_f32 v[76:77], v[76:77], v[8:9] op_sel_hi:[1,0] neg_lo:[0,1] neg_hi:[0,1]
    v_pk_add_f32 v[78:79], v[78:79], v[8:9] op_sel_hi:[1,0] neg_lo:[0,1] neg_hi:[0,1]
    v_pk_add_f32 v[80:81], v[80:81], v[8:9] op_sel_hi:[1,0] neg_lo:[0,1] neg_hi:[0,1]
    v_pk_add_f32 v[82:83], v[82:83], v[8:9] op_sel_hi:[1,0] neg_lo:[0,1] neg_hi:[0,1]
    v_pk_add_f32 v[84:85], v[84:85], v[8:9] op_sel_hi:[1,0] neg_lo:[0,1] neg_hi:[0,1]
    v_pk_add_f32 v[86:87], v[86:87], v[8:9] op_sel_hi:[1,0] neg_lo:[0,1] neg_hi:[0,1]
    v_pk_add_f32 v[88:89], v[88:89], v[8:9] op_sel_hi:[1,0] neg_lo:[0,1] neg_hi:[0,1]
    v_pk_add_f32 v[90:91], v[90:91], v[8:9] op_sel_hi:[1,0] neg_lo:[0,1] neg_hi:[0,1]
    v_pk_add_f32 v[92:93], v[92:93], v[8:9] op_sel_hi:[1,0] neg_lo:[0,1] neg_hi:[0,1]
    v_pk_add_f32 v[94:95], v[94:95], v[8:9] op_sel_hi:[1,0] neg_lo:[0,1] neg_hi:[0,1]
    v_pk_add_f32 v[96:97], v[96:97], v[8:9] op_sel_hi:[1,0] neg_lo:[0,1] neg_hi:[0,1]
    v_pk_add_f32 v[98:99], v[98:99], v[8:9] op_sel_hi:[1,0] neg_lo:[0,1] neg_hi:[0,1]
    v_pk_add_f32 v[100:101], v[100:101], v[8:9] op_sel_hi:[1,0] neg_lo:[0,1] neg_hi:[0,1]
    v_pk_add_f32 v[102:103], v[102:103], v[8:9] op_sel_hi:[1,0] neg_lo:[0,1] neg_hi:[0,1]
    v_pk_add_f32 v[104:105], v[104:105], v[8:9] op_sel_hi:[1,0] neg_lo:[0,1] neg_hi:[0,1]
    v_pk_add_f32 v[106:107], v[106:107], v[8:9] op_sel_hi:[1,0] neg_lo:[0,1] neg_hi:[0,1]
    v_pk_add_f32 v[108:109], v[108:109], v[8:9] op_sel_hi:[1,0] neg_lo:[0,1] neg_hi:[0,1]
    v_pk_add_f32 v[110:111], v[110:111], v[8:9] op_sel_hi:[1,0] neg_lo:[0,1] neg_hi:[0,1]
    v_pk_add_f32 v[112:113], v[112:113], v[8:9] op_sel_hi:[1,0] neg_lo:[0,1] neg_hi:[0,1]
    v_pk_add_f32 v[114:115], v[114:115], v[8:9] op_sel_hi:[1,0] neg_lo:[0,1] neg_hi:[0,1]
    v_pk_add_f32 v[116:117], v[116:117], v[8:9] op_sel_hi:[1,0] neg_lo:[0,1] neg_hi:[0,1]
    v_pk_add_f32 v[118:119], v[118:119], v[8:9] op_sel_hi:[1,0] neg_lo:[0,1] neg_hi:[0,1]
    v_pk_add_f32 v[120:121], v[120:121], v[8:9] op_sel_hi:[1,0] neg_lo:[0,1] neg_hi:[0,1]
    v_pk_add_f32 v[122:123], v[122:123], v[8:9] op_sel_hi:[1,0] neg_lo:[0,1] neg_hi:[0,1]
    v_pk_add_f32 v[124:125], v[124:125], v[8:9] op_sel_hi:[1,0] neg_lo:[0,1] neg_hi:[0,1]
    v_pk_add_f32 v[126:127], v[126:127], v[8:9] op_sel_hi:[1,0] neg_lo:[0,1] neg_hi:[0,1]
    v_pk_mul_f32 v[10:11], v[56:57], v[56:57]
    v_pk_mul_f32 v[12:13], v[58:59], v[58:59]
    v_pk_fma_f32 v[10:11], v[60:61], v[60:61], v[10:11]
    v_pk_fma_f32 v[12:13], v[62:63], v[62:63], v[12:13]
    v_pk_fma_f32 v[10:11], v[64:65], v[64:65], v[10:11]
    v_pk_fma_f32 v[12:13], v[66:67], v[66:67], v[12:13]
    v_pk_fma_f32 v[10:11], v[68:69], v[68:69], v[10:11]
    v_pk_fma_f32 v[12:13], v[70:71], v[70:71], v[12:13]
    v_pk_fma_f32 v[10:11], v[72:73], v[72:73], v[10:11]
    v_pk_fma_f32 v[12:13], v[74:75], v[74:75], v[12:13]
    v_pk_fma_f32 v[10:11], v[76:77], v[76:77], v[10:11]
    v_pk_fma_f32 v[12:13], v[78:79], v[78:79], v[12:13]
    v_pk_fma_f32 v[10:11], v[80:81], v[80:81], v[10:11]
    v_pk_fma_f32 v[12:13], v[82:83], v[82:83], v[12:13]
    v_pk_fma_f32 v[10:11], v[84:85], v[84:85], v[10:11]
    v_pk_fma_f32 v[12:13], v[86:87], v[86:87], v[12:13]
    v_pk_fma_f32 v[10:11], v[88:89], v[88:89], v[10:11]
    v_pk_fma_f32 v[12:13], v[90:91], v[90:91], v[12:13]
    v_pk_fma_f32 v[10:11], v[92:93], v[92:93], v[10:11]
    v_pk_fma_f32 v[12:13], v[94:95], v[94:95], v[12:13]
    v_pk_fma_f32 v[10:11], v[96:97], v[96:97], v[10:11]
    v_pk_fma_f32 v[12:13], v[98:99], v[98:99], v[12:13]
    v_pk_fma_f32 v[10:11], v[100:101], v[100:101], v[10:11]
    v_pk_fma_f32 v[12:13], v[102:103], v[102:103], v[12:13]
    v_pk_fma_f32 v[10:11], v[104:105], v[104:105], v[10:11]
    v_pk_fma_f32 v[12:13], v[106:107], v[106:107], v[12:13]
    v_pk_fma_f32 v[10:11], v[108:109], v[108:109], v[10:11]
    v_pk_fma_f32 v[12:13], v[110:111], v[110:111], v[12:13]
    v_pk_fma_f32 v[10:11], v[112:113], v[112:113], v[10:11]
    v_pk_fma_f32 v[12:13], v[114:115], v[114:115], v[12:13]
    v_pk_fma_f32 v[10:11], v[116:117], v[116:117], v[10:11]
    v_pk_fma_f32 v[12:13], v[118:119], v[118:119], v[12:13]
    v_pk_fma_f32 v[10:11], v[120:121], v[120:121], v[10:11]
    v_pk_fma_f32 v[12:13], v[122:123], v[122:123], v[12:13]
    v_pk_fma_f32 v[10:11], v[124:125], v[124:125], v[10:11]
    v_pk_fma_f32 v[12:13], v[126:127], v[126:127], v[12:13]
    v_pk_add_f32 v[10:11], v[10:11], v[12:13]
    v_add_f32 v10, v10, v11
    s_nop 1
    v_add_f32_dpp v10, v10, v10 quad_perm:[1,0,3,2] row_mask:0xf bank_mask:0xf
    s_nop 1
    v_add_f32_dpp v10, v10, v10 quad_perm:[2,3,0,1] row_mask:0xf bank_mask:0xf
    s_nop 1
    v_add_f32_dpp v10, v10, v10 row_half_mirror row_mask:0xf bank_mask:0xf
    v_mov_b32 v11, 0x3727c5ac
    v_fmac_f32 v11, s45, v10
    v_rsq_f32 v8, v11
    s_mov_b32 s48, 0xffff
    s_mov_b32 s47, 0x7fffffff
    v_pk_mul_f32 v[56:57], v[56:57], v[8:9] op_sel_hi:[1,0]
    v_pk_mul_f32 v[58:59], v[58:59], v[8:9] op_sel_hi:[1,0]
    v_pk_mul_f32 v[60:61], v[60:61], v[8:9] op_sel_hi:[1,0]
    v_pk_mul_f32 v[62:63], v[62:63], v[8:9] op_sel_hi:[1,0]
    v_cvt_pk_bf16_f32 v56, v56, 0
    v_cvt_pk_bf16_f32 v58, v58, 0
    v_cvt_pk_bf16_f32 v60, v60, 0
    v_cvt_pk_bf16_f32 v62, v62, 0
    v_and_b32 v16, s47, v57
    v_and_b32 v17, s47, v59
    v_and_b32 v18, s47, v61
    v_and_b32 v19, s47, v63
    v_add_u32 v16, 0x8000, v16
    v_add_u32 v17, 0x8000, v17
    v_add_u32 v18, 0x8000, v18
    v_add_u32 v19, 0x8000, v19
    v_sub_u32 v16, v16, v56 clamp
    v_sub_u32 v17, v17, v58 clamp
    v_sub_u32 v18, v18, v60 clamp
    v_sub_u32 v19, v19, v62 clamp
    v_bfi_b32 v16, s47, v16, v57
    v_bfi_b32 v17, s47, v17, v59
    v_bfi_b32 v18, s47, v18, v61
    v_bfi_b32 v19, s47, v19, v63
    v_bfi_b32 v16, s48, v56, v16
    v_bfi_b32 v17, s48, v58, v17
    v_bfi_b32 v18, s48, v60, v18
    v_bfi_b32 v19, s48, v62, v19
    ds_write_b128 v6, v[16:19] offset:0
    v_pk_mul_f32 v[64:65], v[64:65], v[8:9] op_sel_hi:[1,0]
    v_pk_mul_f32 v[66:67], v[66:67], v[8:9] op_sel_hi:[1,0]
    v_pk_mul_f32 v[68:69], v[68:69], v[8:9] op_sel_hi:[1,0]
    v_pk_mul_f32 v[70:71], v[70:71], v[8:9] op_sel_hi:[1,0]
    v_cvt_pk_bf16_f32 v64, v64, 0
    v_cvt_pk_bf16_f32 v66, v66, 0
    v_cvt_pk_bf16_f32 v68, v68, 0
    v_cvt_pk_bf16_f32 v70, v70, 0
    v_and_b32 v20, s47, v65
    v_and_b32 v21, s47, v67
    v_and_b32 v22, s47, v69
    v_and_b32 v23, s47, v71
    v_add_u32 v20, 0x8000, v20
    v_add_u32 v21, 0x8000, v21
    v_add_u32 v22, 0x8000, v22
    v_add_u32 v23, 0x8000, v23
    v_sub_u32 v20, v20, v64 clamp
    v_sub_u32 v21, v21, v66 clamp
    v_sub_u32 v22, v22, v68 clamp
    v_sub_u32 v23, v23, v70 clamp
    v_bfi_b32 v20, s47, v20, v65
    v_bfi_b32 v21, s47, v21, v67
    v_bfi_b32 v22, s47, v22, v69
    v_bfi_b32 v23, s47, v23, v71
    v_bfi_b32 v20, s48, v64, v20
    v_bfi_b32 v21, s48, v66, v21
    v_bfi_b32 v22, s48, v68, v22
    v_bfi_b32 v23, s48, v70, v23
    ds_write_b128 v6, v[20:23] offset:1024
    v_pk_mul_f32 v[72:73], v[72:73], v[8:9] op_sel_hi:[1,0]
    v_pk_mul_f32 v[74:75], v[74:75], v[8:9] op_sel_hi:[1,0]
    v_pk_mul_f32 v[76:77], v[76:77], v[8:9] op_sel_hi:[1,0]
    v_pk_mul_f32 v[78:79], v[78:79], v[8:9] op_sel_hi:[1,0]
    v_cvt_pk_bf16_f32 v72, v72, 0
    v_cvt_pk_bf16_f32 v74, v74, 0
    v_cvt_pk_bf16_f32 v76, v76, 0
    v_cvt_pk_bf16_f32 v78, v78, 0
    v_and_b32 v24, s47, v73
    v_and_b32 v25, s47, v75
    v_and_b32 v26, s47, v77
    v_and_b32 v27, s47, v79
    v_add_u32 v24, 0x8000, v24
    v_add_u32 v25, 0x8000, v25
    v_add_u32 v26, 0x8000, v26
    v_add_u32 v27, 0x8000, v27
    v_sub_u32 v24, v24, v72 clamp
    v_sub_u32 v25, v25, v74 clamp
    v_sub_u32 v26, v26, v76 clamp
    v_sub_u32 v27, v27, v78 clamp
    v_bfi_b32 v24, s47, v24, v73
    v_bfi_b32 v25, s47, v25, v75
    v_bfi_b32 v26, s47, v26, v77
    v_bfi_b32 v27, s47, v27, v79
    v_bfi_b32 v24, s48, v72, v24
    v_bfi_b32 v25, s48, v74, v25
    v_bfi_b32 v26, s48, v76, v26
    v_bfi_b32 v27, s48, v78, v27
    ds_write_b128 v6, v[24:27] offset:2048
    v_pk_mul_f32 v[80:81], v[80:81], v[8:9] op_sel_hi:[1,0]
    v_pk_mul_f32 v[82:83], v[82:83], v[8:9] op_sel_hi:[1,0]
    v_pk_mul_f32 v[84:85], v[84:85], v[8:9] op_sel_hi:[1,0]
    v_pk_mul_f32 v[86:87], v[86:87], v[8:9] op_sel_hi:[1,0]
    v_cvt_pk_bf16_f32 v80, v80, 0
    v_cvt_pk_bf16_f32 v82, v82, 0
    v_cvt_pk_bf16_f32 v84, v84, 0
    v_cvt_pk_bf16_f32 v86, v86, 0
    v_and_b32 v28, s47, v81
    v_and_b32 v29, s47, v83
    v_and_b32 v30, s47, v85
    v_and_b32 v31, s47, v87
    v_add_u32 v28, 0x8000, v28
    v_add_u32 v29, 0x8000, v29
    v_add_u32 v30, 0x8000, v30
    v_add_u32 v31, 0x8000, v31
    v_sub_u32 v28, v28, v80 clamp
    v_sub_u32 v29, v29, v82 clamp
    v_sub_u32 v30, v30, v84 clamp
    v_sub_u32 v31, v31, v86 clamp
    v_bfi_b32 v28, s47, v28, v81
    v_bfi_b32 v29, s47, v29, v83
    v_bfi_b32 v30, s47, v30, v85
    v_bfi_b32 v31, s47, v31, v87
    v_bfi_b32 v28, s48, v80, v28
    v_bfi_b32 v29, s48, v82, v29
    v_bfi_b32 v30, s48, v84, v30
    v_bfi_b32 v31, s48, v86, v31
    ds_write_b128 v6, v[28:31] offset:3072
    v_pk_mul_f32 v[88:89], v[88:89], v[8:9] op_sel_hi:[1,0]
    v_pk_mul_f32 v[90:91], v[90:91], v[8:9] op_sel_hi:[1,0]
    v_pk_mul_f32 v[92:93], v[92:93], v[8:9] op_sel_hi:[1,0]
    v_pk_mul_f32 v[94:95], v[94:95], v[8:9] op_sel_hi:[1,0]
    v_cvt_pk_bf16_f32 v88, v88, 0
    v_cvt_pk_bf16_f32 v90, v90, 0
    v_cvt_pk_bf16_f32 v92, v92, 0
    v_cvt_pk_bf16_f32 v94, v94, 0
    v_and_b32 v32, s47, v89
    v_and_b32 v33, s47, v91
    v_and_b32 v34, s47, v93
    v_and_b32 v35, s47, v95
    v_add_u32 v32, 0x8000, v32
    v_add_u32 v33, 0x8000, v33
    v_add_u32 v34, 0x8000, v34
    v_add_u32 v35, 0x8000, v35
    v_sub_u32 v32, v32, v88 clamp
    v_sub_u32 v33, v33, v90 clamp
    v_sub_u32 v34, v34, v92 clamp
    v_sub_u32 v35, v35, v94 clamp
    v_bfi_b32 v32, s47, v32, v89
    v_bfi_b32 v33, s47, v33, v91
    v_bfi_b32 v34, s47, v34, v93
    v_bfi_b32 v35, s47, v35, v95
    v_bfi_b32 v32, s48, v88, v32
    v_bfi_b32 v33, s48, v90, v33
    v_bfi_b32 v34, s48, v92, v34
    v_bfi_b32 v35, s48, v94, v35
    ds_write_b128 v6, v[32:35] offset:4096
    v_pk_mul_f32 v[96:97], v[96:97], v[8:9] op_sel_hi:[1,0]
    v_pk_mul_f32 v[98:99], v[98:99], v[8:9] op_sel_hi:[1,0]
    v_pk_mul_f32 v[100:101], v[100:101], v[8:9] op_sel_hi:[1,0]
    v_pk_mul_f32 v[102:103], v[102:103], v[8:9] op_sel_hi:[1,0]
    v_cvt_pk_bf16_f32 v96, v96, 0
    v_cvt_pk_bf16_f32 v98, v98, 0
    v_cvt_pk_bf16_f32 v100, v100, 0
    v_cvt_pk_bf16_f32 v102, v102, 0
    v_and_b32 v36, s47, v97
    v_and_b32 v37, s47, v99
    v_and_b32 v38, s47, v101
    v_and_b32 v39, s47, v103
    v_add_u32 v36, 0x8000, v36
    v_add_u32 v37, 0x8000, v37
    v_add_u32 v38, 0x8000, v38
    v_add_u32 v39, 0x8000, v39
    v_sub_u32 v36, v36, v96 clamp
    v_sub_u32 v37, v37, v98 clamp
    v_sub_u32 v38, v38, v100 clamp
    v_sub_u32 v39, v39, v102 clamp
    v_bfi_b32 v36, s47, v36, v97
    v_bfi_b32 v37, s47, v37, v99
    v_bfi_b32 v38, s47, v38, v101
    v_bfi_b32 v39, s47, v39, v103
    v_bfi_b32 v36, s48, v96, v36
    v_bfi_b32 v37, s48, v98, v37
    v_bfi_b32 v38, s48, v100, v38
    v_bfi_b32 v39, s48, v102, v39
    ds_write_b128 v6, v[36:39] offset:5120
    v_pk_mul_f32 v[104:105], v[104:105], v[8:9] op_sel_hi:[1,0]
    v_pk_mul_f32 v[106:107], v[106:107], v[8:9] op_sel_hi:[1,0]
    v_pk_mul_f32 v[108:109], v[108:109], v[8:9] op_sel_hi:[1,0]
    v_pk_mul_f32 v[110:111], v[110:111], v[8:9] op_sel_hi:[1,0]
    v_cvt_pk_bf16_f32 v104, v104, 0
    v_cvt_pk_bf16_f32 v106, v106, 0
    v_cvt_pk_bf16_f32 v108, v108, 0
    v_cvt_pk_bf16_f32 v110, v110, 0
    v_and_b32 v40, s47, v105
    v_and_b32 v41, s47, v107
    v_and_b32 v42, s47, v109
    v_and_b32 v43, s47, v111
    v_add_u32 v40, 0x8000, v40
    v_add_u32 v41, 0x8000, v41
    v_add_u32 v42, 0x8000, v42
    v_add_u32 v43, 0x8000, v43
    v_sub_u32 v40, v40, v104 clamp
    v_sub_u32 v41, v41, v106 clamp
    v_sub_u32 v42, v42, v108 clamp
    v_sub_u32 v43, v43, v110 clamp
    v_bfi_b32 v40, s47, v40, v105
    v_bfi_b32 v41, s47, v41, v107
    v_bfi_b32 v42, s47, v42, v109
    v_bfi_b32 v43, s47, v43, v111
    v_bfi_b32 v40, s48, v104, v40
    v_bfi_b32 v41, s48, v106, v41
    v_bfi_b32 v42, s48, v108, v42
    v_bfi_b32 v43, s48, v110, v43
    ds_write_b128 v6, v[40:43] offset:6144
    v_pk_mul_f32 v[112:113], v[112:113], v[8:9] op_sel_hi:[1,0]
    v_pk_mul_f32 v[114:115], v[114:115], v[8:9] op_sel_hi:[1,0]
    v_pk_mul_f32 v[116:117], v[116:117], v[8:9] op_sel_hi:[1,0]
    v_pk_mul_f32 v[118:119], v[118:119], v[8:9] op_sel_hi:[1,0]
    v_cvt_pk_bf16_f32 v112, v112, 0
    v_cvt_pk_bf16_f32 v114, v114, 0
    v_cvt_pk_bf16_f32 v116, v116, 0
    v_cvt_pk_bf16_f32 v118, v118, 0
    v_and_b32 v44, s47, v113
    v_and_b32 v45, s47, v115
    v_and_b32 v46, s47, v117
    v_and_b32 v47, s47, v119
    v_add_u32 v44, 0x8000, v44
    v_add_u32 v45, 0x8000, v45
    v_add_u32 v46, 0x8000, v46
    v_add_u32 v47, 0x8000, v47
    v_sub_u32 v44, v44, v112 clamp
    v_sub_u32 v45, v45, v114 clamp
    v_sub_u32 v46, v46, v116 clamp
    v_sub_u32 v47, v47, v118 clamp
    v_bfi_b32 v44, s47, v44, v113
    v_bfi_b32 v45, s47, v45, v115
    v_bfi_b32 v46, s47, v46, v117
    v_bfi_b32 v47, s47, v47, v119
    v_bfi_b32 v44, s48, v112, v44
    v_bfi_b32 v45, s48, v114, v45
    v_bfi_b32 v46, s48, v116, v46
    v_bfi_b32 v47, s48, v118, v47
    ds_write_b128 v6, v[44:47] offset:7168
    v_pk_mul_f32 v[120:121], v[120:121], v[8:9] op_sel_hi:[1,0]
    v_pk_mul_f32 v[122:123], v[122:123], v[8:9] op_sel_hi:[1,0]
    v_pk_mul_f32 v[124:125], v[124:125], v[8:9] op_sel_hi:[1,0]
    v_pk_mul_f32 v[126:127], v[126:127], v[8:9] op_sel_hi:[1,0]
    v_cvt_pk_bf16_f32 v120, v120, 0
    v_cvt_pk_bf16_f32 v122, v122, 0
    v_cvt_pk_bf16_f32 v124, v124, 0
    v_cvt_pk_bf16_f32 v126, v126, 0
    v_and_b32 v48, s47, v121
    v_and_b32 v49, s47, v123
    v_and_b32 v50, s47, v125
    v_and_b32 v51, s47, v127
    v_add_u32 v48, 0x8000, v48
    v_add_u32 v49, 0x8000, v49
    v_add_u32 v50, 0x8000, v50
    v_add_u32 v51, 0x8000, v51
    v_sub_u32 v48, v48, v120 clamp
    v_sub_u32 v49, v49, v122 clamp
    v_sub_u32 v50, v50, v124 clamp
    v_sub_u32 v51, v51, v126 clamp
    v_bfi_b32 v48, s47, v48, v121
    v_bfi_b32 v49, s47, v49, v123
    v_bfi_b32 v50, s47, v50, v125
    v_bfi_b32 v51, s47, v51, v127
    v_bfi_b32 v48, s48, v120, v48
    v_bfi_b32 v49, s48, v122, v49
    v_bfi_b32 v50, s48, v124, v50
    v_bfi_b32 v51, s48, v126, v51
    ds_write_b128 v6, v[48:51] offset:8192
    ds_read_b128 v[16:19], v7 offset:0
    ds_read_b128 v[20:23], v7 offset:1024
    ds_read_b128 v[24:27], v7 offset:2048
    ds_read_b128 v[28:31], v7 offset:3072
    ds_read_b128 v[32:35], v7 offset:4096
    ds_read_b128 v[36:39], v7 offset:5120
    ds_read_b128 v[40:43], v7 offset:6144
    ds_read_b128 v[44:47], v7 offset:7168
    ds_read_b128 v[48:51], v7 offset:8192
    s_waitcnt lgkmcnt(8)
    buffer_store_dwordx4 v[16:19], v3, s[16:19], s43 offen
    s_add_u32 s43, s43, 4096
    s_waitcnt lgkmcnt(7)
    buffer_store_dwordx4 v[20:23], v3, s[16:19], s43 offen
    s_add_u32 s43, s43, 4096
    s_waitcnt lgkmcnt(6)
    buffer_store_dwordx4 v[24:27], v3, s[16:19], s43 offen
    s_add_u32 s43, s43, 4096
    s_waitcnt lgkmcnt(5)
    buffer_store_dwordx4 v[28:31], v3, s[16:19], s43 offen
    s_add_u32 s43, s43, 4096
    s_waitcnt lgkmcnt(4)
    buffer_store_dwordx4 v[32:35], v3, s[16:19], s43 offen
    s_add_u32 s43, s43, 4096
    s_waitcnt lgkmcnt(3)
    buffer_store_dwordx4 v[36:39], v3, s[16:19], s43 offen
    s_add_u32 s43, s43, 4096
    s_waitcnt lgkmcnt(2)
    buffer_store_dwordx4 v[40:43], v3, s[16:19], s43 offen
    s_add_u32 s43, s43, 4096
    s_waitcnt lgkmcnt(1)
    buffer_store_dwordx4 v[44:47], v3, s[16:19], s43 offen
    s_add_u32 s43, s43, 4096
    s_waitcnt lgkmcnt(0)
    buffer_store_dwordx4 v[48:51], v3, s[16:19], s43 offen
    s_endpgm
L_rolewq_4:
    v_mul_u32_u24 v4, 69, v1
    v_lshrrev_b32 v4, 10, v4
    v_mul_u32_u24 v5, 15, v4
    v_sub_u32 v5, v1, v5
    v_mul_u32_u24 v6, 13, v5
    v_lshrrev_b32 v6, 6, v6
    v_mul_u32_u24 v7, 5, v6
    v_sub_u32 v7, v5, v7
    v_mul_u32_u24 v4, 3456, v4
    v_mul_u32_u24 v6, 1152, v6
    v_add_u32 v4, v4, v6
    v_lshl_add_u32 v2, v7, 4, v4
    s_lshr_b32 s40, s39, 2
    s_and_b32 s41, s39, 3
    s_lshl_b32 s41, s41, 2
    s_add_u32 s41, s41, s34
    s_mul_i32 s42, s41, 72
    s_and_b32 s42, s42, 0xfffffff0
    s_mul_i32 s43, s40, 55296
    s_add_u32 s42, s42, s43
    s_mul_i32 s44, s34, 3840
    s_mov_b32 exec_hi, 0x0fffffff
    s_waitcnt lgkmcnt(0)
    s_mov_b32 s12, s66
    s_mov_b32 s13, s67
    s_mov_b32 s14, 1990656
    s_mov_b32 s15, 0x20000
    s_add_u32 m0, s44, 0
    s_add_u32 s45, s42, 0
    buffer_load_dwordx4 v2, s[12:15], s45 offen lds
    s_add_u32 m0, s44, 960
    s_add_u32 s45, s42, 13824
    buffer_load_dwordx4 v2, s[12:15], s45 offen lds
    s_add_u32 m0, s44, 1920
    s_add_u32 s45, s42, 27648
    buffer_load_dwordx4 v2, s[12:15], s45 offen lds
    s_add_u32 m0, s44, 2880
    s_add_u32 s45, s42, 41472
    buffer_load_dwordx4 v2, s[12:15], s45 offen lds
    s_mov_b32 exec_hi, -1
    s_mov_b32 s16, s86
    s_mov_b32 s17, s87
    s_mov_b32 s18, 268435456
    s_mov_b32 s19, 0x20000
    v_mov_b32 v56, 0
    v_mov_b32 v57, 0
    v_mov_b32 v58, 0
    v_mov_b32 v59, 0
    v_lshlrev_b32 v60, 4, v0
    s_lshl_b32 s48, s39, 12
    s_add_u32 s24, s86, 16384
    s_addc_u32 s25, s87, 0
    s_mov_b32 s26, 262144
    s_mov_b32 s27, 0x20000
    buffer_store_dwordx4 v[56:59], v60, s[24:27], s48 offen
    s_add_u32 s28, s86, 278528
    s_addc_u32 s29, s87, 0
    s_mov_b32 s30, 196608
    s_mov_b32 s31, 0x20000
    v_lshlrev_b32 v60, 4, v0
    s_lshl_b32 s48, s39, 12
    buffer_store_dwordx4 v[56:59], v60, s[28:31], s48 offen
    s_add_u32 s28, s86, 671744
    s_addc_u32 s29, s87, 0
    s_mov_b32 s30, 65536
    s_mov_b32 s31, 0x20000
    v_lshlrev_b32 v60, 4, v0
    s_lshl_b32 s48, s39, 12
    buffer_store_dwordx4 v[56:59], v60, s[28:31], s48 offen
    s_lshr_b32 s48, s39, 3
    s_lshl_b32 s48, s48, 2
    s_add_u32 s48, s48, s34
    s_lshl_b32 s48, s48, 13
    s_getpc_b64 s[50:51]
L_pc_7:
    s_add_u32 s50, s50, k1_kernel-L_pc_7
    s_addc_u32 s51, s51, 0
    v_lshlrev_b32 v60, 7, v1
    v_add_u32 v60, s48, v60
    v_min_u32 v61, L_k1_end-k1_kernel-4, v60
    global_load_dword v62, v61, s[50:51]
    v_lshrrev_b32 v4, 5, v1
    v_bfe_u32 v5, v1, 2, 2
    v_and_b32 v6, 3, v1
    v_bfe_u32 v7, v1, 4, 1
    v_lshlrev_b32 v7, 1, v7
    v_lshrrev_b32 v9, 1, v6
    v_add_u32 v7, v7, v9
    v_lshlrev_b32 v7, 3, v7
    v_and_b32 v8, 1, v6
    v_lshlrev_b32 v8, 2, v8
    s_and_b32 s50, s41, 1
    v_add_u32 v8, s50, v8
    v_lshl_add_u32 v9, v4, 3, v5
    v_mul_u32_u24 v9, 240, v9
    v_add_u32 v9, s44, v9
    s_mov_b32 s52, 50462976
    v_bfe_u32 v10, s52, v7, 8
    v_add_u32 v10, v10, v8
    v_lshl_add_u32 v12, v10, 3, v9
    s_mov_b32 s52, 185208068
    v_bfe_u32 v10, s52, v7, 8
    v_add_u32 v10, v10, v8
    v_lshl_add_u32 v13, v10, 3, v9
    s_mov_b32 s52, 386798860
    v_bfe_u32 v10, s52, v7, 8
    v_add_u32 v10, v10, v8
    v_lshl_add_u32 v14, v10, 3, v9
    s_mov_b32 s52, 370546708
    v_bfe_u32 v10, s52, v7, 8
    v_add_u32 v10, v10, v8
    v_lshl_add_u32 v15, v10, 3, v9
    v_lshlrev_b32 v3, 4, v1
    v_and_b32 v10, 31, v1
    v_mul_u32_u24 v11, 24, v4
    v_add_u32 v11, v11, v10
    v_lshlrev_b32 v11, 4, v11
    s_mul_i32 s46, s41, 138240
    s_mul_i32 s47, s40, 3840
    s_add_u32 s46, s46, s47
    s_add_u32 s46, s46, 3516672
    s_waitcnt vmcnt(0)
    ds_read_b64_tr_b16 v[16:17], v12 offset:0
    ds_read_b64_tr_b16 v[18:19], v12 offset:960
    ds_read_b64_tr_b16 v[20:21], v13 offset:0
    ds_read_b64_tr_b16 v[22:23], v13 offset:960
    ds_read_b64_tr_b16 v[24:25], v14 offset:0
    ds_read_b64_tr_b16 v[26:27], v14 offset:960
    ds_read_b64_tr_b16 v[28:29], v15 offset:0
    ds_read_b64_tr_b16 v[30:31], v15 offset:960
    s_waitcnt lgkmcnt(6)
    buffer_store_dwordx4 v[16:19], v3, s[16:19], s46 offen offset:0
    s_waitcnt lgkmcnt(4)
    buffer_store_dwordx4 v[20:23], v3, s[16:19], s46 offen offset:1024
    s_waitcnt lgkmcnt(2)
    buffer_store_dwordx4 v[24:27], v3, s[16:19], s46 offen offset:2048
    s_mov_b32 exec_lo, 0x00ffffff
    s_mov_b32 exec_hi, 0x00ffffff
    s_waitcnt lgkmcnt(0)
    buffer_store_dwordx4 v[28:31], v11, s[16:19], s46 offen offset:3072
    s_mov_b64 exec, -1
    s_waitcnt vmcnt(0)
L_end_k0_kernel:
    s_endpgm
L_k0_end:

.globl k1_kernel
.p2align 8
.type k1_kernel,@function
k1_kernel:
    s_cmp_ge_u32 s2, 256
    s_cbranch_scc1 L_end_k1_kernel
    s_load_dwordx16 s[64:79], s[0:1], 0
    s_load_dwordx8 s[80:87], s[0:1], 64
    v_lshrrev_b32 v2, 6, v0
    v_and_b32 v1, 63, v0
    v_readfirstlane_b32 s34, v2
    s_and_b32 s40, s2, 7
    s_lshr_b32 s32, s40, 2
    s_lshr_b32 s41, s2, 5
    s_lshl_b32 s41, s41, 1
    s_add_u32 s32, s32, s41
    s_and_b32 s33, s40, 3
    s_lshl_b32 s33, s33, 2
    s_lshr_b32 s41, s2, 3
    s_and_b32 s41, s41, 3
    s_add_u32 s33, s33, s41
    s_mov_b32 s35, 0xffff0000
    s_mov_b32 s36, 0
    s_mov_b32 s37, -1
    v_lshlrev_b32 v244, 4, v1
    s_lshl_b32 s40, s32, 2
    s_add_u32 s40, s40, s34
    s_mul_i32 s40, s40, 36864
    s_add_u32 s40, s40, 1157376
    s_mul_i32 s41, s32, 147456
    s_add_u32 s41, s41, 1120768
    s_cmp_eq_u32 s32, 0
    s_cselect_b32 s41, 1157632, s41
    s_lshl_b32 s42, s34, 11
    s_add_u32 s41, s41, s42
    v_lshrrev_b32 v4, 4, v1
    v_and_b32 v5, 15, v1
    v_lshlrev_b32 v6, 9, v4
    v_lshl_add_u32 v6, v5, 4, v6
    s_mul_i32 s42, s33, 138240
    s_lshl_b32 s43, s34, 10
    s_add_u32 s42, s42, s43
    s_add_u32 s42, s42, 3516672
    s_waitcnt lgkmcnt(0)
    s_mov_b32 s16, s86
    s_mov_b32 s17, s87
    s_mov_b32 s18, 268435456
    s_mov_b32 s19, 0x20000
    s_add_u32 m0, s43, 156672
    s_add_u32 s4, s43, 0
    buffer_load_dwordx4 v244, s[16:19], s4 offen lds
    s_mov_b32 m0, 160768
    s_mov_b32 s4, 4096
    buffer_load_dwordx4 v244, s[16:19], s4 offen lds
    s_add_u32 s3, s40, 0
    buffer_load_dwordx4 v[96:99], v244, s[16:19], s3 offen offset:0
    s_add_u32 s6, s41, 0
    buffer_load_dwordx4 v[214:217], v6, s[16:19], s6 offen
    s_add_u32 s6, s41, 8192
    buffer_load_dwordx4 v[218:221], v6, s[16:19], s6 offen
    s_add_u32 s6, s41, 16384
    buffer_load_dwordx4 v[222:225], v6, s[16:19], s6 offen
    s_add_u32 s6, s41, 24576
    buffer_load_dwordx4 v[226:229], v6, s[16:19], s6 offen
    s_min_u32 s4, s34, 1
    s_sub_u32 s4, s4, s34
    s_lshl_b32 s4, s4, 11
    s_add_u32 s6, s41, s4
    s_add_u32 s6, s6, 32768
    buffer_load_dwordx4 v[230:233], v6, s[16:19], s6 offen
    s_add_u32 m0, s43, 0
    s_add_u32 s4, s42, 0
    buffer_load_dwordx4 v244, s[16:19], s4 offen lds
    s_add_u32 m0, s43, 4096
    s_add_u32 s4, s42, 4096
    buffer_load_dwordx4 v244, s[16:19], s4 offen lds
    s_add_u32 m0, s43, 8192
    s_add_u32 s4, s42, 8192
    buffer_load_dwordx4 v244, s[16:19], s4 offen lds
    s_sub_u32 s8, s72, 4096
    s_subb_u32 s9, s73, 0
    s_mov_b32 s10, 5312512
    s_mov_b32 s11, 0x20000
    s_sub_u32 s12, s74, 5120
    s_subb_u32 s13, s75, 0
    s_mov_b32 s14, 5313536
    s_mov_b32 s15, 0x20000
    s_cmp_lt_u32 s34, 2
    s_cselect_b32 s96, s72, s74
    s_cselect_b32 s97, s73, s75
    s_sub_u32 s20, s96, 4096
    s_subb_u32 s21, s97, 0
    s_mov_b32 s22, 5312512
    s_mov_b32 s23, 0x20000
    s_sub_u32 s24, s76, 4096
    s_subb_u32 s25, s77, 0
    s_mov_b32 s26, 5312512
    s_mov_b32 s27, 0x20000
    s_and_b32 s96, s33, 1
    s_mul_i32 s97, s33, 288
    s_lshl_b32 s98, s96, 5
    s_add_u32 s98, s98, s97
    s_lshl_b32 s56, s98, 1
    s_mul_i32 s58, s98, 1152
    s_cmp_eq_u32 s96, 0
    s_cselect_b32 s98, 256, 0
    s_add_u32 s98, s98, s97
    s_lshl_b32 s57, s98, 1
    s_mul_i32 s59, s98, 1152
    s_lshl_b32 s60, s34, 12
    s_cmp_eq_u32 s96, 0
    s_mov_b32 s98, 4294635520
    s_cmov_b32 s98, 368640
    s_mov_b32 s99, 4294930432
    s_cmov_b32 s99, 331776
    s_cselect_b32 s52, 0, 640
    s_movk_i32 s53, 576
    s_cmov_b32 s53, 512
    s_mul_i32 s100, s97, 1152
    s_add_u32 s50, s100, s98
    s_add_u32 s51, s100, s99
    s_add_u32 s50, s50, s52
    s_add_u32 s51, s51, s52
    s_add_u32 s48, s59, s53
    s_add_u32 s49, s51, s53
    s_sub_u32 s49, s49, s52
    s_add_u32 s46, s58, s53
    s_add_u32 s47, s50, s53
    s_sub_u32 s47, s47, s52
    s_add_u32 s58, s58, s52
    s_add_u32 s59, s59, s52
    s_lshr_b32 s45, s34, 1
    s_mul_i32 s45, s45, 36864
    s_mul_i32 s96, s32, 8
    s_lshr_b32 s97, s33, 1
    s_add_u32 s96, s96, s97
    s_lshl_b32 s96, s96, 3
    s_lshl_b32 s97, s34, 1
    s_add_u32 s96, s96, s97
    s_mul_i32 s55, s96, 18432
    s_add_u32 s55, s55, 16248064
    s_mov_b32 s62, 0xbfb8aa3b
    s_lshl_b32 s96, s53, 4
    s_add_u32 s54, s55, s96
    s_lshl_b32 s96, s52, 4
    s_add_u32 s55, s55, s96
    v_mul_u32_u24 v176, 57, v1
    v_lshrrev_b32 v176, 9, v176
    v_mul_u32_u24 v177, 9, v176
    v_sub_u32 v177, v1, v177
    s_lshl_b32 s96, s32, 2
    s_add_u32 s96, s96, s34
    s_mul_i32 s96, s96, 9
    v_add_u32 v177, s96, v177
    s_movk_i32 s97, 9216
    v_mul_lo_u32 v178, v177, s97
    v_lshlrev_b32 v179, 7, v176
    v_add_u32 v180, s56, v179
    v_mov_b32 v181, s57
    v_cmp_eq_u32 vcc, 4, v176
    s_nop 1
    v_cndmask_b32 v180, v180, v181, vcc
    v_add_u32 v254, v178, v180
    s_lshr_b32 s96, s33, 1
    s_mul_i32 s96, s96, 576
    v_add_u32 v177, s96, v177
    v_mul_u32_u24 v177, 1152, v177
    s_and_b32 s96, s33, 1
    s_lshl_b32 s96, s96, 9
    v_add_u32 v179, s96, v179
    v_add_u32 v255, v177, v179
    s_movk_i32 s91, 4096
    v_lshrrev_b32 v7, 5, v1
    v_and_b32 v10, 31, v1
    v_min_u32 v11, 23, v10
    v_mul_u32_u24 v12, 24, v7
    v_add_u32 v11, v11, v12
    v_lshlrev_b32 v11, 4, v11
    v_add_u32 v11, 3072, v11
    v_add_u32 v12, s43, v244
    s_cmp_eq_u32 s34, 3
    s_cselect_b64 vcc, -1, 0
    v_cndmask_b32 v12, v12, v11, vcc
    v_add_u32 v234, 0, v244
    v_add_u32 v237, 0, v11
    v_add_u32 v240, 0, v12
    v_add_u32 v235, 61440, v244
    v_add_u32 v238, 61440, v11
    v_add_u32 v241, 61440, v12
    v_add_u32 v236, 122880, v244
    v_add_u32 v239, 122880, v11
    v_add_u32 v242, 122880, v12
    v_and_b32 v10, 15, v1
    v_lshlrev_b32 v10, 4, v10
    v_lshl_add_u32 v10, v7, 8, v10
    v_add_u32 v243, 138240, v10
    v_and_b32 v10, 7, v5
    v_lshlrev_b32 v10, 2, v10
    v_lshrrev_b32 v11, 3, v5
    v_lshl_add_u32 v8, v11, 6, v10
    v_lshl_add_u32 v8, v7, 5, v8
    v_add_u32 v8, 158976, v8
    v_lshlrev_b32 v245, 5, v7
    v_add_u32 v245, 156672, v245
    s_lshl_b32 s4, s34, 7
    s_add_u32 s4, s4, 156672
    v_lshlrev_b32 v9, 5, v4
    v_add_u32 v9, s4, v9
    v_add_u32 v10, v9, v10
    v_add_u32 v5, s43, v244
    v_add_u32 v5, 138240, v5
    s_min_u32 s5, s34, 1
    s_sub_u32 s5, s5, s34
    s_lshl_b32 s6, s5, 7
    v_add_u32 v6, s6, v9
    v_add_u32 v11, s6, v10
    s_lshl_b32 s6, s5, 10
    v_add_u32 v7, s6, v5
    s_waitcnt vmcnt(9)
    s_barrier
    ds_read_b32 v176, v8
    ds_read_b128 v[194:197], v245 offset:0
    ds_read_b128 v[198:201], v245 offset:16
    ds_read_b32 v246, v10 offset:2304
    ds_read_b128 v[136:139], v9 offset:0
    ds_read_b128 v[140:143], v9 offset:16
    ds_read_b32 v247, v10 offset:2816
    ds_read_b128 v[144:147], v9 offset:512
    ds_read_b128 v[148:151], v9 offset:528
    ds_read_b32 v248, v10 offset:3328
    ds_read_b128 v[152:155], v9 offset:1024
    ds_read_b128 v[156:159], v9 offset:1040
    ds_read_b32 v249, v10 offset:3840
    ds_read_b128 v[160:163], v9 offset:1536
    ds_read_b128 v[164:167], v9 offset:1552
    ds_read_b32 v250, v11 offset:4352
    ds_read_b128 v[168:171], v6 offset:2048
    ds_read_b128 v[172:175], v6 offset:2064
    ds_read_b128 v[202:205], v245 offset:64
    ds_read_b128 v[206:209], v245 offset:80
    ds_read_b32 v177, v8 offset:128
    ds_read_b32 v178, v8 offset:256
    ds_read_b32 v179, v8 offset:384
    ds_read_b32 v180, v8 offset:512
    ds_read_b32 v181, v8 offset:640
    ds_read_b32 v182, v8 offset:768
    ds_read_b32 v183, v8 offset:896
    ds_read_b32 v184, v8 offset:1024
    ds_read_b32 v185, v8 offset:1152
    ds_read_b32 v186, v8 offset:1280
    ds_read_b32 v187, v8 offset:1408
    ds_read_b32 v188, v8 offset:1536
    ds_read_b32 v189, v8 offset:1664
    ds_read_b32 v190, v8 offset:1792
    ds_read_b32 v191, v8 offset:1920
    ds_read_b32 v192, v8 offset:2048
    ds_read_b32 v193, v8 offset:2176
    buffer_load_dwordx4 v[100:103], v244, s[16:19], s3 offen offset:1024
    buffer_load_dwordx4 v[104:107], v244, s[16:19], s3 offen offset:2048
    s_waitcnt vmcnt(10)
    v_lshlrev_b32 v210, 16, v96
    v_lshlrev_b32 v211, 16, v97
    v_lshlrev_b32 v212, 16, v98
    v_lshlrev_b32 v213, 16, v99
    s_waitcnt lgkmcnt(15)
    v_fmac_f32_dpp v195, v176, v96 row_newbcast:1 row_mask:0xf bank_mask:0xf
    v_fmac_f32_dpp v197, v176, v97 row_newbcast:3 row_mask:0xf bank_mask:0xf
    v_fmac_f32_dpp v199, v176, v98 row_newbcast:5 row_mask:0xf bank_mask:0xf
    v_fmac_f32_dpp v201, v176, v99 row_newbcast:7 row_mask:0xf bank_mask:0xf
    v_fmac_f32_dpp v194, v176, v210 row_newbcast:0 row_mask:0xf bank_mask:0xf
    v_fmac_f32_dpp v196, v176, v211 row_newbcast:2 row_mask:0xf bank_mask:0xf
    v_fmac_f32_dpp v198, v176, v212 row_newbcast:4 row_mask:0xf bank_mask:0xf
    v_fmac_f32_dpp v200, v176, v213 row_newbcast:6 row_mask:0xf bank_mask:0xf
    v_cvt_pk_bf16_f32 v96, v194, v195
    v_cvt_pk_bf16_f32 v97, v196, v197
    v_cvt_pk_bf16_f32 v98, v198, v199
    v_cvt_pk_bf16_f32 v99, v200, v201
    buffer_load_dwordx4 v[108:111], v244, s[16:19], s3 offen offset:3072
    s_waitcnt vmcnt(10)
    v_lshlrev_b32 v210, 16, v214
    v_lshlrev_b32 v211, 16, v215
    v_lshlrev_b32 v212, 16, v216
    v_lshlrev_b32 v213, 16, v217
    v_fmac_f32_dpp v137, v246, v214 row_newbcast:1 row_mask:0xf bank_mask:0xf
    v_fmac_f32_dpp v139, v246, v215 row_newbcast:3 row_mask:0xf bank_mask:0xf
    v_fmac_f32_dpp v141, v246, v216 row_newbcast:5 row_mask:0xf bank_mask:0xf
    v_fmac_f32_dpp v143, v246, v217 row_newbcast:7 row_mask:0xf bank_mask:0xf
    v_fmac_f32_dpp v136, v246, v210 row_newbcast:0 row_mask:0xf bank_mask:0xf
    s_add_u32 m0, s43, 12288
    s_add_u32 s4, s42, 12288
    buffer_load_dwordx4 v244, s[16:19], s4 offen lds
    v_fmac_f32_dpp v138, v246, v211 row_newbcast:2 row_mask:0xf bank_mask:0xf
    v_fmac_f32_dpp v140, v246, v212 row_newbcast:4 row_mask:0xf bank_mask:0xf
    v_fmac_f32_dpp v142, v246, v213 row_newbcast:6 row_mask:0xf bank_mask:0xf
    v_cvt_pk_bf16_f32 v214, v136, v137
    v_cvt_pk_bf16_f32 v215, v138, v139
    v_cvt_pk_bf16_f32 v216, v140, v141
    v_cvt_pk_bf16_f32 v217, v142, v143
    ds_write_b128 v5, v[214:217] offset:0
    s_add_u32 m0, s43, 16384
    s_add_u32 s4, s42, 16384
    buffer_load_dwordx4 v244, s[16:19], s4 offen lds
    s_waitcnt vmcnt(11)
    v_lshlrev_b32 v210, 16, v218
    v_lshlrev_b32 v211, 16, v219
    v_lshlrev_b32 v212, 16, v220
    v_lshlrev_b32 v213, 16, v221
    v_fmac_f32_dpp v145, v247, v218 row_newbcast:1 row_mask:0xf bank_mask:0xf
    v_fmac_f32_dpp v147, v247, v219 row_newbcast:3 row_mask:0xf bank_mask:0xf
    v_fmac_f32_dpp v149, v247, v220 row_newbcast:5 row_mask:0xf bank_mask:0xf
    v_fmac_f32_dpp v151, v247, v221 row_newbcast:7 row_mask:0xf bank_mask:0xf
    v_fmac_f32_dpp v144, v247, v210 row_newbcast:0 row_mask:0xf bank_mask:0xf
    s_add_u32 m0, s43, 20480
    s_add_u32 s4, s42, 20480
    buffer_load_dwordx4 v244, s[16:19], s4 offen lds
    v_fmac_f32_dpp v146, v247, v211 row_newbcast:2 row_mask:0xf bank_mask:0xf
    v_fmac_f32_dpp v148, v247, v212 row_newbcast:4 row_mask:0xf bank_mask:0xf
    v_fmac_f32_dpp v150, v247, v213 row_newbcast:6 row_mask:0xf bank_mask:0xf
    v_cvt_pk_bf16_f32 v218, v144, v145
    v_cvt_pk_bf16_f32 v219, v146, v147
    v_cvt_pk_bf16_f32 v220, v148, v149
    v_cvt_pk_bf16_f32 v221, v150, v151
    ds_write_b128 v5, v[218:221] offset:4096
    s_add_u32 m0, s43, 24576
    s_add_u32 s4, s42, 24576
    buffer_load_dwordx4 v244, s[16:19], s4 offen lds
    s_waitcnt vmcnt(12)
    v_lshlrev_b32 v210, 16, v222
    v_lshlrev_b32 v211, 16, v223
    v_lshlrev_b32 v212, 16, v224
    v_lshlrev_b32 v213, 16, v225
    v_fmac_f32_dpp v153, v248, v222 row_newbcast:1 row_mask:0xf bank_mask:0xf
    v_fmac_f32_dpp v155, v248, v223 row_newbcast:3 row_mask:0xf bank_mask:0xf
    v_fmac_f32_dpp v157, v248, v224 row_newbcast:5 row_mask:0xf bank_mask:0xf
    v_fmac_f32_dpp v159, v248, v225 row_newbcast:7 row_mask:0xf bank_mask:0xf
    v_fmac_f32_dpp v152, v248, v210 row_newbcast:0 row_mask:0xf bank_mask:0xf
    s_add_u32 m0, s43, 28672
    s_add_u32 s4, s42, 28672
    buffer_load_dwordx4 v244, s[16:19], s4 offen lds
    v_fmac_f32_dpp v154, v248, v211 row_newbcast:2 row_mask:0xf bank_mask:0xf
    v_fmac_f32_dpp v156, v248, v212 row_newbcast:4 row_mask:0xf bank_mask:0xf
    v_fmac_f32_dpp v158, v248, v213 row_newbcast:6 row_mask:0xf bank_mask:0xf
    v_cvt_pk_bf16_f32 v222, v152, v153
    v_cvt_pk_bf16_f32 v223, v154, v155
    v_cvt_pk_bf16_f32 v224, v156, v157
    v_cvt_pk_bf16_f32 v225, v158, v159
    ds_write_b128 v5, v[222:225] offset:8192
    s_add_u32 m0, s43, 32768
    s_add_u32 s4, s42, 32768
    buffer_load_dwordx4 v244, s[16:19], s4 offen lds
    s_waitcnt vmcnt(13)
    v_lshlrev_b32 v210, 16, v226
    v_lshlrev_b32 v211, 16, v227
    v_lshlrev_b32 v212, 16, v228
    v_lshlrev_b32 v213, 16, v229
    v_fmac_f32_dpp v161, v249, v226 row_newbcast:1 row_mask:0xf bank_mask:0xf
    v_fmac_f32_dpp v163, v249, v227 row_newbcast:3 row_mask:0xf bank_mask:0xf
    v_fmac_f32_dpp v165, v249, v228 row_newbcast:5 row_mask:0xf bank_mask:0xf
    v_fmac_f32_dpp v167, v249, v229 row_newbcast:7 row_mask:0xf bank_mask:0xf
    v_fmac_f32_dpp v160, v249, v210 row_newbcast:0 row_mask:0xf bank_mask:0xf
    s_add_u32 s3, s40, 4096
    buffer_load_dwordx4 v[112:115], v244, s[16:19], s3 offen offset:0
    v_fmac_f32_dpp v162, v249, v211 row_newbcast:2 row_mask:0xf bank_mask:0xf
    v_fmac_f32_dpp v164, v249, v212 row_newbcast:4 row_mask:0xf bank_mask:0xf
    v_fmac_f32_dpp v166, v249, v213 row_newbcast:6 row_mask:0xf bank_mask:0xf
    v_cvt_pk_bf16_f32 v226, v160, v161
    v_cvt_pk_bf16_f32 v227, v162, v163
    v_cvt_pk_bf16_f32 v228, v164, v165
    v_cvt_pk_bf16_f32 v229, v166, v167
    ds_write_b128 v5, v[226:229] offset:12288
    buffer_load_dwordx4 v[116:119], v244, s[16:19], s3 offen offset:1024
    s_waitcnt vmcnt(14)
    v_lshlrev_b32 v210, 16, v230
    v_lshlrev_b32 v211, 16, v231
    v_lshlrev_b32 v212, 16, v232
    v_lshlrev_b32 v213, 16, v233
    v_fmac_f32_dpp v169, v250, v230 row_newbcast:1 row_mask:0xf bank_mask:0xf
    v_fmac_f32_dpp v171, v250, v231 row_newbcast:3 row_mask:0xf bank_mask:0xf
    v_fmac_f32_dpp v173, v250, v232 row_newbcast:5 row_mask:0xf bank_mask:0xf
    v_fmac_f32_dpp v175, v250, v233 row_newbcast:7 row_mask:0xf bank_mask:0xf
    v_fmac_f32_dpp v168, v250, v210 row_newbcast:0 row_mask:0xf bank_mask:0xf
    buffer_load_dwordx4 v[120:123], v244, s[16:19], s3 offen offset:2048
    v_fmac_f32_dpp v170, v250, v211 row_newbcast:2 row_mask:0xf bank_mask:0xf
    v_fmac_f32_dpp v172, v250, v212 row_newbcast:4 row_mask:0xf bank_mask:0xf
    v_fmac_f32_dpp v174, v250, v213 row_newbcast:6 row_mask:0xf bank_mask:0xf
    v_cvt_pk_bf16_f32 v230, v168, v169
    v_cvt_pk_bf16_f32 v231, v170, v171
    v_cvt_pk_bf16_f32 v232, v172, v173
    v_cvt_pk_bf16_f32 v233, v174, v175
    ds_write_b128 v7, v[230:233] offset:16384
    s_waitcnt vmcnt(12)
    s_waitcnt lgkmcnt(0)
    s_barrier
    ds_read_b128 a[80:83], v234 offset:0
    ds_read_b128 a[84:87], v234 offset:1024
    ds_read_b128 a[88:91], v234 offset:2048
    ds_read_b128 a[92:95], v237 offset:0
    ds_read_b128 a[96:99], v240 offset:0
    ds_read_b128 a[120:123], v243 offset:0
    s_waitcnt lgkmcnt(4)
    v_mfma_f32_32x32x16_bf16 v[16:31], a[80:83], v[96:99], 0
    ds_read_b128 a[100:103], v234 offset:3840
    ds_read_b128 a[124:127], v243 offset:512
    s_waitcnt vmcnt(11)
    v_lshlrev_b32 v210, 16, v100
    v_lshlrev_b32 v211, 16, v101
    v_lshlrev_b32 v212, 16, v102
    buffer_load_dwordx4 v[124:127], v244, s[16:19], s3 offen offset:3072
    v_mfma_f32_32x32x16_bf16 v[32:47], a[84:87], v[96:99], 0
    ds_read_b128 a[104:107], v234 offset:4864
    ds_read_b128 v[194:197], v245 offset:128
    v_lshlrev_b32 v213, 16, v103
    v_fmac_f32_dpp v203, v176, v100 row_newbcast:9 row_mask:0xf bank_mask:0xf
    v_fmac_f32_dpp v205, v176, v101 row_newbcast:11 row_mask:0xf bank_mask:0xf
    s_waitcnt lgkmcnt(4)
    v_mfma_f32_32x32x16_bf16 v[48:63], a[88:91], v[96:99], 0
    ds_read_b128 a[108:111], v234 offset:5888
    ds_read_b128 v[198:201], v245 offset:144
    v_fmac_f32_dpp v207, v176, v102 row_newbcast:13 row_mask:0xf bank_mask:0xf
    v_fmac_f32_dpp v209, v176, v103 row_newbcast:15 row_mask:0xf bank_mask:0xf
    v_fmac_f32_dpp v202, v176, v210 row_newbcast:8 row_mask:0xf bank_mask:0xf
    v_fmac_f32_dpp v204, v176, v211 row_newbcast:10 row_mask:0xf bank_mask:0xf
    v_mfma_f32_32x32x16_bf16 v[64:79], a[92:95], v[96:99], 0
    ds_read_b128 a[112:115], v237 offset:3840
    v_fmac_f32_dpp v206, v176, v212 row_newbcast:12 row_mask:0xf bank_mask:0xf
    v_fmac_f32_dpp v208, v176, v213 row_newbcast:14 row_mask:0xf bank_mask:0xf
    v_cvt_pk_bf16_f32 v100, v202, v203
    s_add_u32 m0, s43, 36864
    s_add_u32 s4, s42, 36864
    buffer_load_dwordx4 v244, s[16:19], s4 offen lds
    v_mfma_f32_32x32x16_bf16 v[80:95], a[96:99], a[120:123], 0
    ds_read_b128 a[116:119], v240 offset:3840
    v_cvt_pk_bf16_f32 v101, v204, v205
    v_cvt_pk_bf16_f32 v102, v206, v207
    v_cvt_pk_bf16_f32 v103, v208, v209
    s_waitcnt lgkmcnt(5)
    s_nop 0
    v_mfma_f32_32x32x16_bf16 v[16:31], a[100:103], v[100:103], v[16:31]
    ds_read_b128 a[80:83], v234 offset:7680
    ds_read_b128 a[120:123], v243 offset:1024
    s_waitcnt vmcnt(12)
    v_lshlrev_b32 v210, 16, v104
    v_lshlrev_b32 v211, 16, v105
    v_lshlrev_b32 v212, 16, v106
    s_add_u32 s3, s40, 8192
    buffer_load_dwordx4 v[128:131], v244, s[16:19], s3 offen offset:0
    v_mfma_f32_32x32x16_bf16 v[32:47], a[104:107], v[100:103], v[32:47]
    ds_read_b128 a[84:87], v234 offset:8704
    ds_read_b128 v[202:205], v245 offset:192
    v_lshlrev_b32 v213, 16, v107
    s_waitcnt lgkmcnt(8)
    v_fmac_f32_dpp v195, v177, v104 row_newbcast:1 row_mask:0xf bank_mask:0xf
    v_fmac_f32_dpp v197, v177, v105 row_newbcast:3 row_mask:0xf bank_mask:0xf
    s_waitcnt lgkmcnt(4)
    v_mfma_f32_32x32x16_bf16 v[48:63], a[108:111], v[100:103], v[48:63]
    ds_read_b128 a[88:91], v234 offset:9728
    ds_read_b128 v[206:209], v245 offset:208
    v_fmac_f32_dpp v199, v177, v106 row_newbcast:5 row_mask:0xf bank_mask:0xf
    v_fmac_f32_dpp v201, v177, v107 row_newbcast:7 row_mask:0xf bank_mask:0xf
    v_fmac_f32_dpp v194, v177, v210 row_newbcast:0 row_mask:0xf bank_mask:0xf
    v_fmac_f32_dpp v196, v177, v211 row_newbcast:2 row_mask:0xf bank_mask:0xf
    v_mfma_f32_32x32x16_bf16 v[64:79], a[112:115], v[100:103], v[64:79]
    ds_read_b128 a[92:95], v237 offset:7680
    v_fmac_f32_dpp v198, v177, v212 row_newbcast:4 row_mask:0xf bank_mask:0xf
    v_fmac_f32_dpp v200, v177, v213 row_newbcast:6 row_mask:0xf bank_mask:0xf
    v_cvt_pk_bf16_f32 v104, v194, v195
    s_add_u32 m0, s43, 40960
    s_add_u32 s4, s42, 40960
    buffer_load_dwordx4 v244, s[16:19], s4 offen lds
    v_mfma_f32_32x32x16_bf16 v[80:95], a[116:119], a[124:127], v[80:95]
    ds_read_b128 a[96:99], v240 offset:7680
    v_cvt_pk_bf16_f32 v105, v196, v197
    v_cvt_pk_bf16_f32 v106, v198, v199
    v_cvt_pk_bf16_f32 v107, v200, v201
    s_waitcnt lgkmcnt(5)
    s_nop 0
    v_mfma_f32_32x32x16_bf16 v[16:31], a[80:83], v[104:107], v[16:31]
    s_waitcnt vmcnt(10)
    s_barrier
    ds_read_b128 a[100:103], v234 offset:11520
    ds_read_b128 a[124:127], v243 offset:1536
    v_lshlrev_b32 v210, 16, v108
    v_lshlrev_b32 v211, 16, v109
    v_lshlrev_b32 v212, 16, v110
    buffer_load_dwordx4 v[132:135], v244, s[16:19], s3 offen offset:1024
    v_mfma_f32_32x32x16_bf16 v[32:47], a[84:87], v[104:107], v[32:47]
    ds_read_b128 a[104:107], v234 offset:12544
    ds_read_b128 v[194:197], v245 offset:256
    v_lshlrev_b32 v213, 16, v111
    s_waitcnt lgkmcnt(8)
    v_fmac_f32_dpp v203, v177, v108 row_newbcast:9 row_mask:0xf bank_mask:0xf
    v_fmac_f32_dpp v205, v177, v109 row_newbcast:11 row_mask:0xf bank_mask:0xf
    s_waitcnt lgkmcnt(4)
    v_mfma_f32_32x32x16_bf16 v[48:63], a[88:91], v[104:107], v[48:63]
    ds_read_b128 a[108:111], v234 offset:13568
    ds_read_b128 v[198:201], v245 offset:272
    v_fmac_f32_dpp v207, v177, v110 row_newbcast:13 row_mask:0xf bank_mask:0xf
    v_fmac_f32_dpp v209, v177, v111 row_newbcast:15 row_mask:0xf bank_mask:0xf
    v_fmac_f32_dpp v202, v177, v210 row_newbcast:8 row_mask:0xf bank_mask:0xf
    v_fmac_f32_dpp v204, v177, v211 row_newbcast:10 row_mask:0xf bank_mask:0xf
    v_mfma_f32_32x32x16_bf16 v[64:79], a[92:95], v[104:107], v[64:79]
    ds_read_b128 a[112:115], v237 offset:11520
    v_fmac_f32_dpp v206, v177, v212 row_newbcast:12 row_mask:0xf bank_mask:0xf
    v_fmac_f32_dpp v208, v177, v213 row_newbcast:14 row_mask:0xf bank_mask:0xf
    v_cvt_pk_bf16_f32 v108, v202, v203
    s_add_u32 m0, s43, 45056
    s_add_u32 s4, s42, 45056
    buffer_load_dwordx4 v244, s[16:19], s4 offen lds
    v_mfma_f32_32x32x16_bf16 v[80:95], a[96:99], a[120:123], v[80:95]
    ds_read_b128 a[116:119], v240 offset:11520
    v_cvt_pk_bf16_f32 v109, v204, v205
    v_cvt_pk_bf16_f32 v110, v206, v207
    v_cvt_pk_bf16_f32 v111, v208, v209
    s_waitcnt lgkmcnt(5)
    s_nop 0
    v_mfma_f32_32x32x16_bf16 v[16:31], a[100:103], v[108:111], v[16:31]
    ds_read_b128 a[80:83], v234 offset:15360
    ds_read_b128 a[120:123], v243 offset:2048
    s_waitcnt vmcnt(8)
    v_lshlrev_b32 v210, 16, v112
    v_lshlrev_b32 v211, 16, v113
    v_lshlrev_b32 v212, 16, v114
    buffer_load_dwordx4 v[96:99], v244, s[16:19], s3 offen offset:2048
    v_mfma_f32_32x32x16_bf16 v[32:47], a[104:107], v[108:111], v[32:47]
    ds_read_b128 a[84:87], v234 offset:16384
    ds_read_b128 v[202:205], v245 offset:320
    v_lshlrev_b32 v213, 16, v115
    s_waitcnt lgkmcnt(8)
    v_fmac_f32_dpp v195, v178, v112 row_newbcast:1 row_mask:0xf bank_mask:0xf
    v_fmac_f32_dpp v197, v178, v113 row_newbcast:3 row_mask:0xf bank_mask:0xf
    s_waitcnt lgkmcnt(4)
    v_mfma_f32_32x32x16_bf16 v[48:63], a[108:111], v[108:111], v[48:63]
    ds_read_b128 a[88:91], v234 offset:17408
    ds_read_b128 v[206:209], v245 offset:336
    v_fmac_f32_dpp v199, v178, v114 row_newbcast:5 row_mask:0xf bank_mask:0xf
    v_fmac_f32_dpp v201, v178, v115 row_newbcast:7 row_mask:0xf bank_mask:0xf
    v_fmac_f32_dpp v194, v178, v210 row_newbcast:0 row_mask:0xf bank_mask:0xf
    v_fmac_f32_dpp v196, v178, v211 row_newbcast:2 row_mask:0xf bank_mask:0xf
    v_mfma_f32_32x32x16_bf16 v[64:79], a[112:115], v[108:111], v[64:79]
    ds_read_b128 a[92:95], v237 offset:15360
    v_fmac_f32_dpp v198, v178, v212 row_newbcast:4 row_mask:0xf bank_mask:0xf
    v_fmac_f32_dpp v200, v178, v213 row_newbcast:6 row_mask:0xf bank_mask:0xf
    v_cvt_pk_bf16_f32 v112, v194, v195
    s_add_u32 m0, s43, 49152
    s_add_u32 s4, s42, 49152
    buffer_load_dwordx4 v244, s[16:19], s4 offen lds
    v_mfma_f32_32x32x16_bf16 v[80:95], a[116:119], a[124:127], v[80:95]
    ds_read_b128 a[96:99], v240 offset:15360
    v_cvt_pk_bf16_f32 v113, v196, v197
    v_cvt_pk_bf16_f32 v114, v198, v199
    v_cvt_pk_bf16_f32 v115, v200, v201
    s_waitcnt lgkmcnt(5)
    s_nop 0
    v_mfma_f32_32x32x16_bf16 v[16:31], a[80:83], v[112:115], v[16:31]
    ds_read_b128 a[100:103], v234 offset:19200
    ds_read_b128 a[124:127], v243 offset:2560
    s_waitcnt vmcnt(9)
    v_lshlrev_b32 v210, 16, v116
    v_lshlrev_b32 v211, 16, v117
    v_lshlrev_b32 v212, 16, v118
    buffer_load_dwordx4 v[100:103], v244, s[16:19], s3 offen offset:3072
    v_mfma_f32_32x32x16_bf16 v[32:47], a[84:87], v[112:115], v[32:47]
    ds_read_b128 a[104:107], v234 offset:20224
    ds_read_b128 v[194:197], v245 offset:384
    v_lshlrev_b32 v213, 16, v119
    s_waitcnt lgkmcnt(8)
    v_fmac_f32_dpp v203, v178, v116 row_newbcast:9 row_mask:0xf bank_mask:0xf
    v_fmac_f32_dpp v205, v178, v117 row_newbcast:11 row_mask:0xf bank_mask:0xf
    s_waitcnt lgkmcnt(4)
    v_mfma_f32_32x32x16_bf16 v[48:63], a[88:91], v[112:115], v[48:63]
    ds_read_b128 a[108:111], v234 offset:21248
    ds_read_b128 v[198:201], v245 offset:400
    v_fmac_f32_dpp v207, v178, v118 row_newbcast:13 row_mask:0xf bank_mask:0xf
    v_fmac_f32_dpp v209, v178, v119 row_newbcast:15 row_mask:0xf bank_mask:0xf
    v_fmac_f32_dpp v202, v178, v210 row_newbcast:8 row_mask:0xf bank_mask:0xf
    v_fmac_f32_dpp v204, v178, v211 row_newbcast:10 row_mask:0xf bank_mask:0xf
    v_mfma_f32_32x32x16_bf16 v[64:79], a[92:95], v[112:115], v[64:79]
    ds_read_b128 a[112:115], v237 offset:19200
    v_fmac_f32_dpp v206, v178, v212 row_newbcast:12 row_mask:0xf bank_mask:0xf
    v_fmac_f32_dpp v208, v178, v213 row_newbcast:14 row_mask:0xf bank_mask:0xf
    v_cvt_pk_bf16_f32 v116, v202, v203
    s_add_u32 m0, s43, 53248
    s_add_u32 s4, s42, 53248
    buffer_load_dwordx4 v244, s[16:19], s4 offen lds
    v_mfma_f32_32x32x16_bf16 v[80:95], a[96:99], a[120:123], v[80:95]
    ds_read_b128 a[116:119], v240 offset:19200
    v_cvt_pk_bf16_f32 v117, v204, v205
    v_cvt_pk_bf16_f32 v118, v206, v207
    v_cvt_pk_bf16_f32 v119, v208, v209
    s_waitcnt lgkmcnt(5)
    s_nop 0
    v_mfma_f32_32x32x16_bf16 v[16:31], a[100:103], v[116:119], v[16:31]
    s_waitcnt vmcnt(8)
    s_barrier
    ds_read_b128 a[80:83], v234 offset:23040
    ds_read_b128 a[120:123], v243 offset:3072
    v_lshlrev_b32 v210, 16, v120
    v_lshlrev_b32 v211, 16, v121
    v_lshlrev_b32 v212, 16, v122
    s_add_u32 s3, s40, 12288
    buffer_load_dwordx4 v[104:107], v244, s[16:19], s3 offen offset:0
    v_mfma_f32_32x32x16_bf16 v[32:47], a[104:107], v[116:119], v[32:47]
    ds_read_b128 a[84:87], v234 offset:24064
    ds_read_b128 v[202:205], v245 offset:448
    v_lshlrev_b32 v213, 16, v123
    s_waitcnt lgkmcnt(8)
    v_fmac_f32_dpp v195, v179, v120 row_newbcast:1 row_mask:0xf bank_mask:0xf
    v_fmac_f32_dpp v197, v179, v121 row_newbcast:3 row_mask:0xf bank_mask:0xf
    s_waitcnt lgkmcnt(4)
    v_mfma_f32_32x32x16_bf16 v[48:63], a[108:111], v[116:119], v[48:63]
    ds_read_b128 a[88:91], v234 offset:25088
    ds_read_b128 v[206:209], v245 offset:464
    v_fmac_f32_dpp v199, v179, v122 row_newbcast:5 row_mask:0xf bank_mask:0xf
    v_fmac_f32_dpp v201, v179, v123 row_newbcast:7 row_mask:0xf bank_mask:0xf
    v_fmac_f32_dpp v194, v179, v210 row_newbcast:0 row_mask:0xf bank_mask:0xf
    v_fmac_f32_dpp v196, v179, v211 row_newbcast:2 row_mask:0xf bank_mask:0xf
    v_mfma_f32_32x32x16_bf16 v[64:79], a[112:115], v[116:119], v[64:79]
    ds_read_b128 a[92:95], v237 offset:23040
    v_fmac_f32_dpp v198, v179, v212 row_newbcast:4 row_mask:0xf bank_mask:0xf
    v_fmac_f32_dpp v200, v179, v213 row_newbcast:6 row_mask:0xf bank_mask:0xf
    v_cvt_pk_bf16_f32 v120, v194, v195
    s_add_u32 m0, s43, 57344
    s_add_u32 s4, s42, 57344
    buffer_load_dwordx4 v244, s[16:19], s4 offen lds
    v_mfma_f32_32x32x16_bf16 v[80:95], a[116:119], a[124:127], v[80:95]
    ds_read_b128 a[96:99], v240 offset:23040
    v_cvt_pk_bf16_f32 v121, v196, v197
    v_cvt_pk_bf16_f32 v122, v198, v199
    v_cvt_pk_bf16_f32 v123, v200, v201
    s_waitcnt lgkmcnt(5)
    s_nop 0
    v_mfma_f32_32x32x16_bf16 v[16:31], a[80:83], v[120:123], v[16:31]
    ds_read_b128 a[100:103], v234 offset:26880
    ds_read_b128 a[124:127], v243 offset:3584
    v_lshlrev_b32 v210, 16, v124
    v_lshlrev_b32 v211, 16, v125
    v_lshlrev_b32 v212, 16, v126
    buffer_load_dwordx4 v[108:111], v244, s[16:19], s3 offen offset:1024
    v_mfma_f32_32x32x16_bf16 v[32:47], a[84:87], v[120:123], v[32:47]
    ds_read_b128 a[104:107], v234 offset:27904
    ds_read_b128 v[194:197], v245 offset:512
    v_lshlrev_b32 v213, 16, v127
    s_waitcnt lgkmcnt(8)
    v_fmac_f32_dpp v203, v179, v124 row_newbcast:9 row_mask:0xf bank_mask:0xf
    v_fmac_f32_dpp v205, v179, v125 row_newbcast:11 row_mask:0xf bank_mask:0xf
    s_waitcnt lgkmcnt(4)
    v_mfma_f32_32x32x16_bf16 v[48:63], a[88:91], v[120:123], v[48:63]
    ds_read_b128 a[108:111], v234 offset:28928
    ds_read_b128 v[198:201], v245 offset:528
    v_fmac_f32_dpp v207, v179, v126 row_newbcast:13 row_mask:0xf bank_mask:0xf
    v_fmac_f32_dpp v209, v179, v127 row_newbcast:15 row_mask:0xf bank_mask:0xf
    v_fmac_f32_dpp v202, v179, v210 row_newbcast:8 row_mask:0xf bank_mask:0xf
    v_fmac_f32_dpp v204, v179, v211 row_newbcast:10 row_mask:0xf bank_mask:0xf
    v_mfma_f32_32x32x16_bf16 v[64:79], a[92:95], v[120:123], v[64:79]
    ds_read_b128 a[112:115], v237 offset:26880
    v_fmac_f32_dpp v206, v179, v212 row_newbcast:12 row_mask:0xf bank_mask:0xf
    v_fmac_f32_dpp v208, v179, v213 row_newbcast:14 row_mask:0xf bank_mask:0xf
    v_cvt_pk_bf16_f32 v124, v202, v203
    s_add_u32 m0, s43, 61440
    s_add_u32 s4, s42, 61440
    buffer_load_dwordx4 v244, s[16:19], s4 offen lds
    v_mfma_f32_32x32x16_bf16 v[80:95], a[96:99], a[120:123], v[80:95]
    ds_read_b128 a[116:119], v240 offset:26880
    v_cvt_pk_bf16_f32 v125, v204, v205
    v_cvt_pk_bf16_f32 v126, v206, v207
    v_cvt_pk_bf16_f32 v127, v208, v209
    s_waitcnt lgkmcnt(5)
    s_nop 0
    v_mfma_f32_32x32x16_bf16 v[16:31], a[100:103], v[124:127], v[16:31]
    ds_read_b128 a[80:83], v234 offset:30720
    ds_read_b128 a[120:123], v243 offset:4096
    s_waitcnt vmcnt(11)
    v_lshlrev_b32 v210, 16, v128
    v_lshlrev_b32 v211, 16, v129
    v_lshlrev_b32 v212, 16, v130
    buffer_load_dwordx4 v[112:115], v244, s[16:19], s3 offen offset:2048
    v_mfma_f32_32x32x16_bf16 v[32:47], a[104:107], v[124:127], v[32:47]
    ds_read_b128 a[84:87], v234 offset:31744
    ds_read_b128 v[202:205], v245 offset:576
    v_lshlrev_b32 v213, 16, v131
    s_waitcnt lgkmcnt(8)
    v_fmac_f32_dpp v195, v180, v128 row_newbcast:1 row_mask:0xf bank_mask:0xf
    v_fmac_f32_dpp v197, v180, v129 row_newbcast:3 row_mask:0xf bank_mask:0xf
    s_waitcnt lgkmcnt(4)
    v_mfma_f32_32x32x16_bf16 v[48:63], a[108:111], v[124:127], v[48:63]
    ds_read_b128 a[88:91], v234 offset:32768
    ds_read_b128 v[206:209], v245 offset:592
    v_fmac_f32_dpp v199, v180, v130 row_newbcast:5 row_mask:0xf bank_mask:0xf
    v_fmac_f32_dpp v201, v180, v131 row_newbcast:7 row_mask:0xf bank_mask:0xf
    v_fmac_f32_dpp v194, v180, v210 row_newbcast:0 row_mask:0xf bank_mask:0xf
    v_fmac_f32_dpp v196, v180, v211 row_newbcast:2 row_mask:0xf bank_mask:0xf
    v_mfma_f32_32x32x16_bf16 v[64:79], a[112:115], v[124:127], v[64:79]
    ds_read_b128 a[92:95], v237 offset:30720
    v_fmac_f32_dpp v198, v180, v212 row_newbcast:4 row_mask:0xf bank_mask:0xf
    v_fmac_f32_dpp v200, v180, v213 row_newbcast:6 row_mask:0xf bank_mask:0xf
    v_cvt_pk_bf16_f32 v128, v194, v195
    s_add_u32 m0, s43, 65536
    s_add_u32 s4, s42, 65536
    buffer_load_dwordx4 v244, s[16:19], s4 offen lds
    v_mfma_f32_32x32x16_bf16 v[80:95], a[116:119], a[124:127], v[80:95]
    ds_read_b128 a[96:99], v240 offset:30720
    v_cvt_pk_bf16_f32 v129, v196, v197
    v_cvt_pk_bf16_f32 v130, v198, v199
    v_cvt_pk_bf16_f32 v131, v200, v201
    s_waitcnt lgkmcnt(5)
    s_nop 0
    v_mfma_f32_32x32x16_bf16 v[16:31], a[80:83], v[128:131], v[16:31]
    ds_read_b128 a[100:103], v234 offset:34560
    ds_read_b128 a[124:127], v243 offset:4608
    s_waitcnt vmcnt(11)
    v_lshlrev_b32 v210, 16, v132
    v_lshlrev_b32 v211, 16, v133
    v_lshlrev_b32 v212, 16, v134
    buffer_load_dwordx4 v[116:119], v244, s[16:19], s3 offen offset:3072
    v_mfma_f32_32x32x16_bf16 v[32:47], a[84:87], v[128:131], v[32:47]
    ds_read_b128 a[104:107], v234 offset:35584
    ds_read_b128 v[194:197], v245 offset:640
    v_lshlrev_b32 v213, 16, v135
    s_waitcnt lgkmcnt(8)
    v_fmac_f32_dpp v203, v180, v132 row_newbcast:9 row_mask:0xf bank_mask:0xf
    v_fmac_f32_dpp v205, v180, v133 row_newbcast:11 row_mask:0xf bank_mask:0xf
    s_waitcnt lgkmcnt(4)
    v_mfma_f32_32x32x16_bf16 v[48:63], a[88:91], v[128:131], v[48:63]
    ds_read_b128 a[108:111], v234 offset:36608
    ds_read_b128 v[198:201], v245 offset:656
    v_fmac_f32_dpp v207, v180, v134 row_newbcast:13 row_mask:0xf bank_mask:0xf
    v_fmac_f32_dpp v209, v180, v135 row_newbcast:15 row_mask:0xf bank_mask:0xf
    v_fmac_f32_dpp v202, v180, v210 row_newbcast:8 row_mask:0xf bank_mask:0xf
    v_fmac_f32_dpp v204, v180, v211 row_newbcast:10 row_mask:0xf bank_mask:0xf
    v_mfma_f32_32x32x16_bf16 v[64:79], a[92:95], v[128:131], v[64:79]
    ds_read_b128 a[112:115], v237 offset:34560
    v_fmac_f32_dpp v206, v180, v212 row_newbcast:12 row_mask:0xf bank_mask:0xf
    v_fmac_f32_dpp v208, v180, v213 row_newbcast:14 row_mask:0xf bank_mask:0xf
    v_cvt_pk_bf16_f32 v132, v202, v203
    s_add_u32 m0, s43, 69632
    s_add_u32 s4, s42, 69632
    buffer_load_dwordx4 v244, s[16:19], s4 offen lds
    v_mfma_f32_32x32x16_bf16 v[80:95], a[96:99], a[120:123], v[80:95]
    ds_read_b128 a[116:119], v240 offset:34560
    v_cvt_pk_bf16_f32 v133, v204, v205
    v_cvt_pk_bf16_f32 v134, v206, v207
    v_cvt_pk_bf16_f32 v135, v208, v209
    s_waitcnt lgkmcnt(5)
    s_nop 0
    v_mfma_f32_32x32x16_bf16 v[16:31], a[100:103], v[132:135], v[16:31]
    s_waitcnt vmcnt(8)
    s_barrier
    ds_read_b128 a[80:83], v234 offset:38400
    ds_read_b128 a[120:123], v243 offset:5120
    v_lshlrev_b32 v210, 16, v96
    v_lshlrev_b32 v211, 16, v97
    v_lshlrev_b32 v212, 16, v98
    s_add_u32 s3, s40, 16384
    buffer_load_dwordx4 v[120:123], v244, s[16:19], s3 offen offset:0
    v_mfma_f32_32x32x16_bf16 v[32:47], a[104:107], v[132:135], v[32:47]
    ds_read_b128 a[84:87], v234 offset:39424
    ds_read_b128 v[202:205], v245 offset:704
    v_lshlrev_b32 v213, 16, v99
    s_waitcnt lgkmcnt(8)
    v_fmac_f32_dpp v195, v181, v96 row_newbcast:1 row_mask:0xf bank_mask:0xf
    v_fmac_f32_dpp v197, v181, v97 row_newbcast:3 row_mask:0xf bank_mask:0xf
    s_waitcnt lgkmcnt(4)
    v_mfma_f32_32x32x16_bf16 v[48:63], a[108:111], v[132:135], v[48:63]
    ds_read_b128 a[88:91], v234 offset:40448
    ds_read_b128 v[206:209], v245 offset:720
    v_fmac_f32_dpp v199, v181, v98 row_newbcast:5 row_mask:0xf bank_mask:0xf
    v_fmac_f32_dpp v201, v181, v99 row_newbcast:7 row_mask:0xf bank_mask:0xf
    v_fmac_f32_dpp v194, v181, v210 row_newbcast:0 row_mask:0xf bank_mask:0xf
    v_fmac_f32_dpp v196, v181, v211 row_newbcast:2 row_mask:0xf bank_mask:0xf
    v_mfma_f32_32x32x16_bf16 v[64:79], a[112:115], v[132:135], v[64:79]
    ds_read_b128 a[92:95], v237 offset:38400
    v_fmac_f32_dpp v198, v181, v212 row_newbcast:4 row_mask:0xf bank_mask:0xf
    v_fmac_f32_dpp v200, v181, v213 row_newbcast:6 row_mask:0xf bank_mask:0xf
    v_cvt_pk_bf16_f32 v96, v194, v195
    s_add_u32 m0, s43, 73728
    s_add_u32 s4, s42, 73728
    buffer_load_dwordx4 v244, s[16:19], s4 offen lds
    v_mfma_f32_32x32x16_bf16 v[80:95], a[116:119], a[124:127], v[80:95]
    ds_read_b128 a[96:99], v240 offset:38400
    v_cvt_pk_bf16_f32 v97, v196, v197
    v_cvt_pk_bf16_f32 v98, v198, v199
    v_cvt_pk_bf16_f32 v99, v200, v201
    s_waitcnt lgkmcnt(5)
    s_nop 0
    v_mfma_f32_32x32x16_bf16 v[16:31], a[80:83], v[96:99], v[16:31]
    ds_read_b128 a[100:103], v234 offset:42240
    ds_read_b128 a[124:127], v243 offset:5632
    v_lshlrev_b32 v210, 16, v100
    v_lshlrev_b32 v211, 16, v101
    v_lshlrev_b32 v212, 16, v102
    buffer_load_dwordx4 v[124:127], v244, s[16:19], s3 offen offset:1024
    v_mfma_f32_32x32x16_bf16 v[32:47], a[84:87], v[96:99], v[32:47]
    ds_read_b128 a[104:107], v234 offset:43264
    ds_read_b128 v[194:197], v245 offset:768
    v_lshlrev_b32 v213, 16, v103
    s_waitcnt lgkmcnt(8)
    v_fmac_f32_dpp v203, v181, v100 row_newbcast:9 row_mask:0xf bank_mask:0xf
    v_fmac_f32_dpp v205, v181, v101 row_newbcast:11 row_mask:0xf bank_mask:0xf
    s_waitcnt lgkmcnt(4)
    v_mfma_f32_32x32x16_bf16 v[48:63], a[88:91], v[96:99], v[48:63]
    ds_read_b128 a[108:111], v234 offset:44288
    ds_read_b128 v[198:201], v245 offset:784
    v_fmac_f32_dpp v207, v181, v102 row_newbcast:13 row_mask:0xf bank_mask:0xf
    v_fmac_f32_dpp v209, v181, v103 row_newbcast:15 row_mask:0xf bank_mask:0xf
    v_fmac_f32_dpp v202, v181, v210 row_newbcast:8 row_mask:0xf bank_mask:0xf
    v_fmac_f32_dpp v204, v181, v211 row_newbcast:10 row_mask:0xf bank_mask:0xf
    v_mfma_f32_32x32x16_bf16 v[64:79], a[92:95], v[96:99], v[64:79]
    ds_read_b128 a[112:115], v237 offset:42240
    v_fmac_f32_dpp v206, v181, v212 row_newbcast:12 row_mask:0xf bank_mask:0xf
    v_fmac_f32_dpp v208, v181, v213 row_newbcast:14 row_mask:0xf bank_mask:0xf
    v_cvt_pk_bf16_f32 v100, v202, v203
    s_add_u32 m0, s43, 77824
    s_add_u32 s4, s42, 77824
    buffer_load_dwordx4 v244, s[16:19], s4 offen lds
    v_mfma_f32_32x32x16_bf16 v[80:95], a[96:99], a[120:123], v[80:95]
    ds_read_b128 a[116:119], v240 offset:42240
    v_cvt_pk_bf16_f32 v101, v204, v205
    v_cvt_pk_bf16_f32 v102, v206, v207
    v_cvt_pk_bf16_f32 v103, v208, v209
    s_waitcnt lgkmcnt(5)
    s_nop 0
    v_mfma_f32_32x32x16_bf16 v[16:31], a[100:103], v[100:103], v[16:31]
    ds_read_b128 a[80:83], v234 offset:46080
    ds_read_b128 a[120:123], v243 offset:6144
    s_waitcnt vmcnt(11)
    v_lshlrev_b32 v210, 16, v104
    v_lshlrev_b32 v211, 16, v105
    v_lshlrev_b32 v212, 16, v106
    buffer_load_dwordx4 v[128:131], v244, s[16:19], s3 offen offset:2048
    v_mfma_f32_32x32x16_bf16 v[32:47], a[104:107], v[100:103], v[32:47]
    ds_read_b128 a[84:87], v234 offset:47104
    ds_read_b128 v[202:205], v245 offset:832
    v_lshlrev_b32 v213, 16, v107
    s_waitcnt lgkmcnt(8)
    v_fmac_f32_dpp v195, v182, v104 row_newbcast:1 row_mask:0xf bank_mask:0xf
    v_fmac_f32_dpp v197, v182, v105 row_newbcast:3 row_mask:0xf bank_mask:0xf
    s_waitcnt lgkmcnt(4)
    v_mfma_f32_32x32x16_bf16 v[48:63], a[108:111], v[100:103], v[48:63]
    ds_read_b128 a[88:91], v234 offset:48128
    ds_read_b128 v[206:209], v245 offset:848
    v_fmac_f32_dpp v199, v182, v106 row_newbcast:5 row_mask:0xf bank_mask:0xf
    v_fmac_f32_dpp v201, v182, v107 row_newbcast:7 row_mask:0xf bank_mask:0xf
    v_fmac_f32_dpp v194, v182, v210 row_newbcast:0 row_mask:0xf bank_mask:0xf
    v_fmac_f32_dpp v196, v182, v211 row_newbcast:2 row_mask:0xf bank_mask:0xf
    v_mfma_f32_32x32x16_bf16 v[64:79], a[112:115], v[100:103], v[64:79]
    ds_read_b128 a[92:95], v237 offset:46080
    v_fmac_f32_dpp v198, v182, v212 row_newbcast:4 row_mask:0xf bank_mask:0xf
    v_fmac_f32_dpp v200, v182, v213 row_newbcast:6 row_mask:0xf bank_mask:0xf
    v_cvt_pk_bf16_f32 v104, v194, v195
    s_add_u32 m0, s43, 81920
    s_add_u32 s4, s42, 81920
    buffer_load_dwordx4 v244, s[16:19], s4 offen lds
    v_mfma_f32_32x32x16_bf16 v[80:95], a[116:119], a[124:127], v[80:95]
    ds_read_b128 a[96:99], v240 offset:46080
    v_cvt_pk_bf16_f32 v105, v196, v197
    v_cvt_pk_bf16_f32 v106, v198, v199
    v_cvt_pk_bf16_f32 v107, v200, v201
    s_waitcnt lgkmcnt(5)
    s_nop 0
    v_mfma_f32_32x32x16_bf16 v[16:31], a[80:83], v[104:107], v[16:31]
    ds_read_b128 a[100:103], v234 offset:49920
    ds_read_b128 a[124:127], v243 offset:6656
    s_waitcnt vmcnt(11)
    v_lshlrev_b32 v210, 16, v108
    v_lshlrev_b32 v211, 16, v109
    v_lshlrev_b32 v212, 16, v110
    buffer_load_dwordx4 v[132:135], v244, s[16:19], s3 offen offset:3072
    v_mfma_f32_32x32x16_bf16 v[32:47], a[84:87], v[104:107], v[32:47]
    ds_read_b128 a[104:107], v234 offset:50944
    ds_read_b128 v[194:197], v245 offset:896
    v_lshlrev_b32 v213, 16, v111
    s_waitcnt lgkmcnt(8)
    v_fmac_f32_dpp v203, v182, v108 row_newbcast:9 row_mask:0xf bank_mask:0xf
    v_fmac_f32_dpp v205, v182, v109 row_newbcast:11 row_mask:0xf bank_mask:0xf
    s_waitcnt lgkmcnt(4)
    v_mfma_f32_32x32x16_bf16 v[48:63], a[88:91], v[104:107], v[48:63]
    ds_read_b128 a[108:111], v234 offset:51968
    ds_read_b128 v[198:201], v245 offset:912
    v_fmac_f32_dpp v207, v182, v110 row_newbcast:13 row_mask:0xf bank_mask:0xf
    v_fmac_f32_dpp v209, v182, v111 row_newbcast:15 row_mask:0xf bank_mask:0xf
    v_fmac_f32_dpp v202, v182, v210 row_newbcast:8 row_mask:0xf bank_mask:0xf
    v_fmac_f32_dpp v204, v182, v211 row_newbcast:10 row_mask:0xf bank_mask:0xf
    v_mfma_f32_32x32x16_bf16 v[64:79], a[92:95], v[104:107], v[64:79]
    ds_read_b128 a[112:115], v237 offset:49920
    v_fmac_f32_dpp v206, v182, v212 row_newbcast:12 row_mask:0xf bank_mask:0xf
    v_fmac_f32_dpp v208, v182, v213 row_newbcast:14 row_mask:0xf bank_mask:0xf
    v_cvt_pk_bf16_f32 v108, v202, v203
    s_add_u32 m0, s43, 86016
    s_add_u32 s4, s42, 86016
    buffer_load_dwordx4 v244, s[16:19], s4 offen lds
    v_mfma_f32_32x32x16_bf16 v[80:95], a[96:99], a[120:123], v[80:95]
    ds_read_b128 a[116:119], v240 offset:49920
    v_cvt_pk_bf16_f32 v109, v204, v205
    v_cvt_pk_bf16_f32 v110, v206, v207
    v_cvt_pk_bf16_f32 v111, v208, v209
    s_waitcnt lgkmcnt(5)
    s_nop 0
    v_mfma_f32_32x32x16_bf16 v[16:31], a[100:103], v[108:111], v[16:31]
    s_waitcnt vmcnt(10)
    s_barrier
    ds_read_b128 a[80:83], v234 offset:53760
    ds_read_b128 a[120:123], v243 offset:7168
    v_lshlrev_b32 v210, 16, v112
    v_lshlrev_b32 v211, 16, v113
    v_lshlrev_b32 v212, 16, v114
    s_add_u32 s3, s40, 20480
    buffer_load_dwordx4 v[96:99], v244, s[16:19], s3 offen offset:0
    v_mfma_f32_32x32x16_bf16 v[32:47], a[104:107], v[108:111], v[32:47]
    ds_read_b128 a[84:87], v234 offset:54784
    ds_read_b128 v[202:205], v245 offset:960
    v_lshlrev_b32 v213, 16, v115
    s_waitcnt lgkmcnt(8)
    v_fmac_f32_dpp v195, v183, v112 row_newbcast:1 row_mask:0xf bank_mask:0xf
    v_fmac_f32_dpp v197, v183, v113 row_newbcast:3 row_mask:0xf bank_mask:0xf
    s_waitcnt lgkmcnt(4)
    v_mfma_f32_32x32x16_bf16 v[48:63], a[108:111], v[108:111], v[48:63]
    ds_read_b128 a[88:91], v234 offset:55808
    ds_read_b128 v[206:209], v245 offset:976
    v_fmac_f32_dpp v199, v183, v114 row_newbcast:5 row_mask:0xf bank_mask:0xf
    v_fmac_f32_dpp v201, v183, v115 row_newbcast:7 row_mask:0xf bank_mask:0xf
    v_fmac_f32_dpp v194, v183, v210 row_newbcast:0 row_mask:0xf bank_mask:0xf
    v_fmac_f32_dpp v196, v183, v211 row_newbcast:2 row_mask:0xf bank_mask:0xf
    v_mfma_f32_32x32x16_bf16 v[64:79], a[112:115], v[108:111], v[64:79]
    ds_read_b128 a[92:95], v237 offset:53760
    v_fmac_f32_dpp v198, v183, v212 row_newbcast:4 row_mask:0xf bank_mask:0xf
    v_fmac_f32_dpp v200, v183, v213 row_newbcast:6 row_mask:0xf bank_mask:0xf
    v_cvt_pk_bf16_f32 v112, v194, v195
    s_add_u32 m0, s43, 90112
    s_add_u32 s4, s42, 90112
    buffer_load_dwordx4 v244, s[16:19], s4 offen lds
    v_mfma_f32_32x32x16_bf16 v[80:95], a[116:119], a[124:127], v[80:95]
    ds_read_b128 a[96:99], v240 offset:53760
    v_cvt_pk_bf16_f32 v113, v196, v197
    v_cvt_pk_bf16_f32 v114, v198, v199
    v_cvt_pk_bf16_f32 v115, v200, v201
    s_waitcnt lgkmcnt(5)
    s_nop 0
    v_mfma_f32_32x32x16_bf16 v[16:31], a[80:83], v[112:115], v[16:31]
    ds_read_b128 a[100:103], v234 offset:57600
    ds_read_b128 a[124:127], v243 offset:7680
    s_waitcnt vmcnt(11)
    v_lshlrev_b32 v210, 16, v116
    v_lshlrev_b32 v211, 16, v117
    v_lshlrev_b32 v212, 16, v118
    buffer_load_dwordx4 v[100:103], v244, s[16:19], s3 offen offset:1024
    v_mfma_f32_32x32x16_bf16 v[32:47], a[84:87], v[112:115], v[32:47]
    ds_read_b128 a[104:107], v234 offset:58624
    ds_read_b128 v[194:197], v245 offset:1024
    v_lshlrev_b32 v213, 16, v119
    s_waitcnt lgkmcnt(8)
    v_fmac_f32_dpp v203, v183, v116 row_newbcast:9 row_mask:0xf bank_mask:0xf
    v_fmac_f32_dpp v205, v183, v117 row_newbcast:11 row_mask:0xf bank_mask:0xf
    s_waitcnt lgkmcnt(4)
    v_mfma_f32_32x32x16_bf16 v[48:63], a[88:91], v[112:115], v[48:63]
    ds_read_b128 a[108:111], v234 offset:59648
    ds_read_b128 v[198:201], v245 offset:1040
    v_fmac_f32_dpp v207, v183, v118 row_newbcast:13 row_mask:0xf bank_mask:0xf
    v_fmac_f32_dpp v209, v183, v119 row_newbcast:15 row_mask:0xf bank_mask:0xf
    v_fmac_f32_dpp v202, v183, v210 row_newbcast:8 row_mask:0xf bank_mask:0xf
    v_fmac_f32_dpp v204, v183, v211 row_newbcast:10 row_mask:0xf bank_mask:0xf
    v_mfma_f32_32x32x16_bf16 v[64:79], a[92:95], v[112:115], v[64:79]
    ds_read_b128 a[112:115], v237 offset:57600
    v_fmac_f32_dpp v206, v183, v212 row_newbcast:12 row_mask:0xf bank_mask:0xf
    v_fmac_f32_dpp v208, v183, v213 row_newbcast:14 row_mask:0xf bank_mask:0xf
    v_cvt_pk_bf16_f32 v116, v202, v203
    s_add_u32 m0, s43, 94208
    s_add_u32 s4, s42, 94208
    buffer_load_dwordx4 v244, s[16:19], s4 offen lds
    v_mfma_f32_32x32x16_bf16 v[80:95], a[96:99], a[120:123], v[80:95]
    ds_read_b128 a[116:119], v240 offset:57600
    v_cvt_pk_bf16_f32 v117, v204, v205
    v_cvt_pk_bf16_f32 v118, v206, v207
    v_cvt_pk_bf16_f32 v119, v208, v209
    s_waitcnt lgkmcnt(5)
    s_nop 0
    v_mfma_f32_32x32x16_bf16 v[16:31], a[100:103], v[116:119], v[16:31]
    ds_read_b128 a[80:83], v235 offset:0
    ds_read_b128 a[120:123], v243 offset:8192
    s_waitcnt vmcnt(11)
    v_lshlrev_b32 v210, 16, v120
    v_lshlrev_b32 v211, 16, v121
    v_lshlrev_b32 v212, 16, v122
    buffer_load_dwordx4 v[104:107], v244, s[16:19], s3 offen offset:2048
    v_mfma_f32_32x32x16_bf16 v[32:47], a[104:107], v[116:119], v[32:47]
    ds_read_b128 a[84:87], v235 offset:1024
    ds_read_b128 v[202:205], v245 offset:1088
    v_lshlrev_b32 v213, 16, v123
    s_waitcnt lgkmcnt(8)
    v_fmac_f32_dpp v195, v184, v120 row_newbcast:1 row_mask:0xf bank_mask:0xf
    v_fmac_f32_dpp v197, v184, v121 row_newbcast:3 row_mask:0xf bank_mask:0xf
    s_waitcnt lgkmcnt(4)
    v_mfma_f32_32x32x16_bf16 v[48:63], a[108:111], v[116:119], v[48:63]
    ds_read_b128 a[88:91], v235 offset:2048
    ds_read_b128 v[206:209], v245 offset:1104
    v_fmac_f32_dpp v199, v184, v122 row_newbcast:5 row_mask:0xf bank_mask:0xf
    v_fmac_f32_dpp v201, v184, v123 row_newbcast:7 row_mask:0xf bank_mask:0xf
    v_fmac_f32_dpp v194, v184, v210 row_newbcast:0 row_mask:0xf bank_mask:0xf
    v_fmac_f32_dpp v196, v184, v211 row_newbcast:2 row_mask:0xf bank_mask:0xf
    v_mfma_f32_32x32x16_bf16 v[64:79], a[112:115], v[116:119], v[64:79]
    ds_read_b128 a[92:95], v238 offset:0
    v_fmac_f32_dpp v198, v184, v212 row_newbcast:4 row_mask:0xf bank_mask:0xf
    v_fmac_f32_dpp v200, v184, v213 row_newbcast:6 row_mask:0xf bank_mask:0xf
    v_cvt_pk_bf16_f32 v120, v194, v195
    s_add_u32 m0, s43, 98304
    s_add_u32 s4, s42, 98304
    buffer_load_dwordx4 v244, s[16:19], s4 offen lds
    v_mfma_f32_32x32x16_bf16 v[80:95], a[116:119], a[124:127], v[80:95]
    ds_read_b128 a[96:99], v241 offset:0
    v_cvt_pk_bf16_f32 v121, v196, v197
    v_cvt_pk_bf16_f32 v122, v198, v199
    v_cvt_pk_bf16_f32 v123, v200, v201
    s_waitcnt lgkmcnt(5)
    s_nop 0
    v_mfma_f32_32x32x16_bf16 v[16:31], a[80:83], v[120:123], v[16:31]
    ds_read_b128 a[100:103], v235 offset:3840
    ds_read_b128 a[124:127], v243 offset:8704
    s_waitcnt vmcnt(11)
    v_lshlrev_b32 v210, 16, v124
    v_lshlrev_b32 v211, 16, v125
    v_lshlrev_b32 v212, 16, v126
    buffer_load_dwordx4 v[108:111], v244, s[16:19], s3 offen offset:3072
    v_mfma_f32_32x32x16_bf16 v[32:47], a[84:87], v[120:123], v[32:47]
    ds_read_b128 a[104:107], v235 offset:4864
    ds_read_b128 v[194:197], v245 offset:1152
    v_lshlrev_b32 v213, 16, v127
    s_waitcnt lgkmcnt(8)
    v_fmac_f32_dpp v203, v184, v124 row_newbcast:9 row_mask:0xf bank_mask:0xf
    v_fmac_f32_dpp v205, v184, v125 row_newbcast:11 row_mask:0xf bank_mask:0xf
    s_waitcnt lgkmcnt(4)
    v_mfma_f32_32x32x16_bf16 v[48:63], a[88:91], v[120:123], v[48:63]
    ds_read_b128 a[108:111], v235 offset:5888
    ds_read_b128 v[198:201], v245 offset:1168
    v_fmac_f32_dpp v207, v184, v126 row_newbcast:13 row_mask:0xf bank_mask:0xf
    v_fmac_f32_dpp v209, v184, v127 row_newbcast:15 row_mask:0xf bank_mask:0xf
    v_fmac_f32_dpp v202, v184, v210 row_newbcast:8 row_mask:0xf bank_mask:0xf
    v_fmac_f32_dpp v204, v184, v211 row_newbcast:10 row_mask:0xf bank_mask:0xf
    v_mfma_f32_32x32x16_bf16 v[64:79], a[92:95], v[120:123], v[64:79]
    ds_read_b128 a[112:115], v238 offset:3840
    v_fmac_f32_dpp v206, v184, v212 row_newbcast:12 row_mask:0xf bank_mask:0xf
    v_fmac_f32_dpp v208, v184, v213 row_newbcast:14 row_mask:0xf bank_mask:0xf
    v_cvt_pk_bf16_f32 v124, v202, v203
    s_add_u32 m0, s43, 102400
    s_add_u32 s4, s42, 102400
    buffer_load_dwordx4 v244, s[16:19], s4 offen lds
    v_mfma_f32_32x32x16_bf16 v[80:95], a[96:99], a[120:123], v[80:95]
    ds_read_b128 a[116:119], v241 offset:3840
    v_cvt_pk_bf16_f32 v125, v204, v205
    v_cvt_pk_bf16_f32 v126, v206, v207
    v_cvt_pk_bf16_f32 v127, v208, v209
    s_waitcnt lgkmcnt(5)
    s_nop 0
    v_mfma_f32_32x32x16_bf16 v[16:31], a[100:103], v[124:127], v[16:31]
    s_waitcnt vmcnt(10)
    s_barrier
    ds_read_b128 a[80:83], v235 offset:7680
    ds_read_b128 a[120:123], v243 offset:9216
    v_lshlrev_b32 v210, 16, v128
    v_lshlrev_b32 v211, 16, v129
    v_lshlrev_b32 v212, 16, v130
    s_add_u32 s3, s40, 24576
    buffer_load_dwordx4 v[112:115], v244, s[16:19], s3 offen offset:0
    v_mfma_f32_32x32x16_bf16 v[32:47], a[104:107], v[124:127], v[32:47]
    ds_read_b128 a[84:87], v235 offset:8704
    ds_read_b128 v[202:205], v245 offset:1216
    v_lshlrev_b32 v213, 16, v131
    s_waitcnt lgkmcnt(8)
    v_fmac_f32_dpp v195, v185, v128 row_newbcast:1 row_mask:0xf bank_mask:0xf
    v_fmac_f32_dpp v197, v185, v129 row_newbcast:3 row_mask:0xf bank_mask:0xf
    s_waitcnt lgkmcnt(4)
    v_mfma_f32_32x32x16_bf16 v[48:63], a[108:111], v[124:127], v[48:63]
    ds_read_b128 a[88:91], v235 offset:9728
    ds_read_b128 v[206:209], v245 offset:1232
    v_fmac_f32_dpp v199, v185, v130 row_newbcast:5 row_mask:0xf bank_mask:0xf
    v_fmac_f32_dpp v201, v185, v131 row_newbcast:7 row_mask:0xf bank_mask:0xf
    v_fmac_f32_dpp v194, v185, v210 row_newbcast:0 row_mask:0xf bank_mask:0xf
    v_fmac_f32_dpp v196, v185, v211 row_newbcast:2 row_mask:0xf bank_mask:0xf
    v_mfma_f32_32x32x16_bf16 v[64:79], a[112:115], v[124:127], v[64:79]
    ds_read_b128 a[92:95], v238 offset:7680
    v_fmac_f32_dpp v198, v185, v212 row_newbcast:4 row_mask:0xf bank_mask:0xf
    v_fmac_f32_dpp v200, v185, v213 row_newbcast:6 row_mask:0xf bank_mask:0xf
    v_cvt_pk_bf16_f32 v128, v194, v195
    s_add_u32 m0, s43, 106496
    s_add_u32 s4, s42, 106496
    buffer_load_dwordx4 v244, s[16:19], s4 offen lds
    v_mfma_f32_32x32x16_bf16 v[80:95], a[116:119], a[124:127], v[80:95]
    ds_read_b128 a[96:99], v241 offset:7680
    v_cvt_pk_bf16_f32 v129, v196, v197
    v_cvt_pk_bf16_f32 v130, v198, v199
    v_cvt_pk_bf16_f32 v131, v200, v201
    s_waitcnt lgkmcnt(5)
    s_nop 0
    v_mfma_f32_32x32x16_bf16 v[16:31], a[80:83], v[128:131], v[16:31]
    ds_read_b128 a[100:103], v235 offset:11520
    ds_read_b128 a[124:127], v243 offset:9728
    s_waitcnt vmcnt(11)
    v_lshlrev_b32 v210, 16, v132
    v_lshlrev_b32 v211, 16, v133
    v_lshlrev_b32 v212, 16, v134
    buffer_load_dwordx4 v[116:119], v244, s[16:19], s3 offen offset:1024
    v_mfma_f32_32x32x16_bf16 v[32:47], a[84:87], v[128:131], v[32:47]
    ds_read_b128 a[104:107], v235 offset:12544
    ds_read_b128 v[194:197], v245 offset:1280
    v_lshlrev_b32 v213, 16, v135
    s_waitcnt lgkmcnt(8)
    v_fmac_f32_dpp v203, v185, v132 row_newbcast:9 row_mask:0xf bank_mask:0xf
    v_fmac_f32_dpp v205, v185, v133 row_newbcast:11 row_mask:0xf bank_mask:0xf
    s_waitcnt lgkmcnt(4)
    v_mfma_f32_32x32x16_bf16 v[48:63], a[88:91], v[128:131], v[48:63]
    ds_read_b128 a[108:111], v235 offset:13568
    ds_read_b128 v[198:201], v245 offset:1296
    v_fmac_f32_dpp v207, v185, v134 row_newbcast:13 row_mask:0xf bank_mask:0xf
    v_fmac_f32_dpp v209, v185, v135 row_newbcast:15 row_mask:0xf bank_mask:0xf
    v_fmac_f32_dpp v202, v185, v210 row_newbcast:8 row_mask:0xf bank_mask:0xf
    v_fmac_f32_dpp v204, v185, v211 row_newbcast:10 row_mask:0xf bank_mask:0xf
    v_mfma_f32_32x32x16_bf16 v[64:79], a[92:95], v[128:131], v[64:79]
    ds_read_b128 a[112:115], v238 offset:11520
    v_fmac_f32_dpp v206, v185, v212 row_newbcast:12 row_mask:0xf bank_mask:0xf
    v_fmac_f32_dpp v208, v185, v213 row_newbcast:14 row_mask:0xf bank_mask:0xf
    v_cvt_pk_bf16_f32 v132, v202, v203
    s_add_u32 m0, s43, 110592
    s_add_u32 s4, s42, 110592
    buffer_load_dwordx4 v244, s[16:19], s4 offen lds
    v_mfma_f32_32x32x16_bf16 v[80:95], a[96:99], a[120:123], v[80:95]
    ds_read_b128 a[116:119], v241 offset:11520
    v_cvt_pk_bf16_f32 v133, v204, v205
    v_cvt_pk_bf16_f32 v134, v206, v207
    v_cvt_pk_bf16_f32 v135, v208, v209
    s_waitcnt lgkmcnt(5)
    s_nop 0
    v_mfma_f32_32x32x16_bf16 v[16:31], a[100:103], v[132:135], v[16:31]
    ds_read_b128 a[80:83], v235 offset:15360
    ds_read_b128 a[120:123], v243 offset:10240
    s_waitcnt vmcnt(11)
    v_lshlrev_b32 v210, 16, v96
    v_lshlrev_b32 v211, 16, v97
    v_lshlrev_b32 v212, 16, v98
    buffer_load_dwordx4 v[120:123], v244, s[16:19], s3 offen offset:2048
    v_mfma_f32_32x32x16_bf16 v[32:47], a[104:107], v[132:135], v[32:47]
    ds_read_b128 a[84:87], v235 offset:16384
    ds_read_b128 v[202:205], v245 offset:1344
    v_lshlrev_b32 v213, 16, v99
    s_waitcnt lgkmcnt(8)
    v_fmac_f32_dpp v195, v186, v96 row_newbcast:1 row_mask:0xf bank_mask:0xf
    v_fmac_f32_dpp v197, v186, v97 row_newbcast:3 row_mask:0xf bank_mask:0xf
    s_waitcnt lgkmcnt(4)
    v_mfma_f32_32x32x16_bf16 v[48:63], a[108:111], v[132:135], v[48:63]
    ds_read_b128 a[88:91], v235 offset:17408
    ds_read_b128 v[206:209], v245 offset:1360
    v_fmac_f32_dpp v199, v186, v98 row_newbcast:5 row_mask:0xf bank_mask:0xf
    v_fmac_f32_dpp v201, v186, v99 row_newbcast:7 row_mask:0xf bank_mask:0xf
    v_fmac_f32_dpp v194, v186, v210 row_newbcast:0 row_mask:0xf bank_mask:0xf
    v_fmac_f32_dpp v196, v186, v211 row_newbcast:2 row_mask:0xf bank_mask:0xf
    v_mfma_f32_32x32x16_bf16 v[64:79], a[112:115], v[132:135], v[64:79]
    ds_read_b128 a[92:95], v238 offset:15360
    v_fmac_f32_dpp v198, v186, v212 row_newbcast:4 row_mask:0xf bank_mask:0xf
    v_fmac_f32_dpp v200, v186, v213 row_newbcast:6 row_mask:0xf bank_mask:0xf
    v_cvt_pk_bf16_f32 v96, v194, v195
    s_add_u32 m0, s43, 114688
    s_add_u32 s4, s42, 114688
    buffer_load_dwordx4 v244, s[16:19], s4 offen lds
    v_mfma_f32_32x32x16_bf16 v[80:95], a[116:119], a[124:127], v[80:95]
    ds_read_b128 a[96:99], v241 offset:15360
    v_cvt_pk_bf16_f32 v97, v196, v197
    v_cvt_pk_bf16_f32 v98, v198, v199
    v_cvt_pk_bf16_f32 v99, v200, v201
    s_waitcnt lgkmcnt(5)
    s_nop 0
    v_mfma_f32_32x32x16_bf16 v[16:31], a[80:83], v[96:99], v[16:31]
    ds_read_b128 a[100:103], v235 offset:19200
    ds_read_b128 a[124:127], v243 offset:10752
    s_waitcnt vmcnt(11)
    v_lshlrev_b32 v210, 16, v100
    v_lshlrev_b32 v211, 16, v101
    v_lshlrev_b32 v212, 16, v102
    buffer_load_dwordx4 v[124:127], v244, s[16:19], s3 offen offset:3072
    v_mfma_f32_32x32x16_bf16 v[32:47], a[84:87], v[96:99], v[32:47]
    ds_read_b128 a[104:107], v235 offset:20224
    ds_read_b128 v[194:197], v245 offset:1408
    v_lshlrev_b32 v213, 16, v103
    s_waitcnt lgkmcnt(8)
    v_fmac_f32_dpp v203, v186, v100 row_newbcast:9 row_mask:0xf bank_mask:0xf
    v_fmac_f32_dpp v205, v186, v101 row_newbcast:11 row_mask:0xf bank_mask:0xf
    s_waitcnt lgkmcnt(4)
    v_mfma_f32_32x32x16_bf16 v[48:63], a[88:91], v[96:99], v[48:63]
    ds_read_b128 a[108:111], v235 offset:21248
    ds_read_b128 v[198:201], v245 offset:1424
    v_fmac_f32_dpp v207, v186, v102 row_newbcast:13 row_mask:0xf bank_mask:0xf
    v_fmac_f32_dpp v209, v186, v103 row_newbcast:15 row_mask:0xf bank_mask:0xf
    v_fmac_f32_dpp v202, v186, v210 row_newbcast:8 row_mask:0xf bank_mask:0xf
    v_fmac_f32_dpp v204, v186, v211 row_newbcast:10 row_mask:0xf bank_mask:0xf
    v_mfma_f32_32x32x16_bf16 v[64:79], a[92:95], v[96:99], v[64:79]
    ds_read_b128 a[112:115], v238 offset:19200
    v_fmac_f32_dpp v206, v186, v212 row_newbcast:12 row_mask:0xf bank_mask:0xf
    v_fmac_f32_dpp v208, v186, v213 row_newbcast:14 row_mask:0xf bank_mask:0xf
    v_cvt_pk_bf16_f32 v100, v202, v203
    s_add_u32 m0, s43, 118784
    s_add_u32 s4, s42, 118784
    buffer_load_dwordx4 v244, s[16:19], s4 offen lds
    v_mfma_f32_32x32x16_bf16 v[80:95], a[96:99], a[120:123], v[80:95]
    ds_read_b128 a[116:119], v241 offset:19200
    v_cvt_pk_bf16_f32 v101, v204, v205
    v_cvt_pk_bf16_f32 v102, v206, v207
    v_cvt_pk_bf16_f32 v103, v208, v209
    s_waitcnt lgkmcnt(5)
    s_nop 0
    v_mfma_f32_32x32x16_bf16 v[16:31], a[100:103], v[100:103], v[16:31]
    s_waitcnt vmcnt(10)
    s_barrier
    ds_read_b128 a[80:83], v235 offset:23040
    ds_read_b128 a[120:123], v243 offset:11264
    v_lshlrev_b32 v210, 16, v104
    v_lshlrev_b32 v211, 16, v105
    v_lshlrev_b32 v212, 16, v106
    s_add_u32 s3, s40, 28672
    buffer_load_dwordx4 v[128:131], v244, s[16:19], s3 offen offset:0
    v_mfma_f32_32x32x16_bf16 v[32:47], a[104:107], v[100:103], v[32:47]
    ds_read_b128 a[84:87], v235 offset:24064
    ds_read_b128 v[202:205], v245 offset:1472
    v_lshlrev_b32 v213, 16, v107
    s_waitcnt lgkmcnt(8)
    v_fmac_f32_dpp v195, v187, v104 row_newbcast:1 row_mask:0xf bank_mask:0xf
    v_fmac_f32_dpp v197, v187, v105 row_newbcast:3 row_mask:0xf bank_mask:0xf
    s_waitcnt lgkmcnt(4)
    v_mfma_f32_32x32x16_bf16 v[48:63], a[108:111], v[100:103], v[48:63]
    ds_read_b128 a[88:91], v235 offset:25088
    ds_read_b128 v[206:209], v245 offset:1488
    v_fmac_f32_dpp v199, v187, v106 row_newbcast:5 row_mask:0xf bank_mask:0xf
    v_fmac_f32_dpp v201, v187, v107 row_newbcast:7 row_mask:0xf bank_mask:0xf
    v_fmac_f32_dpp v194, v187, v210 row_newbcast:0 row_mask:0xf bank_mask:0xf
    v_fmac_f32_dpp v196, v187, v211 row_newbcast:2 row_mask:0xf bank_mask:0xf
    v_mfma_f32_32x32x16_bf16 v[64:79], a[112:115], v[100:103], v[64:79]
    ds_read_b128 a[92:95], v238 offset:23040
    v_fmac_f32_dpp v198, v187, v212 row_newbcast:4 row_mask:0xf bank_mask:0xf
    v_fmac_f32_dpp v200, v187, v213 row_newbcast:6 row_mask:0xf bank_mask:0xf
    v_cvt_pk_bf16_f32 v104, v194, v195
    s_add_u32 m0, s43, 122880
    s_add_u32 s4, s42, 122880
    buffer_load_dwordx4 v244, s[16:19], s4 offen lds
    v_mfma_f32_32x32x16_bf16 v[80:95], a[116:119], a[124:127], v[80:95]
    ds_read_b128 a[96:99], v241 offset:23040
    v_cvt_pk_bf16_f32 v105, v196, v197
    v_cvt_pk_bf16_f32 v106, v198, v199
    v_cvt_pk_bf16_f32 v107, v200, v201
    s_waitcnt lgkmcnt(5)
    s_nop 0
    v_mfma_f32_32x32x16_bf16 v[16:31], a[80:83], v[104:107], v[16:31]
    ds_read_b128 a[100:103], v235 offset:26880
    ds_read_b128 a[124:127], v243 offset:11776
    s_waitcnt vmcnt(11)
    v_lshlrev_b32 v210, 16, v108
    v_lshlrev_b32 v211, 16, v109
    v_lshlrev_b32 v212, 16, v110
    buffer_load_dwordx4 v[132:135], v244, s[16:19], s3 offen offset:1024
    v_mfma_f32_32x32x16_bf16 v[32:47], a[84:87], v[104:107], v[32:47]
    ds_read_b128 a[104:107], v235 offset:27904
    ds_read_b128 v[194:197], v245 offset:1536
    v_lshlrev_b32 v213, 16, v111
    s_waitcnt lgkmcnt(8)
    v_fmac_f32_dpp v203, v187, v108 row_newbcast:9 row_mask:0xf bank_mask:0xf
    v_fmac_f32_dpp v205, v187, v109 row_newbcast:11 row_mask:0xf bank_mask:0xf
    s_waitcnt lgkmcnt(4)
    v_mfma_f32_32x32x16_bf16 v[48:63], a[88:91], v[104:107], v[48:63]
    ds_read_b128 a[108:111], v235 offset:28928
    ds_read_b128 v[198:201], v245 offset:1552
    v_fmac_f32_dpp v207, v187, v110 row_newbcast:13 row_mask:0xf bank_mask:0xf
    v_fmac_f32_dpp v209, v187, v111 row_newbcast:15 row_mask:0xf bank_mask:0xf
    v_fmac_f32_dpp v202, v187, v210 row_newbcast:8 row_mask:0xf bank_mask:0xf
    v_fmac_f32_dpp v204, v187, v211 row_newbcast:10 row_mask:0xf bank_mask:0xf
    v_mfma_f32_32x32x16_bf16 v[64:79], a[92:95], v[104:107], v[64:79]
    ds_read_b128 a[112:115], v238 offset:26880
    v_fmac_f32_dpp v206, v187, v212 row_newbcast:12 row_mask:0xf bank_mask:0xf
    v_fmac_f32_dpp v208, v187, v213 row_newbcast:14 row_mask:0xf bank_mask:0xf
    v_cvt_pk_bf16_f32 v108, v202, v203
    s_add_u32 m0, s43, 126976
    s_add_u32 s4, s42, 126976
    buffer_load_dwordx4 v244, s[16:19], s4 offen lds
    v_mfma_f32_32x32x16_bf16 v[80:95], a[96:99], a[120:123], v[80:95]
    ds_read_b128 a[116:119], v241 offset:26880
    v_cvt_pk_bf16_f32 v109, v204, v205
    v_cvt_pk_bf16_f32 v110, v206, v207
    v_cvt_pk_bf16_f32 v111, v208, v209
    s_waitcnt lgkmcnt(5)
    s_nop 0
    v_mfma_f32_32x32x16_bf16 v[16:31], a[100:103], v[108:111], v[16:31]
    ds_read_b128 a[80:83], v235 offset:30720
    ds_read_b128 a[120:123], v243 offset:12288
    s_waitcnt vmcnt(11)
    v_lshlrev_b32 v210, 16, v112
    v_lshlrev_b32 v211, 16, v113
    v_lshlrev_b32 v212, 16, v114
    buffer_load_dwordx4 v[96:99], v244, s[16:19], s3 offen offset:2048
    v_mfma_f32_32x32x16_bf16 v[32:47], a[104:107], v[108:111], v[32:47]
    ds_read_b128 a[84:87], v235 offset:31744
    ds_read_b128 v[202:205], v245 offset:1600
    v_lshlrev_b32 v213, 16, v115
    s_waitcnt lgkmcnt(8)
    v_fmac_f32_dpp v195, v188, v112 row_newbcast:1 row_mask:0xf bank_mask:0xf
    v_fmac_f32_dpp v197, v188, v113 row_newbcast:3 row_mask:0xf bank_mask:0xf
    s_waitcnt lgkmcnt(4)
    v_mfma_f32_32x32x16_bf16 v[48:63], a[108:111], v[108:111], v[48:63]
    ds_read_b128 a[88:91], v235 offset:32768
    ds_read_b128 v[206:209], v245 offset:1616
    v_fmac_f32_dpp v199, v188, v114 row_newbcast:5 row_mask:0xf bank_mask:0xf
    v_fmac_f32_dpp v201, v188, v115 row_newbcast:7 row_mask:0xf bank_mask:0xf
    v_fmac_f32_dpp v194, v188, v210 row_newbcast:0 row_mask:0xf bank_mask:0xf
    v_fmac_f32_dpp v196, v188, v211 row_newbcast:2 row_mask:0xf bank_mask:0xf
    v_mfma_f32_32x32x16_bf16 v[64:79], a[112:115], v[108:111], v[64:79]
    ds_read_b128 a[92:95], v238 offset:30720
    v_fmac_f32_dpp v198, v188, v212 row_newbcast:4 row_mask:0xf bank_mask:0xf
    v_fmac_f32_dpp v200, v188, v213 row_newbcast:6 row_mask:0xf bank_mask:0xf
    v_cvt_pk_bf16_f32 v112, v194, v195
    s_add_u32 m0, s43, 131072
    s_add_u32 s4, s42, 131072
    buffer_load_dwordx4 v244, s[16:19], s4 offen lds
    v_mfma_f32_32x32x16_bf16 v[80:95], a[116:119], a[124:127], v[80:95]
    ds_read_b128 a[96:99], v241 offset:30720
    v_cvt_pk_bf16_f32 v113, v196, v197
    v_cvt_pk_bf16_f32 v114, v198, v199
    v_cvt_pk_bf16_f32 v115, v200, v201
    s_waitcnt lgkmcnt(5)
    s_nop 0
    v_mfma_f32_32x32x16_bf16 v[16:31], a[80:83], v[112:115], v[16:31]
    ds_read_b128 a[100:103], v235 offset:34560
    ds_read_b128 a[124:127], v243 offset:12800
    s_waitcnt vmcnt(11)
    v_lshlrev_b32 v210, 16, v116
    v_lshlrev_b32 v211, 16, v117
    v_lshlrev_b32 v212, 16, v118
    buffer_load_dwordx4 v[100:103], v244, s[16:19], s3 offen offset:3072
    v_mfma_f32_32x32x16_bf16 v[32:47], a[84:87], v[112:115], v[32:47]
    ds_read_b128 a[104:107], v235 offset:35584
    ds_read_b128 v[194:197], v245 offset:1664
    v_lshlrev_b32 v213, 16, v119
    s_waitcnt lgkmcnt(8)
    v_fmac_f32_dpp v203, v188, v116 row_newbcast:9 row_mask:0xf bank_mask:0xf
    v_fmac_f32_dpp v205, v188, v117 row_newbcast:11 row_mask:0xf bank_mask:0xf
    s_waitcnt lgkmcnt(4)
    v_mfma_f32_32x32x16_bf16 v[48:63], a[88:91], v[112:115], v[48:63]
    ds_read_b128 a[108:111], v235 offset:36608
    ds_read_b128 v[198:201], v245 offset:1680
    v_fmac_f32_dpp v207, v188, v118 row_newbcast:13 row_mask:0xf bank_mask:0xf
    v_fmac_f32_dpp v209, v188, v119 row_newbcast:15 row_mask:0xf bank_mask:0xf
    v_fmac_f32_dpp v202, v188, v210 row_newbcast:8 row_mask:0xf bank_mask:0xf
    v_fmac_f32_dpp v204, v188, v211 row_newbcast:10 row_mask:0xf bank_mask:0xf
    v_mfma_f32_32x32x16_bf16 v[64:79], a[92:95], v[112:115], v[64:79]
    ds_read_b128 a[112:115], v238 offset:34560
    v_fmac_f32_dpp v206, v188, v212 row_newbcast:12 row_mask:0xf bank_mask:0xf
    v_fmac_f32_dpp v208, v188, v213 row_newbcast:14 row_mask:0xf bank_mask:0xf
    v_cvt_pk_bf16_f32 v116, v202, v203
    s_min_u32 s5, s34, 2
    s_lshl_b32 s5, s5, 10
    s_sub_u32 s4, s42, s43
    s_add_u32 s4, s4, s5
    s_add_u32 m0, s5, 135168
    s_add_u32 s4, s4, 135168
    buffer_load_dwordx4 v244, s[16:19], s4 offen lds
    v_mfma_f32_32x32x16_bf16 v[80:95], a[96:99], a[120:123], v[80:95]
    ds_read_b128 a[116:119], v241 offset:34560
    v_cvt_pk_bf16_f32 v117, v204, v205
    v_cvt_pk_bf16_f32 v118, v206, v207
    v_cvt_pk_bf16_f32 v119, v208, v209
    s_waitcnt lgkmcnt(5)
    s_nop 0
    v_mfma_f32_32x32x16_bf16 v[16:31], a[100:103], v[116:119], v[16:31]
    s_waitcnt vmcnt(10)
    s_barrier
    ds_read_b128 a[80:83], v235 offset:38400
    ds_read_b128 a[120:123], v243 offset:13312
    v_lshlrev_b32 v210, 16, v120
    v_lshlrev_b32 v211, 16, v121
    v_lshlrev_b32 v212, 16, v122
    s_add_u32 s3, s40, 32768
    buffer_load_dwordx4 v[104:107], v244, s[16:19], s3 offen offset:0
    v_mfma_f32_32x32x16_bf16 v[32:47], a[104:107], v[116:119], v[32:47]
    ds_read_b128 a[84:87], v235 offset:39424
    ds_read_b128 v[202:205], v245 offset:1728
    v_lshlrev_b32 v213, 16, v123
    s_waitcnt lgkmcnt(8)
    v_fmac_f32_dpp v195, v189, v120 row_newbcast:1 row_mask:0xf bank_mask:0xf
    v_fmac_f32_dpp v197, v189, v121 row_newbcast:3 row_mask:0xf bank_mask:0xf
    s_waitcnt lgkmcnt(4)
    v_mfma_f32_32x32x16_bf16 v[48:63], a[108:111], v[116:119], v[48:63]
    ds_read_b128 a[88:91], v235 offset:40448
    ds_read_b128 v[206:209], v245 offset:1744
    v_fmac_f32_dpp v199, v189, v122 row_newbcast:5 row_mask:0xf bank_mask:0xf
    v_fmac_f32_dpp v201, v189, v123 row_newbcast:7 row_mask:0xf bank_mask:0xf
    v_fmac_f32_dpp v194, v189, v210 row_newbcast:0 row_mask:0xf bank_mask:0xf
    v_fmac_f32_dpp v196, v189, v211 row_newbcast:2 row_mask:0xf bank_mask:0xf
    v_mfma_f32_32x32x16_bf16 v[64:79], a[112:115], v[116:119], v[64:79]
    ds_read_b128 a[92:95], v238 offset:38400
    v_fmac_f32_dpp v198, v189, v212 row_newbcast:4 row_mask:0xf bank_mask:0xf
    v_fmac_f32_dpp v200, v189, v213 row_newbcast:6 row_mask:0xf bank_mask:0xf
    v_cvt_pk_bf16_f32 v120, v194, v195
    v_mfma_f32_32x32x16_bf16 v[80:95], a[116:119], a[124:127], v[80:95]
    ds_read_b128 a[96:99], v241 offset:38400
    v_cvt_pk_bf16_f32 v121, v196, v197
    v_cvt_pk_bf16_f32 v122, v198, v199
    v_cvt_pk_bf16_f32 v123, v200, v201
    s_waitcnt lgkmcnt(5)
    s_nop 0
    v_mfma_f32_32x32x16_bf16 v[16:31], a[80:83], v[120:123], v[16:31]
    ds_read_b128 a[100:103], v235 offset:42240
    ds_read_b128 a[124:127], v243 offset:13824
    s_waitcnt vmcnt(10)
    v_lshlrev_b32 v210, 16, v124
    v_lshlrev_b32 v211, 16, v125
    v_lshlrev_b32 v212, 16, v126
    buffer_load_dwordx4 v[108:111], v244, s[16:19], s3 offen offset:1024
    v_mfma_f32_32x32x16_bf16 v[32:47], a[84:87], v[120:123], v[32:47]
    ds_read_b128 a[104:107], v235 offset:43264
    ds_read_b128 v[194:197], v245 offset:1792
    v_lshlrev_b32 v213, 16, v127
    s_waitcnt lgkmcnt(8)
    v_fmac_f32_dpp v203, v189, v124 row_newbcast:9 row_mask:0xf bank_mask:0xf
    v_fmac_f32_dpp v205, v189, v125 row_newbcast:11 row_mask:0xf bank_mask:0xf
    s_waitcnt lgkmcnt(4)
    v_mfma_f32_32x32x16_bf16 v[48:63], a[88:91], v[120:123], v[48:63]
    ds_read_b128 a[108:111], v235 offset:44288
    ds_read_b128 v[198:201], v245 offset:1808
    v_fmac_f32_dpp v207, v189, v126 row_newbcast:13 row_mask:0xf bank_mask:0xf
    v_fmac_f32_dpp v209, v189, v127 row_newbcast:15 row_mask:0xf bank_mask:0xf
    v_fmac_f32_dpp v202, v189, v210 row_newbcast:8 row_mask:0xf bank_mask:0xf
    v_fmac_f32_dpp v204, v189, v211 row_newbcast:10 row_mask:0xf bank_mask:0xf
    v_mfma_f32_32x32x16_bf16 v[64:79], a[92:95], v[120:123], v[64:79]
    ds_read_b128 a[112:115], v238 offset:42240
    v_fmac_f32_dpp v206, v189, v212 row_newbcast:12 row_mask:0xf bank_mask:0xf
    v_fmac_f32_dpp v208, v189, v213 row_newbcast:14 row_mask:0xf bank_mask:0xf
    v_cvt_pk_bf16_f32 v124, v202, v203
    v_mfma_f32_32x32x16_bf16 v[80:95], a[96:99], a[120:123], v[80:95]
    ds_read_b128 a[116:119], v241 offset:42240
    v_cvt_pk_bf16_f32 v125, v204, v205
    v_cvt_pk_bf16_f32 v126, v206, v207
    v_cvt_pk_bf16_f32 v127, v208, v209
    s_waitcnt lgkmcnt(5)
    s_nop 0
    v_mfma_f32_32x32x16_bf16 v[16:31], a[100:103], v[124:127], v[16:31]
    ds_read_b128 a[80:83], v235 offset:46080
    ds_read_b128 a[120:123], v243 offset:14336
    s_waitcnt vmcnt(9)
    v_lshlrev_b32 v210, 16, v128
    v_lshlrev_b32 v211, 16, v129
    v_lshlrev_b32 v212, 16, v130
    buffer_load_dwordx4 v[112:115], v244, s[16:19], s3 offen offset:2048
    v_mfma_f32_32x32x16_bf16 v[32:47], a[104:107], v[124:127], v[32:47]
    ds_read_b128 a[84:87], v235 offset:47104
    ds_read_b128 v[202:205], v245 offset:1856
    v_lshlrev_b32 v213, 16, v131
    s_waitcnt lgkmcnt(8)
    v_fmac_f32_dpp v195, v190, v128 row_newbcast:1 row_mask:0xf bank_mask:0xf
    v_fmac_f32_dpp v197, v190, v129 row_newbcast:3 row_mask:0xf bank_mask:0xf
    s_waitcnt lgkmcnt(4)
    v_mfma_f32_32x32x16_bf16 v[48:63], a[108:111], v[124:127], v[48:63]
    ds_read_b128 a[88:91], v235 offset:48128
    ds_read_b128 v[206:209], v245 offset:1872
    v_fmac_f32_dpp v199, v190, v130 row_newbcast:5 row_mask:0xf bank_mask:0xf
    v_fmac_f32_dpp v201, v190, v131 row_newbcast:7 row_mask:0xf bank_mask:0xf
    v_fmac_f32_dpp v194, v190, v210 row_newbcast:0 row_mask:0xf bank_mask:0xf
    v_fmac_f32_dpp v196, v190, v211 row_newbcast:2 row_mask:0xf bank_mask:0xf
    v_mfma_f32_32x32x16_bf16 v[64:79], a[112:115], v[124:127], v[64:79]
    ds_read_b128 a[92:95], v238 offset:46080
    v_fmac_f32_dpp v198, v190, v212 row_newbcast:4 row_mask:0xf bank_mask:0xf
    v_fmac_f32_dpp v200, v190, v213 row_newbcast:6 row_mask:0xf bank_mask:0xf
    v_cvt_pk_bf16_f32 v128, v194, v195
    v_mfma_f32_32x32x16_bf16 v[80:95], a[116:119], a[124:127], v[80:95]
    ds_read_b128 a[96:99], v241 offset:46080
    v_cvt_pk_bf16_f32 v129, v196, v197
    v_cvt_pk_bf16_f32 v130, v198, v199
    v_cvt_pk_bf16_f32 v131, v200, v201
    s_waitcnt lgkmcnt(5)
    s_nop 0
    v_mfma_f32_32x32x16_bf16 v[16:31], a[80:83], v[128:131], v[16:31]
    ds_read_b128 a[100:103], v235 offset:49920
    ds_read_b128 a[124:127], v243 offset:14848
    s_waitcnt vmcnt(8)
    v_lshlrev_b32 v210, 16, v132
    v_lshlrev_b32 v211, 16, v133
    v_lshlrev_b32 v212, 16, v134
    buffer_load_dwordx4 v[116:119], v244, s[16:19], s3 offen offset:3072
    v_mfma_f32_32x32x16_bf16 v[32:47], a[84:87], v[128:131], v[32:47]
    ds_read_b128 a[104:107], v235 offset:50944
    ds_read_b128 v[194:197], v245 offset:1920
    v_lshlrev_b32 v213, 16, v135
    s_waitcnt lgkmcnt(8)
    v_fmac_f32_dpp v203, v190, v132 row_newbcast:9 row_mask:0xf bank_mask:0xf
    v_fmac_f32_dpp v205, v190, v133 row_newbcast:11 row_mask:0xf bank_mask:0xf
    s_waitcnt lgkmcnt(4)
    v_mfma_f32_32x32x16_bf16 v[48:63], a[88:91], v[128:131], v[48:63]
    ds_read_b128 a[108:111], v235 offset:51968
    ds_read_b128 v[198:201], v245 offset:1936
    v_fmac_f32_dpp v207, v190, v134 row_newbcast:13 row_mask:0xf bank_mask:0xf
    v_fmac_f32_dpp v209, v190, v135 row_newbcast:15 row_mask:0xf bank_mask:0xf
    v_fmac_f32_dpp v202, v190, v210 row_newbcast:8 row_mask:0xf bank_mask:0xf
    v_fmac_f32_dpp v204, v190, v211 row_newbcast:10 row_mask:0xf bank_mask:0xf
    v_mfma_f32_32x32x16_bf16 v[64:79], a[92:95], v[128:131], v[64:79]
    ds_read_b128 a[112:115], v238 offset:49920
    v_fmac_f32_dpp v206, v190, v212 row_newbcast:12 row_mask:0xf bank_mask:0xf
    v_fmac_f32_dpp v208, v190, v213 row_newbcast:14 row_mask:0xf bank_mask:0xf
    v_cvt_pk_bf16_f32 v132, v202, v203
    v_mfma_f32_32x32x16_bf16 v[80:95], a[96:99], a[120:123], v[80:95]
    ds_read_b128 a[116:119], v241 offset:49920
    v_cvt_pk_bf16_f32 v133, v204, v205
    v_cvt_pk_bf16_f32 v134, v206, v207
    v_cvt_pk_bf16_f32 v135, v208, v209
    s_waitcnt lgkmcnt(5)
    s_nop 0
    v_mfma_f32_32x32x16_bf16 v[16:31], a[100:103], v[132:135], v[16:31]
    s_barrier
    ds_read_b128 a[80:83], v235 offset:53760
    ds_read_b128 a[120:123], v243 offset:15360
    s_waitcnt vmcnt(7)
    v_lshlrev_b32 v210, 16, v96
    v_lshlrev_b32 v211, 16, v97
    v_lshlrev_b32 v212, 16, v98
    v_mfma_f32_32x32x16_bf16 v[32:47], a[104:107], v[132:135], v[32:47]
    ds_read_b128 a[84:87], v235 offset:54784
    ds_read_b128 v[202:205], v245 offset:1984
    v_lshlrev_b32 v213, 16, v99
    s_waitcnt lgkmcnt(8)
    v_fmac_f32_dpp v195, v191, v96 row_newbcast:1 row_mask:0xf bank_mask:0xf
    v_fmac_f32_dpp v197, v191, v97 row_newbcast:3 row_mask:0xf bank_mask:0xf
    s_waitcnt lgkmcnt(4)
    v_mfma_f32_32x32x16_bf16 v[48:63], a[108:111], v[132:135], v[48:63]
    ds_read_b128 a[88:91], v235 offset:55808
    ds_read_b128 v[206:209], v245 offset:2000
    v_fmac_f32_dpp v199, v191, v98 row_newbcast:5 row_mask:0xf bank_mask:0xf
    v_fmac_f32_dpp v201, v191, v99 row_newbcast:7 row_mask:0xf bank_mask:0xf
    v_fmac_f32_dpp v194, v191, v210 row_newbcast:0 row_mask:0xf bank_mask:0xf
    v_fmac_f32_dpp v196, v191, v211 row_newbcast:2 row_mask:0xf bank_mask:0xf
    v_mfma_f32_32x32x16_bf16 v[64:79], a[112:115], v[132:135], v[64:79]
    ds_read_b128 a[92:95], v238 offset:53760
    v_fmac_f32_dpp v198, v191, v212 row_newbcast:4 row_mask:0xf bank_mask:0xf
    v_fmac_f32_dpp v200, v191, v213 row_newbcast:6 row_mask:0xf bank_mask:0xf
    v_cvt_pk_bf16_f32 v96, v194, v195
    v_mfma_f32_32x32x16_bf16 v[80:95], a[116:119], a[124:127], v[80:95]
    ds_read_b128 a[96:99], v241 offset:53760
    v_cvt_pk_bf16_f32 v97, v196, v197
    v_cvt_pk_bf16_f32 v98, v198, v199
    v_cvt_pk_bf16_f32 v99, v200, v201
    s_waitcnt lgkmcnt(5)
    s_nop 0
    v_mfma_f32_32x32x16_bf16 v[16:31], a[80:83], v[96:99], v[16:31]
    ds_read_b128 a[100:103], v235 offset:57600
    ds_read_b128 a[124:127], v243 offset:15872
    s_waitcnt vmcnt(5)
    v_lshlrev_b32 v210, 16, v100
    v_lshlrev_b32 v211, 16, v101
    v_lshlrev_b32 v212, 16, v102
    v_mfma_f32_32x32x16_bf16 v[32:47], a[84:87], v[96:99], v[32:47]
    ds_read_b128 a[104:107], v235 offset:58624
    ds_read_b128 v[194:197], v245 offset:2048
    v_lshlrev_b32 v213, 16, v103
    s_waitcnt lgkmcnt(8)
    v_fmac_f32_dpp v203, v191, v100 row_newbcast:9 row_mask:0xf bank_mask:0xf
    v_fmac_f32_dpp v205, v191, v101 row_newbcast:11 row_mask:0xf bank_mask:0xf
    s_waitcnt lgkmcnt(4)
    v_mfma_f32_32x32x16_bf16 v[48:63], a[88:91], v[96:99], v[48:63]
    ds_read_b128 a[108:111], v235 offset:59648
    ds_read_b128 v[198:201], v245 offset:2064
    v_fmac_f32_dpp v207, v191, v102 row_newbcast:13 row_mask:0xf bank_mask:0xf
    v_fmac_f32_dpp v209, v191, v103 row_newbcast:15 row_mask:0xf bank_mask:0xf
    v_fmac_f32_dpp v202, v191, v210 row_newbcast:8 row_mask:0xf bank_mask:0xf
    v_fmac_f32_dpp v204, v191, v211 row_newbcast:10 row_mask:0xf bank_mask:0xf
    v_mfma_f32_32x32x16_bf16 v[64:79], a[92:95], v[96:99], v[64:79]
    ds_read_b128 a[112:115], v238 offset:57600
    v_fmac_f32_dpp v206, v191, v212 row_newbcast:12 row_mask:0xf bank_mask:0xf
    v_fmac_f32_dpp v208, v191, v213 row_newbcast:14 row_mask:0xf bank_mask:0xf
    v_cvt_pk_bf16_f32 v100, v202, v203
    s_mov_b32 exec_lo, 262143
    s_mov_b32 exec_hi, 0
    buffer_load_dword v13, v254, s[8:11], s91 offen
    buffer_load_dword v13, v254, s[12:15], s91 offen offset:1024
    s_mov_b64 exec, -1
    v_mfma_f32_32x32x16_bf16 v[80:95], a[96:99], a[120:123], v[80:95]
    ds_read_b128 a[116:119], v241 offset:57600
    v_cvt_pk_bf16_f32 v101, v204, v205
    v_cvt_pk_bf16_f32 v102, v206, v207
    v_cvt_pk_bf16_f32 v103, v208, v209
    s_waitcnt lgkmcnt(5)
    s_nop 0
    v_mfma_f32_32x32x16_bf16 v[16:31], a[100:103], v[100:103], v[16:31]
    ds_read_b128 a[80:83], v236 offset:0
    ds_read_b128 a[120:123], v243 offset:16384
    s_waitcnt vmcnt(5)
    v_lshlrev_b32 v210, 16, v104
    v_lshlrev_b32 v211, 16, v105
    v_lshlrev_b32 v212, 16, v106
    v_mfma_f32_32x32x16_bf16 v[32:47], a[104:107], v[100:103], v[32:47]
    ds_read_b128 a[84:87], v236 offset:1024
    ds_read_b128 v[202:205], v245 offset:2112
    v_lshlrev_b32 v213, 16, v107
    s_waitcnt lgkmcnt(8)
    v_fmac_f32_dpp v195, v192, v104 row_newbcast:1 row_mask:0xf bank_mask:0xf
    v_fmac_f32_dpp v197, v192, v105 row_newbcast:3 row_mask:0xf bank_mask:0xf
    s_waitcnt lgkmcnt(4)
    v_mfma_f32_32x32x16_bf16 v[48:63], a[108:111], v[100:103], v[48:63]
    ds_read_b128 a[88:91], v236 offset:2048
    ds_read_b128 v[206:209], v245 offset:2128
    v_fmac_f32_dpp v199, v192, v106 row_newbcast:5 row_mask:0xf bank_mask:0xf
    v_fmac_f32_dpp v201, v192, v107 row_newbcast:7 row_mask:0xf bank_mask:0xf
    v_fmac_f32_dpp v194, v192, v210 row_newbcast:0 row_mask:0xf bank_mask:0xf
    v_fmac_f32_dpp v196, v192, v211 row_newbcast:2 row_mask:0xf bank_mask:0xf
    v_mfma_f32_32x32x16_bf16 v[64:79], a[112:115], v[100:103], v[64:79]
    ds_read_b128 a[92:95], v239 offset:0
    v_fmac_f32_dpp v198, v192, v212 row_newbcast:4 row_mask:0xf bank_mask:0xf
    v_fmac_f32_dpp v200, v192, v213 row_newbcast:6 row_mask:0xf bank_mask:0xf
    v_cvt_pk_bf16_f32 v104, v194, v195
    v_mfma_f32_32x32x16_bf16 v[80:95], a[116:119], a[124:127], v[80:95]
    ds_read_b128 a[96:99], v242 offset:0
    v_cvt_pk_bf16_f32 v105, v196, v197
    v_cvt_pk_bf16_f32 v106, v198, v199
    v_cvt_pk_bf16_f32 v107, v200, v201
    s_waitcnt lgkmcnt(5)
    s_nop 0
    v_mfma_f32_32x32x16_bf16 v[16:31], a[80:83], v[104:107], v[16:31]
    s_barrier
    ds_read_b128 a[100:103], v236 offset:3840
    ds_read_b128 a[124:127], v243 offset:16896
    s_waitcnt vmcnt(4)
    v_lshlrev_b32 v210, 16, v108
    v_lshlrev_b32 v211, 16, v109
    v_lshlrev_b32 v212, 16, v110
    v_mfma_f32_32x32x16_bf16 v[32:47], a[84:87], v[104:107], v[32:47]
    ds_read_b128 a[104:107], v236 offset:4864
    ds_read_b128 v[194:197], v245 offset:2176
    v_lshlrev_b32 v213, 16, v111
    s_waitcnt lgkmcnt(8)
    v_fmac_f32_dpp v203, v192, v108 row_newbcast:9 row_mask:0xf bank_mask:0xf
    v_fmac_f32_dpp v205, v192, v109 row_newbcast:11 row_mask:0xf bank_mask:0xf
    s_waitcnt lgkmcnt(4)
    v_mfma_f32_32x32x16_bf16 v[48:63], a[88:91], v[104:107], v[48:63]
    ds_read_b128 a[108:111], v236 offset:5888
    ds_read_b128 v[198:201], v245 offset:2192
    v_fmac_f32_dpp v207, v192, v110 row_newbcast:13 row_mask:0xf bank_mask:0xf
    v_fmac_f32_dpp v209, v192, v111 row_newbcast:15 row_mask:0xf bank_mask:0xf
    v_fmac_f32_dpp v202, v192, v210 row_newbcast:8 row_mask:0xf bank_mask:0xf
    v_fmac_f32_dpp v204, v192, v211 row_newbcast:10 row_mask:0xf bank_mask:0xf
    v_mfma_f32_32x32x16_bf16 v[64:79], a[92:95], v[104:107], v[64:79]
    ds_read_b128 a[112:115], v239 offset:3840
    v_fmac_f32_dpp v206, v192, v212 row_newbcast:12 row_mask:0xf bank_mask:0xf
    v_fmac_f32_dpp v208, v192, v213 row_newbcast:14 row_mask:0xf bank_mask:0xf
    v_cvt_pk_bf16_f32 v108, v202, v203
    v_mfma_f32_32x32x16_bf16 v[80:95], a[96:99], a[120:123], v[80:95]
    ds_read_b128 a[116:119], v242 offset:3840
    v_cvt_pk_bf16_f32 v109, v204, v205
    v_cvt_pk_bf16_f32 v110, v206, v207
    v_cvt_pk_bf16_f32 v111, v208, v209
    s_waitcnt lgkmcnt(5)
    s_nop 0
    v_mfma_f32_32x32x16_bf16 v[16:31], a[100:103], v[108:111], v[16:31]
    ds_read_b128 a[80:83], v236 offset:7680
    ds_read_b128 a[120:123], v243 offset:17408
    s_waitcnt vmcnt(3)
    v_lshlrev_b32 v210, 16, v112
    v_lshlrev_b32 v211, 16, v113
    v_lshlrev_b32 v212, 16, v114
    v_mfma_f32_32x32x16_bf16 v[32:47], a[104:107], v[108:111], v[32:47]
    ds_read_b128 a[84:87], v236 offset:8704
    ds_read_b128 v[202:205], v245 offset:2240
    v_lshlrev_b32 v213, 16, v115
    s_waitcnt lgkmcnt(8)
    v_fmac_f32_dpp v195, v193, v112 row_newbcast:1 row_mask:0xf bank_mask:0xf
    v_fmac_f32_dpp v197, v193, v113 row_newbcast:3 row_mask:0xf bank_mask:0xf
    s_waitcnt lgkmcnt(4)
    v_mfma_f32_32x32x16_bf16 v[48:63], a[108:111], v[108:111], v[48:63]
    ds_read_b128 a[88:91], v236 offset:9728
    ds_read_b128 v[206:209], v245 offset:2256
    v_fmac_f32_dpp v199, v193, v114 row_newbcast:5 row_mask:0xf bank_mask:0xf
    v_fmac_f32_dpp v201, v193, v115 row_newbcast:7 row_mask:0xf bank_mask:0xf
    v_fmac_f32_dpp v194, v193, v210 row_newbcast:0 row_mask:0xf bank_mask:0xf
    v_fmac_f32_dpp v196, v193, v211 row_newbcast:2 row_mask:0xf bank_mask:0xf
    v_mfma_f32_32x32x16_bf16 v[64:79], a[112:115], v[108:111], v[64:79]
    ds_read_b128 a[92:95], v239 offset:7680
    v_fmac_f32_dpp v198, v193, v212 row_newbcast:4 row_mask:0xf bank_mask:0xf
    v_fmac_f32_dpp v200, v193, v213 row_newbcast:6 row_mask:0xf bank_mask:0xf
    v_cvt_pk_bf16_f32 v112, v194, v195
    v_mfma_f32_32x32x16_bf16 v[80:95], a[116:119], a[124:127], v[80:95]
    ds_read_b128 a[96:99], v242 offset:7680
    v_cvt_pk_bf16_f32 v113, v196, v197
    v_cvt_pk_bf16_f32 v114, v198, v199
    v_cvt_pk_bf16_f32 v115, v200, v201
    s_waitcnt lgkmcnt(5)
    s_nop 0
    v_mfma_f32_32x32x16_bf16 v[16:31], a[80:83], v[112:115], v[16:31]
    ds_read_b128 a[100:103], v236 offset:11520
    ds_read_b128 a[124:127], v243 offset:17920
    s_waitcnt vmcnt(2)
    v_lshlrev_b32 v210, 16, v116
    v_lshlrev_b32 v211, 16, v117
    v_lshlrev_b32 v212, 16, v118
    v_mfma_f32_32x32x16_bf16 v[32:47], a[84:87], v[112:115], v[32:47]
    ds_read_b128 a[104:107], v236 offset:12544
    v_lshlrev_b32 v213, 16, v119
    s_waitcnt lgkmcnt(7)
    v_fmac_f32_dpp v203, v193, v116 row_newbcast:9 row_mask:0xf bank_mask:0xf
    v_fmac_f32_dpp v205, v193, v117 row_newbcast:11 row_mask:0xf bank_mask:0xf
    s_waitcnt lgkmcnt(3)
    v_mfma_f32_32x32x16_bf16 v[48:63], a[88:91], v[112:115], v[48:63]
    ds_read_b128 a[108:111], v236 offset:13568
    v_fmac_f32_dpp v207, v193, v118 row_newbcast:13 row_mask:0xf bank_mask:0xf
    v_fmac_f32_dpp v209, v193, v119 row_newbcast:15 row_mask:0xf bank_mask:0xf
    v_fmac_f32_dpp v202, v193, v210 row_newbcast:8 row_mask:0xf bank_mask:0xf
    v_fmac_f32_dpp v204, v193, v211 row_newbcast:10 row_mask:0xf bank_mask:0xf
    v_mfma_f32_32x32x16_bf16 v[64:79], a[92:95], v[112:115], v[64:79]
    ds_read_b128 a[112:115], v239 offset:11520
    v_fmac_f32_dpp v206, v193, v212 row_newbcast:12 row_mask:0xf bank_mask:0xf
    v_fmac_f32_dpp v208, v193, v213 row_newbcast:14 row_mask:0xf bank_mask:0xf
    v_cvt_pk_bf16_f32 v116, v202, v203
    v_mfma_f32_32x32x16_bf16 v[80:95], a[96:99], a[120:123], v[80:95]
    ds_read_b128 a[116:119], v242 offset:11520
    v_cvt_pk_bf16_f32 v117, v204, v205
    v_cvt_pk_bf16_f32 v118, v206, v207
    v_cvt_pk_bf16_f32 v119, v208, v209
    s_waitcnt lgkmcnt(3)
    s_nop 0
    v_mfma_f32_32x32x16_bf16 v[16:31], a[100:103], v[116:119], v[16:31]
    v_mfma_f32_32x32x16_bf16 v[32:47], a[104:107], v[116:119], v[32:47]
    s_waitcnt lgkmcnt(0)
    v_mfma_f32_32x32x16_bf16 v[48:63], a[108:111], v[116:119], v[48:63]
    v_mfma_f32_32x32x16_bf16 v[64:79], a[112:115], v[116:119], v[64:79]
    v_mfma_f32_32x32x16_bf16 v[80:95], a[116:119], a[124:127], v[80:95]
    s_and_b32 s40, s33, 7
    s_mul_i32 s40, s40, 102400
    s_mul_i32 s41, s34, 25600
    s_add_u32 s40, s40, s41
    s_add_u32 s40, s40, 5729536
    s_add_u32 s41, s41, 61440
    v_lshlrev_b32 v8, 4, v1
    v_lshrrev_b32 v4, 5, v1
    v_and_b32 v5, 31, v1
    v_mul_u32_u24 v6, 144, v4
    v_add_u32 v6, v6, v5
    v_mul_u32_u24 v10, 48, v6
    v_mul_u32_u24 v2, 80, v6
    v_add_u32 v2, 13824, v2
    s_mul_i32 s96, s34, 1536
    s_add_u32 s96, s96, 96
    v_add_u32 v250, s96, v10
    s_mul_i32 s96, s34, 2560
    s_add_u32 s96, s96, 160
    v_add_u32 v251, s96, v2
    s_lshl_b32 s96, s32, 2
    s_add_u32 s96, s96, s34
    s_lshl_b32 s96, s96, 5
    v_add_u32 v3, s96, v5
    v_cvt_pk_bf16_f32 v96, v40, v41
    v_cvt_pk_bf16_f32 v97, v42, v43
    v_cvt_pk_bf16_f32 v98, v44, v45
    v_cvt_pk_bf16_f32 v99, v46, v47
    v_cvt_pk_bf16_f32 v100, v48, v49
    v_cvt_pk_bf16_f32 v101, v50, v51
    v_cvt_pk_bf16_f32 v102, v36, v37
    v_cvt_pk_bf16_f32 v103, v38, v39
    v_cvt_pk_bf16_f32 v104, v56, v57
    v_cvt_pk_bf16_f32 v105, v58, v59
    v_mov_b32 v106, 0
    v_mov_b32 v107, 0
    s_barrier
    ds_write_b128 v250, v[96:99] offset:672
    ds_write_b128 v250, v[100:103] offset:688
    ds_write_b128 v250, v[104:107] offset:704
    ds_write_b128 v251, v[64:67] offset:1120
    ds_write_b128 v251, v[52:55] offset:1136
    ds_write_b128 v251, v[72:75] offset:1152
    ds_write_b128 v251, v[60:63] offset:1168
    ds_write_b128 v251, v[68:71] offset:1184
    s_add_u32 m0, s41, 0
    s_add_u32 s42, s40, 0
    buffer_load_dwordx4 v8, s[16:19], s42 offen offset:0 lds
    buffer_load_dwordx4 v8, s[16:19], s42 offen offset:1024 lds
    buffer_load_dwordx4 v8, s[16:19], s42 offen offset:2048 lds
    s_cmp_lg_u32 s34, 1
    s_nop 0
    s_cbranch_scc1 L_skip_6001
    s_mov_b32 exec_lo, 0xffff
    s_mov_b32 exec_hi, 0xffff
    v_cvt_pk_bf16_f32 v118, v88, v89
    v_cvt_pk_bf16_f32 v119, v90, v91
    ds_write_b64 v10, v[118:119] offset:0
    v_cvt_pk_bf16_f32 v120, v92, v93
    v_cvt_pk_bf16_f32 v121, v94, v95
    ds_write_b64 v10, v[120:121] offset:8
    v_cvt_pk_bf16_f32 v124, v84, v85
    v_cvt_pk_bf16_f32 v125, v86, v87
    ds_write_b64 v10, v[124:125] offset:24
    s_mov_b64 exec, -1
    s_nop 2
L_skip_6001:
    s_cmp_lg_u32 s34, 2
    s_nop 0
    s_cbranch_scc1 L_skip_6002
    s_mov_b32 exec_lo, 0xffff
    s_mov_b32 exec_hi, 0xffff
    ds_write_b128 v2, v[84:87] offset:16
    v_cvt_pk_bf16_f32 v122, v80, v81
    v_cvt_pk_bf16_f32 v123, v82, v83
    ds_write_b64 v10, v[122:123] offset:16
    ds_write_b128 v2, v[92:95] offset:48
    v_cvt_pk_bf16_f32 v126, v88, v89
    v_cvt_pk_bf16_f32 v127, v90, v91
    ds_write_b64 v10, v[126:127] offset:32
    s_mov_b64 exec, -1
    s_nop 2
L_skip_6002:
    s_cmp_lg_u32 s34, 3
    s_nop 0
    s_cbranch_scc1 L_skip_6003
    s_mov_b32 exec_lo, 0xffff
    s_mov_b32 exec_hi, 0xffff
    ds_write_b128 v2, v[80:83] offset:0
    ds_write_b128 v2, v[88:91] offset:32
    ds_write_b128 v2, v[84:87] offset:64
    s_mov_b64 exec, -1
    s_nop 0
L_skip_6003:
    v_cndmask_b32 v16, v16, 0, s[36:37]
    v_cndmask_b32 v34, 0, v34, s[36:37]
    v_cndmask_b32 v17, v17, 0, s[36:37]
    v_cndmask_b32 v35, 0, v35, s[36:37]
    v_cvt_pk_bf16_f32 v108, v16, v17
    v_cvt_pk_bf16_f32 v109, v18, v19
    v_cvt_pk_bf16_f32 v110, v20, v21
    v_cvt_pk_bf16_f32 v111, v22, v23
    v_cvt_pk_bf16_f32 v112, v24, v25
    v_cvt_pk_bf16_f32 v113, v26, v27
    v_cvt_pk_bf16_f32 v114, v28, v29
    v_cvt_pk_bf16_f32 v115, v30, v31
    v_cvt_pk_bf16_f32 v116, v32, v33
    v_cvt_pk_bf16_f32 v117, v34, v35
    buffer_load_dwordx4 v8, s[16:19], s42 offen offset:3072 lds
    s_add_u32 m0, s41, 4096
    s_add_u32 s42, s40, 4096
    buffer_load_dwordx4 v8, s[16:19], s42 offen offset:0 lds
    buffer_load_dwordx4 v8, s[16:19], s42 offen offset:1024 lds
    s_waitcnt lgkmcnt(0)
    s_barrier
    ds_read_b128 v[118:121], v250 offset:576
    ds_read_b128 v[122:125], v250 offset:592
    ds_read_b128 v[126:129], v250 offset:608
    ds_read_b128 v[130:133], v250 offset:480
    ds_read_b128 v[134:137], v250 offset:496
    ds_read_b128 v[138:141], v250 offset:512
    ds_read_b128 v[142:145], v250 offset:384
    ds_read_b128 v[146:149], v250 offset:400
    ds_read_b128 v[150:153], v250 offset:416
    ds_read_b128 v[154:157], v250 offset:288
    ds_read_b128 v[158:161], v250 offset:304
    ds_read_b128 v[162:165], v250 offset:320
    ds_read_b128 v[166:169], v250 offset:192
    ds_read_b128 v[170:173], v250 offset:208
    ds_read_b128 v[174:177], v250 offset:224
    ds_read_b128 v[178:181], v250 offset:96
    ds_read_b128 v[182:185], v250 offset:112
    ds_read_b128 v[186:189], v250 offset:128
    ds_read_b128 v[190:193], v250 offset:0
    ds_read_b128 v[194:197], v250 offset:16
    ds_read_b128 v[198:201], v250 offset:32
    v_dot2_f32_bf16 v242, v108, v96, 0
    s_waitcnt lgkmcnt(15)
    v_dot2_f32_bf16 v243, v108, v118, 0
    v_dot2_f32_bf16 v244, v108, v130, 0
    s_waitcnt lgkmcnt(14)
    v_dot2_f32_bf16 v245, v108, v142, 0
    buffer_load_dwordx4 v8, s[16:19], s42 offen offset:2048 lds
    v_dot2_f32_bf16 v242, v109, v97, v242
    v_dot2_f32_bf16 v243, v109, v119, v243
    v_dot2_f32_bf16 v244, v109, v131, v244
    v_dot2_f32_bf16 v245, v109, v143, v245
    v_dot2_f32_bf16 v242, v110, v98, v242
    v_dot2_f32_bf16 v243, v110, v120, v243
    v_dot2_f32_bf16 v244, v110, v132, v244
    v_dot2_f32_bf16 v245, v110, v144, v245
    v_dot2_f32_bf16 v242, v111, v99, v242
    v_dot2_f32_bf16 v243, v111, v121, v243
    v_dot2_f32_bf16 v244, v111, v133, v244
    v_dot2_f32_bf16 v245, v111, v145, v245
    buffer_load_dwordx4 v8, s[16:19], s42 offen offset:3072 lds
    v_dot2_f32_bf16 v242, v112, v100, v242
    v_dot2_f32_bf16 v243, v112, v122, v243
    v_dot2_f32_bf16 v244, v112, v134, v244
    s_waitcnt lgkmcnt(13)
    v_dot2_f32_bf16 v245, v112, v146, v245
    v_dot2_f32_bf16 v242, v113, v101, v242
    v_dot2_f32_bf16 v243, v113, v123, v243
    v_dot2_f32_bf16 v244, v113, v135, v244
    v_dot2_f32_bf16 v245, v113, v147, v245
    v_dot2_f32_bf16 v242, v114, v102, v242
    v_dot2_f32_bf16 v243, v114, v124, v243
    v_dot2_f32_bf16 v244, v114, v136, v244
    v_dot2_f32_bf16 v245, v114, v148, v245
    s_add_u32 m0, s41, 8192
    s_add_u32 s42, s40, 8192
    buffer_load_dwordx4 v8, s[16:19], s42 offen offset:0 lds
    v_dot2_f32_bf16 v242, v115, v103, v242
    v_dot2_f32_bf16 v243, v115, v125, v243
    v_dot2_f32_bf16 v244, v115, v137, v244
    v_dot2_f32_bf16 v245, v115, v149, v245
    v_dot2_f32_bf16 v242, v116, v104, v242
    v_dot2_f32_bf16 v243, v116, v126, v243
    v_dot2_f32_bf16 v244, v116, v138, v244
    s_waitcnt lgkmcnt(12)
    v_dot2_f32_bf16 v245, v116, v150, v245
    v_dot2_f32_bf16 v242, v117, v105, v242
    v_dot2_f32_bf16 v243, v117, v127, v243
    v_dot2_f32_bf16 v244, v117, v139, v244
    v_dot2_f32_bf16 v245, v117, v151, v245
    buffer_load_dwordx4 v8, s[16:19], s42 offen offset:1024 lds
    ds_read_b128 v[16:19], v251 offset:960
    ds_read_b128 v[20:23], v251 offset:976
    ds_read_b128 v[24:27], v251 offset:992
    ds_read_b128 v[28:31], v251 offset:1008
    ds_read_b128 v[32:35], v251 offset:1024
    ds_read_b128 v[36:39], v251 offset:800
    ds_read_b128 v[40:43], v251 offset:816
    ds_read_b128 v[44:47], v251 offset:832
    ds_read_b128 v[48:51], v251 offset:848
    ds_read_b128 v[56:59], v251 offset:864
    ds_read_b128 v[76:79], v251 offset:640
    ds_read_b128 v[80:83], v251 offset:656
    ds_read_b128 v[84:87], v251 offset:672
    ds_read_b128 v[88:91], v251 offset:688
    ds_read_b128 v[92:95], v251 offset:704
    ds_read_b128 v[202:205], v251 offset:480
    ds_read_b128 v[206:209], v251 offset:496
    ds_read_b128 v[210:213], v251 offset:512
    ds_read_b128 v[214:217], v251 offset:528
    ds_read_b128 v[218:221], v251 offset:544
    ds_read_b128 v[222:225], v251 offset:320
    ds_read_b128 v[226:229], v251 offset:336
    ds_read_b128 v[230:233], v251 offset:352
    ds_read_b128 v[234:237], v251 offset:368
    ds_read_b128 v[238:241], v251 offset:384
    s_waitcnt lgkmcnt(15)
    v_dot2_f32_bf16 v246, v108, v154, 0
    v_dot2_f32_bf16 v247, v108, v166, 0
    v_dot2_f32_bf16 v248, v108, v178, 0
    v_dot2_f32_bf16 v249, v108, v190, 0
    buffer_load_dwordx4 v8, s[16:19], s42 offen offset:2048 lds
    v_dot2_f32_bf16 v246, v109, v155, v246
    v_dot2_f32_bf16 v247, v109, v167, v247
    v_dot2_f32_bf16 v248, v109, v179, v248
    v_dot2_f32_bf16 v249, v109, v191, v249
    v_dot2_f32_bf16 v246, v110, v156, v246
    v_dot2_f32_bf16 v247, v110, v168, v247
    v_dot2_f32_bf16 v248, v110, v180, v248
    v_dot2_f32_bf16 v249, v110, v192, v249
    v_dot2_f32_bf16 v246, v111, v157, v246
    v_dot2_f32_bf16 v247, v111, v169, v247
    v_dot2_f32_bf16 v248, v111, v181, v248
    v_dot2_f32_bf16 v249, v111, v193, v249
    buffer_load_dwordx4 v8, s[16:19], s42 offen offset:3072 lds
    v_dot2_f32_bf16 v246, v112, v158, v246
    v_dot2_f32_bf16 v247, v112, v170, v247
    v_dot2_f32_bf16 v248, v112, v182, v248
    v_dot2_f32_bf16 v249, v112, v194, v249
    v_dot2_f32_bf16 v246, v113, v159, v246
    v_dot2_f32_bf16 v247, v113, v171, v247
    v_dot2_f32_bf16 v248, v113, v183, v248
    v_dot2_f32_bf16 v249, v113, v195, v249
    v_dot2_f32_bf16 v246, v114, v160, v246
    v_dot2_f32_bf16 v247, v114, v172, v247
    v_dot2_f32_bf16 v248, v114, v184, v248
    v_dot2_f32_bf16 v249, v114, v196, v249
    s_add_u32 m0, s41, 12288
    s_add_u32 s42, s40, 12288
    buffer_load_dwordx4 v8, s[16:19], s42 offen offset:0 lds
    v_dot2_f32_bf16 v246, v115, v161, v246
    v_dot2_f32_bf16 v247, v115, v173, v247
    v_dot2_f32_bf16 v248, v115, v185, v248
    v_dot2_f32_bf16 v249, v115, v197, v249
    v_dot2_f32_bf16 v246, v116, v162, v246
    v_dot2_f32_bf16 v247, v116, v174, v247
    v_dot2_f32_bf16 v248, v116, v186, v248
    v_dot2_f32_bf16 v249, v116, v198, v249
    v_dot2_f32_bf16 v246, v117, v163, v246
    v_dot2_f32_bf16 v247, v117, v175, v247
    v_dot2_f32_bf16 v248, v117, v187, v248
    v_dot2_f32_bf16 v249, v117, v199, v249
    buffer_load_dwordx4 v8, s[16:19], s42 offen offset:1024 lds
    ds_read_b128 v[120:123], v251 offset:160
    ds_read_b128 v[124:127], v251 offset:176
    ds_read_b128 v[128:131], v251 offset:192
    ds_read_b128 v[132:135], v251 offset:208
    ds_read_b128 v[136:139], v251 offset:224
    ds_read_b128 v[140:143], v251 offset:0
    ds_read_b128 v[144:147], v251 offset:16
    ds_read_b128 v[148:151], v251 offset:32
    ds_read_b128 v[152:155], v251 offset:48
    ds_read_b128 v[156:159], v251 offset:64
    s_mov_b32 s96, 0x3eae1a93
    s_mov_b32 s97, 0xce6e6b28
    v_mul_f32 v242, s96, v242
    v_mul_f32 v243, s96, v243
    v_mul_f32 v244, s96, v244
    v_mul_f32 v245, s96, v245
    v_mul_f32 v246, s96, v246
    v_mul_f32 v247, s96, v247
    v_mul_f32 v248, s96, v248
    v_mul_f32 v249, s96, v249
    s_or_b32 s98, s32, s34
    s_cmp_lg_u32 s98, 0
    s_nop 2
    s_cbranch_scc1 L_skip_6004
    v_mov_b32 v4, s97
    v_cmp_le_u32 vcc, 2, v3
    s_nop 1
    v_cndmask_b32 v243, v4, v243, vcc
    v_cmp_le_u32 vcc, 4, v3
    s_nop 1
    v_cndmask_b32 v244, v4, v244, vcc
    v_cmp_le_u32 vcc, 6, v3
    s_nop 1
    v_cndmask_b32 v245, v4, v245, vcc
    v_cmp_le_u32 vcc, 8, v3
    s_nop 1
    v_cndmask_b32 v246, v4, v246, vcc
    v_cmp_le_u32 vcc, 10, v3
    s_nop 1
    v_cndmask_b32 v247, v4, v247, vcc
    v_cmp_le_u32 vcc, 12, v3
    s_nop 1
    v_cndmask_b32 v248, v4, v248, vcc
    v_cmp_le_u32 vcc, 14, v3
    s_nop 1
    v_cndmask_b32 v249, v4, v249, vcc
    s_nop 4
L_skip_6004:
    v_max3_f32 v4, v242, v243, v244
    v_max3_f32 v5, v245, v246, v247
    v_max3_f32 v4, v4, v248, v249
    v_max_f32 v4, v4, v5
    v_sub_f32 v242, v242, v4
    v_sub_f32 v243, v243, v4
    v_sub_f32 v244, v244, v4
    v_sub_f32 v245, v245, v4
    v_sub_f32 v246, v246, v4
    v_sub_f32 v247, v247, v4
    v_sub_f32 v248, v248, v4
    v_sub_f32 v249, v249, v4
    v_exp_f32 v242, v242
    v_exp_f32 v243, v243
    v_exp_f32 v244, v244
    v_exp_f32 v245, v245
    v_exp_f32 v246, v246
    v_exp_f32 v247, v247
    v_exp_f32 v248, v248
    v_exp_f32 v249, v249
    v_add_f32 v4, v242, v243
    v_add_f32 v5, v244, v245
    v_add_f32 v6, v246, v247
    v_add_f32 v7, v248, v249
    v_add_f32 v4, v4, v5
    v_add_f32 v6, v6, v7
    v_add_f32 v4, v4, v6
    v_rcp_f32 v4, v4
    s_nop 0
    v_mul_f32 v242, v242, v4
    v_mul_f32 v243, v243, v4
    v_mul_f32 v244, v244, v4
    v_mul_f32 v245, v245, v4
    v_mul_f32 v246, v246, v4
    v_mul_f32 v247, v247, v4
    v_mul_f32 v248, v248, v4
    v_mul_f32 v249, v249, v4
    buffer_load_dwordx4 v8, s[16:19], s42 offen offset:2048 lds
    buffer_load_dwordx4 v8, s[16:19], s42 offen offset:3072 lds
    s_add_u32 m0, s41, 16384
    s_add_u32 s42, s40, 16384
    buffer_load_dwordx4 v8, s[16:19], s42 offen offset:0 lds
    buffer_load_dwordx4 v8, s[16:19], s42 offen offset:1024 lds
    v_pk_mul_f32 v[64:65], v[64:65], v[242:243] op_sel_hi:[1,0]
    v_pk_mul_f32 v[66:67], v[66:67], v[242:243] op_sel_hi:[1,0]
    v_pk_mul_f32 v[52:53], v[52:53], v[242:243] op_sel_hi:[1,0]
    v_pk_mul_f32 v[54:55], v[54:55], v[242:243] op_sel_hi:[1,0]
    v_pk_mul_f32 v[72:73], v[72:73], v[242:243] op_sel_hi:[1,0]
    v_pk_mul_f32 v[74:75], v[74:75], v[242:243] op_sel_hi:[1,0]
    v_pk_mul_f32 v[60:61], v[60:61], v[242:243] op_sel_hi:[1,0]
    v_pk_mul_f32 v[62:63], v[62:63], v[242:243] op_sel_hi:[1,0]
    v_pk_mul_f32 v[68:69], v[68:69], v[242:243] op_sel_hi:[1,0]
    v_pk_mul_f32 v[70:71], v[70:71], v[242:243] op_sel_hi:[1,0]
    buffer_load_dwordx4 v8, s[16:19], s42 offen offset:2048 lds
    v_pk_fma_f32 v[64:65], v[16:17], v[242:243], v[64:65] op_sel:[0,1,0] op_sel_hi:[1,1,1]
    v_pk_fma_f32 v[66:67], v[18:19], v[242:243], v[66:67] op_sel:[0,1,0] op_sel_hi:[1,1,1]
    v_pk_fma_f32 v[52:53], v[20:21], v[242:243], v[52:53] op_sel:[0,1,0] op_sel_hi:[1,1,1]
    v_pk_fma_f32 v[54:55], v[22:23], v[242:243], v[54:55] op_sel:[0,1,0] op_sel_hi:[1,1,1]
    v_pk_fma_f32 v[72:73], v[24:25], v[242:243], v[72:73] op_sel:[0,1,0] op_sel_hi:[1,1,1]
    v_pk_fma_f32 v[74:75], v[26:27], v[242:243], v[74:75] op_sel:[0,1,0] op_sel_hi:[1,1,1]
    v_pk_fma_f32 v[60:61], v[28:29], v[242:243], v[60:61] op_sel:[0,1,0] op_sel_hi:[1,1,1]
    v_pk_fma_f32 v[62:63], v[30:31], v[242:243], v[62:63] op_sel:[0,1,0] op_sel_hi:[1,1,1]
    v_pk_fma_f32 v[68:69], v[32:33], v[242:243], v[68:69] op_sel:[0,1,0] op_sel_hi:[1,1,1]
    v_pk_fma_f32 v[70:71], v[34:35], v[242:243], v[70:71] op_sel:[0,1,0] op_sel_hi:[1,1,1]
    buffer_load_dwordx4 v8, s[16:19], s42 offen offset:3072 lds
    v_pk_fma_f32 v[64:65], v[36:37], v[244:245], v[64:65] op_sel_hi:[1,0,1]
    v_pk_fma_f32 v[66:67], v[38:39], v[244:245], v[66:67] op_sel_hi:[1,0,1]
    v_pk_fma_f32 v[52:53], v[40:41], v[244:245], v[52:53] op_sel_hi:[1,0,1]
    v_pk_fma_f32 v[54:55], v[42:43], v[244:245], v[54:55] op_sel_hi:[1,0,1]
    v_pk_fma_f32 v[72:73], v[44:45], v[244:245], v[72:73] op_sel_hi:[1,0,1]
    v_pk_fma_f32 v[74:75], v[46:47], v[244:245], v[74:75] op_sel_hi:[1,0,1]
    v_pk_fma_f32 v[60:61], v[48:49], v[244:245], v[60:61] op_sel_hi:[1,0,1]
    v_pk_fma_f32 v[62:63], v[50:51], v[244:245], v[62:63] op_sel_hi:[1,0,1]
    v_pk_fma_f32 v[68:69], v[56:57], v[244:245], v[68:69] op_sel_hi:[1,0,1]
    v_pk_fma_f32 v[70:71], v[58:59], v[244:245], v[70:71] op_sel_hi:[1,0,1]
    s_add_u32 m0, s41, 20480
    s_add_u32 s42, s40, 20480
    buffer_load_dwordx4 v8, s[16:19], s42 offen offset:0 lds
    s_waitcnt lgkmcnt(15)
    v_pk_fma_f32 v[64:65], v[76:77], v[244:245], v[64:65] op_sel:[0,1,0] op_sel_hi:[1,1,1]
    v_pk_fma_f32 v[66:67], v[78:79], v[244:245], v[66:67] op_sel:[0,1,0] op_sel_hi:[1,1,1]
    v_pk_fma_f32 v[52:53], v[80:81], v[244:245], v[52:53] op_sel:[0,1,0] op_sel_hi:[1,1,1]
    v_pk_fma_f32 v[54:55], v[82:83], v[244:245], v[54:55] op_sel:[0,1,0] op_sel_hi:[1,1,1]
    v_pk_fma_f32 v[72:73], v[84:85], v[244:245], v[72:73] op_sel:[0,1,0] op_sel_hi:[1,1,1]
    v_pk_fma_f32 v[74:75], v[86:87], v[244:245], v[74:75] op_sel:[0,1,0] op_sel_hi:[1,1,1]
    v_pk_fma_f32 v[60:61], v[88:89], v[244:245], v[60:61] op_sel:[0,1,0] op_sel_hi:[1,1,1]
    v_pk_fma_f32 v[62:63], v[90:91], v[244:245], v[62:63] op_sel:[0,1,0] op_sel_hi:[1,1,1]
    v_pk_fma_f32 v[68:69], v[92:93], v[244:245], v[68:69] op_sel:[0,1,0] op_sel_hi:[1,1,1]
    v_pk_fma_f32 v[70:71], v[94:95], v[244:245], v[70:71] op_sel:[0,1,0] op_sel_hi:[1,1,1]
    buffer_load_dwordx4 v8, s[16:19], s42 offen offset:1024 lds
    v_pk_fma_f32 v[64:65], v[202:203], v[246:247], v[64:65] op_sel_hi:[1,0,1]
    v_pk_fma_f32 v[66:67], v[204:205], v[246:247], v[66:67] op_sel_hi:[1,0,1]
    v_pk_fma_f32 v[52:53], v[206:207], v[246:247], v[52:53] op_sel_hi:[1,0,1]
    v_pk_fma_f32 v[54:55], v[208:209], v[246:247], v[54:55] op_sel_hi:[1,0,1]
    v_pk_fma_f32 v[72:73], v[210:211], v[246:247], v[72:73] op_sel_hi:[1,0,1]
    v_pk_fma_f32 v[74:75], v[212:213], v[246:247], v[74:75] op_sel_hi:[1,0,1]
    v_pk_fma_f32 v[60:61], v[214:215], v[246:247], v[60:61] op_sel_hi:[1,0,1]
    v_pk_fma_f32 v[62:63], v[216:217], v[246:247], v[62:63] op_sel_hi:[1,0,1]
    v_pk_fma_f32 v[68:69], v[218:219], v[246:247], v[68:69] op_sel_hi:[1,0,1]
    v_pk_fma_f32 v[70:71], v[220:221], v[246:247], v[70:71] op_sel_hi:[1,0,1]
    buffer_load_dwordx4 v8, s[16:19], s42 offen offset:2048 lds
    s_waitcnt lgkmcnt(14)
    v_pk_fma_f32 v[64:65], v[222:223], v[246:247], v[64:65] op_sel:[0,1,0] op_sel_hi:[1,1,1]
    v_pk_fma_f32 v[66:67], v[224:225], v[246:247], v[66:67] op_sel:[0,1,0] op_sel_hi:[1,1,1]
    s_waitcnt lgkmcnt(13)
    v_pk_fma_f32 v[52:53], v[226:227], v[246:247], v[52:53] op_sel:[0,1,0] op_sel_hi:[1,1,1]
    v_pk_fma_f32 v[54:55], v[228:229], v[246:247], v[54:55] op_sel:[0,1,0] op_sel_hi:[1,1,1]
    s_waitcnt lgkmcnt(12)
    v_pk_fma_f32 v[72:73], v[230:231], v[246:247], v[72:73] op_sel:[0,1,0] op_sel_hi:[1,1,1]
    v_pk_fma_f32 v[74:75], v[232:233], v[246:247], v[74:75] op_sel:[0,1,0] op_sel_hi:[1,1,1]
    s_waitcnt lgkmcnt(11)
    v_pk_fma_f32 v[60:61], v[234:235], v[246:247], v[60:61] op_sel:[0,1,0] op_sel_hi:[1,1,1]
    v_pk_fma_f32 v[62:63], v[236:237], v[246:247], v[62:63] op_sel:[0,1,0] op_sel_hi:[1,1,1]
    s_waitcnt lgkmcnt(10)
    v_pk_fma_f32 v[68:69], v[238:239], v[246:247], v[68:69] op_sel:[0,1,0] op_sel_hi:[1,1,1]
    v_pk_fma_f32 v[70:71], v[240:241], v[246:247], v[70:71] op_sel:[0,1,0] op_sel_hi:[1,1,1]
    buffer_load_dwordx4 v8, s[16:19], s42 offen offset:3072 lds
    s_waitcnt lgkmcnt(9)
    v_pk_fma_f32 v[64:65], v[120:121], v[248:249], v[64:65] op_sel_hi:[1,0,1]
    v_pk_fma_f32 v[66:67], v[122:123], v[248:249], v[66:67] op_sel_hi:[1,0,1]
    s_waitcnt lgkmcnt(8)
    v_pk_fma_f32 v[52:53], v[124:125], v[248:249], v[52:53] op_sel_hi:[1,0,1]
    v_pk_fma_f32 v[54:55], v[126:127], v[248:249], v[54:55] op_sel_hi:[1,0,1]
    s_waitcnt lgkmcnt(7)
    v_pk_fma_f32 v[72:73], v[128:129], v[248:249], v[72:73] op_sel_hi:[1,0,1]
    v_pk_fma_f32 v[74:75], v[130:131], v[248:249], v[74:75] op_sel_hi:[1,0,1]
    s_waitcnt lgkmcnt(6)
    v_pk_fma_f32 v[60:61], v[132:133], v[248:249], v[60:61] op_sel_hi:[1,0,1]
    v_pk_fma_f32 v[62:63], v[134:135], v[248:249], v[62:63] op_sel_hi:[1,0,1]
    s_waitcnt lgkmcnt(5)
    v_pk_fma_f32 v[68:69], v[136:137], v[248:249], v[68:69] op_sel_hi:[1,0,1]
    v_pk_fma_f32 v[70:71], v[138:139], v[248:249], v[70:71] op_sel_hi:[1,0,1]
    s_add_u32 m0, s41, 24576
    s_add_u32 s42, s40, 24576
    buffer_load_dwordx4 v8, s[16:19], s42 offen offset:0 lds
    s_waitcnt lgkmcnt(4)
    v_pk_fma_f32 v[64:65], v[140:141], v[248:249], v[64:65] op_sel:[0,1,0] op_sel_hi:[1,1,1]
    v_pk_fma_f32 v[66:67], v[142:143], v[248:249], v[66:67] op_sel:[0,1,0] op_sel_hi:[1,1,1]
    s_waitcnt lgkmcnt(3)
    v_pk_fma_f32 v[52:53], v[144:145], v[248:249], v[52:53] op_sel:[0,1,0] op_sel_hi:[1,1,1]
    v_pk_fma_f32 v[54:55], v[146:147], v[248:249], v[54:55] op_sel:[0,1,0] op_sel_hi:[1,1,1]
    s_waitcnt lgkmcnt(2)
    v_pk_fma_f32 v[72:73], v[148:149], v[248:249], v[72:73] op_sel:[0,1,0] op_sel_hi:[1,1,1]
    v_pk_fma_f32 v[74:75], v[150:151], v[248:249], v[74:75] op_sel:[0,1,0] op_sel_hi:[1,1,1]
    s_waitcnt lgkmcnt(1)
    v_pk_fma_f32 v[60:61], v[152:153], v[248:249], v[60:61] op_sel:[0,1,0] op_sel_hi:[1,1,1]
    v_pk_fma_f32 v[62:63], v[154:155], v[248:249], v[62:63] op_sel:[0,1,0] op_sel_hi:[1,1,1]
    s_waitcnt lgkmcnt(0)
    v_pk_fma_f32 v[68:69], v[156:157], v[248:249], v[68:69] op_sel:[0,1,0] op_sel_hi:[1,1,1]
    v_pk_fma_f32 v[70:71], v[158:159], v[248:249], v[70:71] op_sel:[0,1,0] op_sel_hi:[1,1,1]
    v_cvt_pk_bf16_f32 v96, v64, v65
    v_cvt_pk_bf16_f32 v97, v66, v67
    v_cvt_pk_bf16_f32 v98, v52, v53
    v_cvt_pk_bf16_f32 v99, v54, v55
    v_cvt_pk_bf16_f32 v100, v72, v73
    v_cvt_pk_bf16_f32 v101, v74, v75
    v_cvt_pk_bf16_f32 v102, v60, v61
    v_cvt_pk_bf16_f32 v103, v62, v63
    v_cvt_pk_bf16_f32 v104, v68, v69
    v_cvt_pk_bf16_f32 v105, v70, v71
    v_cndmask_b32 v108, v96, v97, s[36:37]
    v_cndmask_b32 v109, v97, v98, s[36:37]
    v_cndmask_b32 v110, v98, v99, s[36:37]
    v_cndmask_b32 v111, v99, v100, s[36:37]
    v_cndmask_b32 v112, v100, v101, s[36:37]
    v_cndmask_b32 v113, v101, v102, s[36:37]
    v_cndmask_b32 v114, v102, v103, s[36:37]
    v_cndmask_b32 v115, v103, v104, s[36:37]
    v_cndmask_b32 v116, v104, v105, s[36:37]
    v_mov_b32 v117, v116
    v_mov_b32 v118, 0
    v_mov_b32 v119, 0
    v_permlane32_swap_b32 v116, v117
    v_bfe_u32 v4, v1, 4, 1
    v_mul_u32_u24 v4, 20480, v4
    v_and_b32 v5, 15, v1
    v_lshl_add_u32 v4, v5, 4, v4
    v_lshrrev_b32 v5, 5, v1
    v_lshl_add_u32 v9, v5, 9, v4
    s_mul_i32 s96, s32, 163840
    s_mul_i32 s97, s34, 40960
    s_add_u32 s96, s96, s97
    s_mul_i32 s97, s33, 1280
    s_add_u32 s96, s96, s97
    s_add_u32 s96, s96, 6548736
    buffer_store_dwordx4 v[108:111], v9, s[16:19], s96 offen sc1
    buffer_store_dwordx4 v[112:115], v9, s[16:19], s96 offen offset:256 sc1
    s_mov_b32 exec_hi, 0
    buffer_store_dwordx4 v[116:119], v9, s[16:19], s96 offen offset:1024 sc1
    s_mov_b32 exec_hi, -1
    s_lshl_b32 s101, s32, 2
    s_add_u32 s101, s101, s34
    s_lshl_b32 s101, s101, 10
    s_add_u32 s101, s101, 278528
    s_lshl_b32 s40, s33, 6
    s_add_u32 s101, s101, s40
    s_waitcnt vmcnt(0)
    v_mov_b32 v4, 1
    v_mov_b32 v5, 0
    s_mov_b64 exec, 1
    buffer_store_dword v4, v5, s[16:19], s101 offen sc1
    s_mov_b64 exec, -1
    s_barrier
    s_lshr_b32 s3, s33, 3
    s_and_b32 s4, s33, 7
    v_lshlrev_b32 v238, 4, v1
    s_lshl_b32 s5, s3, 2
    s_add_u32 s5, s5, s34
    s_mul_i32 s6, s5, 20480
    s_mul_i32 s7, s32, 163840
    s_add_u32 s6, s6, s7
    s_add_u32 s6, s6, 6548736
    v_and_b32 v4, 15, v1
    v_lshrrev_b32 v5, 4, v1
    v_and_b32 v8, 1, v5
    v_lshlrev_b32 v8, 1, v8
    v_lshrrev_b32 v9, 1, v5
    v_or_b32 v8, v8, v9
    v_lshlrev_b32 v8, 8, v8
    v_lshl_add_u32 v239, v4, 4, v8
    v_lshlrev_b32 v252, 4, v4
    s_lshl_b32 s39, s32, 3
    s_add_u32 s39, s39, s5
    s_mul_i32 s96, s39, 18432
    s_mul_i32 s97, s4, 2304
    s_add_u32 s96, s96, s97
    s_add_u32 s7, s96, 13888768
    s_add_u32 s96, s96, 9170176
    v_mul_u32_u24 v6, 57, v1
    v_lshrrev_b32 v6, 10, v6
    v_mul_u32_u24 v6, 2016, v6
    v_add_u32 v6, v6, v238
    s_mul_i32 s38, s4, 288
    s_add_u32 s38, s38, 4608
    s_mov_b32 m0, 49152
    s_mov_b32 exec_hi, 0x3fffff
    buffer_load_dwordx4 v6, s[16:19], s38 offen lds
    s_mov_b32 exec_hi, -1
    s_mov_b32 s28, s64
    s_mov_b32 s29, s65
    s_mov_b32 s30, 2359296
    s_mov_b32 s31, 0x20000
    v_lshrrev_b32 v8, 4, v8
    v_mul_u32_u24 v9, 1152, v4
    v_add_u32 v8, v8, v9
    s_mul_i32 s7, s39, 18432
    s_mul_i32 s38, s4, 144
    s_add_u32 s7, s7, s38
    buffer_load_dwordx4 v[96:99], v8, s[28:31], s7 offen offset:0
    buffer_load_dwordx4 v[100:103], v8, s[28:31], s7 offen offset:64
    buffer_load_dwordx4 v[104:107], v8, s[28:31], s7 offen offset:128
    v_add_u32 v253, 61440, v238
    v_lshlrev_b32 v12, 4, v5
    v_add_u32 v12, 49152, v12
    s_lshl_b32 s97, s39, 11
    s_add_u32 s97, s97, 16384
    s_lshl_b32 s98, s4, 8
    s_add_u32 s98, s98, s97
    s_lshr_b32 s40, s5, 1
    s_lshl_b32 s101, s32, 2
    s_add_u32 s101, s101, s40
    s_lshl_b32 s101, s101, 10
    s_add_u32 s101, s101, 278528
    v_lshrrev_b32 v4, 3, v1
    v_and_b32 v5, 7, v1
    v_bfe_u32 v6, v1, 4, 1
    s_and_b32 s40, s34, 1
    s_lshr_b32 s41, s34, 1
    s_lshl_b32 s42, s40, 1
    v_add_u32 v6, s42, v6
    v_lshlrev_b32 v6, 1, v6
    v_xor_b32 v5, v5, v6
    v_lshlrev_b32 v5, 4, v5
    s_lshl_b32 s42, s34, 3
    v_add_u32 v6, s42, v4
    s_movk_i32 s43, 9216
    v_mul_lo_u32 v6, v6, s43
    v_add_u32 v234, v6, v5
    v_lshrrev_b32 v6, 2, v4
    v_lshlrev_b32 v6, 4, v6
    v_and_b32 v7, 3, v4
    v_add_u32 v6, v6, v7
    s_lshl_b32 s42, s34, 2
    v_add_u32 v6, s42, v6
    v_mul_u32_u24 v6, 1152, v6
    v_add_u32 v236, v6, v5
    v_lshrrev_b32 v4, 2, v1
    v_and_b32 v5, 3, v1
    v_lshrrev_b32 v6, 5, v1
    v_lshlrev_b32 v7, 1, v6
    v_xor_b32 v5, v5, v7
    v_lshlrev_b32 v5, 4, v5
    s_lshl_b32 s42, s40, 4
    v_add_u32 v7, s42, v4
    v_mul_lo_u32 v7, v7, s43
    v_add_u32 v235, v7, v5
    v_bfe_u32 v7, v4, 2, 1
    v_lshlrev_b32 v7, 4, v7
    v_lshl_add_u32 v7, v6, 2, v7
    v_and_b32 v8, 3, v4
    v_add_u32 v7, v7, v8
    s_lshl_b32 s42, s40, 3
    v_add_u32 v7, s42, v7
    v_mul_u32_u24 v7, 1152, v7
    v_add_u32 v237, v7, v5
    v_lshrrev_b32 v4, 4, v1
    v_bfe_u32 v5, v1, 2, 2
    v_bfe_u32 v6, v1, 1, 1
    v_and_b32 v7, 1, v1
    v_lshlrev_b32 v7, 3, v7
    v_lshl_add_u32 v7, v6, 4, v7
    v_and_b32 v8, 1, v4
    v_lshlrev_b32 v9, 1, v8
    v_lshrrev_b32 v10, 1, v5
    v_add_u32 v9, v9, v10
    v_lshlrev_b32 v9, 5, v9
    v_xor_b32 v9, v9, v7
    v_lshl_add_u32 v9, v5, 7, v9
    v_lshl_add_u32 v9, v4, 12, v9
    v_lshlrev_b32 v10, 5, v8
    v_xor_b32 v10, v10, v7
    v_lshl_add_u32 v10, v5, 6, v10
    v_lshl_add_u32 v10, v8, 9, v10
    v_lshrrev_b32 v11, 1, v4
    v_lshl_add_u32 v10, v11, 12, v10
    v_add_u32 v216, 0, v9
    v_xor_b32 v217, 32, v216
    v_xor_b32 v218, 64, v216
    v_xor_b32 v219, 96, v216
    v_add_u32 v228, 0, v10
    v_xor_b32 v229, 32, v228
    v_add_u32 v220, 65536, v9
    v_xor_b32 v221, 32, v220
    v_xor_b32 v222, 64, v220
    v_xor_b32 v223, 96, v220
    v_add_u32 v230, 65536, v10
    v_xor_b32 v231, 32, v230
    v_add_u32 v224, 131072, v9
    v_xor_b32 v225, 32, v224
    v_xor_b32 v226, 64, v224
    v_xor_b32 v227, 96, v224
    v_add_u32 v232, 131072, v10
    v_xor_b32 v233, 32, v232
    v_lshlrev_b32 v238, 4, v1
    v_lshlrev_b32 v8, 1, v8
    v_or_b32 v8, v8, v11
    v_lshlrev_b32 v8, 8, v8
    v_and_b32 v9, 15, v1
    v_lshl_add_u32 v239, v9, 4, v8
    s_add_u32 m0, s60, 0
    s_add_u32 s61, s56, 4096
    buffer_load_dwordx4 v234, s[8:11], s61 offen offset:0 lds
    buffer_load_dwordx4 v234, s[12:15], s61 offen offset:1024 lds
    s_add_u32 s61, s56, 296960
    buffer_load_dwordx4 v234, s[8:11], s61 offen offset:2048 lds
    buffer_load_dwordx4 v234, s[12:15], s61 offen offset:3072 lds
    s_add_u32 m0, s60, 16384
    s_add_u32 s61, s56, 593920
    buffer_load_dwordx4 v234, s[8:11], s61 offen offset:0 lds
    buffer_load_dwordx4 v234, s[12:15], s61 offen offset:1024 lds
    s_add_u32 s61, s56, 886784
    buffer_load_dwordx4 v234, s[8:11], s61 offen offset:2048 lds
    buffer_load_dwordx4 v234, s[12:15], s61 offen offset:3072 lds
    s_add_u32 m0, s60, 32768
    s_add_u32 s61, s56, 1183744
    buffer_load_dwordx4 v234, s[8:11], s61 offen offset:0 lds
    buffer_load_dwordx4 v234, s[12:15], s61 offen offset:1024 lds
    s_add_u32 s61, s56, 1476608
    buffer_load_dwordx4 v234, s[8:11], s61 offen offset:2048 lds
    buffer_load_dwordx4 v234, s[12:15], s61 offen offset:3072 lds
    v_and_b32 v2, 15, v1
    v_lshlrev_b32 v2, 6, v2
    buffer_load_dword v3, v2, s[16:19], s101 offen sc1
    s_waitcnt vmcnt(16)
    ds_read_b128 v[108:111], v12 offset:0
    ds_read_b128 v[112:115], v12 offset:64
    ds_read_b128 v[116:119], v12 offset:128
    ds_read_b128 v[120:123], v12 offset:192
    ds_read_b128 v[124:127], v12 offset:256
    ds_read_b128 v[148:151], v12 offset:288
    ds_read_b128 v[152:155], v12 offset:352
    ds_read_b128 v[156:159], v12 offset:416
    ds_read_b128 v[160:163], v12 offset:480
    ds_read_b128 v[164:167], v12 offset:544
    ds_read_b128 v[128:131], v12 offset:576
    ds_read_b128 v[132:135], v12 offset:640
    ds_read_b128 v[136:139], v12 offset:704
    ds_read_b128 v[140:143], v12 offset:768
    ds_read_b128 v[144:147], v12 offset:832
    s_waitcnt vmcnt(15)
    v_permlane16_swap_b32 v96, v98
    v_permlane16_swap_b32 v97, v99
    s_waitcnt vmcnt(14)
    v_permlane16_swap_b32 v100, v102
    v_permlane16_swap_b32 v101, v103
    s_waitcnt vmcnt(13)
    v_permlane16_swap_b32 v104, v106
    v_permlane16_swap_b32 v105, v107
    s_mov_b32 s99, 0xbfb8aa3b
    s_waitcnt lgkmcnt(9)
    v_mul_f32 v148, s99, v148
    v_mul_f32 v149, s99, v149
    v_mul_f32 v150, s99, v150
    v_mul_f32 v151, s99, v151
    s_waitcnt lgkmcnt(8)
    v_mul_f32 v152, s99, v152
    v_mul_f32 v153, s99, v153
    v_mul_f32 v154, s99, v154
    v_mul_f32 v155, s99, v155
    s_waitcnt lgkmcnt(7)
    v_mul_f32 v156, s99, v156
    v_mul_f32 v157, s99, v157
    v_mul_f32 v158, s99, v158
    v_mul_f32 v159, s99, v159
    s_waitcnt lgkmcnt(6)
    v_mul_f32 v160, s99, v160
    v_mul_f32 v161, s99, v161
    v_mul_f32 v162, s99, v162
    v_mul_f32 v163, s99, v163
    s_waitcnt lgkmcnt(5)
    v_mul_f32 v164, s99, v164
    v_mul_f32 v165, s99, v165
    v_mul_f32 v166, s99, v166
    v_mul_f32 v167, s99, v167
    ds_read_b128 a[32:35], v253 offset:0
    ds_read_b128 a[36:39], v253 offset:1024
    ds_read_b128 a[40:43], v253 offset:2048
    ds_read_b128 a[44:47], v253 offset:3072
    ds_read_b128 a[48:51], v253 offset:4096
    ds_read_b128 a[52:55], v253 offset:5120
    ds_read_b128 a[56:59], v253 offset:6144
    ds_read_b128 a[60:63], v253 offset:7168
    ds_read_b128 a[64:67], v253 offset:8192
    ds_read_b128 a[68:71], v253 offset:9216
    ds_read_b128 a[72:75], v253 offset:10240
    ds_read_b128 a[76:79], v253 offset:11264
    ds_read_b128 a[80:83], v253 offset:12288
    ds_read_b128 a[84:87], v253 offset:13312
    ds_read_b128 a[88:91], v253 offset:14336
    ds_read_b128 a[92:95], v253 offset:15360
    ds_read_b128 a[96:99], v253 offset:16384
    ds_read_b128 a[100:103], v253 offset:17408
    ds_read_b128 a[104:107], v253 offset:18432
    ds_read_b128 a[108:111], v253 offset:19456
    ds_read_b128 a[112:115], v253 offset:20480
    ds_read_b128 a[116:119], v253 offset:21504
    ds_read_b128 a[120:123], v253 offset:22528
    ds_read_b128 a[124:127], v253 offset:23552
    ds_read_b128 a[128:131], v253 offset:24576
    ds_read_b128 a[132:135], v253 offset:25600
    ds_read_b128 a[136:139], v253 offset:26624
    ds_read_b128 a[140:143], v253 offset:27648
    ds_read_b128 a[144:147], v253 offset:28672
    ds_read_b128 a[148:151], v253 offset:29696
    s_waitcnt vmcnt(0)
    v_cmp_gt_u32 vcc, 1, v3
    s_cbranch_vccnz L_pslow_6006
L_back_ok_6005:
    buffer_load_dwordx4 v[16:19], v238, s[16:19], s6 offen offset:0 sc1
    buffer_load_dwordx4 v[20:23], v238, s[16:19], s6 offen offset:1024 sc1
    buffer_load_dwordx4 v[24:27], v238, s[16:19], s6 offen offset:2048 sc1
    buffer_load_dwordx4 v[28:31], v238, s[16:19], s6 offen offset:3072 sc1
    s_add_u32 s6, s6, 4096
    buffer_load_dwordx4 v[32:35], v238, s[16:19], s6 offen offset:0 sc1
    buffer_load_dwordx4 v[36:39], v238, s[16:19], s6 offen offset:1024 sc1
    buffer_load_dwordx4 v[40:43], v238, s[16:19], s6 offen offset:2048 sc1
    buffer_load_dwordx4 v[44:47], v238, s[16:19], s6 offen offset:3072 sc1
    s_add_u32 s6, s6, 4096
    buffer_load_dwordx4 v[48:51], v238, s[16:19], s6 offen offset:0 sc1
    buffer_load_dwordx4 v[52:55], v238, s[16:19], s6 offen offset:1024 sc1
    buffer_load_dwordx4 v[56:59], v238, s[16:19], s6 offen offset:2048 sc1
    buffer_load_dwordx4 v[60:63], v238, s[16:19], s6 offen offset:3072 sc1
    s_add_u32 s6, s6, 4096
    buffer_load_dwordx4 v[64:67], v238, s[16:19], s6 offen offset:0 sc1
    buffer_load_dwordx4 v[68:71], v238, s[16:19], s6 offen offset:1024 sc1
    buffer_load_dwordx4 v[72:75], v238, s[16:19], s6 offen offset:2048 sc1
    buffer_load_dwordx4 v[76:79], v238, s[16:19], s6 offen offset:3072 sc1
    s_add_u32 s6, s6, 4096
    buffer_load_dwordx4 v[80:83], v238, s[16:19], s6 offen offset:0 sc1
    buffer_load_dwordx4 v[84:87], v238, s[16:19], s6 offen offset:1024 sc1
    buffer_load_dwordx4 v[88:91], v238, s[16:19], s6 offen offset:2048 sc1
    buffer_load_dwordx4 v[92:95], v238, s[16:19], s6 offen offset:3072 sc1
    ds_read_b128 a[0:3], v253 offset:30720
    ds_read_b128 a[4:7], v253 offset:31744
    ds_read_b128 a[8:11], v253 offset:32768
    ds_read_b128 a[12:15], v253 offset:33792
    ds_read_b128 a[16:19], v253 offset:34816
    ds_read_b128 a[20:23], v253 offset:35840
    ds_read_b128 a[24:27], v253 offset:36864
    ds_read_b128 a[28:31], v253 offset:37888
    s_waitcnt vmcnt(19) lgkmcnt(15)
    v_mfma_f32_16x16x32_bf16 v[168:171], a[32:35], v[16:19], 0
    v_lshlrev_b32 v188, 16, v96
    v_and_b32 v189, s35, v96
    v_mfma_f32_16x16x32_bf16 v[172:175], a[36:39], v[16:19], 0
    v_lshlrev_b32 v190, 16, v97
    v_and_b32 v191, s35, v97
    v_mfma_f32_16x16x32_bf16 v[176:179], a[40:43], v[16:19], 0
    v_lshlrev_b32 v192, 16, v98
    v_and_b32 v193, s35, v98
    v_mfma_f32_16x16x32_bf16 v[180:183], a[44:47], v[16:19], 0
    v_lshlrev_b32 v194, 16, v99
    v_and_b32 v195, s35, v99
    v_mfma_f32_16x16x32_bf16 v[184:187], a[48:51], v[16:19], 0
    v_lshlrev_b32 v196, 16, v100
    v_and_b32 v197, s35, v100
    s_waitcnt vmcnt(18)
    v_mfma_f32_16x16x32_bf16 v[168:171], a[52:55], v[20:23], v[168:171]
    v_lshlrev_b32 v198, 16, v101
    v_and_b32 v199, s35, v101
    v_mfma_f32_16x16x32_bf16 v[172:175], a[56:59], v[20:23], v[172:175]
    v_lshlrev_b32 v200, 16, v102
    v_and_b32 v201, s35, v102
    v_mfma_f32_16x16x32_bf16 v[176:179], a[60:63], v[20:23], v[176:179]
    v_lshlrev_b32 v202, 16, v103
    v_and_b32 v203, s35, v103
    v_mfma_f32_16x16x32_bf16 v[180:183], a[64:67], v[20:23], v[180:183]
    v_lshlrev_b32 v204, 16, v104
    v_and_b32 v205, s35, v104
    v_mfma_f32_16x16x32_bf16 v[184:187], a[68:71], v[20:23], v[184:187]
    v_lshlrev_b32 v206, 16, v105
    v_and_b32 v207, s35, v105
    s_waitcnt vmcnt(17)
    v_mfma_f32_16x16x32_bf16 v[168:171], a[72:75], v[24:27], v[168:171]
    v_mfma_f32_16x16x32_bf16 v[172:175], a[76:79], v[24:27], v[172:175]
    v_mfma_f32_16x16x32_bf16 v[176:179], a[80:83], v[24:27], v[176:179]
    v_mfma_f32_16x16x32_bf16 v[180:183], a[84:87], v[24:27], v[180:183]
    v_mfma_f32_16x16x32_bf16 v[184:187], a[88:91], v[24:27], v[184:187]
    s_waitcnt vmcnt(16)
    v_mfma_f32_16x16x32_bf16 v[168:171], a[92:95], v[28:31], v[168:171]
    v_mfma_f32_16x16x32_bf16 v[172:175], a[96:99], v[28:31], v[172:175]
    v_mfma_f32_16x16x32_bf16 v[176:179], a[100:103], v[28:31], v[176:179]
    v_mfma_f32_16x16x32_bf16 v[180:183], a[104:107], v[28:31], v[180:183]
    v_mfma_f32_16x16x32_bf16 v[184:187], a[108:111], v[28:31], v[184:187]
    s_waitcnt vmcnt(15)
    v_mfma_f32_16x16x32_bf16 v[168:171], a[112:115], v[32:35], v[168:171]
    v_mfma_f32_16x16x32_bf16 v[172:175], a[116:119], v[32:35], v[172:175]
    v_mfma_f32_16x16x32_bf16 v[176:179], a[120:123], v[32:35], v[176:179]
    s_waitcnt lgkmcnt(14)
    v_mfma_f32_16x16x32_bf16 v[180:183], a[124:127], v[32:35], v[180:183]
    s_waitcnt lgkmcnt(13)
    v_mfma_f32_16x16x32_bf16 v[184:187], a[128:131], v[32:35], v[184:187]
    s_waitcnt vmcnt(14) lgkmcnt(12)
    v_mfma_f32_16x16x32_bf16 v[168:171], a[132:135], v[36:39], v[168:171]
    s_waitcnt lgkmcnt(11)
    v_mfma_f32_16x16x32_bf16 v[172:175], a[136:139], v[36:39], v[172:175]
    s_waitcnt lgkmcnt(10)
    v_mfma_f32_16x16x32_bf16 v[176:179], a[140:143], v[36:39], v[176:179]
    s_waitcnt lgkmcnt(9)
    v_mfma_f32_16x16x32_bf16 v[180:183], a[144:147], v[36:39], v[180:183]
    s_waitcnt lgkmcnt(8)
    v_mfma_f32_16x16x32_bf16 v[184:187], a[148:151], v[36:39], v[184:187]
    s_waitcnt lgkmcnt(6)
    s_waitcnt vmcnt(13)
    v_mfma_f32_16x16x32_bf16 v[168:171], a[0:3], v[40:43], v[168:171]
    ds_read_b128 a[0:3], v253 offset:38912
    v_mfma_f32_16x16x32_bf16 v[172:175], a[4:7], v[40:43], v[172:175]
    ds_read_b128 a[4:7], v253 offset:39936
    s_waitcnt lgkmcnt(6)
    v_mfma_f32_16x16x32_bf16 v[176:179], a[8:11], v[40:43], v[176:179]
    ds_read_b128 a[8:11], v253 offset:40960
    v_mfma_f32_16x16x32_bf16 v[180:183], a[12:15], v[40:43], v[180:183]
    ds_read_b128 a[12:15], v253 offset:41984
    s_waitcnt lgkmcnt(6)
    v_mfma_f32_16x16x32_bf16 v[184:187], a[16:19], v[40:43], v[184:187]
    ds_read_b128 a[16:19], v253 offset:43008
    s_waitcnt vmcnt(12)
    v_mfma_f32_16x16x32_bf16 v[168:171], a[20:23], v[44:47], v[168:171]
    ds_read_b128 a[20:23], v253 offset:44032
    s_waitcnt lgkmcnt(6)
    v_mfma_f32_16x16x32_bf16 v[172:175], a[24:27], v[44:47], v[172:175]
    ds_read_b128 a[24:27], v253 offset:45056
    v_mfma_f32_16x16x32_bf16 v[176:179], a[28:31], v[44:47], v[176:179]
    ds_read_b128 a[28:31], v253 offset:46080
    s_waitcnt lgkmcnt(6)
    v_mfma_f32_16x16x32_bf16 v[180:183], a[0:3], v[44:47], v[180:183]
    ds_read_b128 a[0:3], v253 offset:47104
    v_mfma_f32_16x16x32_bf16 v[184:187], a[4:7], v[44:47], v[184:187]
    ds_read_b128 a[4:7], v253 offset:48128
    s_waitcnt lgkmcnt(6)
    s_waitcnt vmcnt(11)
    v_mfma_f32_16x16x32_bf16 v[168:171], a[8:11], v[48:51], v[168:171]
    ds_read_b128 a[8:11], v253 offset:49152
    v_mfma_f32_16x16x32_bf16 v[172:175], a[12:15], v[48:51], v[172:175]
    ds_read_b128 a[12:15], v253 offset:50176
    s_waitcnt lgkmcnt(6)
    v_mfma_f32_16x16x32_bf16 v[176:179], a[16:19], v[48:51], v[176:179]
    ds_read_b128 a[16:19], v253 offset:51200
    v_mfma_f32_16x16x32_bf16 v[180:183], a[20:23], v[48:51], v[180:183]
    ds_read_b128 a[20:23], v253 offset:52224
    s_waitcnt lgkmcnt(6)
    v_mfma_f32_16x16x32_bf16 v[184:187], a[24:27], v[48:51], v[184:187]
    ds_read_b128 a[24:27], v253 offset:53248
    s_waitcnt vmcnt(10)
    v_mfma_f32_16x16x32_bf16 v[168:171], a[28:31], v[52:55], v[168:171]
    ds_read_b128 a[28:31], v253 offset:54272
    s_waitcnt lgkmcnt(6)
    v_mfma_f32_16x16x32_bf16 v[172:175], a[0:3], v[52:55], v[172:175]
    ds_read_b128 a[0:3], v253 offset:55296
    v_mfma_f32_16x16x32_bf16 v[176:179], a[4:7], v[52:55], v[176:179]
    ds_read_b128 a[4:7], v253 offset:56320
    s_waitcnt lgkmcnt(6)
    v_mfma_f32_16x16x32_bf16 v[180:183], a[8:11], v[52:55], v[180:183]
    ds_read_b128 a[8:11], v253 offset:57344
    v_mfma_f32_16x16x32_bf16 v[184:187], a[12:15], v[52:55], v[184:187]
    ds_read_b128 a[12:15], v253 offset:58368
    s_waitcnt lgkmcnt(6)
    s_waitcnt vmcnt(9)
    v_mfma_f32_16x16x32_bf16 v[168:171], a[16:19], v[56:59], v[168:171]
    ds_read_b128 a[16:19], v253 offset:59392
    v_mfma_f32_16x16x32_bf16 v[172:175], a[20:23], v[56:59], v[172:175]
    ds_read_b128 a[20:23], v253 offset:60416
    s_waitcnt lgkmcnt(6)
    v_mfma_f32_16x16x32_bf16 v[176:179], a[24:27], v[56:59], v[176:179]
    v_add_u32 v253, 61440, v253
    ds_read_b128 a[24:27], v253 offset:0
    v_mfma_f32_16x16x32_bf16 v[180:183], a[28:31], v[56:59], v[180:183]
    ds_read_b128 a[28:31], v253 offset:1024
    s_waitcnt lgkmcnt(6)
    v_mfma_f32_16x16x32_bf16 v[184:187], a[0:3], v[56:59], v[184:187]
    ds_read_b128 a[0:3], v253 offset:2048
    s_waitcnt vmcnt(8)
    v_mfma_f32_16x16x32_bf16 v[168:171], a[4:7], v[60:63], v[168:171]
    ds_read_b128 a[4:7], v253 offset:3072
    s_waitcnt lgkmcnt(6)
    v_mfma_f32_16x16x32_bf16 v[172:175], a[8:11], v[60:63], v[172:175]
    ds_read_b128 a[8:11], v253 offset:4096
    v_mfma_f32_16x16x32_bf16 v[176:179], a[12:15], v[60:63], v[176:179]
    ds_read_b128 a[12:15], v253 offset:5120
    s_waitcnt lgkmcnt(6)
    v_mfma_f32_16x16x32_bf16 v[180:183], a[16:19], v[60:63], v[180:183]
    ds_read_b128 a[16:19], v253 offset:6144
    v_mfma_f32_16x16x32_bf16 v[184:187], a[20:23], v[60:63], v[184:187]
    ds_read_b128 a[20:23], v253 offset:7168
    s_waitcnt lgkmcnt(6)
    s_waitcnt vmcnt(7)
    v_mfma_f32_16x16x32_bf16 v[168:171], a[24:27], v[64:67], v[168:171]
    ds_read_b128 a[24:27], v253 offset:8192
    v_mfma_f32_16x16x32_bf16 v[172:175], a[28:31], v[64:67], v[172:175]
    ds_read_b128 a[28:31], v253 offset:9216
    s_waitcnt lgkmcnt(6)
    v_mfma_f32_16x16x32_bf16 v[176:179], a[0:3], v[64:67], v[176:179]
    ds_read_b128 a[0:3], v253 offset:10240
    v_mfma_f32_16x16x32_bf16 v[180:183], a[4:7], v[64:67], v[180:183]
    ds_read_b128 a[4:7], v253 offset:11264
    s_waitcnt lgkmcnt(6)
    v_mfma_f32_16x16x32_bf16 v[184:187], a[8:11], v[64:67], v[184:187]
    ds_read_b128 a[8:11], v253 offset:12288
    s_waitcnt vmcnt(6)
    v_mfma_f32_16x16x32_bf16 v[168:171], a[12:15], v[68:71], v[168:171]
    ds_read_b128 a[12:15], v253 offset:13312
    s_waitcnt lgkmcnt(6)
    v_mfma_f32_16x16x32_bf16 v[172:175], a[16:19], v[68:71], v[172:175]
    ds_read_b128 a[16:19], v253 offset:14336
    v_mfma_f32_16x16x32_bf16 v[176:179], a[20:23], v[68:71], v[176:179]
    ds_read_b128 a[20:23], v253 offset:15360
    s_waitcnt lgkmcnt(6)
    v_mfma_f32_16x16x32_bf16 v[180:183], a[24:27], v[68:71], v[180:183]
    ds_read_b128 a[24:27], v253 offset:16384
    v_mfma_f32_16x16x32_bf16 v[184:187], a[28:31], v[68:71], v[184:187]
    ds_read_b128 a[28:31], v253 offset:17408
    s_waitcnt lgkmcnt(6)
    s_waitcnt vmcnt(5)
    v_mfma_f32_16x16x32_bf16 v[168:171], a[0:3], v[72:75], v[168:171]
    ds_read_b128 a[0:3], v253 offset:18432
    v_mfma_f32_16x16x32_bf16 v[172:175], a[4:7], v[72:75], v[172:175]
    ds_read_b128 a[4:7], v253 offset:19456
    s_waitcnt lgkmcnt(6)
    v_mfma_f32_16x16x32_bf16 v[176:179], a[8:11], v[72:75], v[176:179]
    ds_read_b128 a[8:11], v253 offset:20480
    v_mfma_f32_16x16x32_bf16 v[180:183], a[12:15], v[72:75], v[180:183]
    ds_read_b128 a[12:15], v253 offset:21504
    s_waitcnt lgkmcnt(6)
    v_mfma_f32_16x16x32_bf16 v[184:187], a[16:19], v[72:75], v[184:187]
    ds_read_b128 a[16:19], v253 offset:22528
    s_waitcnt vmcnt(4)
    v_mfma_f32_16x16x32_bf16 v[168:171], a[20:23], v[76:79], v[168:171]
    ds_read_b128 a[20:23], v253 offset:23552
    s_waitcnt lgkmcnt(6)
    v_mfma_f32_16x16x32_bf16 v[172:175], a[24:27], v[76:79], v[172:175]
    ds_read_b128 a[24:27], v253 offset:24576
    v_mfma_f32_16x16x32_bf16 v[176:179], a[28:31], v[76:79], v[176:179]
    ds_read_b128 a[28:31], v253 offset:25600
    s_waitcnt lgkmcnt(6)
    v_mfma_f32_16x16x32_bf16 v[180:183], a[0:3], v[76:79], v[180:183]
    ds_read_b128 a[0:3], v253 offset:26624
    v_mfma_f32_16x16x32_bf16 v[184:187], a[4:7], v[76:79], v[184:187]
    ds_read_b128 a[4:7], v253 offset:27648
    s_waitcnt lgkmcnt(6)
    s_waitcnt vmcnt(3)
    v_mfma_f32_16x16x32_bf16 v[168:171], a[8:11], v[80:83], v[168:171]
    ds_read_b128 a[8:11], v253 offset:28672
    v_mfma_f32_16x16x32_bf16 v[172:175], a[12:15], v[80:83], v[172:175]
    ds_read_b128 a[12:15], v253 offset:29696
    s_waitcnt lgkmcnt(6)
    v_mfma_f32_16x16x32_bf16 v[176:179], a[16:19], v[80:83], v[176:179]
    ds_read_b128 a[16:19], v253 offset:30720
    v_mfma_f32_16x16x32_bf16 v[180:183], a[20:23], v[80:83], v[180:183]
    ds_read_b128 a[20:23], v253 offset:31744
    s_waitcnt lgkmcnt(6)
    v_mfma_f32_16x16x32_bf16 v[184:187], a[24:27], v[80:83], v[184:187]
    ds_read_b128 a[24:27], v253 offset:32768
    s_waitcnt vmcnt(2)
    v_mfma_f32_16x16x32_bf16 v[168:171], a[28:31], v[84:87], v[168:171]
    ds_read_b128 a[28:31], v253 offset:33792
    s_waitcnt lgkmcnt(6)
    v_mfma_f32_16x16x32_bf16 v[172:175], a[0:3], v[84:87], v[172:175]
    ds_read_b128 a[0:3], v253 offset:34816
    v_mfma_f32_16x16x32_bf16 v[176:179], a[4:7], v[84:87], v[176:179]
    ds_read_b128 a[4:7], v253 offset:35840
    s_waitcnt lgkmcnt(6)
    v_mfma_f32_16x16x32_bf16 v[180:183], a[8:11], v[84:87], v[180:183]
    ds_read_b128 a[8:11], v253 offset:36864
    v_mfma_f32_16x16x32_bf16 v[184:187], a[12:15], v[84:87], v[184:187]
    ds_read_b128 a[12:15], v253 offset:37888
    s_waitcnt lgkmcnt(6)
    s_waitcnt vmcnt(1)
    v_mfma_f32_16x16x32_bf16 v[168:171], a[16:19], v[88:91], v[168:171]
    ds_read_b128 a[16:19], v253 offset:38912
    v_mfma_f32_16x16x32_bf16 v[172:175], a[20:23], v[88:91], v[172:175]
    ds_read_b128 a[20:23], v253 offset:39936
    s_waitcnt lgkmcnt(6)
    v_mfma_f32_16x16x32_bf16 v[176:179], a[24:27], v[88:91], v[176:179]
    v_mfma_f32_16x16x32_bf16 v[180:183], a[28:31], v[88:91], v[180:183]
    s_waitcnt lgkmcnt(4)
    v_mfma_f32_16x16x32_bf16 v[184:187], a[0:3], v[88:91], v[184:187]
    s_waitcnt vmcnt(0)
    v_mfma_f32_16x16x32_bf16 v[168:171], a[4:7], v[92:95], v[168:171]
    s_waitcnt lgkmcnt(2)
    v_mfma_f32_16x16x32_bf16 v[172:175], a[8:11], v[92:95], v[172:175]
    v_mfma_f32_16x16x32_bf16 v[176:179], a[12:15], v[92:95], v[176:179]
    s_waitcnt lgkmcnt(0)
    v_mfma_f32_16x16x32_bf16 v[180:183], a[16:19], v[92:95], v[180:183]
    v_mfma_f32_16x16x32_bf16 v[184:187], a[20:23], v[92:95], v[184:187]
    s_nop 1
    v_pk_fma_f32 v[188:189], v[168:169], v[108:109], v[188:189]
    v_pk_fma_f32 v[190:191], v[170:171], v[110:111], v[190:191]
    v_pk_fma_f32 v[192:193], v[172:173], v[112:113], v[192:193]
    v_pk_fma_f32 v[194:195], v[174:175], v[114:115], v[194:195]
    v_pk_fma_f32 v[196:197], v[176:177], v[116:117], v[196:197]
    v_pk_fma_f32 v[198:199], v[178:179], v[118:119], v[198:199]
    v_pk_fma_f32 v[200:201], v[180:181], v[120:121], v[200:201]
    v_pk_fma_f32 v[202:203], v[182:183], v[122:123], v[202:203]
    v_pk_fma_f32 v[204:205], v[184:185], v[124:125], v[204:205]
    v_pk_fma_f32 v[206:207], v[186:187], v[126:127], v[206:207]
    v_pk_add_f32 v[48:49], v[188:189], v[190:191]
    v_pk_add_f32 v[48:49], v[48:49], v[192:193]
    v_pk_add_f32 v[48:49], v[48:49], v[194:195]
    v_pk_add_f32 v[48:49], v[48:49], v[196:197]
    v_pk_add_f32 v[48:49], v[48:49], v[198:199]
    v_pk_add_f32 v[48:49], v[48:49], v[200:201]
    v_pk_add_f32 v[48:49], v[48:49], v[202:203]
    s_mov_b32 exec_hi, 0
    v_pk_add_f32 v[48:49], v[48:49], v[204:205]
    v_pk_add_f32 v[48:49], v[48:49], v[206:207]
    s_mov_b32 exec_hi, -1
    v_add_f32 v48, v48, v49
    v_mov_b32 v49, v48
    s_nop 1
    v_permlane16_swap_b32 v48, v49
    v_add_f32 v48, v48, v49
    v_mov_b32 v49, v48
    s_nop 1
    v_permlane32_swap_b32 v48, v49
    v_add_f32 v48, v48, v49
    s_mov_b32 s99, 0x3c638e39
    v_mul_f32 v48, s99, v48
    v_pk_add_f32 v[168:169], v[188:189], v[48:49] op_sel_hi:[1,0] neg_lo:[0,1] neg_hi:[0,1]
    v_pk_add_f32 v[170:171], v[190:191], v[48:49] op_sel_hi:[1,0] neg_lo:[0,1] neg_hi:[0,1]
    v_pk_add_f32 v[172:173], v[192:193], v[48:49] op_sel_hi:[1,0] neg_lo:[0,1] neg_hi:[0,1]
    v_pk_add_f32 v[174:175], v[194:195], v[48:49] op_sel_hi:[1,0] neg_lo:[0,1] neg_hi:[0,1]
    v_pk_add_f32 v[176:177], v[196:197], v[48:49] op_sel_hi:[1,0] neg_lo:[0,1] neg_hi:[0,1]
    v_pk_add_f32 v[178:179], v[198:199], v[48:49] op_sel_hi:[1,0] neg_lo:[0,1] neg_hi:[0,1]
    v_pk_add_f32 v[180:181], v[200:201], v[48:49] op_sel_hi:[1,0] neg_lo:[0,1] neg_hi:[0,1]
    v_pk_add_f32 v[182:183], v[202:203], v[48:49] op_sel_hi:[1,0] neg_lo:[0,1] neg_hi:[0,1]
    v_pk_add_f32 v[184:185], v[204:205], v[48:49] op_sel_hi:[1,0] neg_lo:[0,1] neg_hi:[0,1]
    v_pk_add_f32 v[186:187], v[206:207], v[48:49] op_sel_hi:[1,0] neg_lo:[0,1] neg_hi:[0,1]
    v_pk_mul_f32 v[40:41], v[168:169], v[168:169]
    v_pk_fma_f32 v[40:41], v[170:171], v[170:171], v[40:41]
    v_pk_fma_f32 v[40:41], v[172:173], v[172:173], v[40:41]
    v_pk_fma_f32 v[40:41], v[174:175], v[174:175], v[40:41]
    v_pk_fma_f32 v[40:41], v[176:177], v[176:177], v[40:41]
    v_pk_fma_f32 v[40:41], v[178:179], v[178:179], v[40:41]
    v_pk_fma_f32 v[40:41], v[180:181], v[180:181], v[40:41]
    v_pk_fma_f32 v[40:41], v[182:183], v[182:183], v[40:41]
    s_mov_b32 exec_hi, 0
    v_pk_fma_f32 v[40:41], v[184:185], v[184:185], v[40:41]
    v_pk_fma_f32 v[40:41], v[186:187], v[186:187], v[40:41]
    s_mov_b32 exec_hi, -1
    v_add_f32 v40, v40, v41
    v_mov_b32 v41, v40
    s_nop 1
    v_permlane16_swap_b32 v40, v41
    v_add_f32 v40, v40, v41
    v_mov_b32 v41, v40
    s_nop 1
    v_permlane32_swap_b32 v40, v41
    v_add_f32 v40, v40, v41
    v_mov_b32 v49, v40
    v_mov_b32 v51, 0
    v_mov_b32 v50, 1
    s_mov_b64 exec, 0xffff
    buffer_store_dwordx4 v[48:51], v252, s[16:19], s98 offen sc1
    s_mov_b64 exec, -1
    s_barrier
    s_add_u32 m0, s60, 49152
    s_add_u32 s61, s56, 1773568
    buffer_load_dwordx4 v234, s[8:11], s61 offen offset:0 lds
    buffer_load_dwordx4 v234, s[12:15], s61 offen offset:1024 lds
    s_add_u32 s61, s56, 2066432
    buffer_load_dwordx4 v234, s[8:11], s61 offen offset:2048 lds
    buffer_load_dwordx4 v234, s[12:15], s61 offen offset:3072 lds
    s_add_u32 m0, s60, 65536
    s_add_u32 s61, s56, 2363392
    buffer_load_dwordx4 v234, s[8:11], s61 offen offset:0 lds
    buffer_load_dwordx4 v234, s[12:15], s61 offen offset:1024 lds
    s_add_u32 s61, s56, 2656256
    buffer_load_dwordx4 v234, s[8:11], s61 offen offset:2048 lds
    buffer_load_dwordx4 v234, s[12:15], s61 offen offset:3072 lds
    buffer_load_dwordx4 v[32:35], v238, s[16:19], s97 offen sc1
    buffer_load_dwordx4 v[36:39], v238, s[16:19], s97 offen offset:1024 sc1
    s_lshr_b32 s40, s5, 1
    s_lshl_b32 s101, s32, 2
    s_add_u32 s101, s101, s40
    s_lshl_b32 s101, s101, 10
    s_add_u32 s101, s101, 344064
    s_lshl_b32 s40, s4, 1
    s_and_b32 s41, s34, 1
    s_add_u32 s40, s40, s41
    s_lshl_b32 s40, s40, 6
    s_add_u32 s101, s101, s40
    s_lshl_b32 s40, s32, 3
    s_lshl_b32 s41, s34, 1
    s_add_u32 s40, s40, s41
    s_mul_i32 s41, s40, 18432
    s_add_u32 s41, s41, 11529472
    s_add_u32 s42, s41, 18432
    s_lshl_b32 s40, s32, 4
    s_add_u32 s40, s40, s33
    s_lshl_b32 s40, s40, 2
    s_add_u32 s40, s40, s34
    s_xor_b32 s43, s40, 4
    s_mul_i32 s52, s40, 18432
    s_add_u32 s52, s52, 35122432
    s_mul_i32 s53, s43, 18432
    s_add_u32 s53, s53, 35122432
    s_lshl_b32 s7, s40, 6
    s_add_u32 s7, s7, 671744
    s_lshl_b32 s38, s43, 6
    s_add_u32 s38, s38, 671744
    v_mov_b32 v15, 0
    s_lshl_b32 s3, s32, 2
    s_add_u32 s3, s3, s34
    s_lshl_b32 s3, s3, 10
    s_add_u32 s3, s3, 409600
    s_lshl_b32 s40, s33, 6
    s_add_u32 s3, s3, s40
    s_lshr_b32 s40, s33, 2
    s_lshl_b32 s4, s32, 2
    s_add_u32 s4, s4, s40
    s_lshl_b32 s4, s4, 10
    s_add_u32 s4, s4, 409600
    s_mul_i32 s5, s32, 1179648
    s_lshr_b32 s40, s33, 1
    s_mul_i32 s40, s40, 18432
    s_add_u32 s5, s5, s40
    s_and_b32 s40, s33, 1
    s_lshl_b32 s40, s40, 7
    s_add_u32 s5, s5, s40
    s_mul_i32 s40, s34, 294912
    s_add_u32 s5, s5, s40
    s_add_u32 s5, s5, 16248064
    v_and_b32 v6, 15, v1
    v_lshrrev_b32 v8, 5, v1
    v_mul_u32_u24 v8, 147456, v8
    v_bfe_u32 v9, v1, 4, 1
    v_mul_u32_u24 v10, 24, v9
    v_and_b32 v11, 31, v1
    v_add_u32 v10, v10, v11
    v_lshl_add_u32 v4, v10, 8, v8
    v_mul_u32_u24 v8, 147456, v9
    v_bfe_u32 v9, v1, 3, 1
    v_lshlrev_b32 v9, 5, v9
    v_add3_u32 v9, v9, v6, 16
    v_lshl_add_u32 v5, v9, 8, v8
    v_lshlrev_b32 v6, 6, v6
    v_cvt_pk_bf16_f32 v240, v188, v189
    v_cvt_pk_bf16_f32 v241, v190, v191
    v_cvt_pk_bf16_f32 v242, v192, v193
    v_cvt_pk_bf16_f32 v243, v194, v195
    v_cvt_pk_bf16_f32 v244, v196, v197
    v_cvt_pk_bf16_f32 v245, v198, v199
    v_cvt_pk_bf16_f32 v246, v200, v201
    v_cvt_pk_bf16_f32 v247, v202, v203
    v_cvt_pk_bf16_f32 v248, v204, v205
    v_cvt_pk_bf16_f32 v249, v206, v207
    v_mov_b32 v250, v248
    v_mov_b32 v251, v249
    v_permlane16_swap_b32 v240, v242
    v_permlane16_swap_b32 v241, v243
    v_permlane16_swap_b32 v244, v246
    v_permlane16_swap_b32 v245, v247
    v_permlane16_swap_b32 v248, v250
    v_permlane16_swap_b32 v249, v251
    s_waitcnt vmcnt(0)
    v_and_b32 v44, v34, v38
    v_cmp_eq_u32 vcc, 0, v44
    s_cbranch_vccnz L_stslow_6009
L_back_st_6008:
    buffer_store_dwordx4 v[240:243], v239, s[16:19], s96 offen sc1
    buffer_store_dwordx4 v[244:247], v239, s[16:19], s96 offen offset:1024 sc1
    s_mov_b64 exec, 0xffff
    buffer_store_dwordx4 v[248:251], v239, s[16:19], s96 offen offset:2048 sc1
    s_mov_b64 exec, -1
    v_add_f32 v48, v32, v36
    v_mov_b32 v49, v48
    s_nop 1
    v_permlane16_swap_b32 v48, v49
    v_add_f32 v48, v48, v49
    v_mov_b32 v49, v48
    s_nop 1
    v_permlane32_swap_b32 v48, v49
    v_add_f32 v48, v48, v49
    v_mul_f32 v48, 0x3e000000, v48
    v_sub_f32 v32, v32, v48
    v_sub_f32 v36, v36, v48
    v_mul_f32 v32, v32, v32
    v_fmac_f32 v32, v36, v36
    v_add_f32 v40, v33, v37
    s_mov_b32 s99, 0x42900000
    v_fmac_f32 v40, s99, v32
    v_mov_b32 v41, v40
    s_nop 1
    v_permlane16_swap_b32 v40, v41
    v_add_f32 v40, v40, v41
    v_mov_b32 v41, v40
    s_nop 1
    v_permlane32_swap_b32 v40, v41
    v_add_f32 v40, v40, v41
    s_mov_b32 s99, 0x3ae38e39
    v_mov_b32 v41, 0x3727c5ac
    v_fmac_f32 v41, s99, v40
    v_rsq_f32 v40, v41
    v_pk_add_f32 v[188:189], v[188:189], v[48:49] op_sel_hi:[1,0] neg_lo:[0,1] neg_hi:[0,1]
    v_pk_add_f32 v[190:191], v[190:191], v[48:49] op_sel_hi:[1,0] neg_lo:[0,1] neg_hi:[0,1]
    v_pk_add_f32 v[192:193], v[192:193], v[48:49] op_sel_hi:[1,0] neg_lo:[0,1] neg_hi:[0,1]
    v_pk_add_f32 v[194:195], v[194:195], v[48:49] op_sel_hi:[1,0] neg_lo:[0,1] neg_hi:[0,1]
    v_pk_add_f32 v[196:197], v[196:197], v[48:49] op_sel_hi:[1,0] neg_lo:[0,1] neg_hi:[0,1]
    v_pk_add_f32 v[198:199], v[198:199], v[48:49] op_sel_hi:[1,0] neg_lo:[0,1] neg_hi:[0,1]
    v_pk_add_f32 v[200:201], v[200:201], v[48:49] op_sel_hi:[1,0] neg_lo:[0,1] neg_hi:[0,1]
    v_pk_add_f32 v[202:203], v[202:203], v[48:49] op_sel_hi:[1,0] neg_lo:[0,1] neg_hi:[0,1]
    v_pk_add_f32 v[204:205], v[204:205], v[48:49] op_sel_hi:[1,0] neg_lo:[0,1] neg_hi:[0,1]
    v_pk_add_f32 v[206:207], v[206:207], v[48:49] op_sel_hi:[1,0] neg_lo:[0,1] neg_hi:[0,1]
    s_mov_b32 s99, 0xbfb8aa3b
    v_mul_f32 v40, s99, v40
    v_pk_mul_f32 v[188:189], v[188:189], v[40:41] op_sel_hi:[1,0]
    v_pk_mul_f32 v[190:191], v[190:191], v[40:41] op_sel_hi:[1,0]
    v_pk_mul_f32 v[192:193], v[192:193], v[40:41] op_sel_hi:[1,0]
    v_pk_mul_f32 v[194:195], v[194:195], v[40:41] op_sel_hi:[1,0]
    v_pk_mul_f32 v[196:197], v[196:197], v[40:41] op_sel_hi:[1,0]
    v_pk_mul_f32 v[198:199], v[198:199], v[40:41] op_sel_hi:[1,0]
    v_pk_mul_f32 v[200:201], v[200:201], v[40:41] op_sel_hi:[1,0]
    v_pk_mul_f32 v[202:203], v[202:203], v[40:41] op_sel_hi:[1,0]
    v_pk_mul_f32 v[204:205], v[204:205], v[40:41] op_sel_hi:[1,0]
    v_pk_mul_f32 v[206:207], v[206:207], v[40:41] op_sel_hi:[1,0]
    v_pk_fma_f32 v[188:189], v[188:189], v[128:129], v[148:149]
    v_pk_fma_f32 v[190:191], v[190:191], v[130:131], v[150:151]
    v_pk_fma_f32 v[192:193], v[192:193], v[132:133], v[152:153]
    v_pk_fma_f32 v[194:195], v[194:195], v[134:135], v[154:155]
    v_pk_fma_f32 v[196:197], v[196:197], v[136:137], v[156:157]
    v_pk_fma_f32 v[198:199], v[198:199], v[138:139], v[158:159]
    v_pk_fma_f32 v[200:201], v[200:201], v[140:141], v[160:161]
    v_pk_fma_f32 v[202:203], v[202:203], v[142:143], v[162:163]
    v_pk_fma_f32 v[204:205], v[204:205], v[144:145], v[164:165]
    v_pk_fma_f32 v[206:207], v[206:207], v[146:147], v[166:167]
    v_cvt_pk_bf16_f32 v16, v188, v189
    v_cvt_pk_bf16_f32 v17, v190, v191
    v_cvt_pk_bf16_f32 v18, v192, v193
    v_cvt_pk_bf16_f32 v19, v194, v195
    v_cvt_pk_bf16_f32 v20, v196, v197
    v_cvt_pk_bf16_f32 v21, v198, v199
    v_cvt_pk_bf16_f32 v22, v200, v201
    v_cvt_pk_bf16_f32 v23, v202, v203
    v_cvt_pk_bf16_f32 v24, v204, v205
    v_cvt_pk_bf16_f32 v25, v206, v207
    s_add_u32 s96, s96, 2359296
    v_mov_b32 v26, v24
    v_mov_b32 v27, v25
    v_permlane16_swap_b32 v16, v18
    v_permlane16_swap_b32 v17, v19
    v_permlane16_swap_b32 v20, v22
    v_permlane16_swap_b32 v21, v23
    v_permlane16_swap_b32 v24, v26
    v_permlane16_swap_b32 v25, v27
    buffer_store_dwordx4 v[16:19], v239, s[16:19], s96 offen sc1
    buffer_store_dwordx4 v[20:23], v239, s[16:19], s96 offen offset:1024 sc1
    s_mov_b64 exec, 0xffff
    buffer_store_dwordx4 v[24:27], v239, s[16:19], s96 offen offset:2048 sc1
    s_mov_b64 exec, -1
    s_waitcnt vmcnt(0)
    v_mov_b32 v10, 1
    v_mov_b32 v11, 0
    s_mov_b64 exec, 1
    buffer_store_dword v10, v11, s[16:19], s101 offen sc1
    s_mov_b64 exec, -1
    s_lshl_b32 s101, s32, 2
    s_add_u32 s101, s101, s34
    s_lshl_b32 s101, s101, 10
    s_add_u32 s101, s101, 344064
    s_add_u32 m0, s60, 81920
    s_add_u32 s61, s56, 2953216
    buffer_load_dwordx4 v234, s[8:11], s61 offen offset:0 lds
    buffer_load_dwordx4 v234, s[12:15], s61 offen offset:1024 lds
    s_add_u32 s61, s56, 3246080
    buffer_load_dwordx4 v234, s[8:11], s61 offen offset:2048 lds
    buffer_load_dwordx4 v234, s[12:15], s61 offen offset:3072 lds
    s_add_u32 m0, s60, 98304
    s_add_u32 s61, s56, 3543040
    buffer_load_dwordx4 v234, s[8:11], s61 offen offset:0 lds
    buffer_load_dwordx4 v234, s[12:15], s61 offen offset:1024 lds
    s_add_u32 s61, s56, 3835904
    buffer_load_dwordx4 v234, s[8:11], s61 offen offset:2048 lds
    buffer_load_dwordx4 v234, s[12:15], s61 offen offset:3072 lds
    s_add_u32 m0, s60, 114688
    s_add_u32 s61, s56, 4132864
    buffer_load_dwordx4 v234, s[8:11], s61 offen offset:0 lds
    buffer_load_dwordx4 v234, s[12:15], s61 offen offset:1024 lds
    s_add_u32 s61, s56, 4425728
    buffer_load_dwordx4 v234, s[8:11], s61 offen offset:2048 lds
    buffer_load_dwordx4 v234, s[12:15], s61 offen offset:3072 lds
    s_add_u32 m0, s60, 131072
    s_add_u32 s61, s56, 4722688
    buffer_load_dwordx4 v234, s[8:11], s61 offen offset:0 lds
    buffer_load_dwordx4 v234, s[12:15], s61 offen offset:1024 lds
    s_add_u32 s61, s56, 5015552
    buffer_load_dwordx4 v234, s[8:11], s61 offen offset:2048 lds
    buffer_load_dwordx4 v234, s[12:15], s61 offen offset:3072 lds
    v_and_b32 v10, 15, v1
    v_lshlrev_b32 v10, 6, v10
    buffer_load_dword v11, v10, s[16:19], s101 offen sc1
    s_waitcnt vmcnt(0)
    v_cmp_gt_u32 vcc, 1, v11
    s_cbranch_vccnz L_pslow_6012
L_back_ok_6011:
    buffer_load_dwordx4 a[0:3], v238, s[16:19], s41 offen offset:0 sc1
    buffer_load_dwordx4 a[72:75], v238, s[16:19], s42 offen offset:0 sc1
    buffer_load_dwordx4 a[4:7], v238, s[16:19], s41 offen offset:1024 sc1
    buffer_load_dwordx4 a[76:79], v238, s[16:19], s42 offen offset:1024 sc1
    buffer_load_dwordx4 a[8:11], v238, s[16:19], s41 offen offset:2048 sc1
    buffer_load_dwordx4 a[80:83], v238, s[16:19], s42 offen offset:2048 sc1
    buffer_load_dwordx4 a[12:15], v238, s[16:19], s41 offen offset:3072 sc1
    buffer_load_dwordx4 a[84:87], v238, s[16:19], s42 offen offset:3072 sc1
    s_add_u32 s41, s41, 4096
    s_add_u32 s42, s42, 4096
    s_barrier
    ds_read_b64_tr_b16 a[216:217], v216 offset:0
    ds_read_b64_tr_b16 a[218:219], v216 offset:512
    ds_read_b64_tr_b16 a[220:221], v217 offset:0
    ds_read_b64_tr_b16 a[222:223], v217 offset:512
    ds_read_b64_tr_b16 a[224:225], v218 offset:0
    ds_read_b64_tr_b16 a[226:227], v218 offset:512
    ds_read_b64_tr_b16 a[228:229], v219 offset:0
    ds_read_b64_tr_b16 a[230:231], v219 offset:512
    ds_read_b64_tr_b16 a[232:233], v216 offset:1024
    ds_read_b64_tr_b16 a[234:235], v216 offset:1536
    ds_read_b64_tr_b16 a[236:237], v217 offset:1024
    ds_read_b64_tr_b16 a[238:239], v217 offset:1536
L_back_step0:
    s_waitcnt vmcnt(7) lgkmcnt(10)
    v_mfma_f32_16x16x32_bf16 v[16:19], a[216:219], a[0:3], 0
    ds_read_b64_tr_b16 a[240:241], v218 offset:1024
    ds_read_b64_tr_b16 a[242:243], v218 offset:1536
    s_waitcnt vmcnt(6)
    v_mfma_f32_16x16x32_bf16 v[20:23], a[216:219], a[72:75], 0
    buffer_load_dwordx4 a[16:19], v238, s[16:19], s41 offen offset:0 sc1
    s_waitcnt lgkmcnt(10)
    v_mfma_f32_16x16x32_bf16 v[24:27], a[220:223], a[0:3], 0
    ds_read_b64_tr_b16 a[244:245], v219 offset:1024
    ds_read_b64_tr_b16 a[246:247], v219 offset:1536
    v_mfma_f32_16x16x32_bf16 v[28:31], a[220:223], a[72:75], 0
    ds_read_b64_tr_b16 a[248:249], v216 offset:2048
    s_waitcnt lgkmcnt(11)
    v_mfma_f32_16x16x32_bf16 v[32:35], a[224:227], a[0:3], 0
    ds_read_b64_tr_b16 a[250:251], v216 offset:2560
    v_mfma_f32_16x16x32_bf16 v[36:39], a[224:227], a[72:75], 0
    buffer_load_dwordx4 a[88:91], v238, s[16:19], s42 offen offset:0 sc1
    s_waitcnt lgkmcnt(10)
    v_mfma_f32_16x16x32_bf16 v[40:43], a[228:231], a[0:3], 0
    ds_read_b64_tr_b16 a[252:253], v217 offset:2048
    ds_read_b64_tr_b16 a[254:255], v217 offset:2560
    v_mfma_f32_16x16x32_bf16 v[44:47], a[228:231], a[72:75], 0
    ds_read_b64_tr_b16 a[216:217], v218 offset:2048
    s_waitcnt lgkmcnt(5)
L_back_step1:
    v_mfma_f32_16x16x32_bf16 v[48:51], a[232:235], a[0:3], 0
    ds_read_b64_tr_b16 a[218:219], v218 offset:2560
    v_mfma_f32_16x16x32_bf16 v[52:55], a[232:235], a[72:75], 0
    buffer_load_dwordx4 a[20:23], v238, s[16:19], s41 offen offset:1024 sc1
    v_mfma_f32_16x16x32_bf16 v[56:59], a[236:239], a[0:3], 0
    ds_read_b64_tr_b16 a[220:221], v219 offset:2048
    ds_read_b64_tr_b16 a[222:223], v219 offset:2560
    v_mfma_f32_16x16x32_bf16 v[60:63], a[236:239], a[72:75], 0
    ds_read_b64_tr_b16 a[224:225], v216 offset:3072
    v_mfma_f32_16x16x32_bf16 v[64:67], a[240:243], a[0:3], 0
    ds_read_b64_tr_b16 a[226:227], v216 offset:3584
    v_mfma_f32_16x16x32_bf16 v[68:71], a[240:243], a[72:75], 0
    buffer_load_dwordx4 a[92:95], v238, s[16:19], s42 offen offset:1024 sc1
    v_mfma_f32_16x16x32_bf16 v[72:75], a[244:247], a[0:3], 0
    ds_read_b64_tr_b16 a[228:229], v217 offset:3072
    ds_read_b64_tr_b16 a[230:231], v217 offset:3584
    v_mfma_f32_16x16x32_bf16 v[76:79], a[244:247], a[72:75], 0
    ds_read_b64_tr_b16 a[232:233], v218 offset:3072
    s_waitcnt lgkmcnt(5)
L_back_step2:
    s_waitcnt vmcnt(9)
    v_mfma_f32_16x16x32_bf16 v[16:19], a[248:251], a[4:7], v[16:19]
    ds_read_b64_tr_b16 a[234:235], v218 offset:3584
    s_waitcnt vmcnt(8)
    v_mfma_f32_16x16x32_bf16 v[20:23], a[248:251], a[76:79], v[20:23]
    buffer_load_dwordx4 a[24:27], v238, s[16:19], s41 offen offset:2048 sc1
    v_mfma_f32_16x16x32_bf16 v[24:27], a[252:255], a[4:7], v[24:27]
    ds_read_b64_tr_b16 a[236:237], v219 offset:3072
    ds_read_b64_tr_b16 a[238:239], v219 offset:3584
    v_mfma_f32_16x16x32_bf16 v[28:31], a[252:255], a[76:79], v[28:31]
    ds_read_b64_tr_b16 a[240:241], v216 offset:16384
    v_mfma_f32_16x16x32_bf16 v[32:35], a[216:219], a[4:7], v[32:35]
    ds_read_b64_tr_b16 a[242:243], v216 offset:16896
    v_mfma_f32_16x16x32_bf16 v[36:39], a[216:219], a[76:79], v[36:39]
    buffer_load_dwordx4 a[96:99], v238, s[16:19], s42 offen offset:2048 sc1
    v_mfma_f32_16x16x32_bf16 v[40:43], a[220:223], a[4:7], v[40:43]
    ds_read_b64_tr_b16 a[244:245], v217 offset:16384
    ds_read_b64_tr_b16 a[246:247], v217 offset:16896
    v_mfma_f32_16x16x32_bf16 v[44:47], a[220:223], a[76:79], v[44:47]
    ds_read_b64_tr_b16 a[248:249], v218 offset:16384
    s_waitcnt lgkmcnt(5)
L_back_step3:
    v_mfma_f32_16x16x32_bf16 v[48:51], a[224:227], a[4:7], v[48:51]
    ds_read_b64_tr_b16 a[250:251], v218 offset:16896
    v_mfma_f32_16x16x32_bf16 v[52:55], a[224:227], a[76:79], v[52:55]
    buffer_load_dwordx4 a[28:31], v238, s[16:19], s41 offen offset:3072 sc1
    v_mfma_f32_16x16x32_bf16 v[56:59], a[228:231], a[4:7], v[56:59]
    ds_read_b64_tr_b16 a[252:253], v219 offset:16384
    ds_read_b64_tr_b16 a[254:255], v219 offset:16896
    v_mfma_f32_16x16x32_bf16 v[60:63], a[228:231], a[76:79], v[60:63]
    ds_read_b64_tr_b16 a[216:217], v216 offset:17408
    v_mfma_f32_16x16x32_bf16 v[64:67], a[232:235], a[4:7], v[64:67]
    ds_read_b64_tr_b16 a[218:219], v216 offset:17920
    v_mfma_f32_16x16x32_bf16 v[68:71], a[232:235], a[76:79], v[68:71]
    buffer_load_dwordx4 a[100:103], v238, s[16:19], s42 offen offset:3072 sc1
    s_add_u32 s41, s41, 4096
    s_add_u32 s42, s42, 4096
    v_mfma_f32_16x16x32_bf16 v[72:75], a[236:239], a[4:7], v[72:75]
    ds_read_b64_tr_b16 a[220:221], v217 offset:17408
    ds_read_b64_tr_b16 a[222:223], v217 offset:17920
    v_mfma_f32_16x16x32_bf16 v[76:79], a[236:239], a[76:79], v[76:79]
    ds_read_b64_tr_b16 a[224:225], v218 offset:17408
    s_waitcnt lgkmcnt(5)
L_back_step4:
    s_waitcnt vmcnt(11)
    v_mfma_f32_16x16x32_bf16 v[16:19], a[240:243], a[8:11], v[16:19]
    ds_read_b64_tr_b16 a[226:227], v218 offset:17920
    s_waitcnt vmcnt(10)
    v_mfma_f32_16x16x32_bf16 v[20:23], a[240:243], a[80:83], v[20:23]
    buffer_load_dwordx4 a[32:35], v238, s[16:19], s41 offen offset:0 sc1
    v_mfma_f32_16x16x32_bf16 v[24:27], a[244:247], a[8:11], v[24:27]
    ds_read_b64_tr_b16 a[228:229], v219 offset:17408
    ds_read_b64_tr_b16 a[230:231], v219 offset:17920
    v_mfma_f32_16x16x32_bf16 v[28:31], a[244:247], a[80:83], v[28:31]
    ds_read_b64_tr_b16 a[232:233], v216 offset:18432
    v_mfma_f32_16x16x32_bf16 v[32:35], a[248:251], a[8:11], v[32:35]
    ds_read_b64_tr_b16 a[234:235], v216 offset:18944
    v_mfma_f32_16x16x32_bf16 v[36:39], a[248:251], a[80:83], v[36:39]
    buffer_load_dwordx4 a[104:107], v238, s[16:19], s42 offen offset:0 sc1
    v_mfma_f32_16x16x32_bf16 v[40:43], a[252:255], a[8:11], v[40:43]
    ds_read_b64_tr_b16 a[236:237], v217 offset:18432
    ds_read_b64_tr_b16 a[238:239], v217 offset:18944
    v_mfma_f32_16x16x32_bf16 v[44:47], a[252:255], a[80:83], v[44:47]
    ds_read_b64_tr_b16 a[240:241], v218 offset:18432
    s_waitcnt lgkmcnt(5)
L_back_step5:
    v_mfma_f32_16x16x32_bf16 v[48:51], a[216:219], a[8:11], v[48:51]
    ds_read_b64_tr_b16 a[242:243], v218 offset:18944
    v_mfma_f32_16x16x32_bf16 v[52:55], a[216:219], a[80:83], v[52:55]
    buffer_load_dwordx4 a[36:39], v238, s[16:19], s41 offen offset:1024 sc1
    v_mfma_f32_16x16x32_bf16 v[56:59], a[220:223], a[8:11], v[56:59]
    ds_read_b64_tr_b16 a[244:245], v219 offset:18432
    ds_read_b64_tr_b16 a[246:247], v219 offset:18944
    v_mfma_f32_16x16x32_bf16 v[60:63], a[220:223], a[80:83], v[60:63]
    ds_read_b64_tr_b16 a[248:249], v216 offset:19456
    v_mfma_f32_16x16x32_bf16 v[64:67], a[224:227], a[8:11], v[64:67]
    ds_read_b64_tr_b16 a[250:251], v216 offset:19968
    v_mfma_f32_16x16x32_bf16 v[68:71], a[224:227], a[80:83], v[68:71]
    buffer_load_dwordx4 a[108:111], v238, s[16:19], s42 offen offset:1024 sc1
    v_mfma_f32_16x16x32_bf16 v[72:75], a[228:231], a[8:11], v[72:75]
    ds_read_b64_tr_b16 a[252:253], v217 offset:19456
    ds_read_b64_tr_b16 a[254:255], v217 offset:19968
    v_mfma_f32_16x16x32_bf16 v[76:79], a[228:231], a[80:83], v[76:79]
    ds_read_b64_tr_b16 a[216:217], v218 offset:19456
    s_waitcnt lgkmcnt(5)
L_back_step6:
    s_waitcnt vmcnt(13)
    v_mfma_f32_16x16x32_bf16 v[16:19], a[232:235], a[12:15], v[16:19]
    ds_read_b64_tr_b16 a[218:219], v218 offset:19968
    s_waitcnt vmcnt(12)
    v_mfma_f32_16x16x32_bf16 v[20:23], a[232:235], a[84:87], v[20:23]
    buffer_load_dwordx4 a[40:43], v238, s[16:19], s41 offen offset:2048 sc1
    v_mfma_f32_16x16x32_bf16 v[24:27], a[236:239], a[12:15], v[24:27]
    ds_read_b64_tr_b16 a[220:221], v219 offset:19456
    ds_read_b64_tr_b16 a[222:223], v219 offset:19968
    v_mfma_f32_16x16x32_bf16 v[28:31], a[236:239], a[84:87], v[28:31]
    v_mfma_f32_16x16x32_bf16 v[32:35], a[240:243], a[12:15], v[32:35]
    s_barrier
    v_mfma_f32_16x16x32_bf16 v[36:39], a[240:243], a[84:87], v[36:39]
    ds_read_b64_tr_b16 a[224:225], v216 offset:32768
    ds_read_b64_tr_b16 a[226:227], v216 offset:33280
    v_mfma_f32_16x16x32_bf16 v[40:43], a[244:247], a[12:15], v[40:43]
    ds_read_b64_tr_b16 a[228:229], v217 offset:32768
    ds_read_b64_tr_b16 a[230:231], v217 offset:33280
    v_mfma_f32_16x16x32_bf16 v[44:47], a[244:247], a[84:87], v[44:47]
    buffer_load_dwordx4 a[112:115], v238, s[16:19], s42 offen offset:2048 sc1
    s_waitcnt lgkmcnt(4)
L_back_step7:
    v_mfma_f32_16x16x32_bf16 v[48:51], a[248:251], a[12:15], v[48:51]
    ds_read_b64_tr_b16 a[232:233], v218 offset:32768
    ds_read_b64_tr_b16 a[234:235], v218 offset:33280
    v_mfma_f32_16x16x32_bf16 v[52:55], a[248:251], a[84:87], v[52:55]
    ds_read_b64_tr_b16 a[236:237], v219 offset:32768
    v_mfma_f32_16x16x32_bf16 v[56:59], a[252:255], a[12:15], v[56:59]
    ds_read_b64_tr_b16 a[238:239], v219 offset:33280
    v_mfma_f32_16x16x32_bf16 v[60:63], a[252:255], a[84:87], v[60:63]
    buffer_load_dwordx4 a[44:47], v238, s[16:19], s41 offen offset:3072 sc1
    v_mfma_f32_16x16x32_bf16 v[64:67], a[216:219], a[12:15], v[64:67]
    ds_read_b64_tr_b16 a[240:241], v216 offset:33792
    ds_read_b64_tr_b16 a[242:243], v216 offset:34304
    v_mfma_f32_16x16x32_bf16 v[68:71], a[216:219], a[84:87], v[68:71]
    ds_read_b64_tr_b16 a[244:245], v217 offset:33792
    v_mfma_f32_16x16x32_bf16 v[72:75], a[220:223], a[12:15], v[72:75]
    ds_read_b64_tr_b16 a[246:247], v217 offset:34304
    v_mfma_f32_16x16x32_bf16 v[76:79], a[220:223], a[84:87], v[76:79]
    ds_read_b64_tr_b16 a[248:249], v218 offset:33792
    s_waitcnt lgkmcnt(5)
L_back_step8:
    s_waitcnt vmcnt(14)
    v_mfma_f32_16x16x32_bf16 v[16:19], a[224:227], a[16:19], v[16:19]
    buffer_load_dwordx4 a[116:119], v238, s[16:19], s42 offen offset:3072 sc1
    s_add_u32 s41, s41, 4096
    s_add_u32 s42, s42, 4096
    s_waitcnt vmcnt(14)
    v_mfma_f32_16x16x32_bf16 v[20:23], a[224:227], a[88:91], v[20:23]
    ds_read_b64_tr_b16 a[250:251], v218 offset:34304
    ds_read_b64_tr_b16 a[252:253], v219 offset:33792
    v_mfma_f32_16x16x32_bf16 v[24:27], a[228:231], a[16:19], v[24:27]
    ds_read_b64_tr_b16 a[254:255], v219 offset:34304
    v_mfma_f32_16x16x32_bf16 v[28:31], a[228:231], a[88:91], v[28:31]
    ds_read_b64_tr_b16 a[216:217], v216 offset:34816
    v_mfma_f32_16x16x32_bf16 v[32:35], a[232:235], a[16:19], v[32:35]
    buffer_load_dwordx4 a[48:51], v238, s[16:19], s41 offen offset:0 sc1
    v_mfma_f32_16x16x32_bf16 v[36:39], a[232:235], a[88:91], v[36:39]
    ds_read_b64_tr_b16 a[218:219], v216 offset:35328
    ds_read_b64_tr_b16 a[220:221], v217 offset:34816
    v_mfma_f32_16x16x32_bf16 v[40:43], a[236:239], a[16:19], v[40:43]
    ds_read_b64_tr_b16 a[222:223], v217 offset:35328
    v_mfma_f32_16x16x32_bf16 v[44:47], a[236:239], a[88:91], v[44:47]
    ds_read_b64_tr_b16 a[224:225], v218 offset:34816
    s_waitcnt lgkmcnt(5)
L_back_step9:
    v_mfma_f32_16x16x32_bf16 v[48:51], a[240:243], a[16:19], v[48:51]
    buffer_load_dwordx4 a[120:123], v238, s[16:19], s42 offen offset:0 sc1
    v_mfma_f32_16x16x32_bf16 v[52:55], a[240:243], a[88:91], v[52:55]
    ds_read_b64_tr_b16 a[226:227], v218 offset:35328
    ds_read_b64_tr_b16 a[228:229], v219 offset:34816
    v_mfma_f32_16x16x32_bf16 v[56:59], a[244:247], a[16:19], v[56:59]
    ds_read_b64_tr_b16 a[230:231], v219 offset:35328
    v_mfma_f32_16x16x32_bf16 v[60:63], a[244:247], a[88:91], v[60:63]
    ds_read_b64_tr_b16 a[232:233], v216 offset:35840
    v_mfma_f32_16x16x32_bf16 v[64:67], a[248:251], a[16:19], v[64:67]
    buffer_load_dwordx4 a[52:55], v238, s[16:19], s41 offen offset:1024 sc1
    v_mfma_f32_16x16x32_bf16 v[68:71], a[248:251], a[88:91], v[68:71]
    ds_read_b64_tr_b16 a[234:235], v216 offset:36352
    ds_read_b64_tr_b16 a[236:237], v217 offset:35840
    v_mfma_f32_16x16x32_bf16 v[72:75], a[252:255], a[16:19], v[72:75]
    ds_read_b64_tr_b16 a[238:239], v217 offset:36352
    v_mfma_f32_16x16x32_bf16 v[76:79], a[252:255], a[88:91], v[76:79]
    ds_read_b64_tr_b16 a[240:241], v218 offset:35840
    s_waitcnt lgkmcnt(5)
L_back_step10:
    s_waitcnt vmcnt(16)
    v_mfma_f32_16x16x32_bf16 v[16:19], a[216:219], a[20:23], v[16:19]
    buffer_load_dwordx4 a[124:127], v238, s[16:19], s42 offen offset:1024 sc1
    s_waitcnt vmcnt(16)
    v_mfma_f32_16x16x32_bf16 v[20:23], a[216:219], a[92:95], v[20:23]
    ds_read_b64_tr_b16 a[242:243], v218 offset:36352
    ds_read_b64_tr_b16 a[244:245], v219 offset:35840
    v_mfma_f32_16x16x32_bf16 v[24:27], a[220:223], a[20:23], v[24:27]
    ds_read_b64_tr_b16 a[246:247], v219 offset:36352
    v_mfma_f32_16x16x32_bf16 v[28:31], a[220:223], a[92:95], v[28:31]
    ds_read_b64_tr_b16 a[248:249], v216 offset:49152
    v_mfma_f32_16x16x32_bf16 v[32:35], a[224:227], a[20:23], v[32:35]
    buffer_load_dwordx4 a[56:59], v238, s[16:19], s41 offen offset:2048 sc1
    v_mfma_f32_16x16x32_bf16 v[36:39], a[224:227], a[92:95], v[36:39]
    ds_read_b64_tr_b16 a[250:251], v216 offset:49664
    ds_read_b64_tr_b16 a[252:253], v217 offset:49152
    v_mfma_f32_16x16x32_bf16 v[40:43], a[228:231], a[20:23], v[40:43]
    ds_read_b64_tr_b16 a[254:255], v217 offset:49664
    v_mfma_f32_16x16x32_bf16 v[44:47], a[228:231], a[92:95], v[44:47]
    ds_read_b64_tr_b16 a[216:217], v218 offset:49152
    s_waitcnt lgkmcnt(5)
L_back_step11:
    v_mfma_f32_16x16x32_bf16 v[48:51], a[232:235], a[20:23], v[48:51]
    buffer_load_dwordx4 a[128:131], v238, s[16:19], s42 offen offset:2048 sc1
    v_mfma_f32_16x16x32_bf16 v[52:55], a[232:235], a[92:95], v[52:55]
    ds_read_b64_tr_b16 a[218:219], v218 offset:49664
    ds_read_b64_tr_b16 a[220:221], v219 offset:49152
    v_mfma_f32_16x16x32_bf16 v[56:59], a[236:239], a[20:23], v[56:59]
    ds_read_b64_tr_b16 a[222:223], v219 offset:49664
    v_mfma_f32_16x16x32_bf16 v[60:63], a[236:239], a[92:95], v[60:63]
    ds_read_b64_tr_b16 a[224:225], v216 offset:50176
    v_mfma_f32_16x16x32_bf16 v[64:67], a[240:243], a[20:23], v[64:67]
    buffer_load_dwordx4 a[60:63], v238, s[16:19], s41 offen offset:3072 sc1
    v_mfma_f32_16x16x32_bf16 v[68:71], a[240:243], a[92:95], v[68:71]
    ds_read_b64_tr_b16 a[226:227], v216 offset:50688
    ds_read_b64_tr_b16 a[228:229], v217 offset:50176
    v_mfma_f32_16x16x32_bf16 v[72:75], a[244:247], a[20:23], v[72:75]
    ds_read_b64_tr_b16 a[230:231], v217 offset:50688
    v_mfma_f32_16x16x32_bf16 v[76:79], a[244:247], a[92:95], v[76:79]
    ds_read_b64_tr_b16 a[232:233], v218 offset:50176
    s_waitcnt lgkmcnt(5)
L_back_step12:
    s_waitcnt vmcnt(18)
    v_mfma_f32_16x16x32_bf16 v[16:19], a[248:251], a[24:27], v[16:19]
    buffer_load_dwordx4 a[132:135], v238, s[16:19], s42 offen offset:3072 sc1
    s_add_u32 s41, s41, 4096
    s_add_u32 s42, s42, 4096
    s_waitcnt vmcnt(18)
    v_mfma_f32_16x16x32_bf16 v[20:23], a[248:251], a[96:99], v[20:23]
    ds_read_b64_tr_b16 a[234:235], v218 offset:50688
    ds_read_b64_tr_b16 a[236:237], v219 offset:50176
    v_mfma_f32_16x16x32_bf16 v[24:27], a[252:255], a[24:27], v[24:27]
    ds_read_b64_tr_b16 a[238:239], v219 offset:50688
    v_mfma_f32_16x16x32_bf16 v[28:31], a[252:255], a[96:99], v[28:31]
    ds_read_b64_tr_b16 a[240:241], v216 offset:51200
    v_mfma_f32_16x16x32_bf16 v[32:35], a[216:219], a[24:27], v[32:35]
    buffer_load_dwordx4 a[64:67], v238, s[16:19], s41 offen offset:0 sc1
    v_mfma_f32_16x16x32_bf16 v[36:39], a[216:219], a[96:99], v[36:39]
    ds_read_b64_tr_b16 a[242:243], v216 offset:51712
    ds_read_b64_tr_b16 a[244:245], v217 offset:51200
    v_mfma_f32_16x16x32_bf16 v[40:43], a[220:223], a[24:27], v[40:43]
    ds_read_b64_tr_b16 a[246:247], v217 offset:51712
    v_mfma_f32_16x16x32_bf16 v[44:47], a[220:223], a[96:99], v[44:47]
    ds_read_b64_tr_b16 a[248:249], v218 offset:51200
    s_waitcnt lgkmcnt(5)
L_back_step13:
    v_mfma_f32_16x16x32_bf16 v[48:51], a[224:227], a[24:27], v[48:51]
    buffer_load_dwordx4 a[136:139], v238, s[16:19], s42 offen offset:0 sc1
    v_mfma_f32_16x16x32_bf16 v[52:55], a[224:227], a[96:99], v[52:55]
    ds_read_b64_tr_b16 a[250:251], v218 offset:51712
    ds_read_b64_tr_b16 a[252:253], v219 offset:51200
    v_mfma_f32_16x16x32_bf16 v[56:59], a[228:231], a[24:27], v[56:59]
    ds_read_b64_tr_b16 a[254:255], v219 offset:51712
    v_mfma_f32_16x16x32_bf16 v[60:63], a[228:231], a[96:99], v[60:63]
    ds_read_b64_tr_b16 a[216:217], v216 offset:52224
    v_mfma_f32_16x16x32_bf16 v[64:67], a[232:235], a[24:27], v[64:67]
    buffer_load_dwordx4 a[68:71], v238, s[16:19], s41 offen offset:1024 sc1
    v_mfma_f32_16x16x32_bf16 v[68:71], a[232:235], a[96:99], v[68:71]
    ds_read_b64_tr_b16 a[218:219], v216 offset:52736
    ds_read_b64_tr_b16 a[220:221], v217 offset:52224
    v_mfma_f32_16x16x32_bf16 v[72:75], a[236:239], a[24:27], v[72:75]
    ds_read_b64_tr_b16 a[222:223], v217 offset:52736
    v_mfma_f32_16x16x32_bf16 v[76:79], a[236:239], a[96:99], v[76:79]
    ds_read_b64_tr_b16 a[224:225], v218 offset:52224
    s_waitcnt lgkmcnt(5)
L_back_step14:
    s_waitcnt vmcnt(20)
    v_mfma_f32_16x16x32_bf16 v[16:19], a[240:243], a[28:31], v[16:19]
    buffer_load_dwordx4 a[140:143], v238, s[16:19], s42 offen offset:1024 sc1
    s_waitcnt vmcnt(20)
    v_mfma_f32_16x16x32_bf16 v[20:23], a[240:243], a[100:103], v[20:23]
    ds_read_b64_tr_b16 a[226:227], v218 offset:52736
    ds_read_b64_tr_b16 a[228:229], v219 offset:52224
    v_mfma_f32_16x16x32_bf16 v[24:27], a[244:247], a[28:31], v[24:27]
    ds_read_b64_tr_b16 a[230:231], v219 offset:52736
    v_mfma_f32_16x16x32_bf16 v[28:31], a[244:247], a[100:103], v[28:31]
    v_mfma_f32_16x16x32_bf16 v[32:35], a[248:251], a[28:31], v[32:35]
    s_barrier
    v_mfma_f32_16x16x32_bf16 v[36:39], a[248:251], a[100:103], v[36:39]
    ds_read_b64_tr_b16 a[232:233], v220 offset:0
    ds_read_b64_tr_b16 a[234:235], v220 offset:512
    v_mfma_f32_16x16x32_bf16 v[40:43], a[252:255], a[28:31], v[40:43]
    ds_read_b64_tr_b16 a[236:237], v221 offset:0
    s_add_u32 m0, s60, 147456
    v_mfma_f32_16x16x32_bf16 v[44:47], a[252:255], a[100:103], v[44:47]
    ds_read_b64_tr_b16 a[238:239], v221 offset:512
    s_waitcnt lgkmcnt(4)
L_back_step15:
    v_mfma_f32_16x16x32_bf16 v[48:51], a[216:219], a[28:31], v[48:51]
    ds_read_b64_tr_b16 a[240:241], v222 offset:0
    s_add_u32 s61, s56, 4224
    v_mfma_f32_16x16x32_bf16 v[52:55], a[216:219], a[100:103], v[52:55]
    ds_read_b64_tr_b16 a[242:243], v222 offset:512
    ds_read_b64_tr_b16 a[244:245], v223 offset:0
    v_mfma_f32_16x16x32_bf16 v[56:59], a[220:223], a[28:31], v[56:59]
    ds_read_b64_tr_b16 a[246:247], v223 offset:512
    v_mfma_f32_16x16x32_bf16 v[60:63], a[220:223], a[100:103], v[60:63]
    buffer_load_dwordx4 v234, s[8:11], s61 offen offset:0 lds
    v_mfma_f32_16x16x32_bf16 v[64:67], a[224:227], a[28:31], v[64:67]
    ds_read_b64_tr_b16 a[248:249], v220 offset:1024
    ds_read_b64_tr_b16 a[250:251], v220 offset:1536
    v_mfma_f32_16x16x32_bf16 v[68:71], a[224:227], a[100:103], v[68:71]
    buffer_load_dwordx4 v234, s[12:15], s61 offen offset:1024 lds
    v_mfma_f32_16x16x32_bf16 v[72:75], a[228:231], a[28:31], v[72:75]
    ds_read_b64_tr_b16 a[252:253], v221 offset:1024
    ds_read_b64_tr_b16 a[254:255], v221 offset:1536
    v_mfma_f32_16x16x32_bf16 v[76:79], a[228:231], a[100:103], v[76:79]
    ds_read_b64_tr_b16 a[216:217], v222 offset:1024
    s_waitcnt lgkmcnt(5)
L_back_step16:
    s_waitcnt vmcnt(21)
    v_mfma_f32_16x16x32_bf16 v[16:19], a[232:235], a[32:35], v[16:19]
    s_add_u32 s61, s56, 297088
    ds_read_b64_tr_b16 a[218:219], v222 offset:1536
    s_waitcnt vmcnt(20)
    v_mfma_f32_16x16x32_bf16 v[20:23], a[232:235], a[104:107], v[20:23]
    buffer_load_dwordx4 v234, s[8:11], s61 offen offset:2048 lds
    v_mfma_f32_16x16x32_bf16 v[24:27], a[236:239], a[32:35], v[24:27]
    ds_read_b64_tr_b16 a[220:221], v223 offset:1024
    ds_read_b64_tr_b16 a[222:223], v223 offset:1536
    v_mfma_f32_16x16x32_bf16 v[28:31], a[236:239], a[104:107], v[28:31]
    buffer_load_dwordx4 v234, s[12:15], s61 offen offset:3072 lds
    v_mfma_f32_16x16x32_bf16 v[32:35], a[240:243], a[32:35], v[32:35]
    ds_read_b64_tr_b16 a[224:225], v220 offset:2048
    ds_read_b64_tr_b16 a[226:227], v220 offset:2560
    v_mfma_f32_16x16x32_bf16 v[36:39], a[240:243], a[104:107], v[36:39]
    s_add_u32 m0, s60, 0
    s_add_u32 s61, s56, 594048
    buffer_load_dwordx4 v234, s[8:11], s61 offen offset:0 lds
    v_mfma_f32_16x16x32_bf16 v[40:43], a[244:247], a[32:35], v[40:43]
    ds_read_b64_tr_b16 a[228:229], v221 offset:2048
    ds_read_b64_tr_b16 a[230:231], v221 offset:2560
    v_mfma_f32_16x16x32_bf16 v[44:47], a[244:247], a[104:107], v[44:47]
    ds_read_b64_tr_b16 a[232:233], v222 offset:2048
    s_waitcnt lgkmcnt(5)
L_back_step17:
    v_mfma_f32_16x16x32_bf16 v[48:51], a[248:251], a[32:35], v[48:51]
    buffer_load_dwordx4 v234, s[12:15], s61 offen offset:1024 lds
    v_mfma_f32_16x16x32_bf16 v[52:55], a[248:251], a[104:107], v[52:55]
    ds_read_b64_tr_b16 a[234:235], v222 offset:2560
    ds_read_b64_tr_b16 a[236:237], v223 offset:2048
    v_mfma_f32_16x16x32_bf16 v[56:59], a[252:255], a[32:35], v[56:59]
    ds_read_b64_tr_b16 a[238:239], v223 offset:2560
    v_mfma_f32_16x16x32_bf16 v[60:63], a[252:255], a[104:107], v[60:63]
    s_add_u32 s61, s56, 886912
    buffer_load_dwordx4 v234, s[8:11], s61 offen offset:2048 lds
    v_mfma_f32_16x16x32_bf16 v[64:67], a[216:219], a[32:35], v[64:67]
    ds_read_b64_tr_b16 a[240:241], v220 offset:3072
    ds_read_b64_tr_b16 a[242:243], v220 offset:3584
    v_mfma_f32_16x16x32_bf16 v[68:71], a[216:219], a[104:107], v[68:71]
    buffer_load_dwordx4 v234, s[12:15], s61 offen offset:3072 lds
    v_mfma_f32_16x16x32_bf16 v[72:75], a[220:223], a[32:35], v[72:75]
    ds_read_b64_tr_b16 a[244:245], v221 offset:3072
    ds_read_b64_tr_b16 a[246:247], v221 offset:3584
    v_mfma_f32_16x16x32_bf16 v[76:79], a[220:223], a[104:107], v[76:79]
    ds_read_b64_tr_b16 a[248:249], v222 offset:3072
    s_waitcnt lgkmcnt(5)
L_back_step18:
    s_waitcnt vmcnt(25)
    v_mfma_f32_16x16x32_bf16 v[16:19], a[224:227], a[36:39], v[16:19]
    s_add_u32 m0, s60, 16384
    s_add_u32 s61, s56, 1183872
    s_waitcnt vmcnt(24)
    v_mfma_f32_16x16x32_bf16 v[20:23], a[224:227], a[108:111], v[20:23]
    ds_read_b64_tr_b16 a[250:251], v222 offset:3584
    ds_read_b64_tr_b16 a[252:253], v223 offset:3072
    v_mfma_f32_16x16x32_bf16 v[24:27], a[228:231], a[36:39], v[24:27]
    ds_read_b64_tr_b16 a[254:255], v223 offset:3584
    v_mfma_f32_16x16x32_bf16 v[28:31], a[228:231], a[108:111], v[28:31]
    buffer_load_dwordx4 v234, s[8:11], s61 offen offset:0 lds
    v_mfma_f32_16x16x32_bf16 v[32:35], a[232:235], a[36:39], v[32:35]
    ds_read_b64_tr_b16 a[216:217], v220 offset:16384
    ds_read_b64_tr_b16 a[218:219], v220 offset:16896
    v_mfma_f32_16x16x32_bf16 v[36:39], a[232:235], a[108:111], v[36:39]
    ds_read_b64_tr_b16 a[220:221], v221 offset:16384
    v_mfma_f32_16x16x32_bf16 v[40:43], a[236:239], a[36:39], v[40:43]
    ds_read_b64_tr_b16 a[222:223], v221 offset:16896
    v_mfma_f32_16x16x32_bf16 v[44:47], a[236:239], a[108:111], v[44:47]
    ds_read_b64_tr_b16 a[224:225], v222 offset:16384
    s_waitcnt lgkmcnt(5)
L_back_step19:
    v_mfma_f32_16x16x32_bf16 v[48:51], a[240:243], a[36:39], v[48:51]
    buffer_load_dwordx4 v234, s[12:15], s61 offen offset:1024 lds
    v_mfma_f32_16x16x32_bf16 v[52:55], a[240:243], a[108:111], v[52:55]
    ds_read_b64_tr_b16 a[226:227], v222 offset:16896
    ds_read_b64_tr_b16 a[228:229], v223 offset:16384
    v_mfma_f32_16x16x32_bf16 v[56:59], a[244:247], a[36:39], v[56:59]
    ds_read_b64_tr_b16 a[230:231], v223 offset:16896
    v_mfma_f32_16x16x32_bf16 v[60:63], a[244:247], a[108:111], v[60:63]
    ds_read_b64_tr_b16 a[232:233], v220 offset:17408
    v_mfma_f32_16x16x32_bf16 v[64:67], a[248:251], a[36:39], v[64:67]
    ds_read_b64_tr_b16 a[234:235], v220 offset:17920
    v_mfma_f32_16x16x32_bf16 v[68:71], a[248:251], a[108:111], v[68:71]
    ds_read_b64_tr_b16 a[236:237], v221 offset:17408
    v_mfma_f32_16x16x32_bf16 v[72:75], a[252:255], a[36:39], v[72:75]
    ds_read_b64_tr_b16 a[238:239], v221 offset:17920
    v_mfma_f32_16x16x32_bf16 v[76:79], a[252:255], a[108:111], v[76:79]
    ds_read_b64_tr_b16 a[240:241], v222 offset:17408
    s_waitcnt lgkmcnt(5)
L_back_step20:
    s_waitcnt vmcnt(25)
    v_mfma_f32_16x16x32_bf16 v[16:19], a[216:219], a[40:43], v[16:19]
    s_add_u32 s61, s56, 1476736
    ds_read_b64_tr_b16 a[242:243], v222 offset:17920
    s_waitcnt vmcnt(24)
    v_mfma_f32_16x16x32_bf16 v[20:23], a[216:219], a[112:115], v[20:23]
    buffer_load_dwordx4 v234, s[8:11], s61 offen offset:2048 lds
    v_mfma_f32_16x16x32_bf16 v[24:27], a[220:223], a[40:43], v[24:27]
    ds_read_b64_tr_b16 a[244:245], v223 offset:17408
    ds_read_b64_tr_b16 a[246:247], v223 offset:17920
    v_mfma_f32_16x16x32_bf16 v[28:31], a[220:223], a[112:115], v[28:31]
    ds_read_b64_tr_b16 a[248:249], v220 offset:18432
    v_mfma_f32_16x16x32_bf16 v[32:35], a[224:227], a[40:43], v[32:35]
    ds_read_b64_tr_b16 a[250:251], v220 offset:18944
    v_mfma_f32_16x16x32_bf16 v[36:39], a[224:227], a[112:115], v[36:39]
    ds_read_b64_tr_b16 a[252:253], v221 offset:18432
    v_mfma_f32_16x16x32_bf16 v[40:43], a[228:231], a[40:43], v[40:43]
    ds_read_b64_tr_b16 a[254:255], v221 offset:18944
    v_mfma_f32_16x16x32_bf16 v[44:47], a[228:231], a[112:115], v[44:47]
    ds_read_b64_tr_b16 a[216:217], v222 offset:18432
    s_waitcnt lgkmcnt(5)
L_back_step21:
    v_mfma_f32_16x16x32_bf16 v[48:51], a[232:235], a[40:43], v[48:51]
    buffer_load_dwordx4 v234, s[12:15], s61 offen offset:3072 lds
    v_mfma_f32_16x16x32_bf16 v[52:55], a[232:235], a[112:115], v[52:55]
    ds_read_b64_tr_b16 a[218:219], v222 offset:18944
    ds_read_b64_tr_b16 a[220:221], v223 offset:18432
    v_mfma_f32_16x16x32_bf16 v[56:59], a[236:239], a[40:43], v[56:59]
    ds_read_b64_tr_b16 a[222:223], v223 offset:18944
    v_mfma_f32_16x16x32_bf16 v[60:63], a[236:239], a[112:115], v[60:63]
    ds_read_b64_tr_b16 a[224:225], v220 offset:19456
    v_mfma_f32_16x16x32_bf16 v[64:67], a[240:243], a[40:43], v[64:67]
    ds_read_b64_tr_b16 a[226:227], v220 offset:19968
    v_mfma_f32_16x16x32_bf16 v[68:71], a[240:243], a[112:115], v[68:71]
    ds_read_b64_tr_b16 a[228:229], v221 offset:19456
    v_mfma_f32_16x16x32_bf16 v[72:75], a[244:247], a[40:43], v[72:75]
    ds_read_b64_tr_b16 a[230:231], v221 offset:19968
    v_mfma_f32_16x16x32_bf16 v[76:79], a[244:247], a[112:115], v[76:79]
    ds_read_b64_tr_b16 a[232:233], v222 offset:19456
    s_waitcnt lgkmcnt(5)
L_back_step22:
    s_waitcnt vmcnt(25)
    v_mfma_f32_16x16x32_bf16 v[16:19], a[248:251], a[44:47], v[16:19]
    s_add_u32 m0, s60, 32768
    s_add_u32 s61, s56, 1773696
    s_waitcnt vmcnt(24)
    v_mfma_f32_16x16x32_bf16 v[20:23], a[248:251], a[116:119], v[20:23]
    ds_read_b64_tr_b16 a[234:235], v222 offset:19968
    ds_read_b64_tr_b16 a[236:237], v223 offset:19456
    v_mfma_f32_16x16x32_bf16 v[24:27], a[252:255], a[44:47], v[24:27]
    ds_read_b64_tr_b16 a[238:239], v223 offset:19968
    v_mfma_f32_16x16x32_bf16 v[28:31], a[252:255], a[116:119], v[28:31]
    buffer_load_dwordx4 v234, s[8:11], s61 offen offset:0 lds
    v_mfma_f32_16x16x32_bf16 v[32:35], a[216:219], a[44:47], v[32:35]
    s_barrier
    v_mfma_f32_16x16x32_bf16 v[36:39], a[216:219], a[116:119], v[36:39]
    buffer_load_dwordx4 v234, s[12:15], s61 offen offset:1024 lds
    v_mfma_f32_16x16x32_bf16 v[40:43], a[220:223], a[44:47], v[40:43]
    ds_read_b64_tr_b16 a[240:241], v220 offset:32768
    ds_read_b64_tr_b16 a[242:243], v220 offset:33280
    v_mfma_f32_16x16x32_bf16 v[44:47], a[220:223], a[116:119], v[44:47]
    ds_read_b64_tr_b16 a[244:245], v221 offset:32768
    s_waitcnt lgkmcnt(3)
L_back_step23:
    v_mfma_f32_16x16x32_bf16 v[48:51], a[224:227], a[44:47], v[48:51]
    ds_read_b64_tr_b16 a[246:247], v221 offset:33280
    ds_read_b64_tr_b16 a[248:249], v222 offset:32768
    v_mfma_f32_16x16x32_bf16 v[52:55], a[224:227], a[116:119], v[52:55]
    ds_read_b64_tr_b16 a[250:251], v222 offset:33280
    s_add_u32 s61, s56, 2066560
    v_mfma_f32_16x16x32_bf16 v[56:59], a[228:231], a[44:47], v[56:59]
    ds_read_b64_tr_b16 a[252:253], v223 offset:32768
    ds_read_b64_tr_b16 a[254:255], v223 offset:33280
    v_mfma_f32_16x16x32_bf16 v[60:63], a[228:231], a[116:119], v[60:63]
    buffer_load_dwordx4 v234, s[8:11], s61 offen offset:2048 lds
    v_mfma_f32_16x16x32_bf16 v[64:67], a[232:235], a[44:47], v[64:67]
    ds_read_b64_tr_b16 a[216:217], v220 offset:33792
    ds_read_b64_tr_b16 a[218:219], v220 offset:34304
    v_mfma_f32_16x16x32_bf16 v[68:71], a[232:235], a[116:119], v[68:71]
    buffer_load_dwordx4 v234, s[12:15], s61 offen offset:3072 lds
    v_mfma_f32_16x16x32_bf16 v[72:75], a[236:239], a[44:47], v[72:75]
    ds_read_b64_tr_b16 a[220:221], v221 offset:33792
    ds_read_b64_tr_b16 a[222:223], v221 offset:34304
    v_mfma_f32_16x16x32_bf16 v[76:79], a[236:239], a[116:119], v[76:79]
    ds_read_b64_tr_b16 a[224:225], v222 offset:33792
    s_waitcnt lgkmcnt(5)
L_back_step24:
    s_waitcnt vmcnt(27)
    v_mfma_f32_16x16x32_bf16 v[16:19], a[240:243], a[48:51], v[16:19]
    s_add_u32 m0, s60, 49152
    s_add_u32 s61, s56, 2363520
    s_waitcnt vmcnt(26)
    v_mfma_f32_16x16x32_bf16 v[20:23], a[240:243], a[120:123], v[20:23]
    ds_read_b64_tr_b16 a[226:227], v222 offset:34304
    ds_read_b64_tr_b16 a[228:229], v223 offset:33792
    v_mfma_f32_16x16x32_bf16 v[24:27], a[244:247], a[48:51], v[24:27]
    ds_read_b64_tr_b16 a[230:231], v223 offset:34304
    v_mfma_f32_16x16x32_bf16 v[28:31], a[244:247], a[120:123], v[28:31]
    buffer_load_dwordx4 v234, s[8:11], s61 offen offset:0 lds
    v_mfma_f32_16x16x32_bf16 v[32:35], a[248:251], a[48:51], v[32:35]
    ds_read_b64_tr_b16 a[232:233], v220 offset:34816
    ds_read_b64_tr_b16 a[234:235], v220 offset:35328
    v_mfma_f32_16x16x32_bf16 v[36:39], a[248:251], a[120:123], v[36:39]
    ds_read_b64_tr_b16 a[236:237], v221 offset:34816
    v_mfma_f32_16x16x32_bf16 v[40:43], a[252:255], a[48:51], v[40:43]
    s_mov_b32 exec_lo, 4294705152
    s_mov_b32 exec_hi, 15
    buffer_load_dword v13, v254, s[8:11], s91 offen
    buffer_load_dword v13, v254, s[12:15], s91 offen offset:1024
    s_mov_b64 exec, -1
    v_mfma_f32_16x16x32_bf16 v[44:47], a[252:255], a[120:123], v[44:47]
    ds_read_b64_tr_b16 a[238:239], v221 offset:35328
    s_waitcnt lgkmcnt(4)
L_back_step25:
    v_mfma_f32_16x16x32_bf16 v[48:51], a[216:219], a[48:51], v[48:51]
    ds_read_b64_tr_b16 a[240:241], v222 offset:34816
    ds_read_b64_tr_b16 a[242:243], v222 offset:35328
    v_mfma_f32_16x16x32_bf16 v[52:55], a[216:219], a[120:123], v[52:55]
    buffer_load_dwordx4 v234, s[12:15], s61 offen offset:1024 lds
    v_mfma_f32_16x16x32_bf16 v[56:59], a[220:223], a[48:51], v[56:59]
    ds_read_b64_tr_b16 a[244:245], v223 offset:34816
    ds_read_b64_tr_b16 a[246:247], v223 offset:35328
    v_mfma_f32_16x16x32_bf16 v[60:63], a[220:223], a[120:123], v[60:63]
    ds_read_b64_tr_b16 a[248:249], v220 offset:35840
    v_mfma_f32_16x16x32_bf16 v[64:67], a[224:227], a[48:51], v[64:67]
    ds_read_b64_tr_b16 a[250:251], v220 offset:36352
    v_mfma_f32_16x16x32_bf16 v[68:71], a[224:227], a[120:123], v[68:71]
    ds_read_b64_tr_b16 a[252:253], v221 offset:35840
    v_mfma_f32_16x16x32_bf16 v[72:75], a[228:231], a[48:51], v[72:75]
    ds_read_b64_tr_b16 a[254:255], v221 offset:36352
    v_mfma_f32_16x16x32_bf16 v[76:79], a[228:231], a[120:123], v[76:79]
    ds_read_b64_tr_b16 a[216:217], v222 offset:35840
    s_waitcnt lgkmcnt(5)
L_back_step26:
    s_waitcnt vmcnt(29)
    v_mfma_f32_16x16x32_bf16 v[16:19], a[232:235], a[52:55], v[16:19]
    s_add_u32 s61, s56, 2656384
    ds_read_b64_tr_b16 a[218:219], v222 offset:36352
    s_waitcnt vmcnt(28)
    v_mfma_f32_16x16x32_bf16 v[20:23], a[232:235], a[124:127], v[20:23]
    buffer_load_dwordx4 v234, s[8:11], s61 offen offset:2048 lds
    v_mfma_f32_16x16x32_bf16 v[24:27], a[236:239], a[52:55], v[24:27]
    ds_read_b64_tr_b16 a[220:221], v223 offset:35840
    ds_read_b64_tr_b16 a[222:223], v223 offset:36352
    v_mfma_f32_16x16x32_bf16 v[28:31], a[236:239], a[124:127], v[28:31]
    ds_read_b64_tr_b16 a[224:225], v220 offset:49152
    v_mfma_f32_16x16x32_bf16 v[32:35], a[240:243], a[52:55], v[32:35]
    ds_read_b64_tr_b16 a[226:227], v220 offset:49664
    v_mfma_f32_16x16x32_bf16 v[36:39], a[240:243], a[124:127], v[36:39]
    ds_read_b64_tr_b16 a[228:229], v221 offset:49152
    v_mfma_f32_16x16x32_bf16 v[40:43], a[244:247], a[52:55], v[40:43]
    ds_read_b64_tr_b16 a[230:231], v221 offset:49664
    v_mfma_f32_16x16x32_bf16 v[44:47], a[244:247], a[124:127], v[44:47]
    ds_read_b64_tr_b16 a[232:233], v222 offset:49152
    s_waitcnt lgkmcnt(5)
L_back_step27:
    v_mfma_f32_16x16x32_bf16 v[48:51], a[248:251], a[52:55], v[48:51]
    buffer_load_dwordx4 v234, s[12:15], s61 offen offset:3072 lds
    v_mfma_f32_16x16x32_bf16 v[52:55], a[248:251], a[124:127], v[52:55]
    ds_read_b64_tr_b16 a[234:235], v222 offset:49664
    ds_read_b64_tr_b16 a[236:237], v223 offset:49152
    v_mfma_f32_16x16x32_bf16 v[56:59], a[252:255], a[52:55], v[56:59]
    ds_read_b64_tr_b16 a[238:239], v223 offset:49664
    v_mfma_f32_16x16x32_bf16 v[60:63], a[252:255], a[124:127], v[60:63]
    ds_read_b64_tr_b16 a[240:241], v220 offset:50176
    v_mfma_f32_16x16x32_bf16 v[64:67], a[216:219], a[52:55], v[64:67]
    ds_read_b64_tr_b16 a[242:243], v220 offset:50688
    v_mfma_f32_16x16x32_bf16 v[68:71], a[216:219], a[124:127], v[68:71]
    ds_read_b64_tr_b16 a[244:245], v221 offset:50176
    v_mfma_f32_16x16x32_bf16 v[72:75], a[220:223], a[52:55], v[72:75]
    ds_read_b64_tr_b16 a[246:247], v221 offset:50688
    v_mfma_f32_16x16x32_bf16 v[76:79], a[220:223], a[124:127], v[76:79]
    ds_read_b64_tr_b16 a[248:249], v222 offset:50176
    s_waitcnt lgkmcnt(5)
L_back_step28:
    s_waitcnt vmcnt(29)
    v_mfma_f32_16x16x32_bf16 v[16:19], a[224:227], a[56:59], v[16:19]
    s_add_u32 m0, s60, 65536
    s_add_u32 s61, s56, 2953344
    s_waitcnt vmcnt(28)
    v_mfma_f32_16x16x32_bf16 v[20:23], a[224:227], a[128:131], v[20:23]
    ds_read_b64_tr_b16 a[250:251], v222 offset:50688
    ds_read_b64_tr_b16 a[252:253], v223 offset:50176
    v_mfma_f32_16x16x32_bf16 v[24:27], a[228:231], a[56:59], v[24:27]
    ds_read_b64_tr_b16 a[254:255], v223 offset:50688
    v_mfma_f32_16x16x32_bf16 v[28:31], a[228:231], a[128:131], v[28:31]
    buffer_load_dwordx4 v234, s[8:11], s61 offen offset:0 lds
    v_mfma_f32_16x16x32_bf16 v[32:35], a[232:235], a[56:59], v[32:35]
    ds_read_b64_tr_b16 a[216:217], v220 offset:51200
    ds_read_b64_tr_b16 a[218:219], v220 offset:51712
    v_mfma_f32_16x16x32_bf16 v[36:39], a[232:235], a[128:131], v[36:39]
    ds_read_b64_tr_b16 a[220:221], v221 offset:51200
    v_mfma_f32_16x16x32_bf16 v[40:43], a[236:239], a[56:59], v[40:43]
    ds_read_b64_tr_b16 a[222:223], v221 offset:51712
    v_mfma_f32_16x16x32_bf16 v[44:47], a[236:239], a[128:131], v[44:47]
    ds_read_b64_tr_b16 a[224:225], v222 offset:51200
    s_waitcnt lgkmcnt(5)
L_back_step29:
    v_mfma_f32_16x16x32_bf16 v[48:51], a[240:243], a[56:59], v[48:51]
    buffer_load_dwordx4 v234, s[12:15], s61 offen offset:1024 lds
    v_mfma_f32_16x16x32_bf16 v[52:55], a[240:243], a[128:131], v[52:55]
    ds_read_b64_tr_b16 a[226:227], v222 offset:51712
    ds_read_b64_tr_b16 a[228:229], v223 offset:51200
    v_mfma_f32_16x16x32_bf16 v[56:59], a[244:247], a[56:59], v[56:59]
    ds_read_b64_tr_b16 a[230:231], v223 offset:51712
    v_mfma_f32_16x16x32_bf16 v[60:63], a[244:247], a[128:131], v[60:63]
    ds_read_b64_tr_b16 a[232:233], v220 offset:52224
    v_mfma_f32_16x16x32_bf16 v[64:67], a[248:251], a[56:59], v[64:67]
    ds_read_b64_tr_b16 a[234:235], v220 offset:52736
    v_mfma_f32_16x16x32_bf16 v[68:71], a[248:251], a[128:131], v[68:71]
    ds_read_b64_tr_b16 a[236:237], v221 offset:52224
    v_mfma_f32_16x16x32_bf16 v[72:75], a[252:255], a[56:59], v[72:75]
    ds_read_b64_tr_b16 a[238:239], v221 offset:52736
    v_mfma_f32_16x16x32_bf16 v[76:79], a[252:255], a[128:131], v[76:79]
    ds_read_b64_tr_b16 a[240:241], v222 offset:52224
    s_waitcnt lgkmcnt(5)
L_back_step30:
    s_waitcnt vmcnt(29)
    v_mfma_f32_16x16x32_bf16 v[16:19], a[216:219], a[60:63], v[16:19]
    s_add_u32 s61, s56, 3246208
    ds_read_b64_tr_b16 a[242:243], v222 offset:52736
    s_waitcnt vmcnt(28)
    v_mfma_f32_16x16x32_bf16 v[20:23], a[216:219], a[132:135], v[20:23]
    buffer_load_dwordx4 v234, s[8:11], s61 offen offset:2048 lds
    v_mfma_f32_16x16x32_bf16 v[24:27], a[220:223], a[60:63], v[24:27]
    ds_read_b64_tr_b16 a[244:245], v223 offset:52224
    ds_read_b64_tr_b16 a[246:247], v223 offset:52736
    v_mfma_f32_16x16x32_bf16 v[28:31], a[220:223], a[132:135], v[28:31]
    v_mfma_f32_16x16x32_bf16 v[32:35], a[224:227], a[60:63], v[32:35]
    s_waitcnt vmcnt(21)
    s_barrier
    v_mfma_f32_16x16x32_bf16 v[36:39], a[224:227], a[132:135], v[36:39]
    buffer_load_dwordx4 v234, s[12:15], s61 offen offset:3072 lds
    v_mfma_f32_16x16x32_bf16 v[40:43], a[228:231], a[60:63], v[40:43]
    ds_read_b64_tr_b16 a[248:249], v224 offset:0
    ds_read_b64_tr_b16 a[250:251], v224 offset:512
    v_mfma_f32_16x16x32_bf16 v[44:47], a[228:231], a[132:135], v[44:47]
    ds_read_b64_tr_b16 a[252:253], v225 offset:0
    s_waitcnt lgkmcnt(3)
L_back_step31:
    v_mfma_f32_16x16x32_bf16 v[48:51], a[232:235], a[60:63], v[48:51]
    ds_read_b64_tr_b16 a[254:255], v225 offset:512
    ds_read_b64_tr_b16 a[216:217], v226 offset:0
    v_mfma_f32_16x16x32_bf16 v[52:55], a[232:235], a[132:135], v[52:55]
    ds_read_b64_tr_b16 a[218:219], v226 offset:512
    s_add_u32 m0, s60, 81920
    v_mfma_f32_16x16x32_bf16 v[56:59], a[236:239], a[60:63], v[56:59]
    ds_read_b64_tr_b16 a[220:221], v227 offset:0
    ds_read_b64_tr_b16 a[222:223], v227 offset:512
    v_mfma_f32_16x16x32_bf16 v[60:63], a[236:239], a[132:135], v[60:63]
    s_add_u32 s61, s56, 3543168
    buffer_load_dwordx4 v234, s[8:11], s61 offen offset:0 lds
    v_mfma_f32_16x16x32_bf16 v[64:67], a[240:243], a[60:63], v[64:67]
    ds_read_b64_tr_b16 a[224:225], v224 offset:1024
    ds_read_b64_tr_b16 a[226:227], v224 offset:1536
    v_mfma_f32_16x16x32_bf16 v[68:71], a[240:243], a[132:135], v[68:71]
    ds_read_b64_tr_b16 a[228:229], v225 offset:1024
    v_mfma_f32_16x16x32_bf16 v[72:75], a[244:247], a[60:63], v[72:75]
    ds_read_b64_tr_b16 a[230:231], v225 offset:1536
    v_mfma_f32_16x16x32_bf16 v[76:79], a[244:247], a[132:135], v[76:79]
    ds_read_b64_tr_b16 a[232:233], v226 offset:1024
    s_waitcnt lgkmcnt(5)
L_back_step32:
    v_mfma_f32_16x16x32_bf16 v[16:19], a[248:251], a[64:67], v[16:19]
    buffer_load_dwordx4 v234, s[12:15], s61 offen offset:1024 lds
    v_mfma_f32_16x16x32_bf16 v[20:23], a[248:251], a[136:139], v[20:23]
    ds_read_b64_tr_b16 a[234:235], v226 offset:1536
    ds_read_b64_tr_b16 a[236:237], v227 offset:1024
    v_mfma_f32_16x16x32_bf16 v[24:27], a[252:255], a[64:67], v[24:27]
    ds_read_b64_tr_b16 a[238:239], v227 offset:1536
    v_mfma_f32_16x16x32_bf16 v[28:31], a[252:255], a[136:139], v[28:31]
    ds_read_b64_tr_b16 a[240:241], v224 offset:2048
    v_mfma_f32_16x16x32_bf16 v[32:35], a[216:219], a[64:67], v[32:35]
    ds_read_b64_tr_b16 a[242:243], v224 offset:2560
    v_mfma_f32_16x16x32_bf16 v[36:39], a[216:219], a[136:139], v[36:39]
    ds_read_b64_tr_b16 a[244:245], v225 offset:2048
    v_mfma_f32_16x16x32_bf16 v[40:43], a[220:223], a[64:67], v[40:43]
    ds_read_b64_tr_b16 a[246:247], v225 offset:2560
    v_mfma_f32_16x16x32_bf16 v[44:47], a[220:223], a[136:139], v[44:47]
    ds_read_b64_tr_b16 a[248:249], v226 offset:2048
    s_waitcnt lgkmcnt(5)
L_back_step33:
    v_mfma_f32_16x16x32_bf16 v[48:51], a[224:227], a[64:67], v[48:51]
    s_add_u32 s61, s56, 3836032
    ds_read_b64_tr_b16 a[250:251], v226 offset:2560
    v_mfma_f32_16x16x32_bf16 v[52:55], a[224:227], a[136:139], v[52:55]
    buffer_load_dwordx4 v234, s[8:11], s61 offen offset:2048 lds
    v_mfma_f32_16x16x32_bf16 v[56:59], a[228:231], a[64:67], v[56:59]
    ds_read_b64_tr_b16 a[252:253], v227 offset:2048
    ds_read_b64_tr_b16 a[254:255], v227 offset:2560
    v_mfma_f32_16x16x32_bf16 v[60:63], a[228:231], a[136:139], v[60:63]
    ds_read_b64_tr_b16 a[216:217], v224 offset:3072
    v_mfma_f32_16x16x32_bf16 v[64:67], a[232:235], a[64:67], v[64:67]
    ds_read_b64_tr_b16 a[218:219], v224 offset:3584
    v_mfma_f32_16x16x32_bf16 v[68:71], a[232:235], a[136:139], v[68:71]
    ds_read_b64_tr_b16 a[220:221], v225 offset:3072
    v_mfma_f32_16x16x32_bf16 v[72:75], a[236:239], a[64:67], v[72:75]
    ds_read_b64_tr_b16 a[222:223], v225 offset:3584
    v_mfma_f32_16x16x32_bf16 v[76:79], a[236:239], a[136:139], v[76:79]
    ds_read_b64_tr_b16 a[224:225], v226 offset:3072
    s_waitcnt lgkmcnt(5)
L_back_step34:
    v_mfma_f32_16x16x32_bf16 v[16:19], a[240:243], a[68:71], v[16:19]
    buffer_load_dwordx4 v234, s[12:15], s61 offen offset:3072 lds
    v_mfma_f32_16x16x32_bf16 v[20:23], a[240:243], a[140:143], v[20:23]
    ds_read_b64_tr_b16 a[226:227], v226 offset:3584
    ds_read_b64_tr_b16 a[228:229], v227 offset:3072
    v_mfma_f32_16x16x32_bf16 v[24:27], a[244:247], a[68:71], v[24:27]
    ds_read_b64_tr_b16 a[230:231], v227 offset:3584
    v_mfma_f32_16x16x32_bf16 v[28:31], a[244:247], a[140:143], v[28:31]
    ds_read_b64_tr_b16 a[232:233], v224 offset:16384
    v_mfma_f32_16x16x32_bf16 v[32:35], a[248:251], a[68:71], v[32:35]
    ds_read_b64_tr_b16 a[234:235], v224 offset:16896
    v_mfma_f32_16x16x32_bf16 v[36:39], a[248:251], a[140:143], v[36:39]
    ds_read_b64_tr_b16 a[236:237], v225 offset:16384
    v_mfma_f32_16x16x32_bf16 v[40:43], a[252:255], a[68:71], v[40:43]
    ds_read_b64_tr_b16 a[238:239], v225 offset:16896
    v_mfma_f32_16x16x32_bf16 v[44:47], a[252:255], a[140:143], v[44:47]
    ds_read_b64_tr_b16 a[240:241], v226 offset:16384
    s_waitcnt lgkmcnt(5)
L_back_step35:
    v_mfma_f32_16x16x32_bf16 v[48:51], a[216:219], a[68:71], v[48:51]
    s_add_u32 m0, s60, 98304
    s_add_u32 s61, s56, 4132992
    v_mfma_f32_16x16x32_bf16 v[52:55], a[216:219], a[140:143], v[52:55]
    ds_read_b64_tr_b16 a[242:243], v226 offset:16896
    ds_read_b64_tr_b16 a[244:245], v227 offset:16384
    v_mfma_f32_16x16x32_bf16 v[56:59], a[220:223], a[68:71], v[56:59]
    ds_read_b64_tr_b16 a[246:247], v227 offset:16896
    v_mfma_f32_16x16x32_bf16 v[60:63], a[220:223], a[140:143], v[60:63]
    buffer_load_dwordx4 v234, s[8:11], s61 offen offset:0 lds
    v_mfma_f32_16x16x32_bf16 v[64:67], a[224:227], a[68:71], v[64:67]
    ds_read_b64_tr_b16 a[248:249], v224 offset:17408
    ds_read_b64_tr_b16 a[250:251], v224 offset:17920
    v_mfma_f32_16x16x32_bf16 v[68:71], a[224:227], a[140:143], v[68:71]
    ds_read_b64_tr_b16 a[252:253], v225 offset:17408
    v_mfma_f32_16x16x32_bf16 v[72:75], a[228:231], a[68:71], v[72:75]
    ds_read_b64_tr_b16 a[254:255], v225 offset:17920
    v_mfma_f32_16x16x32_bf16 v[76:79], a[228:231], a[140:143], v[76:79]
    ds_read_b64_tr_b16 a[216:217], v226 offset:17408
    s_waitcnt lgkmcnt(5)
L_back_step36:
    v_mfma_f32_16x16x32_bf16 v[80:83], a[232:235], a[0:3], 0
    buffer_load_dwordx4 v234, s[12:15], s61 offen offset:1024 lds
    v_mfma_f32_16x16x32_bf16 v[84:87], a[232:235], a[72:75], 0
    ds_read_b64_tr_b16 a[218:219], v226 offset:17920
    ds_read_b64_tr_b16 a[220:221], v227 offset:17408
    v_mfma_f32_16x16x32_bf16 v[88:91], a[236:239], a[0:3], 0
    ds_read_b64_tr_b16 a[222:223], v227 offset:17920
    v_mfma_f32_16x16x32_bf16 v[92:95], a[236:239], a[72:75], 0
    ds_read_b64_tr_b16 a[224:225], v224 offset:18432
    v_mfma_f32_16x16x32_bf16 v[96:99], a[240:243], a[0:3], 0
    v_exp_f32 v240, v16
    v_mfma_f32_16x16x32_bf16 v[100:103], a[240:243], a[72:75], 0
    ds_read_b64_tr_b16 a[226:227], v224 offset:18944
    ds_read_b64_tr_b16 a[228:229], v225 offset:18432
    v_mfma_f32_16x16x32_bf16 v[104:107], a[244:247], a[0:3], 0
    v_exp_f32 v241, v17
    v_mfma_f32_16x16x32_bf16 v[108:111], a[244:247], a[72:75], 0
    ds_read_b64_tr_b16 a[230:231], v225 offset:18944
    s_waitcnt lgkmcnt(4)
L_back_step37:
    v_mfma_f32_16x16x32_bf16 v[112:115], a[248:251], a[0:3], 0
    ds_read_b64_tr_b16 a[232:233], v226 offset:18432
    ds_read_b64_tr_b16 a[234:235], v226 offset:18944
    v_mfma_f32_16x16x32_bf16 v[116:119], a[248:251], a[72:75], 0
    v_exp_f32 v242, v18
    v_mfma_f32_16x16x32_bf16 v[120:123], a[252:255], a[0:3], 0
    ds_read_b64_tr_b16 a[236:237], v227 offset:18432
    ds_read_b64_tr_b16 a[238:239], v227 offset:18944
    v_mfma_f32_16x16x32_bf16 v[124:127], a[252:255], a[72:75], 0
    v_exp_f32 v243, v19
    v_mfma_f32_16x16x32_bf16 v[128:131], a[216:219], a[0:3], 0
    ds_read_b64_tr_b16 a[240:241], v224 offset:19456
    s_add_u32 s61, s56, 4425856
    buffer_load_dwordx4 v234, s[8:11], s61 offen offset:2048 lds
    v_add_f32 v240, 1.0, v240
    v_mfma_f32_16x16x32_bf16 v[132:135], a[216:219], a[72:75], 0
    ds_read_b64_tr_b16 a[242:243], v224 offset:19968
    v_add_f32 v241, 1.0, v241
    v_mfma_f32_16x16x32_bf16 v[136:139], a[220:223], a[0:3], 0
    ds_read_b64_tr_b16 a[244:245], v225 offset:19456
    v_add_f32 v242, 1.0, v242
    v_mfma_f32_16x16x32_bf16 v[140:143], a[220:223], a[72:75], 0
    ds_read_b64_tr_b16 a[246:247], v225 offset:19968
    s_waitcnt lgkmcnt(4)
L_back_step38:
    v_mfma_f32_16x16x32_bf16 v[80:83], a[224:227], a[4:7], v[80:83]
    ds_read_b64_tr_b16 a[248:249], v226 offset:19456
    ds_read_b64_tr_b16 a[250:251], v226 offset:19968
    v_add_f32 v243, 1.0, v243
    v_mfma_f32_16x16x32_bf16 v[84:87], a[224:227], a[76:79], v[84:87]
    buffer_load_dwordx4 v234, s[12:15], s61 offen offset:3072 lds
    v_mfma_f32_16x16x32_bf16 v[88:91], a[228:231], a[4:7], v[88:91]
    ds_read_b64_tr_b16 a[252:253], v227 offset:19456
    ds_read_b64_tr_b16 a[254:255], v227 offset:19968
    v_mfma_f32_16x16x32_bf16 v[92:95], a[228:231], a[76:79], v[92:95]
    v_rcp_f32 v240, v240
    v_mfma_f32_16x16x32_bf16 v[96:99], a[232:235], a[4:7], v[96:99]
    s_waitcnt vmcnt(22)
    s_barrier
    v_mfma_f32_16x16x32_bf16 v[100:103], a[232:235], a[76:79], v[100:103]
    ds_read_b64_tr_b16 a[216:217], v216 offset:0
    ds_read_b64_tr_b16 a[218:219], v216 offset:512
    v_mfma_f32_16x16x32_bf16 v[104:107], a[236:239], a[4:7], v[104:107]
    ds_read_b64_tr_b16 a[220:221], v217 offset:0
    ds_read_b64_tr_b16 a[222:223], v217 offset:512
    v_rcp_f32 v241, v241
    v_mfma_f32_16x16x32_bf16 v[108:111], a[236:239], a[76:79], v[108:111]
    ds_read_b64_tr_b16 a[224:225], v218 offset:0
    v_rcp_f32 v242, v242
    s_waitcnt lgkmcnt(5)
L_back_step39:
    v_mfma_f32_16x16x32_bf16 v[112:115], a[240:243], a[4:7], v[112:115]
    v_rcp_f32 v243, v243
    v_mfma_f32_16x16x32_bf16 v[116:119], a[240:243], a[76:79], v[116:119]
    ds_read_b64_tr_b16 a[226:227], v218 offset:512
    s_add_u32 m0, s60, 114688
    v_mul_f32 v240, v48, v240
    v_mfma_f32_16x16x32_bf16 v[120:123], a[244:247], a[4:7], v[120:123]
    ds_read_b64_tr_b16 a[228:229], v219 offset:0
    ds_read_b64_tr_b16 a[230:231], v219 offset:512
    v_mfma_f32_16x16x32_bf16 v[124:127], a[244:247], a[76:79], v[124:127]
    s_add_u32 s61, s56, 4722816
    buffer_load_dwordx4 v234, s[8:11], s61 offen offset:0 lds
    v_mul_f32 v241, v49, v241
    v_mfma_f32_16x16x32_bf16 v[128:131], a[248:251], a[4:7], v[128:131]
    ds_read_b64_tr_b16 a[232:233], v216 offset:1024
    v_mul_f32 v242, v50, v242
    v_mfma_f32_16x16x32_bf16 v[132:135], a[248:251], a[76:79], v[132:135]
    ds_read_b64_tr_b16 a[234:235], v216 offset:1536
    v_mul_f32 v243, v51, v243
    v_mfma_f32_16x16x32_bf16 v[136:139], a[252:255], a[4:7], v[136:139]
    ds_read_b64_tr_b16 a[236:237], v217 offset:1024
    v_cvt_pk_bf16_f32 v144, v240, v241
    v_mfma_f32_16x16x32_bf16 v[140:143], a[252:255], a[76:79], v[140:143]
    ds_read_b64_tr_b16 a[238:239], v217 offset:1536
    s_waitcnt lgkmcnt(4)
L_back_step40:
    v_mfma_f32_16x16x32_bf16 v[80:83], a[216:219], a[8:11], v[80:83]
    ds_read_b64_tr_b16 a[240:241], v218 offset:1024
    ds_read_b64_tr_b16 a[242:243], v218 offset:1536
    v_cvt_pk_bf16_f32 v145, v242, v243
    v_mfma_f32_16x16x32_bf16 v[84:87], a[216:219], a[80:83], v[84:87]
    buffer_load_dwordx4 v234, s[12:15], s61 offen offset:1024 lds
    v_mfma_f32_16x16x32_bf16 v[88:91], a[220:223], a[8:11], v[88:91]
    ds_read_b64_tr_b16 a[244:245], v219 offset:1024
    ds_read_b64_tr_b16 a[246:247], v219 offset:1536
    v_mfma_f32_16x16x32_bf16 v[92:95], a[220:223], a[80:83], v[92:95]
    v_exp_f32 v244, v20
    v_mfma_f32_16x16x32_bf16 v[96:99], a[224:227], a[8:11], v[96:99]
    ds_read_b64_tr_b16 a[248:249], v216 offset:2048
    ds_read_b64_tr_b16 a[250:251], v216 offset:2560
    v_mfma_f32_16x16x32_bf16 v[100:103], a[224:227], a[80:83], v[100:103]
    v_exp_f32 v245, v21
    v_mfma_f32_16x16x32_bf16 v[104:107], a[228:231], a[8:11], v[104:107]
    ds_read_b64_tr_b16 a[252:253], v217 offset:2048
    ds_read_b64_tr_b16 a[254:255], v217 offset:2560
    v_mfma_f32_16x16x32_bf16 v[108:111], a[228:231], a[80:83], v[108:111]
    ds_read_b64_tr_b16 a[216:217], v218 offset:2048
    s_waitcnt lgkmcnt(5)
L_back_step41:
    v_mfma_f32_16x16x32_bf16 v[112:115], a[232:235], a[8:11], v[112:115]
    v_exp_f32 v246, v22
    v_mfma_f32_16x16x32_bf16 v[116:119], a[232:235], a[80:83], v[116:119]
    ds_read_b64_tr_b16 a[218:219], v218 offset:2560
    ds_read_b64_tr_b16 a[220:221], v219 offset:2048
    v_exp_f32 v247, v23
    v_add_f32 v244, 1.0, v244
    v_mfma_f32_16x16x32_bf16 v[120:123], a[236:239], a[8:11], v[120:123]
    ds_read_b64_tr_b16 a[222:223], v219 offset:2560
    s_add_u32 s61, s56, 5015680
    v_mfma_f32_16x16x32_bf16 v[124:127], a[236:239], a[80:83], v[124:127]
    buffer_load_dwordx4 v234, s[8:11], s61 offen offset:2048 lds
    v_add_f32 v245, 1.0, v245
    v_mfma_f32_16x16x32_bf16 v[128:131], a[240:243], a[8:11], v[128:131]
    ds_read_b64_tr_b16 a[224:225], v216 offset:3072
    v_add_f32 v246, 1.0, v246
    v_mfma_f32_16x16x32_bf16 v[132:135], a[240:243], a[80:83], v[132:135]
    ds_read_b64_tr_b16 a[226:227], v216 offset:3584
    v_add_f32 v247, 1.0, v247
    v_mfma_f32_16x16x32_bf16 v[136:139], a[244:247], a[8:11], v[136:139]
    ds_read_b64_tr_b16 a[228:229], v217 offset:3072
    ds_read_b64_tr_b16 a[230:231], v217 offset:3584
    v_mfma_f32_16x16x32_bf16 v[140:143], a[244:247], a[80:83], v[140:143]
    ds_read_b64_tr_b16 a[232:233], v218 offset:3072
    s_waitcnt lgkmcnt(5)
L_back_step42:
    v_mfma_f32_16x16x32_bf16 v[80:83], a[248:251], a[12:15], v[80:83]
    buffer_load_dwordx4 v234, s[12:15], s61 offen offset:3072 lds
    v_mfma_f32_16x16x32_bf16 v[84:87], a[248:251], a[84:87], v[84:87]
    ds_read_b64_tr_b16 a[234:235], v218 offset:3584
    ds_read_b64_tr_b16 a[236:237], v219 offset:3072
    v_rcp_f32 v244, v244
    v_mfma_f32_16x16x32_bf16 v[88:91], a[252:255], a[12:15], v[88:91]
    ds_read_b64_tr_b16 a[238:239], v219 offset:3584
    v_mfma_f32_16x16x32_bf16 v[92:95], a[252:255], a[84:87], v[92:95]
    v_rcp_f32 v245, v245
    v_mfma_f32_16x16x32_bf16 v[96:99], a[216:219], a[12:15], v[96:99]
    ds_read_b64_tr_b16 a[240:241], v216 offset:16384
    ds_read_b64_tr_b16 a[242:243], v216 offset:16896
    v_mfma_f32_16x16x32_bf16 v[100:103], a[216:219], a[84:87], v[100:103]
    v_rcp_f32 v246, v246
    v_mfma_f32_16x16x32_bf16 v[104:107], a[220:223], a[12:15], v[104:107]
    ds_read_b64_tr_b16 a[244:245], v217 offset:16384
    ds_read_b64_tr_b16 a[246:247], v217 offset:16896
    v_mfma_f32_16x16x32_bf16 v[108:111], a[220:223], a[84:87], v[108:111]
    ds_read_b64_tr_b16 a[248:249], v218 offset:16384
    v_rcp_f32 v247, v247
    v_mul_f32 v244, v52, v244
    s_waitcnt lgkmcnt(5)
L_back_step43:
    v_mfma_f32_16x16x32_bf16 v[112:115], a[224:227], a[12:15], v[112:115]
    s_add_u32 m0, s60, 131072
    s_add_u32 s61, s56, 4352
    v_mul_f32 v245, v53, v245
    v_mfma_f32_16x16x32_bf16 v[116:119], a[224:227], a[84:87], v[116:119]
    ds_read_b64_tr_b16 a[250:251], v218 offset:16896
    ds_read_b64_tr_b16 a[252:253], v219 offset:16384
    v_mfma_f32_16x16x32_bf16 v[120:123], a[228:231], a[12:15], v[120:123]
    ds_read_b64_tr_b16 a[254:255], v219 offset:16896
    v_mul_f32 v246, v54, v246
    v_mfma_f32_16x16x32_bf16 v[124:127], a[228:231], a[84:87], v[124:127]
    buffer_load_dwordx4 v234, s[8:11], s61 offen offset:0 lds
    v_mfma_f32_16x16x32_bf16 v[128:131], a[232:235], a[12:15], v[128:131]
    ds_read_b64_tr_b16 a[216:217], v216 offset:17408
    v_mul_f32 v247, v55, v247
    v_mfma_f32_16x16x32_bf16 v[132:135], a[232:235], a[84:87], v[132:135]
    ds_read_b64_tr_b16 a[218:219], v216 offset:17920
    v_cvt_pk_bf16_f32 v148, v244, v245
    v_mfma_f32_16x16x32_bf16 v[136:139], a[236:239], a[12:15], v[136:139]
    ds_read_b64_tr_b16 a[220:221], v217 offset:17408
    v_cvt_pk_bf16_f32 v149, v246, v247
    v_mfma_f32_16x16x32_bf16 v[140:143], a[236:239], a[84:87], v[140:143]
    ds_read_b64_tr_b16 a[222:223], v217 offset:17920
    s_waitcnt lgkmcnt(4)
L_back_step44:
    v_mfma_f32_16x16x32_bf16 v[80:83], a[240:243], a[16:19], v[80:83]
    ds_read_b64_tr_b16 a[224:225], v218 offset:17408
    ds_read_b64_tr_b16 a[226:227], v218 offset:17920
    v_mfma_f32_16x16x32_bf16 v[84:87], a[240:243], a[88:91], v[84:87]
    buffer_load_dwordx4 v234, s[12:15], s61 offen offset:1024 lds
    v_mfma_f32_16x16x32_bf16 v[88:91], a[244:247], a[16:19], v[88:91]
    ds_read_b64_tr_b16 a[228:229], v219 offset:17408
    ds_read_b64_tr_b16 a[230:231], v219 offset:17920
    v_exp_f32 v240, v24
    v_mfma_f32_16x16x32_bf16 v[92:95], a[244:247], a[88:91], v[92:95]
    v_exp_f32 v241, v25
    v_mfma_f32_16x16x32_bf16 v[96:99], a[248:251], a[16:19], v[96:99]
    ds_read_b64_tr_b16 a[232:233], v216 offset:18432
    ds_read_b64_tr_b16 a[234:235], v216 offset:18944
    v_mfma_f32_16x16x32_bf16 v[100:103], a[248:251], a[88:91], v[100:103]
    v_exp_f32 v242, v26
    v_mfma_f32_16x16x32_bf16 v[104:107], a[252:255], a[16:19], v[104:107]
    s_mov_b32 exec_lo, 0
    s_mov_b32 exec_hi, 8176
    buffer_load_dword v13, v254, s[8:11], s91 offen
    buffer_load_dword v13, v254, s[12:15], s91 offen offset:1024
    s_mov_b64 exec, -1
    v_mfma_f32_16x16x32_bf16 v[108:111], a[252:255], a[88:91], v[108:111]
    ds_read_b64_tr_b16 a[236:237], v217 offset:18432
    s_waitcnt lgkmcnt(3)
L_back_step45:
    v_mfma_f32_16x16x32_bf16 v[112:115], a[216:219], a[16:19], v[112:115]
    ds_read_b64_tr_b16 a[238:239], v217 offset:18944
    ds_read_b64_tr_b16 a[240:241], v218 offset:18432
    v_exp_f32 v243, v27
    v_add_f32 v240, 1.0, v240
    v_mfma_f32_16x16x32_bf16 v[116:119], a[216:219], a[88:91], v[116:119]
    ds_read_b64_tr_b16 a[242:243], v218 offset:18944
    s_add_u32 s61, s56, 297216
    v_add_f32 v241, 1.0, v241
    v_mfma_f32_16x16x32_bf16 v[120:123], a[220:223], a[16:19], v[120:123]
    ds_read_b64_tr_b16 a[244:245], v219 offset:18432
    ds_read_b64_tr_b16 a[246:247], v219 offset:18944
    v_mfma_f32_16x16x32_bf16 v[124:127], a[220:223], a[88:91], v[124:127]
    buffer_load_dwordx4 v234, s[8:11], s61 offen offset:2048 lds
    v_add_f32 v242, 1.0, v242
    v_mfma_f32_16x16x32_bf16 v[128:131], a[224:227], a[16:19], v[128:131]
    ds_read_b64_tr_b16 a[248:249], v216 offset:19456
    v_add_f32 v243, 1.0, v243
    v_mfma_f32_16x16x32_bf16 v[132:135], a[224:227], a[88:91], v[132:135]
    ds_read_b64_tr_b16 a[250:251], v216 offset:19968
    ds_read_b64_tr_b16 a[252:253], v217 offset:19456
    v_mfma_f32_16x16x32_bf16 v[136:139], a[228:231], a[16:19], v[136:139]
    v_rcp_f32 v240, v240
    v_mfma_f32_16x16x32_bf16 v[140:143], a[228:231], a[88:91], v[140:143]
    ds_read_b64_tr_b16 a[254:255], v217 offset:19968
    s_waitcnt lgkmcnt(4)
L_back_step46:
    v_mfma_f32_16x16x32_bf16 v[80:83], a[232:235], a[20:23], v[80:83]
    ds_read_b64_tr_b16 a[216:217], v218 offset:19456
    ds_read_b64_tr_b16 a[218:219], v218 offset:19968
    v_mfma_f32_16x16x32_bf16 v[84:87], a[232:235], a[92:95], v[84:87]
    buffer_load_dwordx4 v234, s[12:15], s61 offen offset:3072 lds
    v_mfma_f32_16x16x32_bf16 v[88:91], a[236:239], a[20:23], v[88:91]
    ds_read_b64_tr_b16 a[220:221], v219 offset:19456
    ds_read_b64_tr_b16 a[222:223], v219 offset:19968
    v_rcp_f32 v241, v241
    v_mfma_f32_16x16x32_bf16 v[92:95], a[236:239], a[92:95], v[92:95]
    v_rcp_f32 v242, v242
    v_mfma_f32_16x16x32_bf16 v[96:99], a[240:243], a[20:23], v[96:99]
    s_waitcnt vmcnt(22)
    s_barrier
    v_mfma_f32_16x16x32_bf16 v[100:103], a[240:243], a[92:95], v[100:103]
    ds_read_b64_tr_b16 a[224:225], v216 offset:32768
    ds_read_b64_tr_b16 a[226:227], v216 offset:33280
    v_mfma_f32_16x16x32_bf16 v[104:107], a[244:247], a[20:23], v[104:107]
    ds_read_b64_tr_b16 a[228:229], v217 offset:32768
    ds_read_b64_tr_b16 a[230:231], v217 offset:33280
    v_rcp_f32 v243, v243
    v_mul_f32 v240, v56, v240
    v_mfma_f32_16x16x32_bf16 v[108:111], a[244:247], a[92:95], v[108:111]
    v_mul_f32 v241, v57, v241
    s_waitcnt lgkmcnt(4)
L_back_step47:
    v_mfma_f32_16x16x32_bf16 v[112:115], a[248:251], a[20:23], v[112:115]
    ds_read_b64_tr_b16 a[232:233], v218 offset:32768
    s_add_u32 m0, s60, 147456
    v_mfma_f32_16x16x32_bf16 v[116:119], a[248:251], a[92:95], v[116:119]
    ds_read_b64_tr_b16 a[234:235], v218 offset:33280
    s_add_u32 s61, s56, 594176
    v_mul_f32 v242, v58, v242
    v_mfma_f32_16x16x32_bf16 v[120:123], a[252:255], a[20:23], v[120:123]
    ds_read_b64_tr_b16 a[236:237], v219 offset:32768
    ds_read_b64_tr_b16 a[238:239], v219 offset:33280
    v_mfma_f32_16x16x32_bf16 v[124:127], a[252:255], a[92:95], v[124:127]
    buffer_load_dwordx4 v234, s[8:11], s61 offen offset:0 lds
    v_mul_f32 v243, v59, v243
    v_mfma_f32_16x16x32_bf16 v[128:131], a[216:219], a[20:23], v[128:131]
    ds_read_b64_tr_b16 a[240:241], v216 offset:33792
    v_cvt_pk_bf16_f32 v146, v240, v241
    v_mfma_f32_16x16x32_bf16 v[132:135], a[216:219], a[92:95], v[132:135]
    ds_read_b64_tr_b16 a[242:243], v216 offset:34304
    v_cvt_pk_bf16_f32 v147, v242, v243
    v_mfma_f32_16x16x32_bf16 v[136:139], a[220:223], a[20:23], v[136:139]
    ds_read_b64_tr_b16 a[244:245], v217 offset:33792
    ds_read_b64_tr_b16 a[246:247], v217 offset:34304
    v_mfma_f32_16x16x32_bf16 v[140:143], a[220:223], a[92:95], v[140:143]
    ds_read_b64_tr_b16 a[248:249], v218 offset:33792
    s_waitcnt lgkmcnt(5)
L_back_step48:
    v_mfma_f32_16x16x32_bf16 v[80:83], a[224:227], a[24:27], v[80:83]
    buffer_load_dwordx4 v234, s[12:15], s61 offen offset:1024 lds
    v_mfma_f32_16x16x32_bf16 v[84:87], a[224:227], a[96:99], v[84:87]
    ds_read_b64_tr_b16 a[250:251], v218 offset:34304
    ds_read_b64_tr_b16 a[252:253], v219 offset:33792
    v_exp_f32 v244, v28
    v_mfma_f32_16x16x32_bf16 v[88:91], a[228:231], a[24:27], v[88:91]
    ds_read_b64_tr_b16 a[254:255], v219 offset:34304
    v_mfma_f32_16x16x32_bf16 v[92:95], a[228:231], a[96:99], v[92:95]
    v_exp_f32 v245, v29
    v_mfma_f32_16x16x32_bf16 v[96:99], a[232:235], a[24:27], v[96:99]
    ds_read_b64_tr_b16 a[216:217], v216 offset:34816
    ds_read_b64_tr_b16 a[218:219], v216 offset:35328
    v_mfma_f32_16x16x32_bf16 v[100:103], a[232:235], a[96:99], v[100:103]
    v_exp_f32 v246, v30
    v_mfma_f32_16x16x32_bf16 v[104:107], a[236:239], a[24:27], v[104:107]
    ds_read_b64_tr_b16 a[220:221], v217 offset:34816
    ds_read_b64_tr_b16 a[222:223], v217 offset:35328
    v_mfma_f32_16x16x32_bf16 v[108:111], a[236:239], a[96:99], v[108:111]
    ds_read_b64_tr_b16 a[224:225], v218 offset:34816
    v_exp_f32 v247, v31
    v_add_f32 v244, 1.0, v244
    s_waitcnt lgkmcnt(5)
L_back_step49:
    v_mfma_f32_16x16x32_bf16 v[112:115], a[240:243], a[24:27], v[112:115]
    s_add_u32 s61, s56, 887040
    ds_read_b64_tr_b16 a[226:227], v218 offset:35328
    v_mfma_f32_16x16x32_bf16 v[116:119], a[240:243], a[96:99], v[116:119]
    buffer_load_dwordx4 v234, s[8:11], s61 offen offset:2048 lds
    v_add_f32 v245, 1.0, v245
    v_mfma_f32_16x16x32_bf16 v[120:123], a[244:247], a[24:27], v[120:123]
    ds_read_b64_tr_b16 a[228:229], v219 offset:34816
    ds_read_b64_tr_b16 a[230:231], v219 offset:35328
    v_add_f32 v246, 1.0, v246
    v_mfma_f32_16x16x32_bf16 v[124:127], a[244:247], a[96:99], v[124:127]
    v_add_f32 v247, 1.0, v247
    ds_read_b64_tr_b16 a[232:233], v216 offset:35840
    v_mfma_f32_16x16x32_bf16 v[128:131], a[248:251], a[24:27], v[128:131]
    v_rcp_f32 v244, v244
    v_mfma_f32_16x16x32_bf16 v[132:135], a[248:251], a[96:99], v[132:135]
    ds_read_b64_tr_b16 a[234:235], v216 offset:36352
    ds_read_b64_tr_b16 a[236:237], v217 offset:35840
    v_mfma_f32_16x16x32_bf16 v[136:139], a[252:255], a[24:27], v[136:139]
    v_rcp_f32 v245, v245
    v_mfma_f32_16x16x32_bf16 v[140:143], a[252:255], a[96:99], v[140:143]
    ds_read_b64_tr_b16 a[238:239], v217 offset:36352
    s_waitcnt lgkmcnt(4)
L_back_step50:
    v_mfma_f32_16x16x32_bf16 v[80:83], a[216:219], a[28:31], v[80:83]
    ds_read_b64_tr_b16 a[240:241], v218 offset:35840
    ds_read_b64_tr_b16 a[242:243], v218 offset:36352
    v_mfma_f32_16x16x32_bf16 v[84:87], a[216:219], a[100:103], v[84:87]
    buffer_load_dwordx4 v234, s[12:15], s61 offen offset:3072 lds
    v_mfma_f32_16x16x32_bf16 v[88:91], a[220:223], a[28:31], v[88:91]
    ds_read_b64_tr_b16 a[244:245], v219 offset:35840
    ds_read_b64_tr_b16 a[246:247], v219 offset:36352
    v_rcp_f32 v246, v246
    v_mfma_f32_16x16x32_bf16 v[92:95], a[220:223], a[100:103], v[92:95]
    v_rcp_f32 v247, v247
    v_mfma_f32_16x16x32_bf16 v[96:99], a[224:227], a[28:31], v[96:99]
    ds_read_b64_tr_b16 a[248:249], v216 offset:49152
    v_mul_f32 v244, v60, v244
    v_mfma_f32_16x16x32_bf16 v[100:103], a[224:227], a[100:103], v[100:103]
    ds_read_b64_tr_b16 a[250:251], v216 offset:49664
    v_mul_f32 v245, v61, v245
    v_mfma_f32_16x16x32_bf16 v[104:107], a[228:231], a[28:31], v[104:107]
    ds_read_b64_tr_b16 a[252:253], v217 offset:49152
    v_mul_f32 v246, v62, v246
    v_mfma_f32_16x16x32_bf16 v[108:111], a[228:231], a[100:103], v[108:111]
    ds_read_b64_tr_b16 a[254:255], v217 offset:49664
    s_waitcnt lgkmcnt(4)
L_back_step51:
    v_mfma_f32_16x16x32_bf16 v[112:115], a[232:235], a[28:31], v[112:115]
    ds_read_b64_tr_b16 a[216:217], v218 offset:49152
    s_add_u32 m0, s60, 0
    v_mul_f32 v247, v63, v247
    v_mfma_f32_16x16x32_bf16 v[116:119], a[232:235], a[100:103], v[116:119]
    ds_read_b64_tr_b16 a[218:219], v218 offset:49664
    s_add_u32 s61, s56, 1184000
    v_mfma_f32_16x16x32_bf16 v[120:123], a[236:239], a[28:31], v[120:123]
    ds_read_b64_tr_b16 a[220:221], v219 offset:49152
    ds_read_b64_tr_b16 a[222:223], v219 offset:49664
    v_cvt_pk_bf16_f32 v150, v244, v245
    v_mfma_f32_16x16x32_bf16 v[124:127], a[236:239], a[100:103], v[124:127]
    buffer_load_dwordx4 v234, s[8:11], s61 offen offset:0 lds
    v_mfma_f32_16x16x32_bf16 v[128:131], a[240:243], a[28:31], v[128:131]
    ds_read_b64_tr_b16 a[224:225], v216 offset:50176
    v_cvt_pk_bf16_f32 v151, v246, v247
    v_mfma_f32_16x16x32_bf16 v[132:135], a[240:243], a[100:103], v[132:135]
    ds_read_b64_tr_b16 a[226:227], v216 offset:50688
    ds_read_b64_tr_b16 a[228:229], v217 offset:50176
    v_mfma_f32_16x16x32_bf16 v[136:139], a[244:247], a[28:31], v[136:139]
    v_exp_f32 v240, v32
    v_mfma_f32_16x16x32_bf16 v[140:143], a[244:247], a[100:103], v[140:143]
    ds_read_b64_tr_b16 a[230:231], v217 offset:50688
    s_waitcnt lgkmcnt(4)
L_back_step52:
    v_mfma_f32_16x16x32_bf16 v[80:83], a[248:251], a[32:35], v[80:83]
    ds_read_b64_tr_b16 a[232:233], v218 offset:50176
    ds_read_b64_tr_b16 a[234:235], v218 offset:50688
    v_mfma_f32_16x16x32_bf16 v[84:87], a[248:251], a[104:107], v[84:87]
    buffer_load_dwordx4 v234, s[12:15], s61 offen offset:1024 lds
    v_mfma_f32_16x16x32_bf16 v[88:91], a[252:255], a[32:35], v[88:91]
    ds_read_b64_tr_b16 a[236:237], v219 offset:50176
    ds_read_b64_tr_b16 a[238:239], v219 offset:50688
    v_exp_f32 v241, v33
    v_mfma_f32_16x16x32_bf16 v[92:95], a[252:255], a[104:107], v[92:95]
    v_exp_f32 v242, v34
    v_mfma_f32_16x16x32_bf16 v[96:99], a[216:219], a[32:35], v[96:99]
    ds_read_b64_tr_b16 a[240:241], v216 offset:51200
    ds_read_b64_tr_b16 a[242:243], v216 offset:51712
    v_mfma_f32_16x16x32_bf16 v[100:103], a[216:219], a[104:107], v[100:103]
    v_exp_f32 v243, v35
    v_mfma_f32_16x16x32_bf16 v[104:107], a[220:223], a[32:35], v[104:107]
    ds_read_b64_tr_b16 a[244:245], v217 offset:51200
    v_add_f32 v240, 1.0, v240
    v_mfma_f32_16x16x32_bf16 v[108:111], a[220:223], a[104:107], v[108:111]
    ds_read_b64_tr_b16 a[246:247], v217 offset:51712
    s_waitcnt lgkmcnt(4)
L_back_step53:
    v_mfma_f32_16x16x32_bf16 v[112:115], a[224:227], a[32:35], v[112:115]
    ds_read_b64_tr_b16 a[248:249], v218 offset:51200
    s_add_u32 s61, s56, 1476864
    v_add_f32 v241, 1.0, v241
    v_mfma_f32_16x16x32_bf16 v[116:119], a[224:227], a[104:107], v[116:119]
    ds_read_b64_tr_b16 a[250:251], v218 offset:51712
    ds_read_b64_tr_b16 a[252:253], v219 offset:51200
    v_add_f32 v242, 1.0, v242
    v_mfma_f32_16x16x32_bf16 v[120:123], a[228:231], a[32:35], v[120:123]
    ds_read_b64_tr_b16 a[254:255], v219 offset:51712
    v_add_f32 v243, 1.0, v243
    v_mfma_f32_16x16x32_bf16 v[124:127], a[228:231], a[104:107], v[124:127]
    buffer_load_dwordx4 v234, s[8:11], s61 offen offset:2048 lds
    v_mfma_f32_16x16x32_bf16 v[128:131], a[232:235], a[32:35], v[128:131]
    ds_read_b64_tr_b16 a[216:217], v216 offset:52224
    ds_read_b64_tr_b16 a[218:219], v216 offset:52736
    v_mfma_f32_16x16x32_bf16 v[132:135], a[232:235], a[104:107], v[132:135]
    v_rcp_f32 v240, v240
    v_mfma_f32_16x16x32_bf16 v[136:139], a[236:239], a[32:35], v[136:139]
    ds_read_b64_tr_b16 a[220:221], v217 offset:52224
    ds_read_b64_tr_b16 a[222:223], v217 offset:52736
    v_mfma_f32_16x16x32_bf16 v[140:143], a[236:239], a[104:107], v[140:143]
    ds_read_b64_tr_b16 a[224:225], v218 offset:52224
    s_waitcnt lgkmcnt(5)
L_back_step54:
    v_mfma_f32_16x16x32_bf16 v[80:83], a[240:243], a[36:39], v[80:83]
    buffer_load_dwordx4 v234, s[12:15], s61 offen offset:3072 lds
    v_rcp_f32 v241, v241
    v_mfma_f32_16x16x32_bf16 v[84:87], a[240:243], a[108:111], v[84:87]
    ds_read_b64_tr_b16 a[226:227], v218 offset:52736
    ds_read_b64_tr_b16 a[228:229], v219 offset:52224
    v_mfma_f32_16x16x32_bf16 v[88:91], a[244:247], a[36:39], v[88:91]
    ds_read_b64_tr_b16 a[230:231], v219 offset:52736
    v_rcp_f32 v242, v242
    v_mfma_f32_16x16x32_bf16 v[92:95], a[244:247], a[108:111], v[92:95]
    v_rcp_f32 v243, v243
    v_mfma_f32_16x16x32_bf16 v[96:99], a[248:251], a[36:39], v[96:99]
    s_waitcnt vmcnt(22)
    s_barrier
    v_mul_f32 v240, v64, v240
    v_mfma_f32_16x16x32_bf16 v[100:103], a[248:251], a[108:111], v[100:103]
    ds_read_b64_tr_b16 a[232:233], v220 offset:0
    ds_read_b64_tr_b16 a[234:235], v220 offset:512
    v_mfma_f32_16x16x32_bf16 v[104:107], a[252:255], a[36:39], v[104:107]
    ds_read_b64_tr_b16 a[236:237], v221 offset:0
    v_mul_f32 v241, v65, v241
    v_mfma_f32_16x16x32_bf16 v[108:111], a[252:255], a[108:111], v[108:111]
    ds_read_b64_tr_b16 a[238:239], v221 offset:512
    s_waitcnt lgkmcnt(4)
L_back_step55:
    v_mfma_f32_16x16x32_bf16 v[112:115], a[216:219], a[36:39], v[112:115]
    ds_read_b64_tr_b16 a[240:241], v222 offset:0
    s_add_u32 m0, s60, 16384
    v_mul_f32 v242, v66, v242
    v_mfma_f32_16x16x32_bf16 v[116:119], a[216:219], a[108:111], v[116:119]
    ds_read_b64_tr_b16 a[242:243], v222 offset:512
    s_add_u32 s61, s56, 1773824
    v_mfma_f32_16x16x32_bf16 v[120:123], a[220:223], a[36:39], v[120:123]
    ds_read_b64_tr_b16 a[244:245], v223 offset:0
    ds_read_b64_tr_b16 a[246:247], v223 offset:512
    v_mul_f32 v243, v67, v243
    v_mfma_f32_16x16x32_bf16 v[124:127], a[220:223], a[108:111], v[124:127]
    buffer_load_dwordx4 v234, s[8:11], s61 offen offset:0 lds
    v_mfma_f32_16x16x32_bf16 v[128:131], a[224:227], a[36:39], v[128:131]
    ds_read_b64_tr_b16 a[248:249], v220 offset:1024
    v_cvt_pk_bf16_f32 v152, v240, v241
    v_mfma_f32_16x16x32_bf16 v[132:135], a[224:227], a[108:111], v[132:135]
    ds_read_b64_tr_b16 a[250:251], v220 offset:1536
    v_cvt_pk_bf16_f32 v153, v242, v243
    v_mfma_f32_16x16x32_bf16 v[136:139], a[228:231], a[36:39], v[136:139]
    ds_read_b64_tr_b16 a[252:253], v221 offset:1024
    ds_read_b64_tr_b16 a[254:255], v221 offset:1536
    v_mfma_f32_16x16x32_bf16 v[140:143], a[228:231], a[108:111], v[140:143]
    ds_read_b64_tr_b16 a[216:217], v222 offset:1024
    s_waitcnt lgkmcnt(5)
L_back_step56:
    v_mfma_f32_16x16x32_bf16 v[80:83], a[232:235], a[40:43], v[80:83]
    buffer_load_dwordx4 v234, s[12:15], s61 offen offset:1024 lds
    v_mfma_f32_16x16x32_bf16 v[84:87], a[232:235], a[112:115], v[84:87]
    ds_read_b64_tr_b16 a[218:219], v222 offset:1536
    ds_read_b64_tr_b16 a[220:221], v223 offset:1024
    v_exp_f32 v244, v36
    v_mfma_f32_16x16x32_bf16 v[88:91], a[236:239], a[40:43], v[88:91]
    ds_read_b64_tr_b16 a[222:223], v223 offset:1536
    v_mfma_f32_16x16x32_bf16 v[92:95], a[236:239], a[112:115], v[92:95]
    v_exp_f32 v245, v37
    v_mfma_f32_16x16x32_bf16 v[96:99], a[240:243], a[40:43], v[96:99]
    ds_read_b64_tr_b16 a[224:225], v220 offset:2048
    ds_read_b64_tr_b16 a[226:227], v220 offset:2560
    v_mfma_f32_16x16x32_bf16 v[100:103], a[240:243], a[112:115], v[100:103]
    v_exp_f32 v246, v38
    v_mfma_f32_16x16x32_bf16 v[104:107], a[244:247], a[40:43], v[104:107]
    ds_read_b64_tr_b16 a[228:229], v221 offset:2048
    ds_read_b64_tr_b16 a[230:231], v221 offset:2560
    v_mfma_f32_16x16x32_bf16 v[108:111], a[244:247], a[112:115], v[108:111]
    ds_read_b64_tr_b16 a[232:233], v222 offset:2048
    v_exp_f32 v247, v39
    v_add_f32 v244, 1.0, v244
    s_waitcnt lgkmcnt(5)
L_back_step57:
    v_mfma_f32_16x16x32_bf16 v[112:115], a[248:251], a[40:43], v[112:115]
    s_add_u32 s61, s56, 2066688
    ds_read_b64_tr_b16 a[234:235], v222 offset:2560
    v_mfma_f32_16x16x32_bf16 v[116:119], a[248:251], a[112:115], v[116:119]
    buffer_load_dwordx4 v234, s[8:11], s61 offen offset:2048 lds
    v_add_f32 v245, 1.0, v245
    v_mfma_f32_16x16x32_bf16 v[120:123], a[252:255], a[40:43], v[120:123]
    ds_read_b64_tr_b16 a[236:237], v223 offset:2048
    ds_read_b64_tr_b16 a[238:239], v223 offset:2560
    v_mfma_f32_16x16x32_bf16 v[124:127], a[252:255], a[112:115], v[124:127]
    v_add_f32 v246, 1.0, v246
    v_add_f32 v247, 1.0, v247
    v_mfma_f32_16x16x32_bf16 v[128:131], a[216:219], a[40:43], v[128:131]
    ds_read_b64_tr_b16 a[240:241], v220 offset:3072
    ds_read_b64_tr_b16 a[242:243], v220 offset:3584
    v_mfma_f32_16x16x32_bf16 v[132:135], a[216:219], a[112:115], v[132:135]
    v_rcp_f32 v244, v244
    v_mfma_f32_16x16x32_bf16 v[136:139], a[220:223], a[40:43], v[136:139]
    ds_read_b64_tr_b16 a[244:245], v221 offset:3072
    ds_read_b64_tr_b16 a[246:247], v221 offset:3584
    v_mfma_f32_16x16x32_bf16 v[140:143], a[220:223], a[112:115], v[140:143]
    ds_read_b64_tr_b16 a[248:249], v222 offset:3072
    s_waitcnt lgkmcnt(5)
L_back_step58:
    v_mfma_f32_16x16x32_bf16 v[80:83], a[224:227], a[44:47], v[80:83]
    buffer_load_dwordx4 v234, s[12:15], s61 offen offset:3072 lds
    v_mfma_f32_16x16x32_bf16 v[84:87], a[224:227], a[116:119], v[84:87]
    ds_read_b64_tr_b16 a[250:251], v222 offset:3584
    ds_read_b64_tr_b16 a[252:253], v223 offset:3072
    v_rcp_f32 v245, v245
    v_mfma_f32_16x16x32_bf16 v[88:91], a[228:231], a[44:47], v[88:91]
    ds_read_b64_tr_b16 a[254:255], v223 offset:3584
    v_mfma_f32_16x16x32_bf16 v[92:95], a[228:231], a[116:119], v[92:95]
    v_rcp_f32 v246, v246
    v_mfma_f32_16x16x32_bf16 v[96:99], a[232:235], a[44:47], v[96:99]
    ds_read_b64_tr_b16 a[216:217], v220 offset:16384
    ds_read_b64_tr_b16 a[218:219], v220 offset:16896
    v_mfma_f32_16x16x32_bf16 v[100:103], a[232:235], a[116:119], v[100:103]
    v_rcp_f32 v247, v247
    v_mul_f32 v244, v68, v244
    v_mfma_f32_16x16x32_bf16 v[104:107], a[236:239], a[44:47], v[104:107]
    ds_read_b64_tr_b16 a[220:221], v221 offset:16384
    v_mul_f32 v245, v69, v245
    v_mfma_f32_16x16x32_bf16 v[108:111], a[236:239], a[116:119], v[108:111]
    ds_read_b64_tr_b16 a[222:223], v221 offset:16896
    s_waitcnt lgkmcnt(4)
L_back_step59:
    v_mfma_f32_16x16x32_bf16 v[112:115], a[240:243], a[44:47], v[112:115]
    ds_read_b64_tr_b16 a[224:225], v222 offset:16384
    s_add_u32 m0, s60, 32768
    v_mul_f32 v246, v70, v246
    v_mfma_f32_16x16x32_bf16 v[116:119], a[240:243], a[116:119], v[116:119]
    ds_read_b64_tr_b16 a[226:227], v222 offset:16896
    s_add_u32 s61, s56, 2363648
    v_mfma_f32_16x16x32_bf16 v[120:123], a[244:247], a[44:47], v[120:123]
    ds_read_b64_tr_b16 a[228:229], v223 offset:16384
    ds_read_b64_tr_b16 a[230:231], v223 offset:16896
    v_mul_f32 v247, v71, v247
    v_mfma_f32_16x16x32_bf16 v[124:127], a[244:247], a[116:119], v[124:127]
    buffer_load_dwordx4 v234, s[8:11], s61 offen offset:0 lds
    v_mfma_f32_16x16x32_bf16 v[128:131], a[248:251], a[44:47], v[128:131]
    ds_read_b64_tr_b16 a[232:233], v220 offset:17408
    v_cvt_pk_bf16_f32 v156, v244, v245
    v_mfma_f32_16x16x32_bf16 v[132:135], a[248:251], a[116:119], v[132:135]
    ds_read_b64_tr_b16 a[234:235], v220 offset:17920
    v_cvt_pk_bf16_f32 v157, v246, v247
    v_mfma_f32_16x16x32_bf16 v[136:139], a[252:255], a[44:47], v[136:139]
    ds_read_b64_tr_b16 a[236:237], v221 offset:17408
    ds_read_b64_tr_b16 a[238:239], v221 offset:17920
    v_mfma_f32_16x16x32_bf16 v[140:143], a[252:255], a[116:119], v[140:143]
    ds_read_b64_tr_b16 a[240:241], v222 offset:17408
    s_waitcnt lgkmcnt(5)
L_back_step60:
    v_mfma_f32_16x16x32_bf16 v[80:83], a[216:219], a[48:51], v[80:83]
    buffer_load_dwordx4 v234, s[12:15], s61 offen offset:1024 lds
    v_mfma_f32_16x16x32_bf16 v[84:87], a[216:219], a[120:123], v[84:87]
    ds_read_b64_tr_b16 a[242:243], v222 offset:17920
    ds_read_b64_tr_b16 a[244:245], v223 offset:17408
    v_exp_f32 v240, v40
    v_mfma_f32_16x16x32_bf16 v[88:91], a[220:223], a[48:51], v[88:91]
    ds_read_b64_tr_b16 a[246:247], v223 offset:17920
    v_mfma_f32_16x16x32_bf16 v[92:95], a[220:223], a[120:123], v[92:95]
    v_exp_f32 v241, v41
    v_mfma_f32_16x16x32_bf16 v[96:99], a[224:227], a[48:51], v[96:99]
    ds_read_b64_tr_b16 a[248:249], v220 offset:18432
    ds_read_b64_tr_b16 a[250:251], v220 offset:18944
    v_mfma_f32_16x16x32_bf16 v[100:103], a[224:227], a[120:123], v[100:103]
    v_exp_f32 v242, v42
    v_mfma_f32_16x16x32_bf16 v[104:107], a[228:231], a[48:51], v[104:107]
    s_mov_b32 exec_lo, 134217727
    s_mov_b32 exec_hi, 0
    buffer_load_dword v13, v255, s[24:27], s91 offen
    s_mov_b64 exec, -1
    v_mfma_f32_16x16x32_bf16 v[108:111], a[228:231], a[120:123], v[108:111]
    ds_read_b64_tr_b16 a[252:253], v221 offset:18432
    v_exp_f32 v243, v43
    v_add_f32 v240, 1.0, v240
    s_waitcnt lgkmcnt(3)
L_back_step61:
    v_mfma_f32_16x16x32_bf16 v[112:115], a[232:235], a[48:51], v[112:115]
    ds_read_b64_tr_b16 a[254:255], v221 offset:18944
    ds_read_b64_tr_b16 a[216:217], v222 offset:18432
    v_mfma_f32_16x16x32_bf16 v[116:119], a[232:235], a[120:123], v[116:119]
    ds_read_b64_tr_b16 a[218:219], v222 offset:18944
    s_add_u32 s61, s56, 2656512
    v_add_f32 v241, 1.0, v241
    v_mfma_f32_16x16x32_bf16 v[120:123], a[236:239], a[48:51], v[120:123]
    ds_read_b64_tr_b16 a[220:221], v223 offset:18432
    ds_read_b64_tr_b16 a[222:223], v223 offset:18944
    v_mfma_f32_16x16x32_bf16 v[124:127], a[236:239], a[120:123], v[124:127]
    buffer_load_dwordx4 v234, s[8:11], s61 offen offset:2048 lds
    v_add_f32 v242, 1.0, v242
    v_mfma_f32_16x16x32_bf16 v[128:131], a[240:243], a[48:51], v[128:131]
    ds_read_b64_tr_b16 a[224:225], v220 offset:19456
    v_add_f32 v243, 1.0, v243
    v_mfma_f32_16x16x32_bf16 v[132:135], a[240:243], a[120:123], v[132:135]
    ds_read_b64_tr_b16 a[226:227], v220 offset:19968
    ds_read_b64_tr_b16 a[228:229], v221 offset:19456
    v_mfma_f32_16x16x32_bf16 v[136:139], a[244:247], a[48:51], v[136:139]
    v_rcp_f32 v240, v240
    v_mfma_f32_16x16x32_bf16 v[140:143], a[244:247], a[120:123], v[140:143]
    ds_read_b64_tr_b16 a[230:231], v221 offset:19968
    s_waitcnt lgkmcnt(4)
L_back_step62:
    v_mfma_f32_16x16x32_bf16 v[80:83], a[248:251], a[52:55], v[80:83]
    ds_read_b64_tr_b16 a[232:233], v222 offset:19456
    ds_read_b64_tr_b16 a[234:235], v222 offset:19968
    v_mfma_f32_16x16x32_bf16 v[84:87], a[248:251], a[124:127], v[84:87]
    buffer_load_dwordx4 v234, s[12:15], s61 offen offset:3072 lds
    v_mfma_f32_16x16x32_bf16 v[88:91], a[252:255], a[52:55], v[88:91]
    ds_read_b64_tr_b16 a[236:237], v223 offset:19456
    ds_read_b64_tr_b16 a[238:239], v223 offset:19968
    v_rcp_f32 v241, v241
    v_mfma_f32_16x16x32_bf16 v[92:95], a[252:255], a[124:127], v[92:95]
    v_rcp_f32 v242, v242
    v_mfma_f32_16x16x32_bf16 v[96:99], a[216:219], a[52:55], v[96:99]
    s_waitcnt vmcnt(23)
    s_barrier
    v_mfma_f32_16x16x32_bf16 v[100:103], a[216:219], a[124:127], v[100:103]
    ds_read_b64_tr_b16 a[240:241], v220 offset:32768
    ds_read_b64_tr_b16 a[242:243], v220 offset:33280
    v_mfma_f32_16x16x32_bf16 v[104:107], a[220:223], a[52:55], v[104:107]
    ds_read_b64_tr_b16 a[244:245], v221 offset:32768
    ds_read_b64_tr_b16 a[246:247], v221 offset:33280
    v_rcp_f32 v243, v243
    v_mul_f32 v240, v72, v240
    v_mfma_f32_16x16x32_bf16 v[108:111], a[220:223], a[124:127], v[108:111]
    v_mul_f32 v241, v73, v241
    s_waitcnt lgkmcnt(4)
L_back_step63:
    v_mfma_f32_16x16x32_bf16 v[112:115], a[224:227], a[52:55], v[112:115]
    ds_read_b64_tr_b16 a[248:249], v222 offset:32768
    s_add_u32 m0, s60, 49152
    v_mfma_f32_16x16x32_bf16 v[116:119], a[224:227], a[124:127], v[116:119]
    ds_read_b64_tr_b16 a[250:251], v222 offset:33280
    s_add_u32 s61, s56, 2953472
    v_mfma_f32_16x16x32_bf16 v[120:123], a[228:231], a[52:55], v[120:123]
    ds_read_b64_tr_b16 a[252:253], v223 offset:32768
    ds_read_b64_tr_b16 a[254:255], v223 offset:33280
    v_mul_f32 v242, v74, v242
    v_mfma_f32_16x16x32_bf16 v[124:127], a[228:231], a[124:127], v[124:127]
    buffer_load_dwordx4 v234, s[8:11], s61 offen offset:0 lds
    v_mfma_f32_16x16x32_bf16 v[128:131], a[232:235], a[52:55], v[128:131]
    ds_read_b64_tr_b16 a[216:217], v220 offset:33792
    v_mul_f32 v243, v75, v243
    v_mfma_f32_16x16x32_bf16 v[132:135], a[232:235], a[124:127], v[132:135]
    ds_read_b64_tr_b16 a[218:219], v220 offset:34304
    v_cvt_pk_bf16_f32 v154, v240, v241
    v_mfma_f32_16x16x32_bf16 v[136:139], a[236:239], a[52:55], v[136:139]
    ds_read_b64_tr_b16 a[220:221], v221 offset:33792
    v_cvt_pk_bf16_f32 v155, v242, v243
    v_mfma_f32_16x16x32_bf16 v[140:143], a[236:239], a[124:127], v[140:143]
    ds_read_b64_tr_b16 a[222:223], v221 offset:34304
    s_waitcnt lgkmcnt(4)
L_back_step64:
    v_mfma_f32_16x16x32_bf16 v[80:83], a[240:243], a[56:59], v[80:83]
    ds_read_b64_tr_b16 a[224:225], v222 offset:33792
    ds_read_b64_tr_b16 a[226:227], v222 offset:34304
    v_mfma_f32_16x16x32_bf16 v[84:87], a[240:243], a[128:131], v[84:87]
    buffer_load_dwordx4 v234, s[12:15], s61 offen offset:1024 lds
    v_mfma_f32_16x16x32_bf16 v[88:91], a[244:247], a[56:59], v[88:91]
    ds_read_b64_tr_b16 a[228:229], v223 offset:33792
    ds_read_b64_tr_b16 a[230:231], v223 offset:34304
    v_mfma_f32_16x16x32_bf16 v[92:95], a[244:247], a[128:131], v[92:95]
    v_exp_f32 v244, v44
    v_mfma_f32_16x16x32_bf16 v[96:99], a[248:251], a[56:59], v[96:99]
    ds_read_b64_tr_b16 a[232:233], v220 offset:34816
    ds_read_b64_tr_b16 a[234:235], v220 offset:35328
    v_mfma_f32_16x16x32_bf16 v[100:103], a[248:251], a[128:131], v[100:103]
    v_exp_f32 v245, v45
    v_mfma_f32_16x16x32_bf16 v[104:107], a[252:255], a[56:59], v[104:107]
    ds_read_b64_tr_b16 a[236:237], v221 offset:34816
    ds_read_b64_tr_b16 a[238:239], v221 offset:35328
    v_mfma_f32_16x16x32_bf16 v[108:111], a[252:255], a[128:131], v[108:111]
    ds_read_b64_tr_b16 a[240:241], v222 offset:34816
    v_exp_f32 v246, v46
    s_waitcnt lgkmcnt(5)
L_back_step65:
    v_mfma_f32_16x16x32_bf16 v[112:115], a[216:219], a[56:59], v[112:115]
    v_exp_f32 v247, v47
    v_mfma_f32_16x16x32_bf16 v[116:119], a[216:219], a[128:131], v[116:119]
    ds_read_b64_tr_b16 a[242:243], v222 offset:35328
    s_add_u32 s61, s56, 3246336
    v_add_f32 v244, 1.0, v244
    v_mfma_f32_16x16x32_bf16 v[120:123], a[220:223], a[56:59], v[120:123]
    ds_read_b64_tr_b16 a[244:245], v223 offset:34816
    ds_read_b64_tr_b16 a[246:247], v223 offset:35328
    v_mfma_f32_16x16x32_bf16 v[124:127], a[220:223], a[128:131], v[124:127]
    buffer_load_dwordx4 v234, s[8:11], s61 offen offset:2048 lds
    v_add_f32 v245, 1.0, v245
    v_mfma_f32_16x16x32_bf16 v[128:131], a[224:227], a[56:59], v[128:131]
    ds_read_b64_tr_b16 a[248:249], v220 offset:35840
    v_add_f32 v246, 1.0, v246
    v_mfma_f32_16x16x32_bf16 v[132:135], a[224:227], a[128:131], v[132:135]
    ds_read_b64_tr_b16 a[250:251], v220 offset:36352
    v_add_f32 v247, 1.0, v247
    v_mfma_f32_16x16x32_bf16 v[136:139], a[228:231], a[56:59], v[136:139]
    ds_read_b64_tr_b16 a[252:253], v221 offset:35840
    ds_read_b64_tr_b16 a[254:255], v221 offset:36352
    v_mfma_f32_16x16x32_bf16 v[140:143], a[228:231], a[128:131], v[140:143]
    ds_read_b64_tr_b16 a[216:217], v222 offset:35840
    s_waitcnt lgkmcnt(5)
L_back_step66:
    v_mfma_f32_16x16x32_bf16 v[80:83], a[232:235], a[60:63], v[80:83]
    buffer_load_dwordx4 v234, s[12:15], s61 offen offset:3072 lds
    v_mfma_f32_16x16x32_bf16 v[84:87], a[232:235], a[132:135], v[84:87]
    ds_read_b64_tr_b16 a[218:219], v222 offset:36352
    ds_read_b64_tr_b16 a[220:221], v223 offset:35840
    v_mfma_f32_16x16x32_bf16 v[88:91], a[236:239], a[60:63], v[88:91]
    ds_read_b64_tr_b16 a[222:223], v223 offset:36352
    v_rcp_f32 v244, v244
    v_mfma_f32_16x16x32_bf16 v[92:95], a[236:239], a[132:135], v[92:95]
    v_rcp_f32 v245, v245
    v_mfma_f32_16x16x32_bf16 v[96:99], a[240:243], a[60:63], v[96:99]
    ds_read_b64_tr_b16 a[224:225], v220 offset:49152
    ds_read_b64_tr_b16 a[226:227], v220 offset:49664
    v_mfma_f32_16x16x32_bf16 v[100:103], a[240:243], a[132:135], v[100:103]
    v_rcp_f32 v246, v246
    v_mfma_f32_16x16x32_bf16 v[104:107], a[244:247], a[60:63], v[104:107]
    ds_read_b64_tr_b16 a[228:229], v221 offset:49152
    ds_read_b64_tr_b16 a[230:231], v221 offset:49664
    v_mfma_f32_16x16x32_bf16 v[108:111], a[244:247], a[132:135], v[108:111]
    ds_read_b64_tr_b16 a[232:233], v222 offset:49152
    s_waitcnt lgkmcnt(5)
L_back_step67:
    v_mfma_f32_16x16x32_bf16 v[112:115], a[248:251], a[60:63], v[112:115]
    v_rcp_f32 v247, v247
    v_mul_f32 v244, v76, v244
    v_mfma_f32_16x16x32_bf16 v[116:119], a[248:251], a[132:135], v[116:119]
    ds_read_b64_tr_b16 a[234:235], v222 offset:49664
    s_add_u32 m0, s60, 65536
    v_mfma_f32_16x16x32_bf16 v[120:123], a[252:255], a[60:63], v[120:123]
    ds_read_b64_tr_b16 a[236:237], v223 offset:49152
    ds_read_b64_tr_b16 a[238:239], v223 offset:49664
    v_mul_f32 v245, v77, v245
    v_mfma_f32_16x16x32_bf16 v[124:127], a[252:255], a[132:135], v[124:127]
    s_add_u32 s61, s56, 3543296
    buffer_load_dwordx4 v234, s[8:11], s61 offen offset:0 lds
    v_mfma_f32_16x16x32_bf16 v[128:131], a[216:219], a[60:63], v[128:131]
    ds_read_b64_tr_b16 a[240:241], v220 offset:50176
    v_mul_f32 v246, v78, v246
    v_mfma_f32_16x16x32_bf16 v[132:135], a[216:219], a[132:135], v[132:135]
    ds_read_b64_tr_b16 a[242:243], v220 offset:50688
    v_mul_f32 v247, v79, v247
    v_mfma_f32_16x16x32_bf16 v[136:139], a[220:223], a[60:63], v[136:139]
    ds_read_b64_tr_b16 a[244:245], v221 offset:50176
    v_cvt_pk_bf16_f32 v158, v244, v245
    v_mfma_f32_16x16x32_bf16 v[140:143], a[220:223], a[132:135], v[140:143]
    ds_read_b64_tr_b16 a[246:247], v221 offset:50688
    s_waitcnt lgkmcnt(4)
L_back_step68:
    v_mfma_f32_16x16x32_bf16 v[80:83], a[224:227], a[64:67], v[80:83]
    ds_read_b64_tr_b16 a[248:249], v222 offset:50176
    ds_read_b64_tr_b16 a[250:251], v222 offset:50688
    v_mfma_f32_16x16x32_bf16 v[84:87], a[224:227], a[136:139], v[84:87]
    buffer_load_dwordx4 v234, s[12:15], s61 offen offset:1024 lds
    v_cvt_pk_bf16_f32 v159, v246, v247
    v_mfma_f32_16x16x32_bf16 v[88:91], a[228:231], a[64:67], v[88:91]
    ds_read_b64_tr_b16 a[252:253], v223 offset:50176
    ds_read_b64_tr_b16 a[254:255], v223 offset:50688
    v_mfma_f32_16x16x32_bf16 v[92:95], a[228:231], a[136:139], v[92:95]
    s_add_u32 s39, s52, 0
    ds_read_b64_tr_b16 a[216:217], v220 offset:51200
    v_mfma_f32_16x16x32_bf16 v[96:99], a[232:235], a[64:67], v[96:99]
    buffer_store_dwordx4 v[144:147], v238, s[16:19], s39 offen offset:0 sc1
    v_mfma_f32_16x16x32_bf16 v[100:103], a[232:235], a[136:139], v[100:103]
    ds_read_b64_tr_b16 a[218:219], v220 offset:51712
    ds_read_b64_tr_b16 a[220:221], v221 offset:51200
    v_mfma_f32_16x16x32_bf16 v[104:107], a[236:239], a[64:67], v[104:107]
    buffer_store_dwordx4 v[148:151], v238, s[16:19], s39 offen offset:1024 sc1
    v_mfma_f32_16x16x32_bf16 v[108:111], a[236:239], a[136:139], v[108:111]
    ds_read_b64_tr_b16 a[222:223], v221 offset:51712
    s_waitcnt lgkmcnt(4)
L_back_step69:
    v_mfma_f32_16x16x32_bf16 v[112:115], a[240:243], a[64:67], v[112:115]
    ds_read_b64_tr_b16 a[224:225], v222 offset:51200
    ds_read_b64_tr_b16 a[226:227], v222 offset:51712
    v_mfma_f32_16x16x32_bf16 v[116:119], a[240:243], a[136:139], v[116:119]
    buffer_store_dwordx4 v[152:155], v238, s[16:19], s39 offen offset:2048 sc1
    v_mfma_f32_16x16x32_bf16 v[120:123], a[244:247], a[64:67], v[120:123]
    ds_read_b64_tr_b16 a[228:229], v223 offset:51200
    ds_read_b64_tr_b16 a[230:231], v223 offset:51712
    v_mfma_f32_16x16x32_bf16 v[124:127], a[244:247], a[136:139], v[124:127]
    buffer_store_dwordx4 v[156:159], v238, s[16:19], s39 offen offset:3072 sc1
    v_mfma_f32_16x16x32_bf16 v[128:131], a[248:251], a[64:67], v[128:131]
    ds_read_b64_tr_b16 a[232:233], v220 offset:52224
    s_add_u32 s61, s56, 3836160
    buffer_load_dwordx4 v234, s[8:11], s61 offen offset:2048 lds
    v_mfma_f32_16x16x32_bf16 v[132:135], a[248:251], a[136:139], v[132:135]
    ds_read_b64_tr_b16 a[234:235], v220 offset:52736
    ds_read_b64_tr_b16 a[236:237], v221 offset:52224
    v_mfma_f32_16x16x32_bf16 v[136:139], a[252:255], a[64:67], v[136:139]
    ds_read_b64_tr_b16 a[238:239], v221 offset:52736
    v_mfma_f32_16x16x32_bf16 v[140:143], a[252:255], a[136:139], v[140:143]
    ds_read_b64_tr_b16 a[240:241], v222 offset:52224
    s_waitcnt lgkmcnt(5)
L_back_step70:
    v_mfma_f32_16x16x32_bf16 v[80:83], a[216:219], a[68:71], v[80:83]
    buffer_load_dwordx4 v234, s[12:15], s61 offen offset:3072 lds
    v_mfma_f32_16x16x32_bf16 v[84:87], a[216:219], a[140:143], v[84:87]
    ds_read_b64_tr_b16 a[242:243], v222 offset:52736
    ds_read_b64_tr_b16 a[244:245], v223 offset:52224
    v_mfma_f32_16x16x32_bf16 v[88:91], a[220:223], a[68:71], v[88:91]
    ds_read_b64_tr_b16 a[246:247], v223 offset:52736
    v_mfma_f32_16x16x32_bf16 v[92:95], a[220:223], a[140:143], v[92:95]
    v_mfma_f32_16x16x32_bf16 v[96:99], a[224:227], a[68:71], v[96:99]
    s_waitcnt vmcnt(25)
    s_barrier
    v_mfma_f32_16x16x32_bf16 v[100:103], a[224:227], a[140:143], v[100:103]
    ds_read_b64_tr_b16 a[248:249], v224 offset:0
    ds_read_b64_tr_b16 a[250:251], v224 offset:512
    v_mfma_f32_16x16x32_bf16 v[104:107], a[228:231], a[68:71], v[104:107]
    ds_read_b64_tr_b16 a[252:253], v225 offset:0
    ds_read_b64_tr_b16 a[254:255], v225 offset:512
    v_mfma_f32_16x16x32_bf16 v[108:111], a[228:231], a[140:143], v[108:111]
    ds_read_b64_tr_b16 a[216:217], v226 offset:0
    s_waitcnt lgkmcnt(5)
L_back_step71:
    v_mfma_f32_16x16x32_bf16 v[112:115], a[232:235], a[68:71], v[112:115]
    s_add_u32 m0, s60, 81920
    s_add_u32 s61, s56, 4133120
    v_mfma_f32_16x16x32_bf16 v[116:119], a[232:235], a[140:143], v[116:119]
    ds_read_b64_tr_b16 a[218:219], v226 offset:512
    ds_read_b64_tr_b16 a[220:221], v227 offset:0
    v_mfma_f32_16x16x32_bf16 v[120:123], a[236:239], a[68:71], v[120:123]
    ds_read_b64_tr_b16 a[222:223], v227 offset:512
    v_mfma_f32_16x16x32_bf16 v[124:127], a[236:239], a[140:143], v[124:127]
    buffer_load_dwordx4 v234, s[8:11], s61 offen offset:0 lds
    v_mfma_f32_16x16x32_bf16 v[128:131], a[240:243], a[68:71], v[128:131]
    ds_read_b64_tr_b16 a[224:225], v224 offset:1024
    ds_read_b64_tr_b16 a[226:227], v224 offset:1536
    v_mfma_f32_16x16x32_bf16 v[132:135], a[240:243], a[140:143], v[132:135]
    ds_read_b64_tr_b16 a[228:229], v225 offset:1024
    v_mfma_f32_16x16x32_bf16 v[136:139], a[244:247], a[68:71], v[136:139]
    ds_read_b64_tr_b16 a[230:231], v225 offset:1536
    v_mfma_f32_16x16x32_bf16 v[140:143], a[244:247], a[140:143], v[140:143]
    ds_read_b64_tr_b16 a[232:233], v226 offset:1024
    s_waitcnt lgkmcnt(5)
L_back_step72:
    v_mfma_f32_16x16x32_bf16 v[16:19], a[248:251], a[0:3], 0
    buffer_load_dwordx4 v234, s[12:15], s61 offen offset:1024 lds
    v_mfma_f32_16x16x32_bf16 v[20:23], a[248:251], a[72:75], 0
    ds_read_b64_tr_b16 a[234:235], v226 offset:1536
    ds_read_b64_tr_b16 a[236:237], v227 offset:1024
    v_mfma_f32_16x16x32_bf16 v[24:27], a[252:255], a[0:3], 0
    ds_read_b64_tr_b16 a[238:239], v227 offset:1536
    v_mfma_f32_16x16x32_bf16 v[28:31], a[252:255], a[72:75], 0
    ds_read_b64_tr_b16 a[240:241], v224 offset:2048
    v_mfma_f32_16x16x32_bf16 v[32:35], a[216:219], a[0:3], 0
    v_exp_f32 v240, v80
    v_mfma_f32_16x16x32_bf16 v[36:39], a[216:219], a[72:75], 0
    ds_read_b64_tr_b16 a[242:243], v224 offset:2560
    ds_read_b64_tr_b16 a[244:245], v225 offset:2048
    v_mfma_f32_16x16x32_bf16 v[40:43], a[220:223], a[0:3], 0
    v_exp_f32 v241, v81
    v_mfma_f32_16x16x32_bf16 v[44:47], a[220:223], a[72:75], 0
    ds_read_b64_tr_b16 a[246:247], v225 offset:2560
    s_waitcnt lgkmcnt(4)
L_back_step73:
    v_mfma_f32_16x16x32_bf16 v[48:51], a[224:227], a[0:3], 0
    ds_read_b64_tr_b16 a[248:249], v226 offset:2048
    ds_read_b64_tr_b16 a[250:251], v226 offset:2560
    v_mfma_f32_16x16x32_bf16 v[52:55], a[224:227], a[72:75], 0
    v_exp_f32 v242, v82
    v_mfma_f32_16x16x32_bf16 v[56:59], a[228:231], a[0:3], 0
    ds_read_b64_tr_b16 a[252:253], v227 offset:2048
    ds_read_b64_tr_b16 a[254:255], v227 offset:2560
    v_mfma_f32_16x16x32_bf16 v[60:63], a[228:231], a[72:75], 0
    v_exp_f32 v243, v83
    v_mfma_f32_16x16x32_bf16 v[64:67], a[232:235], a[0:3], 0
    ds_read_b64_tr_b16 a[216:217], v224 offset:3072
    s_add_u32 s61, s56, 4425984
    buffer_load_dwordx4 v234, s[8:11], s61 offen offset:2048 lds
    v_add_f32 v240, 1.0, v240
    v_mfma_f32_16x16x32_bf16 v[68:71], a[232:235], a[72:75], 0
    ds_read_b64_tr_b16 a[218:219], v224 offset:3584
    v_add_f32 v241, 1.0, v241
    v_mfma_f32_16x16x32_bf16 v[72:75], a[236:239], a[0:3], 0
    ds_read_b64_tr_b16 a[220:221], v225 offset:3072
    v_add_f32 v242, 1.0, v242
    v_mfma_f32_16x16x32_bf16 v[76:79], a[236:239], a[72:75], 0
    ds_read_b64_tr_b16 a[222:223], v225 offset:3584
    s_waitcnt lgkmcnt(4)
L_back_step74:
    v_mfma_f32_16x16x32_bf16 v[16:19], a[240:243], a[4:7], v[16:19]
    ds_read_b64_tr_b16 a[224:225], v226 offset:3072
    ds_read_b64_tr_b16 a[226:227], v226 offset:3584
    v_add_f32 v243, 1.0, v243
    v_mfma_f32_16x16x32_bf16 v[20:23], a[240:243], a[76:79], v[20:23]
    buffer_load_dwordx4 v234, s[12:15], s61 offen offset:3072 lds
    v_mfma_f32_16x16x32_bf16 v[24:27], a[244:247], a[4:7], v[24:27]
    ds_read_b64_tr_b16 a[228:229], v227 offset:3072
    ds_read_b64_tr_b16 a[230:231], v227 offset:3584
    v_mfma_f32_16x16x32_bf16 v[28:31], a[244:247], a[76:79], v[28:31]
    v_rcp_f32 v240, v240
    v_mfma_f32_16x16x32_bf16 v[32:35], a[248:251], a[4:7], v[32:35]
    ds_read_b64_tr_b16 a[232:233], v224 offset:16384
    ds_read_b64_tr_b16 a[234:235], v224 offset:16896
    v_mfma_f32_16x16x32_bf16 v[36:39], a[248:251], a[76:79], v[36:39]
    v_rcp_f32 v241, v241
    v_mfma_f32_16x16x32_bf16 v[40:43], a[252:255], a[4:7], v[40:43]
    ds_read_b64_tr_b16 a[236:237], v225 offset:16384
    ds_read_b64_tr_b16 a[238:239], v225 offset:16896
    v_mfma_f32_16x16x32_bf16 v[44:47], a[252:255], a[76:79], v[44:47]
    ds_read_b64_tr_b16 a[240:241], v226 offset:16384
    v_rcp_f32 v242, v242
    s_waitcnt lgkmcnt(5)
L_back_step75:
    v_mfma_f32_16x16x32_bf16 v[48:51], a[216:219], a[4:7], v[48:51]
    v_rcp_f32 v243, v243
    v_mfma_f32_16x16x32_bf16 v[52:55], a[216:219], a[76:79], v[52:55]
    ds_read_b64_tr_b16 a[242:243], v226 offset:16896
    s_add_u32 m0, s60, 98304
    v_mul_f32 v240, v112, v240
    v_mfma_f32_16x16x32_bf16 v[56:59], a[220:223], a[4:7], v[56:59]
    ds_read_b64_tr_b16 a[244:245], v227 offset:16384
    ds_read_b64_tr_b16 a[246:247], v227 offset:16896
    v_mfma_f32_16x16x32_bf16 v[60:63], a[220:223], a[76:79], v[60:63]
    s_add_u32 s61, s56, 4722944
    buffer_load_dwordx4 v234, s[8:11], s61 offen offset:0 lds
    v_mul_f32 v241, v113, v241
    v_mfma_f32_16x16x32_bf16 v[64:67], a[224:227], a[4:7], v[64:67]
    ds_read_b64_tr_b16 a[248:249], v224 offset:17408
    v_mul_f32 v242, v114, v242
    v_mfma_f32_16x16x32_bf16 v[68:71], a[224:227], a[76:79], v[68:71]
    ds_read_b64_tr_b16 a[250:251], v224 offset:17920
    v_mul_f32 v243, v115, v243
    v_mfma_f32_16x16x32_bf16 v[72:75], a[228:231], a[4:7], v[72:75]
    ds_read_b64_tr_b16 a[252:253], v225 offset:17408
    v_cvt_pk_bf16_f32 v160, v240, v241
    v_mfma_f32_16x16x32_bf16 v[76:79], a[228:231], a[76:79], v[76:79]
    ds_read_b64_tr_b16 a[254:255], v225 offset:17920
    s_waitcnt lgkmcnt(4)
L_back_step76:
    v_mfma_f32_16x16x32_bf16 v[16:19], a[232:235], a[8:11], v[16:19]
    ds_read_b64_tr_b16 a[216:217], v226 offset:17408
    ds_read_b64_tr_b16 a[218:219], v226 offset:17920
    v_cvt_pk_bf16_f32 v161, v242, v243
    v_mfma_f32_16x16x32_bf16 v[20:23], a[232:235], a[80:83], v[20:23]
    buffer_load_dwordx4 v234, s[12:15], s61 offen offset:1024 lds
    v_mfma_f32_16x16x32_bf16 v[24:27], a[236:239], a[8:11], v[24:27]
    ds_read_b64_tr_b16 a[220:221], v227 offset:17408
    ds_read_b64_tr_b16 a[222:223], v227 offset:17920
    v_mfma_f32_16x16x32_bf16 v[28:31], a[236:239], a[80:83], v[28:31]
    v_exp_f32 v244, v84
    v_mfma_f32_16x16x32_bf16 v[32:35], a[240:243], a[8:11], v[32:35]
    ds_read_b64_tr_b16 a[224:225], v224 offset:18432
    ds_read_b64_tr_b16 a[226:227], v224 offset:18944
    v_mfma_f32_16x16x32_bf16 v[36:39], a[240:243], a[80:83], v[36:39]
    v_exp_f32 v245, v85
    v_mfma_f32_16x16x32_bf16 v[40:43], a[244:247], a[8:11], v[40:43]
    ds_read_b64_tr_b16 a[228:229], v225 offset:18432
    ds_read_b64_tr_b16 a[230:231], v225 offset:18944
    v_mfma_f32_16x16x32_bf16 v[44:47], a[244:247], a[80:83], v[44:47]
    ds_read_b64_tr_b16 a[232:233], v226 offset:18432
    s_waitcnt lgkmcnt(5)
L_back_step77:
    v_mfma_f32_16x16x32_bf16 v[48:51], a[248:251], a[8:11], v[48:51]
    v_exp_f32 v246, v86
    v_mfma_f32_16x16x32_bf16 v[52:55], a[248:251], a[80:83], v[52:55]
    ds_read_b64_tr_b16 a[234:235], v226 offset:18944
    ds_read_b64_tr_b16 a[236:237], v227 offset:18432
    v_exp_f32 v247, v87
    v_add_f32 v244, 1.0, v244
    v_mfma_f32_16x16x32_bf16 v[56:59], a[252:255], a[8:11], v[56:59]
    ds_read_b64_tr_b16 a[238:239], v227 offset:18944
    s_add_u32 s61, s56, 5015808
    v_mfma_f32_16x16x32_bf16 v[60:63], a[252:255], a[80:83], v[60:63]
    buffer_load_dwordx4 v234, s[8:11], s61 offen offset:2048 lds
    v_add_f32 v245, 1.0, v245
    v_mfma_f32_16x16x32_bf16 v[64:67], a[216:219], a[8:11], v[64:67]
    ds_read_b64_tr_b16 a[240:241], v224 offset:19456
    v_add_f32 v246, 1.0, v246
    v_mfma_f32_16x16x32_bf16 v[68:71], a[216:219], a[80:83], v[68:71]
    ds_read_b64_tr_b16 a[242:243], v224 offset:19968
    v_add_f32 v247, 1.0, v247
    v_mfma_f32_16x16x32_bf16 v[72:75], a[220:223], a[8:11], v[72:75]
    ds_read_b64_tr_b16 a[244:245], v225 offset:19456
    ds_read_b64_tr_b16 a[246:247], v225 offset:19968
    v_mfma_f32_16x16x32_bf16 v[76:79], a[220:223], a[80:83], v[76:79]
    ds_read_b64_tr_b16 a[248:249], v226 offset:19456
    s_waitcnt lgkmcnt(5)
L_back_step78:
    v_mfma_f32_16x16x32_bf16 v[16:19], a[224:227], a[12:15], v[16:19]
    buffer_load_dwordx4 v234, s[12:15], s61 offen offset:3072 lds
    v_mfma_f32_16x16x32_bf16 v[20:23], a[224:227], a[84:87], v[20:23]
    ds_read_b64_tr_b16 a[250:251], v226 offset:19968
    ds_read_b64_tr_b16 a[252:253], v227 offset:19456
    v_rcp_f32 v244, v244
    v_mfma_f32_16x16x32_bf16 v[24:27], a[228:231], a[12:15], v[24:27]
    ds_read_b64_tr_b16 a[254:255], v227 offset:19968
    v_mfma_f32_16x16x32_bf16 v[28:31], a[228:231], a[84:87], v[28:31]
    v_rcp_f32 v245, v245
    v_mfma_f32_16x16x32_bf16 v[32:35], a[232:235], a[12:15], v[32:35]
    s_waitcnt vmcnt(25)
    s_barrier
    v_mfma_f32_16x16x32_bf16 v[36:39], a[232:235], a[84:87], v[36:39]
    ds_read_b64_tr_b16 a[216:217], v216 offset:0
    ds_read_b64_tr_b16 a[218:219], v216 offset:512
    v_rcp_f32 v246, v246
    v_mfma_f32_16x16x32_bf16 v[40:43], a[236:239], a[12:15], v[40:43]
    ds_read_b64_tr_b16 a[220:221], v217 offset:0
    ds_read_b64_tr_b16 a[222:223], v217 offset:512
    v_mfma_f32_16x16x32_bf16 v[44:47], a[236:239], a[84:87], v[44:47]
    ds_read_b64_tr_b16 a[224:225], v218 offset:0
    v_rcp_f32 v247, v247
    v_mul_f32 v244, v116, v244
    s_waitcnt lgkmcnt(5)
L_back_step79:
    v_mfma_f32_16x16x32_bf16 v[48:51], a[240:243], a[12:15], v[48:51]
    s_add_u32 m0, s60, 114688
    s_add_u32 s61, s56, 4480
    v_mul_f32 v245, v117, v245
    v_mfma_f32_16x16x32_bf16 v[52:55], a[240:243], a[84:87], v[52:55]
    ds_read_b64_tr_b16 a[226:227], v218 offset:512
    ds_read_b64_tr_b16 a[228:229], v219 offset:0
    v_mfma_f32_16x16x32_bf16 v[56:59], a[244:247], a[12:15], v[56:59]
    ds_read_b64_tr_b16 a[230:231], v219 offset:512
    v_mul_f32 v246, v118, v246
    v_mfma_f32_16x16x32_bf16 v[60:63], a[244:247], a[84:87], v[60:63]
    buffer_load_dwordx4 v234, s[8:11], s61 offen offset:0 lds
    v_mfma_f32_16x16x32_bf16 v[64:67], a[248:251], a[12:15], v[64:67]
    ds_read_b64_tr_b16 a[232:233], v216 offset:1024
    v_mul_f32 v247, v119, v247
    v_mfma_f32_16x16x32_bf16 v[68:71], a[248:251], a[84:87], v[68:71]
    ds_read_b64_tr_b16 a[234:235], v216 offset:1536
    v_cvt_pk_bf16_f32 v164, v244, v245
    v_mfma_f32_16x16x32_bf16 v[72:75], a[252:255], a[12:15], v[72:75]
    ds_read_b64_tr_b16 a[236:237], v217 offset:1024
    v_cvt_pk_bf16_f32 v165, v246, v247
    v_mfma_f32_16x16x32_bf16 v[76:79], a[252:255], a[84:87], v[76:79]
    ds_read_b64_tr_b16 a[238:239], v217 offset:1536
    s_waitcnt lgkmcnt(4)
L_back_step80:
    v_mfma_f32_16x16x32_bf16 v[16:19], a[216:219], a[16:19], v[16:19]
    ds_read_b64_tr_b16 a[240:241], v218 offset:1024
    ds_read_b64_tr_b16 a[242:243], v218 offset:1536
    v_mfma_f32_16x16x32_bf16 v[20:23], a[216:219], a[88:91], v[20:23]
    buffer_load_dwordx4 v234, s[12:15], s61 offen offset:1024 lds
    v_mfma_f32_16x16x32_bf16 v[24:27], a[220:223], a[16:19], v[24:27]
    ds_read_b64_tr_b16 a[244:245], v219 offset:1024
    ds_read_b64_tr_b16 a[246:247], v219 offset:1536
    v_exp_f32 v240, v88
    v_mfma_f32_16x16x32_bf16 v[28:31], a[220:223], a[88:91], v[28:31]
    v_exp_f32 v241, v89
    v_mfma_f32_16x16x32_bf16 v[32:35], a[224:227], a[16:19], v[32:35]
    ds_read_b64_tr_b16 a[248:249], v216 offset:2048
    ds_read_b64_tr_b16 a[250:251], v216 offset:2560
    v_mfma_f32_16x16x32_bf16 v[36:39], a[224:227], a[88:91], v[36:39]
    v_exp_f32 v242, v90
    v_mfma_f32_16x16x32_bf16 v[40:43], a[228:231], a[16:19], v[40:43]
    s_mov_b32 exec_lo, 4160749568
    s_mov_b32 exec_hi, 8191
    buffer_load_dword v13, v255, s[24:27], s91 offen
    s_mov_b64 exec, -1
    v_mfma_f32_16x16x32_bf16 v[44:47], a[228:231], a[88:91], v[44:47]
    ds_read_b64_tr_b16 a[252:253], v217 offset:2048
    s_waitcnt lgkmcnt(3)
L_back_step81:
    v_mfma_f32_16x16x32_bf16 v[48:51], a[232:235], a[16:19], v[48:51]
    ds_read_b64_tr_b16 a[254:255], v217 offset:2560
    ds_read_b64_tr_b16 a[216:217], v218 offset:2048
    v_exp_f32 v243, v91
    v_add_f32 v240, 1.0, v240
    v_mfma_f32_16x16x32_bf16 v[52:55], a[232:235], a[88:91], v[52:55]
    ds_read_b64_tr_b16 a[218:219], v218 offset:2560
    s_add_u32 s61, s56, 297344
    v_add_f32 v241, 1.0, v241
    v_mfma_f32_16x16x32_bf16 v[56:59], a[236:239], a[16:19], v[56:59]
    ds_read_b64_tr_b16 a[220:221], v219 offset:2048
    ds_read_b64_tr_b16 a[222:223], v219 offset:2560
    v_mfma_f32_16x16x32_bf16 v[60:63], a[236:239], a[88:91], v[60:63]
    buffer_load_dwordx4 v234, s[8:11], s61 offen offset:2048 lds
    v_add_f32 v242, 1.0, v242
    v_mfma_f32_16x16x32_bf16 v[64:67], a[240:243], a[16:19], v[64:67]
    ds_read_b64_tr_b16 a[224:225], v216 offset:3072
    v_add_f32 v243, 1.0, v243
    v_mfma_f32_16x16x32_bf16 v[68:71], a[240:243], a[88:91], v[68:71]
    ds_read_b64_tr_b16 a[226:227], v216 offset:3584
    ds_read_b64_tr_b16 a[228:229], v217 offset:3072
    v_mfma_f32_16x16x32_bf16 v[72:75], a[244:247], a[16:19], v[72:75]
    v_rcp_f32 v240, v240
    v_mfma_f32_16x16x32_bf16 v[76:79], a[244:247], a[88:91], v[76:79]
    ds_read_b64_tr_b16 a[230:231], v217 offset:3584
    s_waitcnt lgkmcnt(4)
L_back_step82:
    v_mfma_f32_16x16x32_bf16 v[16:19], a[248:251], a[20:23], v[16:19]
    ds_read_b64_tr_b16 a[232:233], v218 offset:3072
    ds_read_b64_tr_b16 a[234:235], v218 offset:3584
    v_mfma_f32_16x16x32_bf16 v[20:23], a[248:251], a[92:95], v[20:23]
    buffer_load_dwordx4 v234, s[12:15], s61 offen offset:3072 lds
    v_mfma_f32_16x16x32_bf16 v[24:27], a[252:255], a[20:23], v[24:27]
    ds_read_b64_tr_b16 a[236:237], v219 offset:3072
    ds_read_b64_tr_b16 a[238:239], v219 offset:3584
    v_rcp_f32 v241, v241
    v_mfma_f32_16x16x32_bf16 v[28:31], a[252:255], a[92:95], v[28:31]
    v_rcp_f32 v242, v242
    v_mfma_f32_16x16x32_bf16 v[32:35], a[216:219], a[20:23], v[32:35]
    ds_read_b64_tr_b16 a[240:241], v216 offset:16384
    ds_read_b64_tr_b16 a[242:243], v216 offset:16896
    v_mfma_f32_16x16x32_bf16 v[36:39], a[216:219], a[92:95], v[36:39]
    v_rcp_f32 v243, v243
    v_mfma_f32_16x16x32_bf16 v[40:43], a[220:223], a[20:23], v[40:43]
    ds_read_b64_tr_b16 a[244:245], v217 offset:16384
    v_mul_f32 v240, v120, v240
    v_mfma_f32_16x16x32_bf16 v[44:47], a[220:223], a[92:95], v[44:47]
    ds_read_b64_tr_b16 a[246:247], v217 offset:16896
    v_mul_f32 v241, v121, v241
    s_waitcnt lgkmcnt(4)
L_back_step83:
    v_mfma_f32_16x16x32_bf16 v[48:51], a[224:227], a[20:23], v[48:51]
    ds_read_b64_tr_b16 a[248:249], v218 offset:16384
    s_add_u32 m0, s60, 131072
    v_mfma_f32_16x16x32_bf16 v[52:55], a[224:227], a[92:95], v[52:55]
    ds_read_b64_tr_b16 a[250:251], v218 offset:16896
    s_add_u32 s61, s56, 594304
    v_mul_f32 v242, v122, v242
    v_mfma_f32_16x16x32_bf16 v[56:59], a[228:231], a[20:23], v[56:59]
    ds_read_b64_tr_b16 a[252:253], v219 offset:16384
    ds_read_b64_tr_b16 a[254:255], v219 offset:16896
    v_mfma_f32_16x16x32_bf16 v[60:63], a[228:231], a[92:95], v[60:63]
    buffer_load_dwordx4 v234, s[8:11], s61 offen offset:0 lds
    v_mul_f32 v243, v123, v243
    v_mfma_f32_16x16x32_bf16 v[64:67], a[232:235], a[20:23], v[64:67]
    ds_read_b64_tr_b16 a[216:217], v216 offset:17408
    v_cvt_pk_bf16_f32 v162, v240, v241
    v_mfma_f32_16x16x32_bf16 v[68:71], a[232:235], a[92:95], v[68:71]
    ds_read_b64_tr_b16 a[218:219], v216 offset:17920
    v_cvt_pk_bf16_f32 v163, v242, v243
    v_mfma_f32_16x16x32_bf16 v[72:75], a[236:239], a[20:23], v[72:75]
    ds_read_b64_tr_b16 a[220:221], v217 offset:17408
    ds_read_b64_tr_b16 a[222:223], v217 offset:17920
    v_mfma_f32_16x16x32_bf16 v[76:79], a[236:239], a[92:95], v[76:79]
    ds_read_b64_tr_b16 a[224:225], v218 offset:17408
    s_waitcnt lgkmcnt(5)
L_back_step84:
    v_mfma_f32_16x16x32_bf16 v[16:19], a[240:243], a[24:27], v[16:19]
    buffer_load_dwordx4 v234, s[12:15], s61 offen offset:1024 lds
    v_mfma_f32_16x16x32_bf16 v[20:23], a[240:243], a[96:99], v[20:23]
    ds_read_b64_tr_b16 a[226:227], v218 offset:17920
    ds_read_b64_tr_b16 a[228:229], v219 offset:17408
    v_exp_f32 v244, v92
    v_mfma_f32_16x16x32_bf16 v[24:27], a[244:247], a[24:27], v[24:27]
    ds_read_b64_tr_b16 a[230:231], v219 offset:17920
    v_mfma_f32_16x16x32_bf16 v[28:31], a[244:247], a[96:99], v[28:31]
    v_exp_f32 v245, v93
    v_mfma_f32_16x16x32_bf16 v[32:35], a[248:251], a[24:27], v[32:35]
    ds_read_b64_tr_b16 a[232:233], v216 offset:18432
    ds_read_b64_tr_b16 a[234:235], v216 offset:18944
    v_mfma_f32_16x16x32_bf16 v[36:39], a[248:251], a[96:99], v[36:39]
    v_exp_f32 v246, v94
    v_mfma_f32_16x16x32_bf16 v[40:43], a[252:255], a[24:27], v[40:43]
    ds_read_b64_tr_b16 a[236:237], v217 offset:18432
    ds_read_b64_tr_b16 a[238:239], v217 offset:18944
    v_mfma_f32_16x16x32_bf16 v[44:47], a[252:255], a[96:99], v[44:47]
    ds_read_b64_tr_b16 a[240:241], v218 offset:18432
    v_exp_f32 v247, v95
    v_add_f32 v244, 1.0, v244
    s_waitcnt lgkmcnt(5)
L_back_step85:
    v_mfma_f32_16x16x32_bf16 v[48:51], a[216:219], a[24:27], v[48:51]
    s_add_u32 s61, s56, 887168
    ds_read_b64_tr_b16 a[242:243], v218 offset:18944
    v_add_f32 v245, 1.0, v245
    v_mfma_f32_16x16x32_bf16 v[52:55], a[216:219], a[96:99], v[52:55]
    buffer_load_dwordx4 v234, s[8:11], s61 offen offset:2048 lds
    v_mfma_f32_16x16x32_bf16 v[56:59], a[220:223], a[24:27], v[56:59]
    ds_read_b64_tr_b16 a[244:245], v219 offset:18432
    ds_read_b64_tr_b16 a[246:247], v219 offset:18944
    v_add_f32 v246, 1.0, v246
    v_mfma_f32_16x16x32_bf16 v[60:63], a[220:223], a[96:99], v[60:63]
    v_add_f32 v247, 1.0, v247
    ds_read_b64_tr_b16 a[248:249], v216 offset:19456
    v_mfma_f32_16x16x32_bf16 v[64:67], a[224:227], a[24:27], v[64:67]
    v_rcp_f32 v244, v244
    v_mfma_f32_16x16x32_bf16 v[68:71], a[224:227], a[96:99], v[68:71]
    ds_read_b64_tr_b16 a[250:251], v216 offset:19968
    ds_read_b64_tr_b16 a[252:253], v217 offset:19456
    v_mfma_f32_16x16x32_bf16 v[72:75], a[228:231], a[24:27], v[72:75]
    v_rcp_f32 v245, v245
    v_mfma_f32_16x16x32_bf16 v[76:79], a[228:231], a[96:99], v[76:79]
    ds_read_b64_tr_b16 a[254:255], v217 offset:19968
    s_waitcnt lgkmcnt(4)
L_back_step86:
    v_mfma_f32_16x16x32_bf16 v[16:19], a[232:235], a[28:31], v[16:19]
    ds_read_b64_tr_b16 a[216:217], v218 offset:19456
    ds_read_b64_tr_b16 a[218:219], v218 offset:19968
    v_mfma_f32_16x16x32_bf16 v[20:23], a[232:235], a[100:103], v[20:23]
    buffer_load_dwordx4 v234, s[12:15], s61 offen offset:3072 lds
    v_mfma_f32_16x16x32_bf16 v[24:27], a[236:239], a[28:31], v[24:27]
    ds_read_b64_tr_b16 a[220:221], v219 offset:19456
    ds_read_b64_tr_b16 a[222:223], v219 offset:19968
    v_rcp_f32 v246, v246
    v_mfma_f32_16x16x32_bf16 v[28:31], a[236:239], a[100:103], v[28:31]
    v_rcp_f32 v247, v247
    v_mfma_f32_16x16x32_bf16 v[32:35], a[240:243], a[28:31], v[32:35]
    s_waitcnt vmcnt(25)
    s_barrier
    v_mul_f32 v244, v124, v244
    v_mfma_f32_16x16x32_bf16 v[36:39], a[240:243], a[100:103], v[36:39]
    ds_read_b64_tr_b16 a[224:225], v216 offset:32768
    ds_read_b64_tr_b16 a[226:227], v216 offset:33280
    v_mfma_f32_16x16x32_bf16 v[40:43], a[244:247], a[28:31], v[40:43]
    ds_read_b64_tr_b16 a[228:229], v217 offset:32768
    v_mul_f32 v245, v125, v245
    v_mfma_f32_16x16x32_bf16 v[44:47], a[244:247], a[100:103], v[44:47]
    ds_read_b64_tr_b16 a[230:231], v217 offset:33280
    s_waitcnt lgkmcnt(4)
L_back_step87:
    v_mfma_f32_16x16x32_bf16 v[48:51], a[248:251], a[28:31], v[48:51]
    ds_read_b64_tr_b16 a[232:233], v218 offset:32768
    s_add_u32 m0, s60, 147456
    v_mul_f32 v246, v126, v246
    v_mfma_f32_16x16x32_bf16 v[52:55], a[248:251], a[100:103], v[52:55]
    ds_read_b64_tr_b16 a[234:235], v218 offset:33280
    s_add_u32 s61, s56, 1184128
    v_mfma_f32_16x16x32_bf16 v[56:59], a[252:255], a[28:31], v[56:59]
    ds_read_b64_tr_b16 a[236:237], v219 offset:32768
    ds_read_b64_tr_b16 a[238:239], v219 offset:33280
    v_mul_f32 v247, v127, v247
    v_mfma_f32_16x16x32_bf16 v[60:63], a[252:255], a[100:103], v[60:63]
    buffer_load_dwordx4 v234, s[8:11], s61 offen offset:0 lds
    v_cvt_pk_bf16_f32 v166, v244, v245
    v_mfma_f32_16x16x32_bf16 v[64:67], a[216:219], a[28:31], v[64:67]
    ds_read_b64_tr_b16 a[240:241], v216 offset:33792
    v_cvt_pk_bf16_f32 v167, v246, v247
    v_mfma_f32_16x16x32_bf16 v[68:71], a[216:219], a[100:103], v[68:71]
    ds_read_b64_tr_b16 a[242:243], v216 offset:34304
    ds_read_b64_tr_b16 a[244:245], v217 offset:33792
    v_mfma_f32_16x16x32_bf16 v[72:75], a[220:223], a[28:31], v[72:75]
    v_exp_f32 v240, v96
    v_mfma_f32_16x16x32_bf16 v[76:79], a[220:223], a[100:103], v[76:79]
    ds_read_b64_tr_b16 a[246:247], v217 offset:34304
    s_waitcnt lgkmcnt(4)
L_back_step88:
    v_mfma_f32_16x16x32_bf16 v[16:19], a[224:227], a[32:35], v[16:19]
    ds_read_b64_tr_b16 a[248:249], v218 offset:33792
    ds_read_b64_tr_b16 a[250:251], v218 offset:34304
    v_mfma_f32_16x16x32_bf16 v[20:23], a[224:227], a[104:107], v[20:23]
    buffer_load_dwordx4 v234, s[12:15], s61 offen offset:1024 lds
    v_mfma_f32_16x16x32_bf16 v[24:27], a[228:231], a[32:35], v[24:27]
    ds_read_b64_tr_b16 a[252:253], v219 offset:33792
    ds_read_b64_tr_b16 a[254:255], v219 offset:34304
    v_exp_f32 v241, v97
    v_mfma_f32_16x16x32_bf16 v[28:31], a[228:231], a[104:107], v[28:31]
    v_exp_f32 v242, v98
    v_mfma_f32_16x16x32_bf16 v[32:35], a[232:235], a[32:35], v[32:35]
    ds_read_b64_tr_b16 a[216:217], v216 offset:34816
    ds_read_b64_tr_b16 a[218:219], v216 offset:35328
    v_mfma_f32_16x16x32_bf16 v[36:39], a[232:235], a[104:107], v[36:39]
    v_exp_f32 v243, v99
    v_mfma_f32_16x16x32_bf16 v[40:43], a[236:239], a[32:35], v[40:43]
    ds_read_b64_tr_b16 a[220:221], v217 offset:34816
    v_add_f32 v240, 1.0, v240
    v_mfma_f32_16x16x32_bf16 v[44:47], a[236:239], a[104:107], v[44:47]
    ds_read_b64_tr_b16 a[222:223], v217 offset:35328
    s_waitcnt lgkmcnt(4)
L_back_step89:
    v_mfma_f32_16x16x32_bf16 v[48:51], a[240:243], a[32:35], v[48:51]
    ds_read_b64_tr_b16 a[224:225], v218 offset:34816
    s_add_u32 s61, s56, 1476992
    v_add_f32 v241, 1.0, v241
    v_mfma_f32_16x16x32_bf16 v[52:55], a[240:243], a[104:107], v[52:55]
    ds_read_b64_tr_b16 a[226:227], v218 offset:35328
    ds_read_b64_tr_b16 a[228:229], v219 offset:34816
    v_mfma_f32_16x16x32_bf16 v[56:59], a[244:247], a[32:35], v[56:59]
    ds_read_b64_tr_b16 a[230:231], v219 offset:35328
    v_add_f32 v242, 1.0, v242
    v_mfma_f32_16x16x32_bf16 v[60:63], a[244:247], a[104:107], v[60:63]
    buffer_load_dwordx4 v234, s[8:11], s61 offen offset:2048 lds
    v_add_f32 v243, 1.0, v243
    v_mfma_f32_16x16x32_bf16 v[64:67], a[248:251], a[32:35], v[64:67]
    ds_read_b64_tr_b16 a[232:233], v216 offset:35840
    ds_read_b64_tr_b16 a[234:235], v216 offset:36352
    v_mfma_f32_16x16x32_bf16 v[68:71], a[248:251], a[104:107], v[68:71]
    v_rcp_f32 v240, v240
    v_mfma_f32_16x16x32_bf16 v[72:75], a[252:255], a[32:35], v[72:75]
    ds_read_b64_tr_b16 a[236:237], v217 offset:35840
    ds_read_b64_tr_b16 a[238:239], v217 offset:36352
    v_mfma_f32_16x16x32_bf16 v[76:79], a[252:255], a[104:107], v[76:79]
    ds_read_b64_tr_b16 a[240:241], v218 offset:35840
    s_waitcnt lgkmcnt(5)
L_back_step90:
    v_mfma_f32_16x16x32_bf16 v[16:19], a[216:219], a[36:39], v[16:19]
    buffer_load_dwordx4 v234, s[12:15], s61 offen offset:3072 lds
    v_mfma_f32_16x16x32_bf16 v[20:23], a[216:219], a[108:111], v[20:23]
    ds_read_b64_tr_b16 a[242:243], v218 offset:36352
    ds_read_b64_tr_b16 a[244:245], v219 offset:35840
    v_rcp_f32 v241, v241
    v_mfma_f32_16x16x32_bf16 v[24:27], a[220:223], a[36:39], v[24:27]
    ds_read_b64_tr_b16 a[246:247], v219 offset:36352
    v_mfma_f32_16x16x32_bf16 v[28:31], a[220:223], a[108:111], v[28:31]
    v_rcp_f32 v242, v242
    v_mfma_f32_16x16x32_bf16 v[32:35], a[224:227], a[36:39], v[32:35]
    ds_read_b64_tr_b16 a[248:249], v216 offset:49152
    ds_read_b64_tr_b16 a[250:251], v216 offset:49664
    v_mfma_f32_16x16x32_bf16 v[36:39], a[224:227], a[108:111], v[36:39]
    v_rcp_f32 v243, v243
    v_mul_f32 v240, v128, v240
    v_mfma_f32_16x16x32_bf16 v[40:43], a[228:231], a[36:39], v[40:43]
    ds_read_b64_tr_b16 a[252:253], v217 offset:49152
    v_mul_f32 v241, v129, v241
    v_mfma_f32_16x16x32_bf16 v[44:47], a[228:231], a[108:111], v[44:47]
    ds_read_b64_tr_b16 a[254:255], v217 offset:49664
    s_waitcnt lgkmcnt(4)
L_back_step91:
    v_mfma_f32_16x16x32_bf16 v[48:51], a[232:235], a[36:39], v[48:51]
    ds_read_b64_tr_b16 a[216:217], v218 offset:49152
    s_add_u32 m0, s60, 0
    v_mul_f32 v242, v130, v242
    v_mfma_f32_16x16x32_bf16 v[52:55], a[232:235], a[108:111], v[52:55]
    ds_read_b64_tr_b16 a[218:219], v218 offset:49664
    s_add_u32 s61, s56, 1773952
    v_mfma_f32_16x16x32_bf16 v[56:59], a[236:239], a[36:39], v[56:59]
    ds_read_b64_tr_b16 a[220:221], v219 offset:49152
    ds_read_b64_tr_b16 a[222:223], v219 offset:49664
    v_mul_f32 v243, v131, v243
    v_mfma_f32_16x16x32_bf16 v[60:63], a[236:239], a[108:111], v[60:63]
    buffer_load_dwordx4 v234, s[8:11], s61 offen offset:0 lds
    v_mfma_f32_16x16x32_bf16 v[64:67], a[240:243], a[36:39], v[64:67]
    ds_read_b64_tr_b16 a[224:225], v216 offset:50176
    v_cvt_pk_bf16_f32 v168, v240, v241
    v_mfma_f32_16x16x32_bf16 v[68:71], a[240:243], a[108:111], v[68:71]
    ds_read_b64_tr_b16 a[226:227], v216 offset:50688
    v_cvt_pk_bf16_f32 v169, v242, v243
    v_mfma_f32_16x16x32_bf16 v[72:75], a[244:247], a[36:39], v[72:75]
    ds_read_b64_tr_b16 a[228:229], v217 offset:50176
    ds_read_b64_tr_b16 a[230:231], v217 offset:50688
    v_mfma_f32_16x16x32_bf16 v[76:79], a[244:247], a[108:111], v[76:79]
    ds_read_b64_tr_b16 a[232:233], v218 offset:50176
    s_waitcnt lgkmcnt(5)
L_back_step92:
    v_mfma_f32_16x16x32_bf16 v[16:19], a[248:251], a[40:43], v[16:19]
    buffer_load_dwordx4 v234, s[12:15], s61 offen offset:1024 lds
    v_mfma_f32_16x16x32_bf16 v[20:23], a[248:251], a[112:115], v[20:23]
    ds_read_b64_tr_b16 a[234:235], v218 offset:50688
    ds_read_b64_tr_b16 a[236:237], v219 offset:50176
    v_exp_f32 v244, v100
    v_mfma_f32_16x16x32_bf16 v[24:27], a[252:255], a[40:43], v[24:27]
    ds_read_b64_tr_b16 a[238:239], v219 offset:50688
    v_mfma_f32_16x16x32_bf16 v[28:31], a[252:255], a[112:115], v[28:31]
    v_exp_f32 v245, v101
    v_mfma_f32_16x16x32_bf16 v[32:35], a[216:219], a[40:43], v[32:35]
    ds_read_b64_tr_b16 a[240:241], v216 offset:51200
    ds_read_b64_tr_b16 a[242:243], v216 offset:51712
    v_mfma_f32_16x16x32_bf16 v[36:39], a[216:219], a[112:115], v[36:39]
    v_exp_f32 v246, v102
    v_mfma_f32_16x16x32_bf16 v[40:43], a[220:223], a[40:43], v[40:43]
    ds_read_b64_tr_b16 a[244:245], v217 offset:51200
    ds_read_b64_tr_b16 a[246:247], v217 offset:51712
    v_mfma_f32_16x16x32_bf16 v[44:47], a[220:223], a[112:115], v[44:47]
    ds_read_b64_tr_b16 a[248:249], v218 offset:51200
    v_exp_f32 v247, v103
    v_add_f32 v244, 1.0, v244
    s_waitcnt lgkmcnt(5)
L_back_step93:
    v_mfma_f32_16x16x32_bf16 v[48:51], a[224:227], a[40:43], v[48:51]
    s_add_u32 s61, s56, 2066816
    ds_read_b64_tr_b16 a[250:251], v218 offset:51712
    v_mfma_f32_16x16x32_bf16 v[52:55], a[224:227], a[112:115], v[52:55]
    buffer_load_dwordx4 v234, s[8:11], s61 offen offset:2048 lds
    v_add_f32 v245, 1.0, v245
    v_mfma_f32_16x16x32_bf16 v[56:59], a[228:231], a[40:43], v[56:59]
    ds_read_b64_tr_b16 a[252:253], v219 offset:51200
    ds_read_b64_tr_b16 a[254:255], v219 offset:51712
    v_mfma_f32_16x16x32_bf16 v[60:63], a[228:231], a[112:115], v[60:63]
    v_add_f32 v246, 1.0, v246
    v_add_f32 v247, 1.0, v247
    v_mfma_f32_16x16x32_bf16 v[64:67], a[232:235], a[40:43], v[64:67]
    ds_read_b64_tr_b16 a[216:217], v216 offset:52224
    ds_read_b64_tr_b16 a[218:219], v216 offset:52736
    v_mfma_f32_16x16x32_bf16 v[68:71], a[232:235], a[112:115], v[68:71]
    v_rcp_f32 v244, v244
    v_mfma_f32_16x16x32_bf16 v[72:75], a[236:239], a[40:43], v[72:75]
    ds_read_b64_tr_b16 a[220:221], v217 offset:52224
    ds_read_b64_tr_b16 a[222:223], v217 offset:52736
    v_mfma_f32_16x16x32_bf16 v[76:79], a[236:239], a[112:115], v[76:79]
    ds_read_b64_tr_b16 a[224:225], v218 offset:52224
    s_waitcnt lgkmcnt(5)
L_back_step94:
    v_mfma_f32_16x16x32_bf16 v[16:19], a[240:243], a[44:47], v[16:19]
    buffer_load_dwordx4 v234, s[12:15], s61 offen offset:3072 lds
    v_mfma_f32_16x16x32_bf16 v[20:23], a[240:243], a[116:119], v[20:23]
    ds_read_b64_tr_b16 a[226:227], v218 offset:52736
    ds_read_b64_tr_b16 a[228:229], v219 offset:52224
    v_rcp_f32 v245, v245
    v_mfma_f32_16x16x32_bf16 v[24:27], a[244:247], a[44:47], v[24:27]
    ds_read_b64_tr_b16 a[230:231], v219 offset:52736
    v_mfma_f32_16x16x32_bf16 v[28:31], a[244:247], a[116:119], v[28:31]
    v_rcp_f32 v246, v246
    v_mfma_f32_16x16x32_bf16 v[32:35], a[248:251], a[44:47], v[32:35]
    s_waitcnt vmcnt(21)
    s_barrier
    v_mfma_f32_16x16x32_bf16 v[36:39], a[248:251], a[116:119], v[36:39]
    ds_read_b64_tr_b16 a[232:233], v220 offset:0
    ds_read_b64_tr_b16 a[234:235], v220 offset:512
    v_rcp_f32 v247, v247
    v_mul_f32 v244, v132, v244
    v_mfma_f32_16x16x32_bf16 v[40:43], a[252:255], a[44:47], v[40:43]
    ds_read_b64_tr_b16 a[236:237], v221 offset:0
    v_mul_f32 v245, v133, v245
    v_mfma_f32_16x16x32_bf16 v[44:47], a[252:255], a[116:119], v[44:47]
    ds_read_b64_tr_b16 a[238:239], v221 offset:512
    s_waitcnt lgkmcnt(4)
L_back_step95:
    v_mfma_f32_16x16x32_bf16 v[48:51], a[216:219], a[44:47], v[48:51]
    ds_read_b64_tr_b16 a[240:241], v222 offset:0
    s_add_u32 m0, s60, 16384
    v_mul_f32 v246, v134, v246
    v_mfma_f32_16x16x32_bf16 v[52:55], a[216:219], a[116:119], v[52:55]
    ds_read_b64_tr_b16 a[242:243], v222 offset:512
    s_add_u32 s61, s56, 2363776
    v_mfma_f32_16x16x32_bf16 v[56:59], a[220:223], a[44:47], v[56:59]
    ds_read_b64_tr_b16 a[244:245], v223 offset:0
    ds_read_b64_tr_b16 a[246:247], v223 offset:512
    v_mul_f32 v247, v135, v247
    v_mfma_f32_16x16x32_bf16 v[60:63], a[220:223], a[116:119], v[60:63]
    buffer_load_dwordx4 v234, s[8:11], s61 offen offset:0 lds
    v_mfma_f32_16x16x32_bf16 v[64:67], a[224:227], a[44:47], v[64:67]
    ds_read_b64_tr_b16 a[248:249], v220 offset:1024
    v_cvt_pk_bf16_f32 v172, v244, v245
    v_mfma_f32_16x16x32_bf16 v[68:71], a[224:227], a[116:119], v[68:71]
    ds_read_b64_tr_b16 a[250:251], v220 offset:1536
    v_cvt_pk_bf16_f32 v173, v246, v247
    v_mfma_f32_16x16x32_bf16 v[72:75], a[228:231], a[44:47], v[72:75]
    ds_read_b64_tr_b16 a[252:253], v221 offset:1024
    ds_read_b64_tr_b16 a[254:255], v221 offset:1536
    v_mfma_f32_16x16x32_bf16 v[76:79], a[228:231], a[116:119], v[76:79]
    ds_read_b64_tr_b16 a[216:217], v222 offset:1024
    s_waitcnt lgkmcnt(5)
L_back_step96:
    v_mfma_f32_16x16x32_bf16 v[16:19], a[232:235], a[48:51], v[16:19]
    buffer_load_dwordx4 v234, s[12:15], s61 offen offset:1024 lds
    v_mfma_f32_16x16x32_bf16 v[20:23], a[232:235], a[120:123], v[20:23]
    ds_read_b64_tr_b16 a[218:219], v222 offset:1536
    ds_read_b64_tr_b16 a[220:221], v223 offset:1024
    v_exp_f32 v240, v104
    v_mfma_f32_16x16x32_bf16 v[24:27], a[236:239], a[48:51], v[24:27]
    ds_read_b64_tr_b16 a[222:223], v223 offset:1536
    v_mfma_f32_16x16x32_bf16 v[28:31], a[236:239], a[120:123], v[28:31]
    v_exp_f32 v241, v105
    v_mfma_f32_16x16x32_bf16 v[32:35], a[240:243], a[48:51], v[32:35]
    ds_read_b64_tr_b16 a[224:225], v220 offset:2048
    ds_read_b64_tr_b16 a[226:227], v220 offset:2560
    v_mfma_f32_16x16x32_bf16 v[36:39], a[240:243], a[120:123], v[36:39]
    v_exp_f32 v242, v106
    v_mfma_f32_16x16x32_bf16 v[40:43], a[244:247], a[48:51], v[40:43]
    ds_read_b64_tr_b16 a[228:229], v221 offset:2048
    ds_read_b64_tr_b16 a[230:231], v221 offset:2560
    v_mfma_f32_16x16x32_bf16 v[44:47], a[244:247], a[120:123], v[44:47]
    ds_read_b64_tr_b16 a[232:233], v222 offset:2048
    v_exp_f32 v243, v107
    v_add_f32 v240, 1.0, v240
    s_waitcnt lgkmcnt(5)
L_back_step97:
    v_mfma_f32_16x16x32_bf16 v[48:51], a[248:251], a[48:51], v[48:51]
    s_add_u32 s61, s56, 2656640
    ds_read_b64_tr_b16 a[234:235], v222 offset:2560
    v_mfma_f32_16x16x32_bf16 v[52:55], a[248:251], a[120:123], v[52:55]
    buffer_load_dwordx4 v234, s[8:11], s61 offen offset:2048 lds
    v_add_f32 v241, 1.0, v241
    v_mfma_f32_16x16x32_bf16 v[56:59], a[252:255], a[48:51], v[56:59]
    ds_read_b64_tr_b16 a[236:237], v223 offset:2048
    ds_read_b64_tr_b16 a[238:239], v223 offset:2560
    v_mfma_f32_16x16x32_bf16 v[60:63], a[252:255], a[120:123], v[60:63]
    v_add_f32 v242, 1.0, v242
    v_add_f32 v243, 1.0, v243
    v_mfma_f32_16x16x32_bf16 v[64:67], a[216:219], a[48:51], v[64:67]
    ds_read_b64_tr_b16 a[240:241], v220 offset:3072
    ds_read_b64_tr_b16 a[242:243], v220 offset:3584
    v_mfma_f32_16x16x32_bf16 v[68:71], a[216:219], a[120:123], v[68:71]
    v_rcp_f32 v240, v240
    v_mfma_f32_16x16x32_bf16 v[72:75], a[220:223], a[48:51], v[72:75]
    ds_read_b64_tr_b16 a[244:245], v221 offset:3072
    ds_read_b64_tr_b16 a[246:247], v221 offset:3584
    v_mfma_f32_16x16x32_bf16 v[76:79], a[220:223], a[120:123], v[76:79]
    ds_read_b64_tr_b16 a[248:249], v222 offset:3072
    s_waitcnt lgkmcnt(5)
L_back_step98:
    v_mfma_f32_16x16x32_bf16 v[16:19], a[224:227], a[52:55], v[16:19]
    buffer_load_dwordx4 v234, s[12:15], s61 offen offset:3072 lds
    v_mfma_f32_16x16x32_bf16 v[20:23], a[224:227], a[124:127], v[20:23]
    ds_read_b64_tr_b16 a[250:251], v222 offset:3584
    ds_read_b64_tr_b16 a[252:253], v223 offset:3072
    v_rcp_f32 v241, v241
    v_mfma_f32_16x16x32_bf16 v[24:27], a[228:231], a[52:55], v[24:27]
    ds_read_b64_tr_b16 a[254:255], v223 offset:3584
    v_mfma_f32_16x16x32_bf16 v[28:31], a[228:231], a[124:127], v[28:31]
    v_rcp_f32 v242, v242
    v_mfma_f32_16x16x32_bf16 v[32:35], a[232:235], a[52:55], v[32:35]
    ds_read_b64_tr_b16 a[216:217], v220 offset:16384
    ds_read_b64_tr_b16 a[218:219], v220 offset:16896
    v_mfma_f32_16x16x32_bf16 v[36:39], a[232:235], a[124:127], v[36:39]
    v_rcp_f32 v243, v243
    v_mul_f32 v240, v136, v240
    v_mfma_f32_16x16x32_bf16 v[40:43], a[236:239], a[52:55], v[40:43]
    ds_read_b64_tr_b16 a[220:221], v221 offset:16384
    v_mul_f32 v241, v137, v241
    v_mfma_f32_16x16x32_bf16 v[44:47], a[236:239], a[124:127], v[44:47]
    ds_read_b64_tr_b16 a[222:223], v221 offset:16896
    s_waitcnt lgkmcnt(4)
L_back_step99:
    v_mfma_f32_16x16x32_bf16 v[48:51], a[240:243], a[52:55], v[48:51]
    ds_read_b64_tr_b16 a[224:225], v222 offset:16384
    s_add_u32 m0, s60, 32768
    v_mfma_f32_16x16x32_bf16 v[52:55], a[240:243], a[124:127], v[52:55]
    ds_read_b64_tr_b16 a[226:227], v222 offset:16896
    s_add_u32 s61, s56, 2953600
    v_mul_f32 v242, v138, v242
    v_mfma_f32_16x16x32_bf16 v[56:59], a[244:247], a[52:55], v[56:59]
    ds_read_b64_tr_b16 a[228:229], v223 offset:16384
    ds_read_b64_tr_b16 a[230:231], v223 offset:16896
    v_mul_f32 v243, v139, v243
    v_mfma_f32_16x16x32_bf16 v[60:63], a[244:247], a[124:127], v[60:63]
    buffer_load_dwordx4 v234, s[8:11], s61 offen offset:0 lds
    v_mfma_f32_16x16x32_bf16 v[64:67], a[248:251], a[52:55], v[64:67]
    ds_read_b64_tr_b16 a[232:233], v220 offset:17408
    v_cvt_pk_bf16_f32 v170, v240, v241
    v_mfma_f32_16x16x32_bf16 v[68:71], a[248:251], a[124:127], v[68:71]
    ds_read_b64_tr_b16 a[234:235], v220 offset:17920
    v_cvt_pk_bf16_f32 v171, v242, v243
    v_mfma_f32_16x16x32_bf16 v[72:75], a[252:255], a[52:55], v[72:75]
    ds_read_b64_tr_b16 a[236:237], v221 offset:17408
    ds_read_b64_tr_b16 a[238:239], v221 offset:17920
    v_mfma_f32_16x16x32_bf16 v[76:79], a[252:255], a[124:127], v[76:79]
    ds_read_b64_tr_b16 a[240:241], v222 offset:17408
    s_waitcnt lgkmcnt(5)
L_back_step100:
    v_mfma_f32_16x16x32_bf16 v[16:19], a[216:219], a[56:59], v[16:19]
    buffer_load_dwordx4 v234, s[12:15], s61 offen offset:1024 lds
    v_mfma_f32_16x16x32_bf16 v[20:23], a[216:219], a[128:131], v[20:23]
    ds_read_b64_tr_b16 a[242:243], v222 offset:17920
    ds_read_b64_tr_b16 a[244:245], v223 offset:17408
    v_mfma_f32_16x16x32_bf16 v[24:27], a[220:223], a[56:59], v[24:27]
    ds_read_b64_tr_b16 a[246:247], v223 offset:17920
    v_exp_f32 v244, v108
    v_mfma_f32_16x16x32_bf16 v[28:31], a[220:223], a[128:131], v[28:31]
    v_exp_f32 v245, v109
    v_mfma_f32_16x16x32_bf16 v[32:35], a[224:227], a[56:59], v[32:35]
    ds_read_b64_tr_b16 a[248:249], v220 offset:18432
    ds_read_b64_tr_b16 a[250:251], v220 offset:18944
    v_mfma_f32_16x16x32_bf16 v[36:39], a[224:227], a[128:131], v[36:39]
    v_exp_f32 v246, v110
    v_mfma_f32_16x16x32_bf16 v[40:43], a[228:231], a[56:59], v[40:43]
    ds_read_b64_tr_b16 a[252:253], v221 offset:18432
    ds_read_b64_tr_b16 a[254:255], v221 offset:18944
    v_mfma_f32_16x16x32_bf16 v[44:47], a[228:231], a[128:131], v[44:47]
    ds_read_b64_tr_b16 a[216:217], v222 offset:18432
    v_exp_f32 v247, v111
    v_add_f32 v244, 1.0, v244
    s_waitcnt lgkmcnt(5)
L_back_step101:
    v_mfma_f32_16x16x32_bf16 v[48:51], a[232:235], a[56:59], v[48:51]
    s_add_u32 s61, s56, 3246464
    ds_read_b64_tr_b16 a[218:219], v222 offset:18944
    v_mfma_f32_16x16x32_bf16 v[52:55], a[232:235], a[128:131], v[52:55]
    buffer_load_dwordx4 v234, s[8:11], s61 offen offset:2048 lds
    v_mfma_f32_16x16x32_bf16 v[56:59], a[236:239], a[56:59], v[56:59]
    ds_read_b64_tr_b16 a[220:221], v223 offset:18432
    ds_read_b64_tr_b16 a[222:223], v223 offset:18944
    v_add_f32 v245, 1.0, v245
    v_mfma_f32_16x16x32_bf16 v[60:63], a[236:239], a[128:131], v[60:63]
    v_add_f32 v246, 1.0, v246
    v_add_f32 v247, 1.0, v247
    v_mfma_f32_16x16x32_bf16 v[64:67], a[240:243], a[56:59], v[64:67]
    ds_read_b64_tr_b16 a[224:225], v220 offset:19456
    ds_read_b64_tr_b16 a[226:227], v220 offset:19968
    v_mfma_f32_16x16x32_bf16 v[68:71], a[240:243], a[128:131], v[68:71]
    v_rcp_f32 v244, v244
    v_mfma_f32_16x16x32_bf16 v[72:75], a[244:247], a[56:59], v[72:75]
    ds_read_b64_tr_b16 a[228:229], v221 offset:19456
    ds_read_b64_tr_b16 a[230:231], v221 offset:19968
    v_mfma_f32_16x16x32_bf16 v[76:79], a[244:247], a[128:131], v[76:79]
    ds_read_b64_tr_b16 a[232:233], v222 offset:19456
    s_waitcnt lgkmcnt(5)
L_back_step102:
    v_mfma_f32_16x16x32_bf16 v[16:19], a[248:251], a[60:63], v[16:19]
    buffer_load_dwordx4 v234, s[12:15], s61 offen offset:3072 lds
    v_mfma_f32_16x16x32_bf16 v[20:23], a[248:251], a[132:135], v[20:23]
    ds_read_b64_tr_b16 a[234:235], v222 offset:19968
    ds_read_b64_tr_b16 a[236:237], v223 offset:19456
    v_mfma_f32_16x16x32_bf16 v[24:27], a[252:255], a[60:63], v[24:27]
    ds_read_b64_tr_b16 a[238:239], v223 offset:19968
    v_rcp_f32 v245, v245
    v_mfma_f32_16x16x32_bf16 v[28:31], a[252:255], a[132:135], v[28:31]
    v_rcp_f32 v246, v246
    v_mfma_f32_16x16x32_bf16 v[32:35], a[216:219], a[60:63], v[32:35]
    s_waitcnt vmcnt(20)
    s_barrier
    v_mfma_f32_16x16x32_bf16 v[36:39], a[216:219], a[132:135], v[36:39]
    ds_read_b64_tr_b16 a[240:241], v220 offset:32768
    ds_read_b64_tr_b16 a[242:243], v220 offset:33280
    v_mfma_f32_16x16x32_bf16 v[40:43], a[220:223], a[60:63], v[40:43]
    ds_read_b64_tr_b16 a[244:245], v221 offset:32768
    ds_read_b64_tr_b16 a[246:247], v221 offset:33280
    v_rcp_f32 v247, v247
    v_mul_f32 v244, v140, v244
    v_mfma_f32_16x16x32_bf16 v[44:47], a[220:223], a[132:135], v[44:47]
    v_mul_f32 v245, v141, v245
    s_waitcnt lgkmcnt(4)
L_back_step103:
    v_mfma_f32_16x16x32_bf16 v[48:51], a[224:227], a[60:63], v[48:51]
    ds_read_b64_tr_b16 a[248:249], v222 offset:32768
    s_add_u32 m0, s60, 49152
    v_mfma_f32_16x16x32_bf16 v[52:55], a[224:227], a[132:135], v[52:55]
    ds_read_b64_tr_b16 a[250:251], v222 offset:33280
    s_add_u32 s61, s56, 3543424
    v_mfma_f32_16x16x32_bf16 v[56:59], a[228:231], a[60:63], v[56:59]
    ds_read_b64_tr_b16 a[252:253], v223 offset:32768
    ds_read_b64_tr_b16 a[254:255], v223 offset:33280
    v_mul_f32 v246, v142, v246
    v_mfma_f32_16x16x32_bf16 v[60:63], a[228:231], a[132:135], v[60:63]
    buffer_load_dwordx4 v234, s[8:11], s61 offen offset:0 lds
    v_mfma_f32_16x16x32_bf16 v[64:67], a[232:235], a[60:63], v[64:67]
    ds_read_b64_tr_b16 a[216:217], v220 offset:33792
    v_mul_f32 v247, v143, v247
    v_mfma_f32_16x16x32_bf16 v[68:71], a[232:235], a[132:135], v[68:71]
    ds_read_b64_tr_b16 a[218:219], v220 offset:34304
    v_cvt_pk_bf16_f32 v174, v244, v245
    v_mfma_f32_16x16x32_bf16 v[72:75], a[236:239], a[60:63], v[72:75]
    ds_read_b64_tr_b16 a[220:221], v221 offset:33792
    v_cvt_pk_bf16_f32 v175, v246, v247
    v_mfma_f32_16x16x32_bf16 v[76:79], a[236:239], a[132:135], v[76:79]
    ds_read_b64_tr_b16 a[222:223], v221 offset:34304
    s_waitcnt lgkmcnt(4)
L_back_step104:
    v_mfma_f32_16x16x32_bf16 v[16:19], a[240:243], a[64:67], v[16:19]
    ds_read_b64_tr_b16 a[224:225], v222 offset:33792
    ds_read_b64_tr_b16 a[226:227], v222 offset:34304
    v_mfma_f32_16x16x32_bf16 v[20:23], a[240:243], a[136:139], v[20:23]
    buffer_load_dwordx4 v234, s[12:15], s61 offen offset:1024 lds
    s_add_u32 s39, s52, 4096
    v_mfma_f32_16x16x32_bf16 v[24:27], a[244:247], a[64:67], v[24:27]
    ds_read_b64_tr_b16 a[228:229], v223 offset:33792
    ds_read_b64_tr_b16 a[230:231], v223 offset:34304
    v_mfma_f32_16x16x32_bf16 v[28:31], a[244:247], a[136:139], v[28:31]
    buffer_store_dwordx4 v[160:163], v238, s[16:19], s39 offen offset:0 sc1
    v_mfma_f32_16x16x32_bf16 v[32:35], a[248:251], a[64:67], v[32:35]
    ds_read_b64_tr_b16 a[232:233], v220 offset:34816
    ds_read_b64_tr_b16 a[234:235], v220 offset:35328
    v_mfma_f32_16x16x32_bf16 v[36:39], a[248:251], a[136:139], v[36:39]
    buffer_store_dwordx4 v[164:167], v238, s[16:19], s39 offen offset:1024 sc1
    v_mfma_f32_16x16x32_bf16 v[40:43], a[252:255], a[64:67], v[40:43]
    ds_read_b64_tr_b16 a[236:237], v221 offset:34816
    ds_read_b64_tr_b16 a[238:239], v221 offset:35328
    v_mfma_f32_16x16x32_bf16 v[44:47], a[252:255], a[136:139], v[44:47]
    ds_read_b64_tr_b16 a[240:241], v222 offset:34816
    s_waitcnt lgkmcnt(5)
L_back_step105:
    v_mfma_f32_16x16x32_bf16 v[48:51], a[216:219], a[64:67], v[48:51]
    buffer_store_dwordx4 v[168:171], v238, s[16:19], s39 offen offset:2048 sc1
    v_mfma_f32_16x16x32_bf16 v[52:55], a[216:219], a[136:139], v[52:55]
    ds_read_b64_tr_b16 a[242:243], v222 offset:35328
    ds_read_b64_tr_b16 a[244:245], v223 offset:34816
    v_mfma_f32_16x16x32_bf16 v[56:59], a[220:223], a[64:67], v[56:59]
    ds_read_b64_tr_b16 a[246:247], v223 offset:35328
    s_add_u32 s61, s56, 3836288
    v_mfma_f32_16x16x32_bf16 v[60:63], a[220:223], a[136:139], v[60:63]
    buffer_load_dwordx4 v234, s[8:11], s61 offen offset:2048 lds
    v_mfma_f32_16x16x32_bf16 v[64:67], a[224:227], a[64:67], v[64:67]
    ds_read_b64_tr_b16 a[248:249], v220 offset:35840
    ds_read_b64_tr_b16 a[250:251], v220 offset:36352
    v_mfma_f32_16x16x32_bf16 v[68:71], a[224:227], a[136:139], v[68:71]
    buffer_store_dwordx4 v[172:175], v238, s[16:19], s39 offen offset:3072 sc1
    v_mfma_f32_16x16x32_bf16 v[72:75], a[228:231], a[64:67], v[72:75]
    ds_read_b64_tr_b16 a[252:253], v221 offset:35840
    ds_read_b64_tr_b16 a[254:255], v221 offset:36352
    v_mfma_f32_16x16x32_bf16 v[76:79], a[228:231], a[136:139], v[76:79]
    ds_read_b64_tr_b16 a[216:217], v222 offset:35840
    s_waitcnt lgkmcnt(5)
L_back_step106:
    v_mfma_f32_16x16x32_bf16 v[16:19], a[232:235], a[68:71], v[16:19]
    buffer_load_dwordx4 v234, s[12:15], s61 offen offset:3072 lds
    v_mfma_f32_16x16x32_bf16 v[20:23], a[232:235], a[140:143], v[20:23]
    ds_read_b64_tr_b16 a[218:219], v222 offset:36352
    ds_read_b64_tr_b16 a[220:221], v223 offset:35840
    v_mfma_f32_16x16x32_bf16 v[24:27], a[236:239], a[68:71], v[24:27]
    ds_read_b64_tr_b16 a[222:223], v223 offset:36352
    v_mfma_f32_16x16x32_bf16 v[28:31], a[236:239], a[140:143], v[28:31]
    ds_read_b64_tr_b16 a[224:225], v220 offset:49152
    v_mfma_f32_16x16x32_bf16 v[32:35], a[240:243], a[68:71], v[32:35]
    ds_read_b64_tr_b16 a[226:227], v220 offset:49664
    v_mfma_f32_16x16x32_bf16 v[36:39], a[240:243], a[140:143], v[36:39]
    ds_read_b64_tr_b16 a[228:229], v221 offset:49152
    v_mfma_f32_16x16x32_bf16 v[40:43], a[244:247], a[68:71], v[40:43]
    ds_read_b64_tr_b16 a[230:231], v221 offset:49664
    v_mfma_f32_16x16x32_bf16 v[44:47], a[244:247], a[140:143], v[44:47]
    ds_read_b64_tr_b16 a[232:233], v222 offset:49152
    s_waitcnt lgkmcnt(5)
L_back_step107:
    v_mfma_f32_16x16x32_bf16 v[48:51], a[248:251], a[68:71], v[48:51]
    s_add_u32 m0, s60, 65536
    s_add_u32 s61, s56, 4133248
    v_mfma_f32_16x16x32_bf16 v[52:55], a[248:251], a[140:143], v[52:55]
    ds_read_b64_tr_b16 a[234:235], v222 offset:49664
    ds_read_b64_tr_b16 a[236:237], v223 offset:49152
    v_mfma_f32_16x16x32_bf16 v[56:59], a[252:255], a[68:71], v[56:59]
    ds_read_b64_tr_b16 a[238:239], v223 offset:49664
    v_mfma_f32_16x16x32_bf16 v[60:63], a[252:255], a[140:143], v[60:63]
    buffer_load_dwordx4 v234, s[8:11], s61 offen offset:0 lds
    v_mfma_f32_16x16x32_bf16 v[64:67], a[216:219], a[68:71], v[64:67]
    ds_read_b64_tr_b16 a[240:241], v220 offset:50176
    ds_read_b64_tr_b16 a[242:243], v220 offset:50688
    v_mfma_f32_16x16x32_bf16 v[68:71], a[216:219], a[140:143], v[68:71]
    ds_read_b64_tr_b16 a[244:245], v221 offset:50176
    v_mfma_f32_16x16x32_bf16 v[72:75], a[220:223], a[68:71], v[72:75]
    ds_read_b64_tr_b16 a[246:247], v221 offset:50688
    v_mfma_f32_16x16x32_bf16 v[76:79], a[220:223], a[140:143], v[76:79]
    ds_read_b64_tr_b16 a[248:249], v222 offset:50176
    s_waitcnt lgkmcnt(5)
L_back_step108:
    v_mfma_f32_16x16x32_bf16 v[80:83], a[224:227], a[0:3], 0
    buffer_load_dwordx4 v234, s[12:15], s61 offen offset:1024 lds
    v_mfma_f32_16x16x32_bf16 v[84:87], a[224:227], a[72:75], 0
    ds_read_b64_tr_b16 a[250:251], v222 offset:50688
    ds_read_b64_tr_b16 a[252:253], v223 offset:50176
    v_mfma_f32_16x16x32_bf16 v[88:91], a[228:231], a[0:3], 0
    ds_read_b64_tr_b16 a[254:255], v223 offset:50688
    v_mfma_f32_16x16x32_bf16 v[92:95], a[228:231], a[72:75], 0
    ds_read_b64_tr_b16 a[216:217], v220 offset:51200
    v_mfma_f32_16x16x32_bf16 v[96:99], a[232:235], a[0:3], 0
    v_exp_f32 v240, v16
    v_mfma_f32_16x16x32_bf16 v[100:103], a[232:235], a[72:75], 0
    ds_read_b64_tr_b16 a[218:219], v220 offset:51712
    ds_read_b64_tr_b16 a[220:221], v221 offset:51200
    v_mfma_f32_16x16x32_bf16 v[104:107], a[236:239], a[0:3], 0
    v_exp_f32 v241, v17
    v_mfma_f32_16x16x32_bf16 v[108:111], a[236:239], a[72:75], 0
    ds_read_b64_tr_b16 a[222:223], v221 offset:51712
    s_waitcnt lgkmcnt(4)
L_back_step109:
    v_mfma_f32_16x16x32_bf16 v[112:115], a[240:243], a[0:3], 0
    ds_read_b64_tr_b16 a[224:225], v222 offset:51200
    ds_read_b64_tr_b16 a[226:227], v222 offset:51712
    v_mfma_f32_16x16x32_bf16 v[116:119], a[240:243], a[72:75], 0
    v_exp_f32 v242, v18
    v_mfma_f32_16x16x32_bf16 v[120:123], a[244:247], a[0:3], 0
    ds_read_b64_tr_b16 a[228:229], v223 offset:51200
    ds_read_b64_tr_b16 a[230:231], v223 offset:51712
    v_mfma_f32_16x16x32_bf16 v[124:127], a[244:247], a[72:75], 0
    v_exp_f32 v243, v19
    v_mfma_f32_16x16x32_bf16 v[128:131], a[248:251], a[0:3], 0
    ds_read_b64_tr_b16 a[232:233], v220 offset:52224
    s_add_u32 s61, s56, 4426112
    buffer_load_dwordx4 v234, s[8:11], s61 offen offset:2048 lds
    v_add_f32 v240, 1.0, v240
    v_mfma_f32_16x16x32_bf16 v[132:135], a[248:251], a[72:75], 0
    ds_read_b64_tr_b16 a[234:235], v220 offset:52736
    v_add_f32 v241, 1.0, v241
    v_mfma_f32_16x16x32_bf16 v[136:139], a[252:255], a[0:3], 0
    ds_read_b64_tr_b16 a[236:237], v221 offset:52224
    v_add_f32 v242, 1.0, v242
    v_mfma_f32_16x16x32_bf16 v[140:143], a[252:255], a[72:75], 0
    ds_read_b64_tr_b16 a[238:239], v221 offset:52736
    s_waitcnt lgkmcnt(4)
L_back_step110:
    v_mfma_f32_16x16x32_bf16 v[80:83], a[216:219], a[4:7], v[80:83]
    ds_read_b64_tr_b16 a[240:241], v222 offset:52224
    ds_read_b64_tr_b16 a[242:243], v222 offset:52736
    v_add_f32 v243, 1.0, v243
    v_mfma_f32_16x16x32_bf16 v[84:87], a[216:219], a[76:79], v[84:87]
    buffer_load_dwordx4 v234, s[12:15], s61 offen offset:3072 lds
    v_mfma_f32_16x16x32_bf16 v[88:91], a[220:223], a[4:7], v[88:91]
    ds_read_b64_tr_b16 a[244:245], v223 offset:52224
    ds_read_b64_tr_b16 a[246:247], v223 offset:52736
    v_mfma_f32_16x16x32_bf16 v[92:95], a[220:223], a[76:79], v[92:95]
    v_rcp_f32 v240, v240
    v_mfma_f32_16x16x32_bf16 v[96:99], a[224:227], a[4:7], v[96:99]
    s_waitcnt vmcnt(24)
    s_barrier
    v_mfma_f32_16x16x32_bf16 v[100:103], a[224:227], a[76:79], v[100:103]
    ds_read_b64_tr_b16 a[248:249], v224 offset:0
    ds_read_b64_tr_b16 a[250:251], v224 offset:512
    v_mfma_f32_16x16x32_bf16 v[104:107], a[228:231], a[4:7], v[104:107]
    ds_read_b64_tr_b16 a[252:253], v225 offset:0
    ds_read_b64_tr_b16 a[254:255], v225 offset:512
    v_rcp_f32 v241, v241
    v_mfma_f32_16x16x32_bf16 v[108:111], a[228:231], a[76:79], v[108:111]
    ds_read_b64_tr_b16 a[216:217], v226 offset:0
    v_rcp_f32 v242, v242
    s_waitcnt lgkmcnt(5)
L_back_step111:
    v_mfma_f32_16x16x32_bf16 v[112:115], a[232:235], a[4:7], v[112:115]
    v_rcp_f32 v243, v243
    v_mfma_f32_16x16x32_bf16 v[116:119], a[232:235], a[76:79], v[116:119]
    ds_read_b64_tr_b16 a[218:219], v226 offset:512
    s_add_u32 m0, s60, 81920
    v_mul_f32 v240, v48, v240
    v_mfma_f32_16x16x32_bf16 v[120:123], a[236:239], a[4:7], v[120:123]
    ds_read_b64_tr_b16 a[220:221], v227 offset:0
    ds_read_b64_tr_b16 a[222:223], v227 offset:512
    v_mfma_f32_16x16x32_bf16 v[124:127], a[236:239], a[76:79], v[124:127]
    s_add_u32 s61, s56, 4723072
    buffer_load_dwordx4 v234, s[8:11], s61 offen offset:0 lds
    v_mul_f32 v241, v49, v241
    v_mfma_f32_16x16x32_bf16 v[128:131], a[240:243], a[4:7], v[128:131]
    ds_read_b64_tr_b16 a[224:225], v224 offset:1024
    v_mul_f32 v242, v50, v242
    v_mfma_f32_16x16x32_bf16 v[132:135], a[240:243], a[76:79], v[132:135]
    ds_read_b64_tr_b16 a[226:227], v224 offset:1536
    v_mul_f32 v243, v51, v243
    v_mfma_f32_16x16x32_bf16 v[136:139], a[244:247], a[4:7], v[136:139]
    ds_read_b64_tr_b16 a[228:229], v225 offset:1024
    v_cvt_pk_bf16_f32 v176, v240, v241
    v_mfma_f32_16x16x32_bf16 v[140:143], a[244:247], a[76:79], v[140:143]
    ds_read_b64_tr_b16 a[230:231], v225 offset:1536
    s_waitcnt lgkmcnt(4)
L_back_step112:
    v_mfma_f32_16x16x32_bf16 v[80:83], a[248:251], a[8:11], v[80:83]
    ds_read_b64_tr_b16 a[232:233], v226 offset:1024
    ds_read_b64_tr_b16 a[234:235], v226 offset:1536
    v_cvt_pk_bf16_f32 v177, v242, v243
    v_mfma_f32_16x16x32_bf16 v[84:87], a[248:251], a[80:83], v[84:87]
    buffer_load_dwordx4 v234, s[12:15], s61 offen offset:1024 lds
    v_mfma_f32_16x16x32_bf16 v[88:91], a[252:255], a[8:11], v[88:91]
    ds_read_b64_tr_b16 a[236:237], v227 offset:1024
    ds_read_b64_tr_b16 a[238:239], v227 offset:1536
    v_mfma_f32_16x16x32_bf16 v[92:95], a[252:255], a[80:83], v[92:95]
    v_exp_f32 v244, v20
    v_mfma_f32_16x16x32_bf16 v[96:99], a[216:219], a[8:11], v[96:99]
    ds_read_b64_tr_b16 a[240:241], v224 offset:2048
    ds_read_b64_tr_b16 a[242:243], v224 offset:2560
    v_mfma_f32_16x16x32_bf16 v[100:103], a[216:219], a[80:83], v[100:103]
    v_exp_f32 v245, v21
    v_mfma_f32_16x16x32_bf16 v[104:107], a[220:223], a[8:11], v[104:107]
    ds_read_b64_tr_b16 a[244:245], v225 offset:2048
    ds_read_b64_tr_b16 a[246:247], v225 offset:2560
    v_mfma_f32_16x16x32_bf16 v[108:111], a[220:223], a[80:83], v[108:111]
    ds_read_b64_tr_b16 a[248:249], v226 offset:2048
    s_waitcnt lgkmcnt(5)
L_back_step113:
    v_mfma_f32_16x16x32_bf16 v[112:115], a[224:227], a[8:11], v[112:115]
    v_exp_f32 v246, v22
    v_mfma_f32_16x16x32_bf16 v[116:119], a[224:227], a[80:83], v[116:119]
    ds_read_b64_tr_b16 a[250:251], v226 offset:2560
    ds_read_b64_tr_b16 a[252:253], v227 offset:2048
    v_exp_f32 v247, v23
    v_add_f32 v244, 1.0, v244
    v_mfma_f32_16x16x32_bf16 v[120:123], a[228:231], a[8:11], v[120:123]
    ds_read_b64_tr_b16 a[254:255], v227 offset:2560
    s_add_u32 s61, s56, 5015936
    v_mfma_f32_16x16x32_bf16 v[124:127], a[228:231], a[80:83], v[124:127]
    buffer_load_dwordx4 v234, s[8:11], s61 offen offset:2048 lds
    v_add_f32 v245, 1.0, v245
    v_mfma_f32_16x16x32_bf16 v[128:131], a[232:235], a[8:11], v[128:131]
    ds_read_b64_tr_b16 a[216:217], v224 offset:3072
    v_add_f32 v246, 1.0, v246
    v_mfma_f32_16x16x32_bf16 v[132:135], a[232:235], a[80:83], v[132:135]
    s_waitcnt vmcnt(8)
    v_mov_b32 v3, 1
    s_mov_b64 exec, 1
    buffer_store_dword v3, v15, s[16:19], s7 offen sc1
    s_mov_b64 exec, -1
    v_mfma_f32_16x16x32_bf16 v[136:139], a[236:239], a[8:11], v[136:139]
    ds_read_b64_tr_b16 a[218:219], v224 offset:3584
    ds_read_b64_tr_b16 a[220:221], v225 offset:3072
    v_add_f32 v247, 1.0, v247
    v_mfma_f32_16x16x32_bf16 v[140:143], a[236:239], a[80:83], v[140:143]
    ds_read_b64_tr_b16 a[222:223], v225 offset:3584
    s_waitcnt lgkmcnt(4)
L_back_step114:
    v_mfma_f32_16x16x32_bf16 v[80:83], a[240:243], a[12:15], v[80:83]
    ds_read_b64_tr_b16 a[224:225], v226 offset:3072
    ds_read_b64_tr_b16 a[226:227], v226 offset:3584
    v_mfma_f32_16x16x32_bf16 v[84:87], a[240:243], a[84:87], v[84:87]
    buffer_load_dwordx4 v234, s[12:15], s61 offen offset:3072 lds
    v_mfma_f32_16x16x32_bf16 v[88:91], a[244:247], a[12:15], v[88:91]
    ds_read_b64_tr_b16 a[228:229], v227 offset:3072
    ds_read_b64_tr_b16 a[230:231], v227 offset:3584
    v_rcp_f32 v244, v244
    v_mfma_f32_16x16x32_bf16 v[92:95], a[244:247], a[84:87], v[92:95]
    v_rcp_f32 v245, v245
    v_mfma_f32_16x16x32_bf16 v[96:99], a[248:251], a[12:15], v[96:99]
    ds_read_b64_tr_b16 a[232:233], v224 offset:16384
    ds_read_b64_tr_b16 a[234:235], v224 offset:16896
    v_mfma_f32_16x16x32_bf16 v[100:103], a[248:251], a[84:87], v[100:103]
    v_rcp_f32 v246, v246
    v_mfma_f32_16x16x32_bf16 v[104:107], a[252:255], a[12:15], v[104:107]
    ds_read_b64_tr_b16 a[236:237], v225 offset:16384
    ds_read_b64_tr_b16 a[238:239], v225 offset:16896
    v_mfma_f32_16x16x32_bf16 v[108:111], a[252:255], a[84:87], v[108:111]
    ds_read_b64_tr_b16 a[240:241], v226 offset:16384
    v_rcp_f32 v247, v247
    v_mul_f32 v244, v52, v244
    s_waitcnt lgkmcnt(5)
L_back_step115:
    v_mfma_f32_16x16x32_bf16 v[112:115], a[216:219], a[12:15], v[112:115]
    s_add_u32 m0, s60, 98304
    s_add_u32 s61, s57, 4096
    v_mfma_f32_16x16x32_bf16 v[116:119], a[216:219], a[84:87], v[116:119]
    ds_read_b64_tr_b16 a[242:243], v226 offset:16896
    ds_read_b64_tr_b16 a[244:245], v227 offset:16384
    v_mul_f32 v245, v53, v245
    v_mfma_f32_16x16x32_bf16 v[120:123], a[220:223], a[12:15], v[120:123]
    ds_read_b64_tr_b16 a[246:247], v227 offset:16896
    v_mul_f32 v246, v54, v246
    v_mfma_f32_16x16x32_bf16 v[124:127], a[220:223], a[84:87], v[124:127]
    buffer_load_dwordx4 v235, s[20:23], s61 offen offset:0 lds
    v_mfma_f32_16x16x32_bf16 v[128:131], a[224:227], a[12:15], v[128:131]
    ds_read_b64_tr_b16 a[248:249], v224 offset:17408
    v_mul_f32 v247, v55, v247
    v_mfma_f32_16x16x32_bf16 v[132:135], a[224:227], a[84:87], v[132:135]
    ds_read_b64_tr_b16 a[250:251], v224 offset:17920
    v_cvt_pk_bf16_f32 v180, v244, v245
    v_mfma_f32_16x16x32_bf16 v[136:139], a[228:231], a[12:15], v[136:139]
    ds_read_b64_tr_b16 a[252:253], v225 offset:17408
    v_cvt_pk_bf16_f32 v181, v246, v247
    v_mfma_f32_16x16x32_bf16 v[140:143], a[228:231], a[84:87], v[140:143]
    ds_read_b64_tr_b16 a[254:255], v225 offset:17920
    s_waitcnt lgkmcnt(4)
L_back_step116:
    v_mfma_f32_16x16x32_bf16 v[80:83], a[232:235], a[16:19], v[80:83]
    ds_read_b64_tr_b16 a[216:217], v226 offset:17408
    ds_read_b64_tr_b16 a[218:219], v226 offset:17920
    v_mfma_f32_16x16x32_bf16 v[84:87], a[232:235], a[88:91], v[84:87]
    v_exp_f32 v240, v24
    v_mfma_f32_16x16x32_bf16 v[88:91], a[236:239], a[16:19], v[88:91]
    ds_read_b64_tr_b16 a[220:221], v227 offset:17408
    ds_read_b64_tr_b16 a[222:223], v227 offset:17920
    v_mfma_f32_16x16x32_bf16 v[92:95], a[236:239], a[88:91], v[92:95]
    v_exp_f32 v241, v25
    v_mfma_f32_16x16x32_bf16 v[96:99], a[240:243], a[16:19], v[96:99]
    ds_read_b64_tr_b16 a[224:225], v224 offset:18432
    ds_read_b64_tr_b16 a[226:227], v224 offset:18944
    v_mfma_f32_16x16x32_bf16 v[100:103], a[240:243], a[88:91], v[100:103]
    v_exp_f32 v242, v26
    v_mfma_f32_16x16x32_bf16 v[104:107], a[244:247], a[16:19], v[104:107]
    ds_read_b64_tr_b16 a[228:229], v225 offset:18432
    ds_read_b64_tr_b16 a[230:231], v225 offset:18944
    v_mfma_f32_16x16x32_bf16 v[108:111], a[244:247], a[88:91], v[108:111]
    ds_read_b64_tr_b16 a[232:233], v226 offset:18432
    s_waitcnt lgkmcnt(5)
L_back_step117:
    v_mfma_f32_16x16x32_bf16 v[112:115], a[248:251], a[16:19], v[112:115]
    v_exp_f32 v243, v27
    v_add_f32 v240, 1.0, v240
    v_mfma_f32_16x16x32_bf16 v[116:119], a[248:251], a[88:91], v[116:119]
    ds_read_b64_tr_b16 a[234:235], v226 offset:18944
    s_add_u32 s61, s57, 297984
    v_add_f32 v241, 1.0, v241
    v_mfma_f32_16x16x32_bf16 v[120:123], a[252:255], a[16:19], v[120:123]
    ds_read_b64_tr_b16 a[236:237], v227 offset:18432
    ds_read_b64_tr_b16 a[238:239], v227 offset:18944
    v_mfma_f32_16x16x32_bf16 v[124:127], a[252:255], a[88:91], v[124:127]
    buffer_load_dwordx4 v235, s[20:23], s61 offen offset:1024 lds
    v_add_f32 v242, 1.0, v242
    v_mfma_f32_16x16x32_bf16 v[128:131], a[216:219], a[16:19], v[128:131]
    ds_read_b64_tr_b16 a[240:241], v224 offset:19456
    v_add_f32 v243, 1.0, v243
    v_mfma_f32_16x16x32_bf16 v[132:135], a[216:219], a[88:91], v[132:135]
    ds_read_b64_tr_b16 a[242:243], v224 offset:19968
    ds_read_b64_tr_b16 a[244:245], v225 offset:19456
    v_mfma_f32_16x16x32_bf16 v[136:139], a[220:223], a[16:19], v[136:139]
    v_rcp_f32 v240, v240
    v_mfma_f32_16x16x32_bf16 v[140:143], a[220:223], a[88:91], v[140:143]
    ds_read_b64_tr_b16 a[246:247], v225 offset:19968
    s_waitcnt lgkmcnt(4)
L_back_step118:
    v_mfma_f32_16x16x32_bf16 v[80:83], a[224:227], a[20:23], v[80:83]
    ds_read_b64_tr_b16 a[248:249], v226 offset:19456
    ds_read_b64_tr_b16 a[250:251], v226 offset:19968
    v_mfma_f32_16x16x32_bf16 v[84:87], a[224:227], a[92:95], v[84:87]
    v_rcp_f32 v241, v241
    v_mfma_f32_16x16x32_bf16 v[88:91], a[228:231], a[20:23], v[88:91]
    ds_read_b64_tr_b16 a[252:253], v227 offset:19456
    ds_read_b64_tr_b16 a[254:255], v227 offset:19968
    v_mfma_f32_16x16x32_bf16 v[92:95], a[228:231], a[92:95], v[92:95]
    v_rcp_f32 v242, v242
    v_mfma_f32_16x16x32_bf16 v[96:99], a[232:235], a[20:23], v[96:99]
    s_barrier
    v_mfma_f32_16x16x32_bf16 v[100:103], a[232:235], a[92:95], v[100:103]
    ds_read_b64_tr_b16 a[216:217], v216 offset:0
    ds_read_b64_tr_b16 a[218:219], v216 offset:512
    v_mfma_f32_16x16x32_bf16 v[104:107], a[236:239], a[20:23], v[104:107]
    ds_read_b64_tr_b16 a[220:221], v217 offset:0
    ds_read_b64_tr_b16 a[222:223], v217 offset:512
    v_rcp_f32 v243, v243
    v_mul_f32 v240, v56, v240
    v_mfma_f32_16x16x32_bf16 v[108:111], a[236:239], a[92:95], v[108:111]
    s_add_u32 s61, s57, 591872
    buffer_load_dwordx4 v235, s[20:23], s61 offen offset:2048 lds
    v_mul_f32 v241, v57, v241
    s_waitcnt lgkmcnt(4)
L_back_step119:
    v_mfma_f32_16x16x32_bf16 v[112:115], a[240:243], a[20:23], v[112:115]
    ds_read_b64_tr_b16 a[224:225], v218 offset:0
    s_add_u32 s61, s57, 885760
    v_mfma_f32_16x16x32_bf16 v[116:119], a[240:243], a[92:95], v[116:119]
    ds_read_b64_tr_b16 a[226:227], v218 offset:512
    ds_read_b64_tr_b16 a[228:229], v219 offset:0
    v_mul_f32 v242, v58, v242
    v_mfma_f32_16x16x32_bf16 v[120:123], a[244:247], a[20:23], v[120:123]
    ds_read_b64_tr_b16 a[230:231], v219 offset:512
    v_mul_f32 v243, v59, v243
    v_mfma_f32_16x16x32_bf16 v[124:127], a[244:247], a[92:95], v[124:127]
    buffer_load_dwordx4 v235, s[20:23], s61 offen offset:3072 lds
    v_mfma_f32_16x16x32_bf16 v[128:131], a[248:251], a[20:23], v[128:131]
    ds_read_b64_tr_b16 a[232:233], v216 offset:1024
    v_cvt_pk_bf16_f32 v178, v240, v241
    v_mfma_f32_16x16x32_bf16 v[132:135], a[248:251], a[92:95], v[132:135]
    ds_read_b64_tr_b16 a[234:235], v216 offset:1536
    v_cvt_pk_bf16_f32 v179, v242, v243
    v_mfma_f32_16x16x32_bf16 v[136:139], a[252:255], a[20:23], v[136:139]
    ds_read_b64_tr_b16 a[236:237], v217 offset:1024
    ds_read_b64_tr_b16 a[238:239], v217 offset:1536
    v_mfma_f32_16x16x32_bf16 v[140:143], a[252:255], a[92:95], v[140:143]
    ds_read_b64_tr_b16 a[240:241], v218 offset:1024
    s_waitcnt lgkmcnt(5)
L_back_step120:
    v_mfma_f32_16x16x32_bf16 v[80:83], a[216:219], a[24:27], v[80:83]
    v_exp_f32 v244, v28
    v_mfma_f32_16x16x32_bf16 v[84:87], a[216:219], a[96:99], v[84:87]
    ds_read_b64_tr_b16 a[242:243], v218 offset:1536
    ds_read_b64_tr_b16 a[244:245], v219 offset:1024
    v_mfma_f32_16x16x32_bf16 v[88:91], a[220:223], a[24:27], v[88:91]
    ds_read_b64_tr_b16 a[246:247], v219 offset:1536
    s_add_u32 m0, s60, 114688
    v_mfma_f32_16x16x32_bf16 v[92:95], a[220:223], a[96:99], v[92:95]
    v_exp_f32 v245, v29
    v_mfma_f32_16x16x32_bf16 v[96:99], a[224:227], a[24:27], v[96:99]
    ds_read_b64_tr_b16 a[248:249], v216 offset:2048
    ds_read_b64_tr_b16 a[250:251], v216 offset:2560
    v_mfma_f32_16x16x32_bf16 v[100:103], a[224:227], a[96:99], v[100:103]
    v_exp_f32 v246, v30
    v_mfma_f32_16x16x32_bf16 v[104:107], a[228:231], a[24:27], v[104:107]
    ds_read_b64_tr_b16 a[252:253], v217 offset:2048
    ds_read_b64_tr_b16 a[254:255], v217 offset:2560
    v_mfma_f32_16x16x32_bf16 v[108:111], a[228:231], a[96:99], v[108:111]
    ds_read_b64_tr_b16 a[216:217], v218 offset:2048
    v_exp_f32 v247, v31
    v_add_f32 v244, 1.0, v244
    s_waitcnt lgkmcnt(5)
L_back_step121:
    v_mfma_f32_16x16x32_bf16 v[112:115], a[232:235], a[24:27], v[112:115]
    s_add_u32 s61, s57, 1183744
    ds_read_b64_tr_b16 a[218:219], v218 offset:2560
    v_add_f32 v245, 1.0, v245
    v_mfma_f32_16x16x32_bf16 v[116:119], a[232:235], a[96:99], v[116:119]
    buffer_load_dwordx4 v235, s[20:23], s61 offen offset:0 lds
    v_mfma_f32_16x16x32_bf16 v[120:123], a[236:239], a[24:27], v[120:123]
    ds_read_b64_tr_b16 a[220:221], v219 offset:2048
    ds_read_b64_tr_b16 a[222:223], v219 offset:2560
    v_add_f32 v246, 1.0, v246
    v_mfma_f32_16x16x32_bf16 v[124:127], a[236:239], a[96:99], v[124:127]
    v_add_f32 v247, 1.0, v247
    ds_read_b64_tr_b16 a[224:225], v216 offset:3072
    v_mfma_f32_16x16x32_bf16 v[128:131], a[240:243], a[24:27], v[128:131]
    v_rcp_f32 v244, v244
    v_mfma_f32_16x16x32_bf16 v[132:135], a[240:243], a[96:99], v[132:135]
    ds_read_b64_tr_b16 a[226:227], v216 offset:3584
    ds_read_b64_tr_b16 a[228:229], v217 offset:3072
    v_mfma_f32_16x16x32_bf16 v[136:139], a[244:247], a[24:27], v[136:139]
    v_rcp_f32 v245, v245
    v_mfma_f32_16x16x32_bf16 v[140:143], a[244:247], a[96:99], v[140:143]
    ds_read_b64_tr_b16 a[230:231], v217 offset:3584
    s_waitcnt lgkmcnt(4)
L_back_step122:
    v_mfma_f32_16x16x32_bf16 v[80:83], a[248:251], a[28:31], v[80:83]
    ds_read_b64_tr_b16 a[232:233], v218 offset:3072
    ds_read_b64_tr_b16 a[234:235], v218 offset:3584
    v_mfma_f32_16x16x32_bf16 v[84:87], a[248:251], a[100:103], v[84:87]
    v_rcp_f32 v246, v246
    v_mfma_f32_16x16x32_bf16 v[88:91], a[252:255], a[28:31], v[88:91]
    ds_read_b64_tr_b16 a[236:237], v219 offset:3072
    ds_read_b64_tr_b16 a[238:239], v219 offset:3584
    buffer_load_dword v2, v15, s[16:19], s38 offen sc1
    v_mfma_f32_16x16x32_bf16 v[92:95], a[252:255], a[100:103], v[92:95]
    v_rcp_f32 v247, v247
    v_mfma_f32_16x16x32_bf16 v[96:99], a[216:219], a[28:31], v[96:99]
    ds_read_b64_tr_b16 a[240:241], v216 offset:16384
    s_add_u32 s61, s57, 1477632
    buffer_load_dwordx4 v235, s[20:23], s61 offen offset:1024 lds
    v_mul_f32 v244, v60, v244
    v_mfma_f32_16x16x32_bf16 v[100:103], a[216:219], a[100:103], v[100:103]
    ds_read_b64_tr_b16 a[242:243], v216 offset:16896
    v_mul_f32 v245, v61, v245
    v_mfma_f32_16x16x32_bf16 v[104:107], a[220:223], a[28:31], v[104:107]
    ds_read_b64_tr_b16 a[244:245], v217 offset:16384
    v_mul_f32 v246, v62, v246
    v_mfma_f32_16x16x32_bf16 v[108:111], a[220:223], a[100:103], v[108:111]
    ds_read_b64_tr_b16 a[246:247], v217 offset:16896
    s_waitcnt lgkmcnt(4)
L_back_step123:
    v_mfma_f32_16x16x32_bf16 v[112:115], a[224:227], a[28:31], v[112:115]
    ds_read_b64_tr_b16 a[248:249], v218 offset:16384
    s_add_u32 s61, s57, 1771520
    v_mul_f32 v247, v63, v247
    v_mfma_f32_16x16x32_bf16 v[116:119], a[224:227], a[100:103], v[116:119]
    ds_read_b64_tr_b16 a[250:251], v218 offset:16896
    ds_read_b64_tr_b16 a[252:253], v219 offset:16384
    v_mfma_f32_16x16x32_bf16 v[120:123], a[228:231], a[28:31], v[120:123]
    ds_read_b64_tr_b16 a[254:255], v219 offset:16896
    v_cvt_pk_bf16_f32 v182, v244, v245
    v_mfma_f32_16x16x32_bf16 v[124:127], a[228:231], a[100:103], v[124:127]
    buffer_load_dwordx4 v235, s[20:23], s61 offen offset:2048 lds
    v_mfma_f32_16x16x32_bf16 v[128:131], a[232:235], a[28:31], v[128:131]
    ds_read_b64_tr_b16 a[216:217], v216 offset:17408
    v_cvt_pk_bf16_f32 v183, v246, v247
    v_mfma_f32_16x16x32_bf16 v[132:135], a[232:235], a[100:103], v[132:135]
    ds_read_b64_tr_b16 a[218:219], v216 offset:17920
    ds_read_b64_tr_b16 a[220:221], v217 offset:17408
    v_mfma_f32_16x16x32_bf16 v[136:139], a[236:239], a[28:31], v[136:139]
    v_exp_f32 v240, v32
    v_mfma_f32_16x16x32_bf16 v[140:143], a[236:239], a[100:103], v[140:143]
    ds_read_b64_tr_b16 a[222:223], v217 offset:17920
    s_waitcnt lgkmcnt(4)
L_back_step124:
    v_mfma_f32_16x16x32_bf16 v[80:83], a[240:243], a[32:35], v[80:83]
    ds_read_b64_tr_b16 a[224:225], v218 offset:17408
    ds_read_b64_tr_b16 a[226:227], v218 offset:17920
    v_mfma_f32_16x16x32_bf16 v[84:87], a[240:243], a[104:107], v[84:87]
    v_exp_f32 v241, v33
    v_mfma_f32_16x16x32_bf16 v[88:91], a[244:247], a[32:35], v[88:91]
    ds_read_b64_tr_b16 a[228:229], v219 offset:17408
    ds_read_b64_tr_b16 a[230:231], v219 offset:17920
    v_mfma_f32_16x16x32_bf16 v[92:95], a[244:247], a[104:107], v[92:95]
    v_exp_f32 v242, v34
    v_mfma_f32_16x16x32_bf16 v[96:99], a[248:251], a[32:35], v[96:99]
    ds_read_b64_tr_b16 a[232:233], v216 offset:18432
    ds_read_b64_tr_b16 a[234:235], v216 offset:18944
    v_mfma_f32_16x16x32_bf16 v[100:103], a[248:251], a[104:107], v[100:103]
    v_exp_f32 v243, v35
    v_add_f32 v240, 1.0, v240
    v_mfma_f32_16x16x32_bf16 v[104:107], a[252:255], a[32:35], v[104:107]
    ds_read_b64_tr_b16 a[236:237], v217 offset:18432
    s_add_u32 s61, s57, 2065408
    buffer_load_dwordx4 v235, s[20:23], s61 offen offset:3072 lds
    v_mfma_f32_16x16x32_bf16 v[108:111], a[252:255], a[104:107], v[108:111]
    ds_read_b64_tr_b16 a[238:239], v217 offset:18944
    v_add_f32 v241, 1.0, v241
    s_waitcnt lgkmcnt(4)
L_back_step125:
    v_mfma_f32_16x16x32_bf16 v[112:115], a[216:219], a[32:35], v[112:115]
    ds_read_b64_tr_b16 a[240:241], v218 offset:18432
    s_add_u32 m0, s60, 131072
    v_mfma_f32_16x16x32_bf16 v[116:119], a[216:219], a[104:107], v[116:119]
    ds_read_b64_tr_b16 a[242:243], v218 offset:18944
    s_add_u32 s61, s57, 2363392
    v_add_f32 v242, 1.0, v242
    v_mfma_f32_16x16x32_bf16 v[120:123], a[220:223], a[32:35], v[120:123]
    ds_read_b64_tr_b16 a[244:245], v219 offset:18432
    ds_read_b64_tr_b16 a[246:247], v219 offset:18944
    v_mfma_f32_16x16x32_bf16 v[124:127], a[220:223], a[104:107], v[124:127]
    buffer_load_dwordx4 v235, s[20:23], s61 offen offset:0 lds
    v_add_f32 v243, 1.0, v243
    v_mfma_f32_16x16x32_bf16 v[128:131], a[224:227], a[32:35], v[128:131]
    ds_read_b64_tr_b16 a[248:249], v216 offset:19456
    ds_read_b64_tr_b16 a[250:251], v216 offset:19968
    v_mfma_f32_16x16x32_bf16 v[132:135], a[224:227], a[104:107], v[132:135]
    v_rcp_f32 v240, v240
    v_mfma_f32_16x16x32_bf16 v[136:139], a[228:231], a[32:35], v[136:139]
    ds_read_b64_tr_b16 a[252:253], v217 offset:19456
    ds_read_b64_tr_b16 a[254:255], v217 offset:19968
    v_mfma_f32_16x16x32_bf16 v[140:143], a[228:231], a[104:107], v[140:143]
    ds_read_b64_tr_b16 a[216:217], v218 offset:19456
    s_waitcnt lgkmcnt(5)
L_back_step126:
    v_mfma_f32_16x16x32_bf16 v[80:83], a[232:235], a[36:39], v[80:83]
    v_rcp_f32 v241, v241
    v_mfma_f32_16x16x32_bf16 v[84:87], a[232:235], a[108:111], v[84:87]
    ds_read_b64_tr_b16 a[218:219], v218 offset:19968
    ds_read_b64_tr_b16 a[220:221], v219 offset:19456
    v_mfma_f32_16x16x32_bf16 v[88:91], a[236:239], a[36:39], v[88:91]
    ds_read_b64_tr_b16 a[222:223], v219 offset:19968
    s_add_u32 s61, s57, 2657280
    v_mfma_f32_16x16x32_bf16 v[92:95], a[236:239], a[108:111], v[92:95]
    buffer_load_dwordx4 v235, s[20:23], s61 offen offset:1024 lds
    v_rcp_f32 v242, v242
    v_mfma_f32_16x16x32_bf16 v[96:99], a[240:243], a[36:39], v[96:99]
    s_waitcnt vmcnt(20)
    s_barrier
    v_rcp_f32 v243, v243
    v_mul_f32 v240, v64, v240
    v_mfma_f32_16x16x32_bf16 v[100:103], a[240:243], a[108:111], v[100:103]
    ds_read_b64_tr_b16 a[224:225], v216 offset:32768
    ds_read_b64_tr_b16 a[226:227], v216 offset:33280
    v_mfma_f32_16x16x32_bf16 v[104:107], a[244:247], a[36:39], v[104:107]
    ds_read_b64_tr_b16 a[228:229], v217 offset:32768
    s_add_u32 s61, s57, 2951168
    buffer_load_dwordx4 v235, s[20:23], s61 offen offset:2048 lds
    v_mul_f32 v241, v65, v241
    v_mfma_f32_16x16x32_bf16 v[108:111], a[244:247], a[108:111], v[108:111]
    ds_read_b64_tr_b16 a[230:231], v217 offset:33280
    s_waitcnt lgkmcnt(4)
L_back_step127:
    v_mfma_f32_16x16x32_bf16 v[112:115], a[248:251], a[36:39], v[112:115]
    ds_read_b64_tr_b16 a[232:233], v218 offset:32768
    s_add_u32 s61, s57, 3245056
    v_mul_f32 v242, v66, v242
    v_mfma_f32_16x16x32_bf16 v[116:119], a[248:251], a[108:111], v[116:119]
    ds_read_b64_tr_b16 a[234:235], v218 offset:33280
    ds_read_b64_tr_b16 a[236:237], v219 offset:32768
    v_mfma_f32_16x16x32_bf16 v[120:123], a[252:255], a[36:39], v[120:123]
    ds_read_b64_tr_b16 a[238:239], v219 offset:33280
    v_mul_f32 v243, v67, v243
    v_mfma_f32_16x16x32_bf16 v[124:127], a[252:255], a[108:111], v[124:127]
    buffer_load_dwordx4 v235, s[20:23], s61 offen offset:3072 lds
    v_mfma_f32_16x16x32_bf16 v[128:131], a[216:219], a[36:39], v[128:131]
    ds_read_b64_tr_b16 a[240:241], v216 offset:33792
    v_cvt_pk_bf16_f32 v184, v240, v241
    v_mfma_f32_16x16x32_bf16 v[132:135], a[216:219], a[108:111], v[132:135]
    ds_read_b64_tr_b16 a[242:243], v216 offset:34304
    v_cvt_pk_bf16_f32 v185, v242, v243
    v_mfma_f32_16x16x32_bf16 v[136:139], a[220:223], a[36:39], v[136:139]
    ds_read_b64_tr_b16 a[244:245], v217 offset:33792
    ds_read_b64_tr_b16 a[246:247], v217 offset:34304
    v_mfma_f32_16x16x32_bf16 v[140:143], a[220:223], a[108:111], v[140:143]
    ds_read_b64_tr_b16 a[248:249], v218 offset:33792
    s_waitcnt lgkmcnt(5)
L_back_step128:
    v_mfma_f32_16x16x32_bf16 v[80:83], a[224:227], a[40:43], v[80:83]
    v_exp_f32 v244, v36
    v_mfma_f32_16x16x32_bf16 v[84:87], a[224:227], a[112:115], v[84:87]
    ds_read_b64_tr_b16 a[250:251], v218 offset:34304
    ds_read_b64_tr_b16 a[252:253], v219 offset:33792
    v_mfma_f32_16x16x32_bf16 v[88:91], a[228:231], a[40:43], v[88:91]
    ds_read_b64_tr_b16 a[254:255], v219 offset:34304
    s_add_u32 m0, s60, 147456
    v_mfma_f32_16x16x32_bf16 v[92:95], a[228:231], a[112:115], v[92:95]
    s_waitcnt vmcnt(7)
    v_readfirstlane_b32 s40, v2
    s_nop 0
    s_cmp_ge_u32 s40, 1
    s_cbranch_scc0 L_slow_6014
L_back_6015:
    s_add_u32 s43, s53, 0
    buffer_load_dwordx4 a[144:147], v238, s[16:19], s43 offen offset:0 sc1
    v_exp_f32 v245, v37
    v_mfma_f32_16x16x32_bf16 v[96:99], a[232:235], a[40:43], v[96:99]
    ds_read_b64_tr_b16 a[216:217], v216 offset:34816
    ds_read_b64_tr_b16 a[218:219], v216 offset:35328
    v_mfma_f32_16x16x32_bf16 v[100:103], a[232:235], a[112:115], v[100:103]
    v_exp_f32 v246, v38
    v_mfma_f32_16x16x32_bf16 v[104:107], a[236:239], a[40:43], v[104:107]
    ds_read_b64_tr_b16 a[220:221], v217 offset:34816
    ds_read_b64_tr_b16 a[222:223], v217 offset:35328
    v_mfma_f32_16x16x32_bf16 v[108:111], a[236:239], a[112:115], v[108:111]
    ds_read_b64_tr_b16 a[224:225], v218 offset:34816
    v_exp_f32 v247, v39
    v_add_f32 v244, 1.0, v244
    s_waitcnt lgkmcnt(5)
L_back_step129:
    v_mfma_f32_16x16x32_bf16 v[112:115], a[240:243], a[40:43], v[112:115]
    buffer_load_dwordx4 a[148:151], v238, s[16:19], s43 offen offset:1024 sc1
    v_mfma_f32_16x16x32_bf16 v[116:119], a[240:243], a[112:115], v[116:119]
    ds_read_b64_tr_b16 a[226:227], v218 offset:35328
    s_add_u32 s61, s57, 3543040
    v_add_f32 v245, 1.0, v245
    v_mfma_f32_16x16x32_bf16 v[120:123], a[244:247], a[40:43], v[120:123]
    ds_read_b64_tr_b16 a[228:229], v219 offset:34816
    ds_read_b64_tr_b16 a[230:231], v219 offset:35328
    v_mfma_f32_16x16x32_bf16 v[124:127], a[244:247], a[112:115], v[124:127]
    buffer_load_dwordx4 v235, s[20:23], s61 offen offset:0 lds
    v_add_f32 v246, 1.0, v246
    v_mfma_f32_16x16x32_bf16 v[128:131], a[248:251], a[40:43], v[128:131]
    ds_read_b64_tr_b16 a[232:233], v216 offset:35840
    ds_read_b64_tr_b16 a[234:235], v216 offset:36352
    v_add_f32 v247, 1.0, v247
    v_mfma_f32_16x16x32_bf16 v[132:135], a[248:251], a[112:115], v[132:135]
    buffer_load_dwordx4 a[152:155], v238, s[16:19], s43 offen offset:2048 sc1
    v_mfma_f32_16x16x32_bf16 v[136:139], a[252:255], a[40:43], v[136:139]
    ds_read_b64_tr_b16 a[236:237], v217 offset:35840
    ds_read_b64_tr_b16 a[238:239], v217 offset:36352
    v_mfma_f32_16x16x32_bf16 v[140:143], a[252:255], a[112:115], v[140:143]
    ds_read_b64_tr_b16 a[240:241], v218 offset:35840
    s_waitcnt lgkmcnt(5)
L_back_step130:
    v_mfma_f32_16x16x32_bf16 v[80:83], a[216:219], a[44:47], v[80:83]
    v_rcp_f32 v244, v244
    v_mfma_f32_16x16x32_bf16 v[84:87], a[216:219], a[116:119], v[84:87]
    ds_read_b64_tr_b16 a[242:243], v218 offset:36352
    ds_read_b64_tr_b16 a[244:245], v219 offset:35840
    v_mfma_f32_16x16x32_bf16 v[88:91], a[220:223], a[44:47], v[88:91]
    ds_read_b64_tr_b16 a[246:247], v219 offset:36352
    s_add_u32 s61, s57, 3836928
    v_rcp_f32 v245, v245
    v_mfma_f32_16x16x32_bf16 v[92:95], a[220:223], a[116:119], v[92:95]
    buffer_load_dwordx4 a[156:159], v238, s[16:19], s43 offen offset:3072 sc1
    s_add_u32 s43, s53, 4096
    buffer_load_dwordx4 v235, s[20:23], s61 offen offset:1024 lds
    v_mfma_f32_16x16x32_bf16 v[96:99], a[224:227], a[44:47], v[96:99]
    ds_read_b64_tr_b16 a[248:249], v216 offset:49152
    ds_read_b64_tr_b16 a[250:251], v216 offset:49664
    v_rcp_f32 v246, v246
    v_mfma_f32_16x16x32_bf16 v[100:103], a[224:227], a[116:119], v[100:103]
    v_rcp_f32 v247, v247
    v_mfma_f32_16x16x32_bf16 v[104:107], a[228:231], a[44:47], v[104:107]
    ds_read_b64_tr_b16 a[252:253], v217 offset:49152
    v_mul_f32 v244, v68, v244
    v_mfma_f32_16x16x32_bf16 v[108:111], a[228:231], a[116:119], v[108:111]
    ds_read_b64_tr_b16 a[254:255], v217 offset:49664
    s_waitcnt lgkmcnt(4)
L_back_step131:
    v_mfma_f32_16x16x32_bf16 v[112:115], a[232:235], a[44:47], v[112:115]
    ds_read_b64_tr_b16 a[216:217], v218 offset:49152
    ds_read_b64_tr_b16 a[218:219], v218 offset:49664
    v_mul_f32 v245, v69, v245
    v_mfma_f32_16x16x32_bf16 v[116:119], a[232:235], a[116:119], v[116:119]
    buffer_load_dwordx4 a[160:163], v238, s[16:19], s43 offen offset:0 sc1
    v_mfma_f32_16x16x32_bf16 v[120:123], a[236:239], a[44:47], v[120:123]
    ds_read_b64_tr_b16 a[220:221], v219 offset:49152
    ds_read_b64_tr_b16 a[222:223], v219 offset:49664
    v_mul_f32 v246, v70, v246
    v_mfma_f32_16x16x32_bf16 v[124:127], a[236:239], a[116:119], v[124:127]
    s_add_u32 s61, s57, 4130816
    buffer_load_dwordx4 v235, s[20:23], s61 offen offset:2048 lds
    v_mul_f32 v247, v71, v247
    v_mfma_f32_16x16x32_bf16 v[128:131], a[240:243], a[44:47], v[128:131]
    ds_read_b64_tr_b16 a[224:225], v216 offset:50176
    v_cvt_pk_bf16_f32 v188, v244, v245
    v_mfma_f32_16x16x32_bf16 v[132:135], a[240:243], a[116:119], v[132:135]
    ds_read_b64_tr_b16 a[226:227], v216 offset:50688
    ds_read_b64_tr_b16 a[228:229], v217 offset:50176
    v_mfma_f32_16x16x32_bf16 v[136:139], a[244:247], a[44:47], v[136:139]
    buffer_load_dwordx4 a[164:167], v238, s[16:19], s43 offen offset:1024 sc1
    v_cvt_pk_bf16_f32 v189, v246, v247
    v_mfma_f32_16x16x32_bf16 v[140:143], a[244:247], a[116:119], v[140:143]
    ds_read_b64_tr_b16 a[230:231], v217 offset:50688
    s_waitcnt lgkmcnt(4)
L_back_step132:
    v_mfma_f32_16x16x32_bf16 v[80:83], a[248:251], a[48:51], v[80:83]
    ds_read_b64_tr_b16 a[232:233], v218 offset:50176
    ds_read_b64_tr_b16 a[234:235], v218 offset:50688
    v_mfma_f32_16x16x32_bf16 v[84:87], a[248:251], a[120:123], v[84:87]
    v_exp_f32 v240, v40
    v_mfma_f32_16x16x32_bf16 v[88:91], a[252:255], a[48:51], v[88:91]
    ds_read_b64_tr_b16 a[236:237], v219 offset:50176
    ds_read_b64_tr_b16 a[238:239], v219 offset:50688
    v_mfma_f32_16x16x32_bf16 v[92:95], a[252:255], a[120:123], v[92:95]
    buffer_load_dwordx4 a[168:171], v238, s[16:19], s43 offen offset:2048 sc1
    v_mfma_f32_16x16x32_bf16 v[96:99], a[216:219], a[48:51], v[96:99]
    ds_read_b64_tr_b16 a[240:241], v216 offset:51200
    ds_read_b64_tr_b16 a[242:243], v216 offset:51712
    v_exp_f32 v241, v41
    v_mfma_f32_16x16x32_bf16 v[100:103], a[216:219], a[120:123], v[100:103]
    v_exp_f32 v242, v42
    v_mfma_f32_16x16x32_bf16 v[104:107], a[220:223], a[48:51], v[104:107]
    ds_read_b64_tr_b16 a[244:245], v217 offset:51200
    ds_read_b64_tr_b16 a[246:247], v217 offset:51712
    v_mfma_f32_16x16x32_bf16 v[108:111], a[220:223], a[120:123], v[108:111]
    ds_read_b64_tr_b16 a[248:249], v218 offset:51200
    s_waitcnt lgkmcnt(5)
L_back_step133:
    v_mfma_f32_16x16x32_bf16 v[112:115], a[224:227], a[48:51], v[112:115]
    buffer_load_dwordx4 a[172:175], v238, s[16:19], s43 offen offset:3072 sc1
    v_exp_f32 v243, v43
    v_add_f32 v240, 1.0, v240
    v_mfma_f32_16x16x32_bf16 v[116:119], a[224:227], a[120:123], v[116:119]
    ds_read_b64_tr_b16 a[250:251], v218 offset:51712
    s_add_u32 s61, s57, 4424704
    v_mfma_f32_16x16x32_bf16 v[120:123], a[228:231], a[48:51], v[120:123]
    ds_read_b64_tr_b16 a[252:253], v219 offset:51200
    ds_read_b64_tr_b16 a[254:255], v219 offset:51712
    v_add_f32 v241, 1.0, v241
    v_mfma_f32_16x16x32_bf16 v[124:127], a[228:231], a[120:123], v[124:127]
    buffer_load_dwordx4 v235, s[20:23], s61 offen offset:3072 lds
    v_mfma_f32_16x16x32_bf16 v[128:131], a[232:235], a[48:51], v[128:131]
    ds_read_b64_tr_b16 a[216:217], v216 offset:52224
    v_add_f32 v242, 1.0, v242
    v_mfma_f32_16x16x32_bf16 v[132:135], a[232:235], a[120:123], v[132:135]
    ds_read_b64_tr_b16 a[218:219], v216 offset:52736
    v_add_f32 v243, 1.0, v243
    v_mfma_f32_16x16x32_bf16 v[136:139], a[236:239], a[48:51], v[136:139]
    ds_read_b64_tr_b16 a[220:221], v217 offset:52224
    ds_read_b64_tr_b16 a[222:223], v217 offset:52736
    v_mfma_f32_16x16x32_bf16 v[140:143], a[236:239], a[120:123], v[140:143]
    ds_read_b64_tr_b16 a[224:225], v218 offset:52224
    s_waitcnt lgkmcnt(5)
L_back_step134:
    v_mfma_f32_16x16x32_bf16 v[80:83], a[240:243], a[52:55], v[80:83]
    v_rcp_f32 v240, v240
    v_mfma_f32_16x16x32_bf16 v[84:87], a[240:243], a[124:127], v[84:87]
    ds_read_b64_tr_b16 a[226:227], v218 offset:52736
    ds_read_b64_tr_b16 a[228:229], v219 offset:52224
    v_mfma_f32_16x16x32_bf16 v[88:91], a[244:247], a[52:55], v[88:91]
    ds_read_b64_tr_b16 a[230:231], v219 offset:52736
    s_add_u32 m0, s60, 0
    v_mfma_f32_16x16x32_bf16 v[92:95], a[244:247], a[124:127], v[92:95]
    v_rcp_f32 v241, v241
    v_mfma_f32_16x16x32_bf16 v[96:99], a[248:251], a[52:55], v[96:99]
    s_barrier
    v_mfma_f32_16x16x32_bf16 v[100:103], a[248:251], a[124:127], v[100:103]
    ds_read_b64_tr_b16 a[232:233], v220 offset:0
    ds_read_b64_tr_b16 a[234:235], v220 offset:512
    v_rcp_f32 v242, v242
    v_mfma_f32_16x16x32_bf16 v[104:107], a[252:255], a[52:55], v[104:107]
    ds_read_b64_tr_b16 a[236:237], v221 offset:0
    ds_read_b64_tr_b16 a[238:239], v221 offset:512
    v_mfma_f32_16x16x32_bf16 v[108:111], a[252:255], a[124:127], v[108:111]
    ds_read_b64_tr_b16 a[240:241], v222 offset:0
    v_rcp_f32 v243, v243
    v_mul_f32 v240, v72, v240
    s_waitcnt lgkmcnt(5)
L_back_step135:
    v_mfma_f32_16x16x32_bf16 v[112:115], a[216:219], a[52:55], v[112:115]
    s_add_u32 s61, s57, 4722688
    ds_read_b64_tr_b16 a[242:243], v222 offset:512
    v_mfma_f32_16x16x32_bf16 v[116:119], a[216:219], a[124:127], v[116:119]
    buffer_load_dwordx4 v235, s[20:23], s61 offen offset:0 lds
    v_mul_f32 v241, v73, v241
    v_mfma_f32_16x16x32_bf16 v[120:123], a[220:223], a[52:55], v[120:123]
    ds_read_b64_tr_b16 a[244:245], v223 offset:0
    ds_read_b64_tr_b16 a[246:247], v223 offset:512
    v_mfma_f32_16x16x32_bf16 v[124:127], a[220:223], a[124:127], v[124:127]
    s_add_u32 s61, s57, 5016576
    buffer_load_dwordx4 v235, s[20:23], s61 offen offset:1024 lds
    v_mul_f32 v242, v74, v242
    v_mfma_f32_16x16x32_bf16 v[128:131], a[224:227], a[52:55], v[128:131]
    ds_read_b64_tr_b16 a[248:249], v220 offset:1024
    v_mul_f32 v243, v75, v243
    v_mfma_f32_16x16x32_bf16 v[132:135], a[224:227], a[124:127], v[132:135]
    ds_read_b64_tr_b16 a[250:251], v220 offset:1536
    s_add_u32 s61, s58, 2048
    buffer_load_dwordx4 v236, s[24:27], s61 offen offset:2048 lds
    v_mfma_f32_16x16x32_bf16 v[136:139], a[228:231], a[52:55], v[136:139]
    ds_read_b64_tr_b16 a[252:253], v221 offset:1024
    v_cvt_pk_bf16_f32 v186, v240, v241
    v_mfma_f32_16x16x32_bf16 v[140:143], a[228:231], a[124:127], v[140:143]
    ds_read_b64_tr_b16 a[254:255], v221 offset:1536
    s_waitcnt lgkmcnt(4)
L_back_step136:
    v_mfma_f32_16x16x32_bf16 v[80:83], a[232:235], a[56:59], v[80:83]
    ds_read_b64_tr_b16 a[216:217], v222 offset:1024
    s_add_u32 s61, s58, 37888
    v_cvt_pk_bf16_f32 v187, v242, v243
    v_mfma_f32_16x16x32_bf16 v[84:87], a[232:235], a[128:131], v[84:87]
    ds_read_b64_tr_b16 a[218:219], v222 offset:1536
    ds_read_b64_tr_b16 a[220:221], v223 offset:1024
    v_mfma_f32_16x16x32_bf16 v[88:91], a[236:239], a[56:59], v[88:91]
    ds_read_b64_tr_b16 a[222:223], v223 offset:1536
    v_mfma_f32_16x16x32_bf16 v[92:95], a[236:239], a[128:131], v[92:95]
    buffer_load_dwordx4 v236, s[24:27], s61 offen offset:3072 lds
    v_mfma_f32_16x16x32_bf16 v[96:99], a[240:243], a[56:59], v[96:99]
    ds_read_b64_tr_b16 a[224:225], v220 offset:2048
    ds_read_b64_tr_b16 a[226:227], v220 offset:2560
    v_exp_f32 v244, v44
    v_mfma_f32_16x16x32_bf16 v[100:103], a[240:243], a[128:131], v[100:103]
    v_exp_f32 v245, v45
    v_mfma_f32_16x16x32_bf16 v[104:107], a[244:247], a[56:59], v[104:107]
    ds_read_b64_tr_b16 a[228:229], v221 offset:2048
    ds_read_b64_tr_b16 a[230:231], v221 offset:2560
    v_mfma_f32_16x16x32_bf16 v[108:111], a[244:247], a[128:131], v[108:111]
    ds_read_b64_tr_b16 a[232:233], v222 offset:2048
    s_waitcnt lgkmcnt(5)
L_back_step137:
    v_mfma_f32_16x16x32_bf16 v[112:115], a[248:251], a[56:59], v[112:115]
    v_exp_f32 v246, v46
    v_mfma_f32_16x16x32_bf16 v[116:119], a[248:251], a[128:131], v[116:119]
    ds_read_b64_tr_b16 a[234:235], v222 offset:2560
    ds_read_b64_tr_b16 a[236:237], v223 offset:2048
    v_mfma_f32_16x16x32_bf16 v[120:123], a[252:255], a[56:59], v[120:123]
    ds_read_b64_tr_b16 a[238:239], v223 offset:2560
    s_add_u32 m0, s60, 16384
    v_exp_f32 v247, v47
    v_add_f32 v244, 1.0, v244
    v_mfma_f32_16x16x32_bf16 v[124:127], a[252:255], a[128:131], v[124:127]
    s_add_u32 s61, s58, 77824
    buffer_load_dwordx4 v236, s[24:27], s61 offen offset:0 lds
    v_mfma_f32_16x16x32_bf16 v[128:131], a[216:219], a[56:59], v[128:131]
    ds_read_b64_tr_b16 a[240:241], v220 offset:3072
    v_add_f32 v245, 1.0, v245
    v_mfma_f32_16x16x32_bf16 v[132:135], a[216:219], a[128:131], v[132:135]
    ds_read_b64_tr_b16 a[242:243], v220 offset:3584
    v_add_f32 v246, 1.0, v246
    v_mfma_f32_16x16x32_bf16 v[136:139], a[220:223], a[56:59], v[136:139]
    ds_read_b64_tr_b16 a[244:245], v221 offset:3072
    v_add_f32 v247, 1.0, v247
    v_mfma_f32_16x16x32_bf16 v[140:143], a[220:223], a[128:131], v[140:143]
    ds_read_b64_tr_b16 a[246:247], v221 offset:3584
    s_waitcnt lgkmcnt(4)
L_back_step138:
    v_mfma_f32_16x16x32_bf16 v[80:83], a[224:227], a[60:63], v[80:83]
    ds_read_b64_tr_b16 a[248:249], v222 offset:3072
    ds_read_b64_tr_b16 a[250:251], v222 offset:3584
    v_mfma_f32_16x16x32_bf16 v[84:87], a[224:227], a[132:135], v[84:87]
    v_rcp_f32 v244, v244
    v_mfma_f32_16x16x32_bf16 v[88:91], a[228:231], a[60:63], v[88:91]
    ds_read_b64_tr_b16 a[252:253], v223 offset:3072
    ds_read_b64_tr_b16 a[254:255], v223 offset:3584
    v_mfma_f32_16x16x32_bf16 v[92:95], a[228:231], a[132:135], v[92:95]
    v_rcp_f32 v245, v245
    v_mfma_f32_16x16x32_bf16 v[96:99], a[232:235], a[60:63], v[96:99]
    ds_read_b64_tr_b16 a[216:217], v220 offset:16384
    ds_read_b64_tr_b16 a[218:219], v220 offset:16896
    v_mfma_f32_16x16x32_bf16 v[100:103], a[232:235], a[132:135], v[100:103]
    v_rcp_f32 v246, v246
    v_mfma_f32_16x16x32_bf16 v[104:107], a[236:239], a[60:63], v[104:107]
    ds_read_b64_tr_b16 a[220:221], v221 offset:16384
    ds_read_b64_tr_b16 a[222:223], v221 offset:16896
    v_mfma_f32_16x16x32_bf16 v[108:111], a[236:239], a[132:135], v[108:111]
    ds_read_b64_tr_b16 a[224:225], v222 offset:16384
    s_waitcnt lgkmcnt(5)
L_back_step139:
    v_mfma_f32_16x16x32_bf16 v[112:115], a[240:243], a[60:63], v[112:115]
    v_rcp_f32 v247, v247
    v_mul_f32 v244, v76, v244
    v_mfma_f32_16x16x32_bf16 v[116:119], a[240:243], a[132:135], v[116:119]
    ds_read_b64_tr_b16 a[226:227], v222 offset:16896
    s_add_u32 s61, s58, 113664
    v_mfma_f32_16x16x32_bf16 v[120:123], a[244:247], a[60:63], v[120:123]
    ds_read_b64_tr_b16 a[228:229], v223 offset:16384
    ds_read_b64_tr_b16 a[230:231], v223 offset:16896
    v_mul_f32 v245, v77, v245
    v_mfma_f32_16x16x32_bf16 v[124:127], a[244:247], a[132:135], v[124:127]
    buffer_load_dwordx4 v236, s[24:27], s61 offen offset:1024 lds
    v_mfma_f32_16x16x32_bf16 v[128:131], a[248:251], a[60:63], v[128:131]
    ds_read_b64_tr_b16 a[232:233], v220 offset:17408
    v_mul_f32 v246, v78, v246
    v_mfma_f32_16x16x32_bf16 v[132:135], a[248:251], a[132:135], v[132:135]
    ds_read_b64_tr_b16 a[234:235], v220 offset:17920
    v_mul_f32 v247, v79, v247
    v_mfma_f32_16x16x32_bf16 v[136:139], a[252:255], a[60:63], v[136:139]
    ds_read_b64_tr_b16 a[236:237], v221 offset:17408
    v_cvt_pk_bf16_f32 v190, v244, v245
    v_mfma_f32_16x16x32_bf16 v[140:143], a[252:255], a[132:135], v[140:143]
    ds_read_b64_tr_b16 a[238:239], v221 offset:17920
    s_waitcnt lgkmcnt(4)
L_back_step140:
    v_mfma_f32_16x16x32_bf16 v[80:83], a[216:219], a[64:67], v[80:83]
    ds_read_b64_tr_b16 a[240:241], v222 offset:17408
    s_add_u32 s61, s58, 149504
    v_mfma_f32_16x16x32_bf16 v[84:87], a[216:219], a[136:139], v[84:87]
    ds_read_b64_tr_b16 a[242:243], v222 offset:17920
    ds_read_b64_tr_b16 a[244:245], v223 offset:17408
    v_cvt_pk_bf16_f32 v191, v246, v247
    v_mfma_f32_16x16x32_bf16 v[88:91], a[220:223], a[64:67], v[88:91]
    ds_read_b64_tr_b16 a[246:247], v223 offset:17920
    s_add_u32 s39, s52, 8192
    v_mfma_f32_16x16x32_bf16 v[92:95], a[220:223], a[136:139], v[92:95]
    buffer_load_dwordx4 v236, s[24:27], s61 offen offset:2048 lds
    v_mfma_f32_16x16x32_bf16 v[96:99], a[224:227], a[64:67], v[96:99]
    ds_read_b64_tr_b16 a[248:249], v220 offset:18432
    ds_read_b64_tr_b16 a[250:251], v220 offset:18944
    v_mfma_f32_16x16x32_bf16 v[100:103], a[224:227], a[136:139], v[100:103]
    buffer_store_dwordx4 v[176:179], v238, s[16:19], s39 offen offset:0 sc1
    v_mfma_f32_16x16x32_bf16 v[104:107], a[228:231], a[64:67], v[104:107]
    ds_read_b64_tr_b16 a[252:253], v221 offset:18432
    ds_read_b64_tr_b16 a[254:255], v221 offset:18944
    v_mfma_f32_16x16x32_bf16 v[108:111], a[228:231], a[136:139], v[108:111]
    ds_read_b64_tr_b16 a[216:217], v222 offset:18432
    s_waitcnt lgkmcnt(5)
L_back_step141:
    v_mfma_f32_16x16x32_bf16 v[112:115], a[232:235], a[64:67], v[112:115]
    buffer_store_dwordx4 v[180:183], v238, s[16:19], s39 offen offset:1024 sc1
    v_mfma_f32_16x16x32_bf16 v[116:119], a[232:235], a[136:139], v[116:119]
    ds_read_b64_tr_b16 a[218:219], v222 offset:18944
    ds_read_b64_tr_b16 a[220:221], v223 offset:18432
    v_mfma_f32_16x16x32_bf16 v[120:123], a[236:239], a[64:67], v[120:123]
    ds_read_b64_tr_b16 a[222:223], v223 offset:18944
    s_add_u32 s61, s58, 185344
    v_mfma_f32_16x16x32_bf16 v[124:127], a[236:239], a[136:139], v[124:127]
    buffer_load_dwordx4 v236, s[24:27], s61 offen offset:3072 lds
    buffer_store_dwordx4 v[184:187], v238, s[16:19], s39 offen offset:2048 sc1
    v_mfma_f32_16x16x32_bf16 v[128:131], a[240:243], a[64:67], v[128:131]
    ds_read_b64_tr_b16 a[224:225], v220 offset:19456
    ds_read_b64_tr_b16 a[226:227], v220 offset:19968
    v_mfma_f32_16x16x32_bf16 v[132:135], a[240:243], a[136:139], v[132:135]
    buffer_store_dwordx4 v[188:191], v238, s[16:19], s39 offen offset:3072 sc1
    v_mfma_f32_16x16x32_bf16 v[136:139], a[244:247], a[64:67], v[136:139]
    ds_read_b64_tr_b16 a[228:229], v221 offset:19456
    ds_read_b64_tr_b16 a[230:231], v221 offset:19968
    v_mfma_f32_16x16x32_bf16 v[140:143], a[244:247], a[136:139], v[140:143]
    ds_read_b64_tr_b16 a[232:233], v222 offset:19456
    s_waitcnt lgkmcnt(5)
L_back_step142:
    v_mfma_f32_16x16x32_bf16 v[80:83], a[248:251], a[68:71], v[80:83]
    s_add_u32 m0, s60, 32768
    s_add_u32 s61, s50, 4096
    v_mfma_f32_16x16x32_bf16 v[84:87], a[248:251], a[140:143], v[84:87]
    ds_read_b64_tr_b16 a[234:235], v222 offset:19968
    ds_read_b64_tr_b16 a[236:237], v223 offset:19456
    v_mfma_f32_16x16x32_bf16 v[88:91], a[252:255], a[68:71], v[88:91]
    ds_read_b64_tr_b16 a[238:239], v223 offset:19968
    v_mfma_f32_16x16x32_bf16 v[92:95], a[252:255], a[140:143], v[92:95]
    buffer_load_dwordx4 v236, s[24:27], s61 offen offset:0 lds
    v_mfma_f32_16x16x32_bf16 v[96:99], a[216:219], a[68:71], v[96:99]
    s_waitcnt vmcnt(29)
    s_barrier
    v_mfma_f32_16x16x32_bf16 v[100:103], a[216:219], a[140:143], v[100:103]
    ds_read_b64_tr_b16 a[240:241], v230 offset:32768
    ds_read_b64_tr_b16 a[242:243], v230 offset:33024
    v_mfma_f32_16x16x32_bf16 v[104:107], a[220:223], a[68:71], v[104:107]
    ds_read_b64_tr_b16 a[244:245], v231 offset:32768
    s_add_u32 s61, s50, 39936
    buffer_load_dwordx4 v236, s[24:27], s61 offen offset:1024 lds
    v_mfma_f32_16x16x32_bf16 v[108:111], a[220:223], a[140:143], v[108:111]
    ds_read_b64_tr_b16 a[246:247], v231 offset:33024
    s_waitcnt lgkmcnt(4)
L_back_step143:
    v_mfma_f32_16x16x32_bf16 v[112:115], a[224:227], a[68:71], v[112:115]
    ds_read_b64_tr_b16 a[248:249], v230 offset:40960
    s_add_u32 s61, s50, 75776
    v_mfma_f32_16x16x32_bf16 v[116:119], a[224:227], a[140:143], v[116:119]
    ds_read_b64_tr_b16 a[250:251], v230 offset:41216
    ds_read_b64_tr_b16 a[252:253], v231 offset:40960
    v_mfma_f32_16x16x32_bf16 v[120:123], a[228:231], a[68:71], v[120:123]
    ds_read_b64_tr_b16 a[254:255], v231 offset:41216
    v_mfma_f32_16x16x32_bf16 v[124:127], a[228:231], a[140:143], v[124:127]
    buffer_load_dwordx4 v236, s[24:27], s61 offen offset:2048 lds
    v_mfma_f32_16x16x32_bf16 v[128:131], a[232:235], a[68:71], v[128:131]
    ds_read_b64_tr_b16 a[216:217], v230 offset:33792
    ds_read_b64_tr_b16 a[218:219], v230 offset:34048
    v_mfma_f32_16x16x32_bf16 v[132:135], a[232:235], a[140:143], v[132:135]
    s_add_u32 s61, s50, 111616
    buffer_load_dwordx4 v236, s[24:27], s61 offen offset:3072 lds
    v_mfma_f32_16x16x32_bf16 v[136:139], a[236:239], a[68:71], v[136:139]
    ds_read_b64_tr_b16 a[220:221], v231 offset:33792
    ds_read_b64_tr_b16 a[222:223], v231 offset:34048
    v_mfma_f32_16x16x32_bf16 v[140:143], a[236:239], a[140:143], v[140:143]
    ds_read_b64_tr_b16 a[224:225], v230 offset:41984
    s_waitcnt lgkmcnt(5)
L_back_step144:
    v_mfma_f32_16x16x32_bf16 v[16:19], a[240:243], a[0:3], 0
    s_add_u32 m0, s60, 49152
    s_add_u32 s61, s50, 151552
    v_mfma_f32_16x16x32_bf16 v[20:23], a[240:243], a[72:75], 0
    ds_read_b64_tr_b16 a[226:227], v230 offset:42240
    ds_read_b64_tr_b16 a[228:229], v231 offset:41984
    v_mfma_f32_16x16x32_bf16 v[24:27], a[244:247], a[0:3], 0
    ds_read_b64_tr_b16 a[230:231], v231 offset:42240
    v_mfma_f32_16x16x32_bf16 v[28:31], a[244:247], a[72:75], 0
    buffer_load_dwordx4 v236, s[24:27], s61 offen offset:0 lds
    v_mfma_f32_16x16x32_bf16 v[48:51], a[248:251], a[0:3], 0
    ds_read_b64_tr_b16 a[232:233], v230 offset:34816
    ds_read_b64_tr_b16 a[234:235], v230 offset:35072
    v_mfma_f32_16x16x32_bf16 v[52:55], a[248:251], a[72:75], 0
    v_exp_f32 v240, v80
    v_mfma_f32_16x16x32_bf16 v[56:59], a[252:255], a[0:3], 0
    ds_read_b64_tr_b16 a[236:237], v231 offset:34816
    ds_read_b64_tr_b16 a[238:239], v231 offset:35072
    v_exp_f32 v241, v81
    v_mfma_f32_16x16x32_bf16 v[60:63], a[252:255], a[72:75], 0
    ds_read_b64_tr_b16 a[240:241], v230 offset:43008
    v_exp_f32 v242, v82
    s_waitcnt lgkmcnt(5)
L_back_step145:
    v_mfma_f32_16x16x32_bf16 v[16:19], a[216:219], a[4:7], v[16:19]
    v_exp_f32 v243, v83
    v_add_f32 v240, 1.0, v240
    v_mfma_f32_16x16x32_bf16 v[20:23], a[216:219], a[76:79], v[20:23]
    ds_read_b64_tr_b16 a[242:243], v230 offset:43264
    s_add_u32 s61, s50, 187392
    v_add_f32 v241, 1.0, v241
    v_mfma_f32_16x16x32_bf16 v[24:27], a[220:223], a[4:7], v[24:27]
    ds_read_b64_tr_b16 a[244:245], v231 offset:43008
    ds_read_b64_tr_b16 a[246:247], v231 offset:43264
    v_add_f32 v242, 1.0, v242
    v_mfma_f32_16x16x32_bf16 v[28:31], a[220:223], a[76:79], v[28:31]
    buffer_load_dwordx4 v236, s[24:27], s61 offen offset:1024 lds
    v_add_f32 v243, 1.0, v243
    v_mfma_f32_16x16x32_bf16 v[48:51], a[224:227], a[4:7], v[48:51]
    ds_read_b64_tr_b16 a[248:249], v230 offset:35840
    ds_read_b64_tr_b16 a[250:251], v230 offset:36096
    v_mfma_f32_16x16x32_bf16 v[52:55], a[224:227], a[76:79], v[52:55]
    v_rcp_f32 v240, v240
    v_mfma_f32_16x16x32_bf16 v[56:59], a[228:231], a[4:7], v[56:59]
    ds_read_b64_tr_b16 a[252:253], v231 offset:35840
    ds_read_b64_tr_b16 a[254:255], v231 offset:36096
    v_rcp_f32 v241, v241
    v_mfma_f32_16x16x32_bf16 v[60:63], a[228:231], a[76:79], v[60:63]
    ds_read_b64_tr_b16 a[216:217], v230 offset:44032
    v_rcp_f32 v242, v242
    s_waitcnt lgkmcnt(5)
L_back_step146:
    v_mfma_f32_16x16x32_bf16 v[16:19], a[232:235], a[8:11], v[16:19]
    v_rcp_f32 v243, v243
    v_mul_f32 v240, v112, v240
    v_mul_f32 v241, v113, v241
    v_mfma_f32_16x16x32_bf16 v[20:23], a[232:235], a[80:83], v[20:23]
    ds_read_b64_tr_b16 a[218:219], v230 offset:44288
    s_add_u32 s61, s58, 2176
    v_mul_f32 v242, v114, v242
    v_mfma_f32_16x16x32_bf16 v[24:27], a[236:239], a[8:11], v[24:27]
    ds_read_b64_tr_b16 a[220:221], v231 offset:44032
    ds_read_b64_tr_b16 a[222:223], v231 offset:44288
    v_mul_f32 v243, v115, v243
    v_mfma_f32_16x16x32_bf16 v[28:31], a[236:239], a[80:83], v[28:31]
    buffer_load_dwordx4 v236, s[24:27], s61 offen offset:2048 lds
    v_cvt_pk_bf16_f32 v192, v240, v241
    v_mfma_f32_16x16x32_bf16 v[48:51], a[240:243], a[8:11], v[48:51]
    ds_read_b64_tr_b16 a[224:225], v230 offset:49152
    v_cvt_pk_bf16_f32 v193, v242, v243
    v_mfma_f32_16x16x32_bf16 v[52:55], a[240:243], a[80:83], v[52:55]
    ds_read_b64_tr_b16 a[226:227], v230 offset:49408
    ds_read_b64_tr_b16 a[228:229], v231 offset:49152
    v_mfma_f32_16x16x32_bf16 v[56:59], a[244:247], a[8:11], v[56:59]
    v_exp_f32 v244, v84
    v_mfma_f32_16x16x32_bf16 v[60:63], a[244:247], a[80:83], v[60:63]
    ds_read_b64_tr_b16 a[230:231], v231 offset:49408
    v_exp_f32 v245, v85
    s_waitcnt lgkmcnt(4)
L_back_step147:
    v_mfma_f32_16x16x32_bf16 v[16:19], a[248:251], a[12:15], v[16:19]
    ds_read_b64_tr_b16 a[232:233], v230 offset:57344
    ds_read_b64_tr_b16 a[234:235], v230 offset:57600
    v_exp_f32 v246, v86
    v_mfma_f32_16x16x32_bf16 v[20:23], a[248:251], a[84:87], v[20:23]
    v_exp_f32 v247, v87
    v_add_f32 v244, 1.0, v244
    v_mfma_f32_16x16x32_bf16 v[24:27], a[252:255], a[12:15], v[24:27]
    ds_read_b64_tr_b16 a[236:237], v231 offset:57344
    ds_read_b64_tr_b16 a[238:239], v231 offset:57600
    v_add_f32 v245, 1.0, v245
    v_mfma_f32_16x16x32_bf16 v[28:31], a[252:255], a[84:87], v[28:31]
    s_add_u32 s61, s58, 38016
    buffer_load_dwordx4 v236, s[24:27], s61 offen offset:3072 lds
    v_add_f32 v246, 1.0, v246
    v_mfma_f32_16x16x32_bf16 v[48:51], a[216:219], a[12:15], v[48:51]
    ds_read_b64_tr_b16 a[240:241], v230 offset:50176
    v_add_f32 v247, 1.0, v247
    v_mfma_f32_16x16x32_bf16 v[52:55], a[216:219], a[84:87], v[52:55]
    ds_read_b64_tr_b16 a[242:243], v230 offset:50432
    ds_read_b64_tr_b16 a[244:245], v231 offset:50176
    v_rcp_f32 v244, v244
    v_mfma_f32_16x16x32_bf16 v[56:59], a[220:223], a[12:15], v[56:59]
    v_rcp_f32 v245, v245
    v_mfma_f32_16x16x32_bf16 v[60:63], a[220:223], a[84:87], v[60:63]
    ds_read_b64_tr_b16 a[246:247], v231 offset:50432
    v_rcp_f32 v246, v246
    s_waitcnt lgkmcnt(4)
L_back_step148:
    v_mfma_f32_16x16x32_bf16 v[16:19], a[224:227], a[16:19], v[16:19]
    ds_read_b64_tr_b16 a[248:249], v230 offset:58368
    ds_read_b64_tr_b16 a[250:251], v230 offset:58624
    v_rcp_f32 v247, v247
    v_mul_f32 v244, v116, v244
    v_mfma_f32_16x16x32_bf16 v[20:23], a[224:227], a[88:91], v[20:23]
    s_add_u32 m0, s60, 65536
    s_add_u32 s61, s58, 77952
    v_mul_f32 v245, v117, v245
    v_mfma_f32_16x16x32_bf16 v[24:27], a[228:231], a[16:19], v[24:27]
    ds_read_b64_tr_b16 a[252:253], v231 offset:58368
    ds_read_b64_tr_b16 a[254:255], v231 offset:58624
    v_mul_f32 v246, v118, v246
    v_mfma_f32_16x16x32_bf16 v[28:31], a[228:231], a[88:91], v[28:31]
    buffer_load_dwordx4 v236, s[24:27], s61 offen offset:0 lds
    v_mul_f32 v247, v119, v247
    v_mfma_f32_16x16x32_bf16 v[48:51], a[232:235], a[16:19], v[48:51]
    ds_read_b64_tr_b16 a[216:217], v230 offset:51200
    v_cvt_pk_bf16_f32 v196, v244, v245
    v_mfma_f32_16x16x32_bf16 v[52:55], a[232:235], a[88:91], v[52:55]
    ds_read_b64_tr_b16 a[218:219], v230 offset:51456
    v_cvt_pk_bf16_f32 v197, v246, v247
    v_mfma_f32_16x16x32_bf16 v[56:59], a[236:239], a[16:19], v[56:59]
    ds_read_b64_tr_b16 a[220:221], v231 offset:51200
    ds_read_b64_tr_b16 a[222:223], v231 offset:51456
    v_mfma_f32_16x16x32_bf16 v[60:63], a[236:239], a[88:91], v[60:63]
    ds_read_b64_tr_b16 a[224:225], v230 offset:59392
    v_exp_f32 v240, v88
    s_waitcnt lgkmcnt(5)
L_back_step149:
    v_mfma_f32_16x16x32_bf16 v[16:19], a[240:243], a[20:23], v[16:19]
    v_exp_f32 v241, v89
    v_mfma_f32_16x16x32_bf16 v[20:23], a[240:243], a[92:95], v[20:23]
    ds_read_b64_tr_b16 a[226:227], v230 offset:59648
    ds_read_b64_tr_b16 a[228:229], v231 offset:59392
    v_exp_f32 v242, v90
    v_mfma_f32_16x16x32_bf16 v[24:27], a[244:247], a[20:23], v[24:27]
    ds_read_b64_tr_b16 a[230:231], v231 offset:59648
    s_add_u32 s61, s58, 113792
    v_exp_f32 v243, v91
    v_add_f32 v240, 1.0, v240
    v_add_f32 v241, 1.0, v241
    v_mfma_f32_16x16x32_bf16 v[28:31], a[244:247], a[92:95], v[28:31]
    buffer_load_dwordx4 v236, s[24:27], s61 offen offset:1024 lds
    v_add_f32 v242, 1.0, v242
    v_mfma_f32_16x16x32_bf16 v[48:51], a[248:251], a[20:23], v[48:51]
    ds_read_b64_tr_b16 a[232:233], v230 offset:52224
    v_add_f32 v243, 1.0, v243
    v_mfma_f32_16x16x32_bf16 v[52:55], a[248:251], a[92:95], v[52:55]
    s_waitcnt vmcnt(10)
    v_mov_b32 v3, 2
    s_mov_b64 exec, 1
    buffer_store_dword v3, v15, s[16:19], s7 offen sc1
    s_mov_b64 exec, -1
    v_mfma_f32_16x16x32_bf16 v[56:59], a[252:255], a[20:23], v[56:59]
    ds_read_b64_tr_b16 a[234:235], v230 offset:52480
    ds_read_b64_tr_b16 a[236:237], v231 offset:52224
    v_rcp_f32 v240, v240
    v_mfma_f32_16x16x32_bf16 v[60:63], a[252:255], a[92:95], v[60:63]
    ds_read_b64_tr_b16 a[238:239], v231 offset:52480
    v_rcp_f32 v241, v241
    s_waitcnt lgkmcnt(4)
L_back_step150:
    v_mfma_f32_16x16x32_bf16 v[16:19], a[216:219], a[24:27], v[16:19]
    ds_read_b64_tr_b16 a[240:241], v230 offset:60416
    ds_read_b64_tr_b16 a[242:243], v230 offset:60672
    v_rcp_f32 v242, v242
    v_mfma_f32_16x16x32_bf16 v[20:23], a[216:219], a[96:99], v[20:23]
    v_rcp_f32 v243, v243
    v_mul_f32 v240, v120, v240
    v_mfma_f32_16x16x32_bf16 v[24:27], a[220:223], a[24:27], v[24:27]
    ds_read_b64_tr_b16 a[244:245], v231 offset:60416
    ds_read_b64_tr_b16 a[246:247], v231 offset:60672
    v_mul_f32 v241, v121, v241
    v_mfma_f32_16x16x32_bf16 v[28:31], a[220:223], a[96:99], v[28:31]
    s_add_u32 s61, s58, 149632
    buffer_load_dwordx4 v236, s[24:27], s61 offen offset:2048 lds
    v_mul_f32 v242, v122, v242
    v_mfma_f32_16x16x32_bf16 v[48:51], a[224:227], a[24:27], v[48:51]
    s_barrier
    v_mul_f32 v243, v123, v243
    v_mfma_f32_16x16x32_bf16 v[52:55], a[224:227], a[96:99], v[52:55]
    ds_read_b64_tr_b16 a[248:249], v232 offset:0
    ds_read_b64_tr_b16 a[250:251], v232 offset:256
    v_cvt_pk_bf16_f32 v194, v240, v241
    v_mfma_f32_16x16x32_bf16 v[56:59], a[228:231], a[24:27], v[56:59]
    ds_read_b64_tr_b16 a[252:253], v233 offset:0
    s_add_u32 s61, s58, 185472
    buffer_load_dwordx4 v236, s[24:27], s61 offen offset:3072 lds
    v_cvt_pk_bf16_f32 v195, v242, v243
    v_mfma_f32_16x16x32_bf16 v[60:63], a[228:231], a[96:99], v[60:63]
    ds_read_b64_tr_b16 a[254:255], v233 offset:256
    v_exp_f32 v244, v92
    s_waitcnt lgkmcnt(4)
L_back_step151:
    v_mfma_f32_16x16x32_bf16 v[16:19], a[232:235], a[28:31], v[16:19]
    ds_read_b64_tr_b16 a[216:217], v232 offset:8192
    ds_read_b64_tr_b16 a[218:219], v232 offset:8448
    v_exp_f32 v245, v93
    v_mfma_f32_16x16x32_bf16 v[20:23], a[232:235], a[100:103], v[20:23]
    v_exp_f32 v246, v94
    v_mfma_f32_16x16x32_bf16 v[24:27], a[236:239], a[28:31], v[24:27]
    ds_read_b64_tr_b16 a[220:221], v233 offset:8192
    ds_read_b64_tr_b16 a[222:223], v233 offset:8448
    v_exp_f32 v247, v95
    v_add_f32 v244, 1.0, v244
    v_mfma_f32_16x16x32_bf16 v[28:31], a[236:239], a[100:103], v[28:31]
    s_add_u32 m0, s60, 81920
    s_add_u32 s61, s50, 4224
    buffer_load_dwordx4 v236, s[24:27], s61 offen offset:0 lds
    v_add_f32 v245, 1.0, v245
    v_mfma_f32_16x16x32_bf16 v[48:51], a[240:243], a[28:31], v[48:51]
    ds_read_b64_tr_b16 a[224:225], v232 offset:1024
    v_add_f32 v246, 1.0, v246
    v_mfma_f32_16x16x32_bf16 v[52:55], a[240:243], a[100:103], v[52:55]
    ds_read_b64_tr_b16 a[226:227], v232 offset:1280
    v_add_f32 v247, 1.0, v247
    v_mfma_f32_16x16x32_bf16 v[56:59], a[244:247], a[28:31], v[56:59]
    ds_read_b64_tr_b16 a[228:229], v233 offset:1024
    ds_read_b64_tr_b16 a[230:231], v233 offset:1280
    v_mfma_f32_16x16x32_bf16 v[60:63], a[244:247], a[100:103], v[60:63]
    ds_read_b64_tr_b16 a[232:233], v232 offset:9216
    v_rcp_f32 v244, v244
    s_waitcnt lgkmcnt(5)
L_back_step152:
    v_mfma_f32_16x16x32_bf16 v[16:19], a[248:251], a[32:35], v[16:19]
    v_rcp_f32 v245, v245
    v_mfma_f32_16x16x32_bf16 v[20:23], a[248:251], a[104:107], v[20:23]
    ds_read_b64_tr_b16 a[234:235], v232 offset:9472
    ds_read_b64_tr_b16 a[236:237], v233 offset:9216
    v_rcp_f32 v246, v246
    v_mfma_f32_16x16x32_bf16 v[24:27], a[252:255], a[32:35], v[24:27]
    ds_read_b64_tr_b16 a[238:239], v233 offset:9472
    s_add_u32 s61, s50, 40064
    v_rcp_f32 v247, v247
    v_mul_f32 v244, v124, v244
    v_mfma_f32_16x16x32_bf16 v[28:31], a[252:255], a[104:107], v[28:31]
    buffer_load_dwordx4 v236, s[24:27], s61 offen offset:1024 lds
    v_mul_f32 v245, v125, v245
    v_mul_f32 v246, v126, v246
    v_mfma_f32_16x16x32_bf16 v[48:51], a[216:219], a[32:35], v[48:51]
    ds_read_b64_tr_b16 a[240:241], v232 offset:2048
    v_mul_f32 v247, v127, v247
    v_mfma_f32_16x16x32_bf16 v[52:55], a[216:219], a[104:107], v[52:55]
    ds_read_b64_tr_b16 a[242:243], v232 offset:2304
    v_cvt_pk_bf16_f32 v198, v244, v245
    v_mfma_f32_16x16x32_bf16 v[56:59], a[220:223], a[32:35], v[56:59]
    ds_read_b64_tr_b16 a[244:245], v233 offset:2048
    v_cvt_pk_bf16_f32 v199, v246, v247
    v_mfma_f32_16x16x32_bf16 v[60:63], a[220:223], a[104:107], v[60:63]
    ds_read_b64_tr_b16 a[246:247], v233 offset:2304
    s_waitcnt lgkmcnt(4)
L_back_step153:
    v_mfma_f32_16x16x32_bf16 v[16:19], a[224:227], a[36:39], v[16:19]
    ds_read_b64_tr_b16 a[248:249], v232 offset:10240
    ds_read_b64_tr_b16 a[250:251], v232 offset:10496
    v_exp_f32 v240, v96
    v_mfma_f32_16x16x32_bf16 v[20:23], a[224:227], a[108:111], v[20:23]
    v_exp_f32 v241, v97
    v_mfma_f32_16x16x32_bf16 v[24:27], a[228:231], a[36:39], v[24:27]
    ds_read_b64_tr_b16 a[252:253], v233 offset:10240
    ds_read_b64_tr_b16 a[254:255], v233 offset:10496
    v_exp_f32 v242, v98
    v_mfma_f32_16x16x32_bf16 v[28:31], a[228:231], a[108:111], v[28:31]
    v_exp_f32 v243, v99
    v_add_f32 v240, 1.0, v240
    v_mfma_f32_16x16x32_bf16 v[48:51], a[232:235], a[36:39], v[48:51]
    ds_read_b64_tr_b16 a[216:217], v232 offset:3072
    s_add_u32 s61, s50, 75904
    buffer_load_dwordx4 v236, s[24:27], s61 offen offset:2048 lds
    v_add_f32 v241, 1.0, v241
    v_mfma_f32_16x16x32_bf16 v[52:55], a[232:235], a[108:111], v[52:55]
    ds_read_b64_tr_b16 a[218:219], v232 offset:3328
    v_add_f32 v242, 1.0, v242
    v_mfma_f32_16x16x32_bf16 v[56:59], a[236:239], a[36:39], v[56:59]
    ds_read_b64_tr_b16 a[220:221], v233 offset:3072
    v_add_f32 v243, 1.0, v243
    v_mfma_f32_16x16x32_bf16 v[60:63], a[236:239], a[108:111], v[60:63]
    ds_read_b64_tr_b16 a[222:223], v233 offset:3328
    s_waitcnt lgkmcnt(4)
L_back_step154:
    v_mfma_f32_16x16x32_bf16 v[16:19], a[240:243], a[40:43], v[16:19]
    ds_read_b64_tr_b16 a[224:225], v232 offset:11264
    ds_read_b64_tr_b16 a[226:227], v232 offset:11520
    v_rcp_f32 v240, v240
    v_rcp_f32 v241, v241
    v_mfma_f32_16x16x32_bf16 v[20:23], a[240:243], a[112:115], v[20:23]
    v_rcp_f32 v242, v242
    v_mfma_f32_16x16x32_bf16 v[24:27], a[244:247], a[40:43], v[24:27]
    ds_read_b64_tr_b16 a[228:229], v233 offset:11264
    ds_read_b64_tr_b16 a[230:231], v233 offset:11520
    buffer_load_dword v2, v15, s[16:19], s38 offen sc1
    v_rcp_f32 v243, v243
    v_mul_f32 v240, v128, v240
    v_mfma_f32_16x16x32_bf16 v[28:31], a[244:247], a[112:115], v[28:31]
    s_add_u32 s61, s50, 111744
    buffer_load_dwordx4 v236, s[24:27], s61 offen offset:3072 lds
    v_mul_f32 v241, v129, v241
    v_mfma_f32_16x16x32_bf16 v[48:51], a[248:251], a[40:43], v[48:51]
    ds_read_b64_tr_b16 a[232:233], v232 offset:16384
    v_mul_f32 v242, v130, v242
    v_mfma_f32_16x16x32_bf16 v[52:55], a[248:251], a[112:115], v[52:55]
    ds_read_b64_tr_b16 a[234:235], v232 offset:16640
    v_mul_f32 v243, v131, v243
    v_mfma_f32_16x16x32_bf16 v[56:59], a[252:255], a[40:43], v[56:59]
    ds_read_b64_tr_b16 a[236:237], v233 offset:16384
    v_cvt_pk_bf16_f32 v200, v240, v241
    v_mfma_f32_16x16x32_bf16 v[60:63], a[252:255], a[112:115], v[60:63]
    ds_read_b64_tr_b16 a[238:239], v233 offset:16640
    v_cvt_pk_bf16_f32 v201, v242, v243
    s_waitcnt lgkmcnt(4)
L_back_step155:
    v_mfma_f32_16x16x32_bf16 v[16:19], a[216:219], a[44:47], v[16:19]
    ds_read_b64_tr_b16 a[240:241], v232 offset:24576
    ds_read_b64_tr_b16 a[242:243], v232 offset:24832
    v_mfma_f32_16x16x32_bf16 v[20:23], a[216:219], a[116:119], v[20:23]
    v_exp_f32 v244, v100
    v_mfma_f32_16x16x32_bf16 v[24:27], a[220:223], a[44:47], v[24:27]
    ds_read_b64_tr_b16 a[244:245], v233 offset:24576
    ds_read_b64_tr_b16 a[246:247], v233 offset:24832
    v_exp_f32 v245, v101
    v_mfma_f32_16x16x32_bf16 v[28:31], a[220:223], a[116:119], v[28:31]
    v_exp_f32 v246, v102
    v_mfma_f32_16x16x32_bf16 v[48:51], a[224:227], a[44:47], v[48:51]
    ds_read_b64_tr_b16 a[248:249], v232 offset:17408
    ds_read_b64_tr_b16 a[250:251], v232 offset:17664
    v_exp_f32 v247, v103
    v_add_f32 v244, 1.0, v244
    v_mfma_f32_16x16x32_bf16 v[52:55], a[224:227], a[116:119], v[52:55]
    s_add_u32 m0, s60, 98304
    s_add_u32 s61, s50, 151680
    buffer_load_dwordx4 v236, s[24:27], s61 offen offset:0 lds
    v_add_f32 v245, 1.0, v245
    v_add_f32 v246, 1.0, v246
    v_mfma_f32_16x16x32_bf16 v[56:59], a[228:231], a[44:47], v[56:59]
    ds_read_b64_tr_b16 a[252:253], v233 offset:17408
    v_add_f32 v247, 1.0, v247
    v_mfma_f32_16x16x32_bf16 v[60:63], a[228:231], a[116:119], v[60:63]
    ds_read_b64_tr_b16 a[254:255], v233 offset:17664
    s_waitcnt lgkmcnt(4)
L_back_step156:
    v_mfma_f32_16x16x32_bf16 v[16:19], a[232:235], a[48:51], v[16:19]
    ds_read_b64_tr_b16 a[216:217], v232 offset:25600
    ds_read_b64_tr_b16 a[218:219], v232 offset:25856
    v_rcp_f32 v244, v244
    v_mfma_f32_16x16x32_bf16 v[20:23], a[232:235], a[120:123], v[20:23]
    v_rcp_f32 v245, v245
    v_mfma_f32_16x16x32_bf16 v[24:27], a[236:239], a[48:51], v[24:27]
    ds_read_b64_tr_b16 a[220:221], v233 offset:25600
    ds_read_b64_tr_b16 a[222:223], v233 offset:25856
    v_rcp_f32 v246, v246
    v_mfma_f32_16x16x32_bf16 v[28:31], a[236:239], a[120:123], v[28:31]
    v_rcp_f32 v247, v247
    v_mul_f32 v244, v132, v244
    v_mfma_f32_16x16x32_bf16 v[48:51], a[240:243], a[48:51], v[48:51]
    ds_read_b64_tr_b16 a[224:225], v232 offset:18432
    s_add_u32 s61, s50, 187520
    buffer_load_dwordx4 v236, s[24:27], s61 offen offset:1024 lds
    v_mul_f32 v245, v133, v245
    v_mfma_f32_16x16x32_bf16 v[52:55], a[240:243], a[120:123], v[52:55]
    ds_read_b64_tr_b16 a[226:227], v232 offset:18688
    v_mul_f32 v246, v134, v246
    v_mfma_f32_16x16x32_bf16 v[56:59], a[244:247], a[48:51], v[56:59]
    ds_read_b64_tr_b16 a[228:229], v233 offset:18432
    v_mul_f32 v247, v135, v247
    v_mfma_f32_16x16x32_bf16 v[60:63], a[244:247], a[120:123], v[60:63]
    ds_read_b64_tr_b16 a[230:231], v233 offset:18688
    v_cvt_pk_bf16_f32 v204, v244, v245
    s_waitcnt lgkmcnt(4)
L_back_step157:
    v_mfma_f32_16x16x32_bf16 v[16:19], a[248:251], a[52:55], v[16:19]
    ds_read_b64_tr_b16 a[232:233], v232 offset:26624
    s_add_u32 s61, s58, 223232
    v_cvt_pk_bf16_f32 v205, v246, v247
    v_mfma_f32_16x16x32_bf16 v[20:23], a[248:251], a[124:127], v[20:23]
    ds_read_b64_tr_b16 a[234:235], v232 offset:26880
    ds_read_b64_tr_b16 a[236:237], v233 offset:26624
    v_mfma_f32_16x16x32_bf16 v[24:27], a[252:255], a[52:55], v[24:27]
    ds_read_b64_tr_b16 a[238:239], v233 offset:26880
    v_exp_f32 v240, v104
    v_exp_f32 v241, v105
    v_mfma_f32_16x16x32_bf16 v[28:31], a[252:255], a[124:127], v[28:31]
    buffer_load_dwordx4 v236, s[24:27], s61 offen offset:2048 lds
    v_exp_f32 v242, v106
    v_mfma_f32_16x16x32_bf16 v[48:51], a[216:219], a[52:55], v[48:51]
    ds_read_b64_tr_b16 a[240:241], v232 offset:19456
    ds_read_b64_tr_b16 a[242:243], v232 offset:19712
    v_exp_f32 v243, v107
    v_add_f32 v240, 1.0, v240
    v_mfma_f32_16x16x32_bf16 v[52:55], a[216:219], a[124:127], v[52:55]
    v_add_f32 v241, 1.0, v241
    v_add_f32 v242, 1.0, v242
    v_mfma_f32_16x16x32_bf16 v[56:59], a[220:223], a[52:55], v[56:59]
    ds_read_b64_tr_b16 a[244:245], v233 offset:19456
    v_add_f32 v243, 1.0, v243
    v_mfma_f32_16x16x32_bf16 v[60:63], a[220:223], a[124:127], v[60:63]
    ds_read_b64_tr_b16 a[246:247], v233 offset:19712
    s_waitcnt lgkmcnt(4)
L_back_step158:
    v_mfma_f32_16x16x32_bf16 v[16:19], a[224:227], a[56:59], v[16:19]
    ds_read_b64_tr_b16 a[248:249], v232 offset:27648
    ds_read_b64_tr_b16 a[250:251], v232 offset:27904
    v_rcp_f32 v240, v240
    v_mfma_f32_16x16x32_bf16 v[20:23], a[224:227], a[128:131], v[20:23]
    v_rcp_f32 v241, v241
    v_mfma_f32_16x16x32_bf16 v[24:27], a[228:231], a[56:59], v[24:27]
    ds_read_b64_tr_b16 a[252:253], v233 offset:27648
    ds_read_b64_tr_b16 a[254:255], v233 offset:27904
    v_rcp_f32 v242, v242
    v_mfma_f32_16x16x32_bf16 v[28:31], a[228:231], a[128:131], v[28:31]
    v_rcp_f32 v243, v243
    v_mul_f32 v240, v136, v240
    v_mfma_f32_16x16x32_bf16 v[48:51], a[232:235], a[56:59], v[48:51]
    s_barrier
    v_mul_f32 v241, v137, v241
    v_mfma_f32_16x16x32_bf16 v[52:55], a[232:235], a[128:131], v[52:55]
    ds_read_b64_tr_b16 a[216:217], v228 offset:0
    ds_read_b64_tr_b16 a[218:219], v228 offset:256
    v_mul_f32 v242, v138, v242
    v_mfma_f32_16x16x32_bf16 v[56:59], a[236:239], a[56:59], v[56:59]
    ds_read_b64_tr_b16 a[220:221], v229 offset:0
    s_add_u32 s61, s58, 259072
    buffer_load_dwordx4 v236, s[24:27], s61 offen offset:3072 lds
    v_mul_f32 v243, v139, v243
    v_mfma_f32_16x16x32_bf16 v[60:63], a[236:239], a[128:131], v[60:63]
    ds_read_b64_tr_b16 a[222:223], v229 offset:256
    v_cvt_pk_bf16_f32 v202, v240, v241
    s_waitcnt lgkmcnt(4)
L_back_step159:
    v_mfma_f32_16x16x32_bf16 v[16:19], a[240:243], a[60:63], v[16:19]
    ds_read_b64_tr_b16 a[224:225], v228 offset:8192
    s_add_u32 m0, s60, 114688
    v_cvt_pk_bf16_f32 v203, v242, v243
    v_mfma_f32_16x16x32_bf16 v[20:23], a[240:243], a[132:135], v[20:23]
    ds_read_b64_tr_b16 a[226:227], v228 offset:8448
    ds_read_b64_tr_b16 a[228:229], v229 offset:8192
    v_mfma_f32_16x16x32_bf16 v[24:27], a[244:247], a[60:63], v[24:27]
    ds_read_b64_tr_b16 a[230:231], v229 offset:8448
    s_add_u32 s61, s59, 4096
    v_exp_f32 v244, v108
    v_mfma_f32_16x16x32_bf16 v[28:31], a[244:247], a[132:135], v[28:31]
    s_waitcnt vmcnt(5)
    v_readfirstlane_b32 s40, v2
    s_nop 0
    s_cmp_ge_u32 s40, 2
    s_cbranch_scc0 L_slow_6017
L_back_6018:
    s_add_u32 s43, s53, 8192
    buffer_load_dwordx4 a[176:179], v238, s[16:19], s43 offen offset:0 sc1
    buffer_load_dwordx4 v236, s[24:27], s61 offen offset:0 lds
    v_exp_f32 v245, v109
    v_mfma_f32_16x16x32_bf16 v[48:51], a[248:251], a[60:63], v[48:51]
    ds_read_b64_tr_b16 a[232:233], v228 offset:1024
    ds_read_b64_tr_b16 a[234:235], v228 offset:1280
    v_exp_f32 v246, v110
    v_mfma_f32_16x16x32_bf16 v[52:55], a[248:251], a[132:135], v[52:55]
    v_exp_f32 v247, v111
    v_add_f32 v244, 1.0, v244
    v_mfma_f32_16x16x32_bf16 v[56:59], a[252:255], a[60:63], v[56:59]
    ds_read_b64_tr_b16 a[236:237], v229 offset:1024
    v_add_f32 v245, 1.0, v245
    v_add_f32 v246, 1.0, v246
    v_mfma_f32_16x16x32_bf16 v[60:63], a[252:255], a[132:135], v[60:63]
    ds_read_b64_tr_b16 a[238:239], v229 offset:1280
    v_add_f32 v247, 1.0, v247
    s_waitcnt lgkmcnt(4)
L_back_step160:
    v_mfma_f32_16x16x32_bf16 v[16:19], a[216:219], a[64:67], v[16:19]
    ds_read_b64_tr_b16 a[240:241], v228 offset:9216
    ds_read_b64_tr_b16 a[242:243], v228 offset:9472
    v_mfma_f32_16x16x32_bf16 v[20:23], a[216:219], a[136:139], v[20:23]
    buffer_load_dwordx4 a[180:183], v238, s[16:19], s43 offen offset:1024 sc1
    v_rcp_f32 v244, v244
    v_mfma_f32_16x16x32_bf16 v[24:27], a[220:223], a[64:67], v[24:27]
    ds_read_b64_tr_b16 a[244:245], v229 offset:9216
    ds_read_b64_tr_b16 a[246:247], v229 offset:9472
    v_rcp_f32 v245, v245
    v_mfma_f32_16x16x32_bf16 v[28:31], a[220:223], a[136:139], v[28:31]
    v_rcp_f32 v246, v246
    v_mfma_f32_16x16x32_bf16 v[48:51], a[224:227], a[64:67], v[48:51]
    ds_read_b64_tr_b16 a[248:249], v216 offset:2048
    ds_read_b64_tr_b16 a[250:251], v216 offset:2560
    v_rcp_f32 v247, v247
    v_mul_f32 v244, v140, v244
    v_mfma_f32_16x16x32_bf16 v[52:55], a[224:227], a[136:139], v[52:55]
    buffer_load_dwordx4 a[184:187], v238, s[16:19], s43 offen offset:2048 sc1
    v_mul_f32 v245, v141, v245
    v_mfma_f32_16x16x32_bf16 v[56:59], a[228:231], a[64:67], v[56:59]
    ds_read_b64_tr_b16 a[252:253], v217 offset:2048
    s_add_u32 s61, s58, 224384
    buffer_load_dwordx4 v236, s[24:27], s61 offen offset:1024 lds
    v_mul_f32 v246, v142, v246
    v_mfma_f32_16x16x32_bf16 v[60:63], a[228:231], a[136:139], v[60:63]
    ds_read_b64_tr_b16 a[254:255], v217 offset:2560
    v_mul_f32 v247, v143, v247
    s_waitcnt lgkmcnt(4)
L_back_step161:
    v_mfma_f32_16x16x32_bf16 v[16:19], a[232:235], a[68:71], v[16:19]
    ds_read_b64_tr_b16 a[216:217], v218 offset:2048
    s_add_u32 s61, s58, 260224
    v_cvt_pk_bf16_f32 v206, v244, v245
    v_mfma_f32_16x16x32_bf16 v[20:23], a[232:235], a[140:143], v[20:23]
    ds_read_b64_tr_b16 a[218:219], v218 offset:2560
    ds_read_b64_tr_b16 a[220:221], v219 offset:2048
    v_cvt_pk_bf16_f32 v207, v246, v247
    v_mfma_f32_16x16x32_bf16 v[24:27], a[236:239], a[68:71], v[24:27]
    ds_read_b64_tr_b16 a[222:223], v219 offset:2560
    s_add_u32 s39, s52, 12288
    v_mfma_f32_16x16x32_bf16 v[28:31], a[236:239], a[140:143], v[28:31]
    buffer_load_dwordx4 a[188:191], v238, s[16:19], s43 offen offset:3072 sc1
    buffer_load_dwordx4 v236, s[24:27], s61 offen offset:2048 lds
    v_mfma_f32_16x16x32_bf16 v[48:51], a[240:243], a[68:71], v[48:51]
    ds_read_b64_tr_b16 a[224:225], v216 offset:3072
    ds_read_b64_tr_b16 a[226:227], v216 offset:3584
    buffer_store_dwordx4 v[192:195], v238, s[16:19], s39 offen offset:0 sc1
    v_mfma_f32_16x16x32_bf16 v[52:55], a[240:243], a[140:143], v[52:55]
    buffer_store_dwordx4 v[196:199], v238, s[16:19], s39 offen offset:1024 sc1
    v_mfma_f32_16x16x32_bf16 v[56:59], a[244:247], a[68:71], v[56:59]
    ds_read_b64_tr_b16 a[228:229], v217 offset:3072
    ds_read_b64_tr_b16 a[230:231], v217 offset:3584
    buffer_store_dwordx4 v[200:203], v238, s[16:19], s39 offen offset:2048 sc1
    buffer_store_dwordx4 v[204:207], v238, s[16:19], s39 offen offset:3072 sc1
    v_mfma_f32_16x16x32_bf16 v[60:63], a[244:247], a[140:143], v[60:63]
    ds_read_b64_tr_b16 a[232:233], v218 offset:3072
    s_waitcnt lgkmcnt(5)
L_back_step162:
    v_mfma_f32_16x16x32_bf16 a[0:3], a[248:251], v[144:147], 0
    s_add_u32 s61, s59, 1152
    ds_read_b64_tr_b16 a[234:235], v218 offset:3584
    v_mfma_f32_16x16x32_bf16 a[4:7], a[248:251], v[148:151], 0
    buffer_load_dwordx4 v236, s[24:27], s61 offen offset:3072 lds
    v_mfma_f32_16x16x32_bf16 a[8:11], a[252:255], v[144:147], 0
    ds_read_b64_tr_b16 a[236:237], v219 offset:3072
    ds_read_b64_tr_b16 a[238:239], v219 offset:3584
    v_mfma_f32_16x16x32_bf16 a[12:15], a[252:255], v[148:151], 0
    ds_read_b64_tr_b16 a[240:241], v216 offset:16384
    v_mfma_f32_16x16x32_bf16 a[16:19], a[216:219], v[144:147], 0
    v_exp_f32 v240, v16
    v_mfma_f32_16x16x32_bf16 a[20:23], a[216:219], v[148:151], 0
    ds_read_b64_tr_b16 a[242:243], v216 offset:16896
    ds_read_b64_tr_b16 a[244:245], v217 offset:16384
    v_mfma_f32_16x16x32_bf16 a[24:27], a[220:223], v[144:147], 0
    v_exp_f32 v241, v17
    v_mfma_f32_16x16x32_bf16 a[28:31], a[220:223], v[148:151], 0
    ds_read_b64_tr_b16 a[246:247], v217 offset:16896
    v_exp_f32 v242, v18
    s_waitcnt lgkmcnt(4)
L_back_step163:
    v_mfma_f32_16x16x32_bf16 a[0:3], a[224:227], v[152:155], a[0:3]
    ds_read_b64_tr_b16 a[248:249], v218 offset:16384
    ds_read_b64_tr_b16 a[250:251], v218 offset:16896
    v_exp_f32 v243, v19
    v_add_f32 v240, 1.0, v240
    v_mfma_f32_16x16x32_bf16 a[4:7], a[224:227], v[156:159], a[4:7]
    s_add_u32 m0, s60, 131072
    s_add_u32 s61, s50, 225280
    v_add_f32 v241, 1.0, v241
    v_mfma_f32_16x16x32_bf16 a[8:11], a[228:231], v[152:155], a[8:11]
    ds_read_b64_tr_b16 a[252:253], v219 offset:16384
    ds_read_b64_tr_b16 a[254:255], v219 offset:16896
    v_add_f32 v242, 1.0, v242
    v_mfma_f32_16x16x32_bf16 a[12:15], a[228:231], v[156:159], a[12:15]
    buffer_load_dwordx4 v236, s[24:27], s61 offen offset:0 lds
    v_add_f32 v243, 1.0, v243
    v_mfma_f32_16x16x32_bf16 a[16:19], a[232:235], v[152:155], a[16:19]
    ds_read_b64_tr_b16 a[216:217], v216 offset:17408
    ds_read_b64_tr_b16 a[218:219], v216 offset:17920
    v_mfma_f32_16x16x32_bf16 a[20:23], a[232:235], v[156:159], a[20:23]
    v_rcp_f32 v240, v240
    v_mfma_f32_16x16x32_bf16 a[24:27], a[236:239], v[152:155], a[24:27]
    ds_read_b64_tr_b16 a[220:221], v217 offset:17408
    ds_read_b64_tr_b16 a[222:223], v217 offset:17920
    v_rcp_f32 v241, v241
    v_mfma_f32_16x16x32_bf16 a[28:31], a[236:239], v[156:159], a[28:31]
    ds_read_b64_tr_b16 a[224:225], v218 offset:17408
    v_rcp_f32 v242, v242
    s_waitcnt lgkmcnt(5)
L_back_step164:
    v_mfma_f32_16x16x32_bf16 a[0:3], a[240:243], v[160:163], a[0:3]
    v_rcp_f32 v243, v243
    v_mul_f32 v240, v48, v240
    v_mfma_f32_16x16x32_bf16 a[4:7], a[240:243], v[164:167], a[4:7]
    ds_read_b64_tr_b16 a[226:227], v218 offset:17920
    s_add_u32 s61, s50, 261120
    v_mul_f32 v241, v49, v241
    v_mfma_f32_16x16x32_bf16 a[8:11], a[244:247], v[160:163], a[8:11]
    ds_read_b64_tr_b16 a[228:229], v219 offset:17408
    ds_read_b64_tr_b16 a[230:231], v219 offset:17920
    v_mul_f32 v242, v50, v242
    v_mfma_f32_16x16x32_bf16 a[12:15], a[244:247], v[164:167], a[12:15]
    buffer_load_dwordx4 v236, s[24:27], s61 offen offset:1024 lds
    v_mul_f32 v243, v51, v243
    v_mfma_f32_16x16x32_bf16 a[16:19], a[248:251], v[160:163], a[16:19]
    ds_read_b64_tr_b16 a[232:233], v216 offset:18432
    v_cvt_pk_bf16_f32 v208, v240, v241
    v_mfma_f32_16x16x32_bf16 a[20:23], a[248:251], v[164:167], a[20:23]
    ds_read_b64_tr_b16 a[234:235], v216 offset:18944
    v_cvt_pk_bf16_f32 v209, v242, v243
    v_mfma_f32_16x16x32_bf16 a[24:27], a[252:255], v[160:163], a[24:27]
    ds_read_b64_tr_b16 a[236:237], v217 offset:18432
    ds_read_b64_tr_b16 a[238:239], v217 offset:18944
    v_mfma_f32_16x16x32_bf16 a[28:31], a[252:255], v[164:167], a[28:31]
    ds_read_b64_tr_b16 a[240:241], v218 offset:18432
    v_exp_f32 v244, v20
    s_waitcnt lgkmcnt(5)
L_back_step165:
    v_mfma_f32_16x16x32_bf16 a[0:3], a[216:219], v[168:171], a[0:3]
    v_exp_f32 v245, v21
    v_mfma_f32_16x16x32_bf16 a[4:7], a[216:219], v[172:175], a[4:7]
    ds_read_b64_tr_b16 a[242:243], v218 offset:18944
    ds_read_b64_tr_b16 a[244:245], v219 offset:18432
    v_exp_f32 v246, v22
    v_mfma_f32_16x16x32_bf16 a[8:11], a[220:223], v[168:171], a[8:11]
    ds_read_b64_tr_b16 a[246:247], v219 offset:18944
    s_add_u32 s61, s51, 2048
    v_exp_f32 v247, v23
    v_add_f32 v244, 1.0, v244
    v_mfma_f32_16x16x32_bf16 a[12:15], a[220:223], v[172:175], a[12:15]
    buffer_load_dwordx4 v236, s[24:27], s61 offen offset:2048 lds
    v_add_f32 v245, 1.0, v245
    v_mfma_f32_16x16x32_bf16 a[16:19], a[224:227], v[168:171], a[16:19]
    ds_read_b64_tr_b16 a[248:249], v216 offset:19456
    v_add_f32 v246, 1.0, v246
    v_mfma_f32_16x16x32_bf16 a[20:23], a[224:227], v[172:175], a[20:23]
    ds_read_b64_tr_b16 a[250:251], v216 offset:19968
    v_add_f32 v247, 1.0, v247
    v_mfma_f32_16x16x32_bf16 a[24:27], a[228:231], v[168:171], a[24:27]
    ds_read_b64_tr_b16 a[252:253], v217 offset:19456
    ds_read_b64_tr_b16 a[254:255], v217 offset:19968
    v_mfma_f32_16x16x32_bf16 a[28:31], a[228:231], v[172:175], a[28:31]
    ds_read_b64_tr_b16 a[216:217], v218 offset:19456
    v_rcp_f32 v244, v244
    s_waitcnt lgkmcnt(5)
L_back_step166:
    v_mfma_f32_16x16x32_bf16 a[0:3], a[232:235], v[176:179], a[0:3]
    v_rcp_f32 v245, v245
    v_mfma_f32_16x16x32_bf16 a[4:7], a[232:235], v[180:183], a[4:7]
    ds_read_b64_tr_b16 a[218:219], v218 offset:19968
    ds_read_b64_tr_b16 a[220:221], v219 offset:19456
    v_rcp_f32 v246, v246
    v_mfma_f32_16x16x32_bf16 a[8:11], a[236:239], v[176:179], a[8:11]
    ds_read_b64_tr_b16 a[222:223], v219 offset:19968
    s_add_u32 s61, s50, 222336
    v_rcp_f32 v247, v247
    v_mul_f32 v244, v52, v244
    v_mfma_f32_16x16x32_bf16 a[12:15], a[236:239], v[180:183], a[12:15]
    buffer_load_dwordx4 v236, s[24:27], s61 offen offset:3072 lds
    v_mul_f32 v245, v53, v245
    v_mfma_f32_16x16x32_bf16 a[16:19], a[240:243], v[176:179], a[16:19]
    s_barrier
    v_mul_f32 v246, v54, v246
    v_mfma_f32_16x16x32_bf16 a[20:23], a[240:243], v[180:183], a[20:23]
    ds_read_b64_tr_b16 a[224:225], v216 offset:32768
    ds_read_b64_tr_b16 a[226:227], v216 offset:33280
    v_mul_f32 v247, v55, v247
    v_mfma_f32_16x16x32_bf16 a[24:27], a[244:247], v[176:179], a[24:27]
    ds_read_b64_tr_b16 a[228:229], v217 offset:32768
    v_cvt_pk_bf16_f32 v212, v244, v245
    v_mfma_f32_16x16x32_bf16 a[28:31], a[244:247], v[180:183], a[28:31]
    ds_read_b64_tr_b16 a[230:231], v217 offset:33280
    v_cvt_pk_bf16_f32 v213, v246, v247
    s_waitcnt lgkmcnt(4)
L_back_step167:
    v_mfma_f32_16x16x32_bf16 a[0:3], a[248:251], v[184:187], a[0:3]
    ds_read_b64_tr_b16 a[232:233], v218 offset:32768
    ds_read_b64_tr_b16 a[234:235], v218 offset:33280
    v_mfma_f32_16x16x32_bf16 a[4:7], a[248:251], v[188:191], a[4:7]
    v_exp_f32 v240, v24
    v_mfma_f32_16x16x32_bf16 a[8:11], a[252:255], v[184:187], a[8:11]
    ds_read_b64_tr_b16 a[236:237], v219 offset:32768
    ds_read_b64_tr_b16 a[238:239], v219 offset:33280
    v_exp_f32 v241, v25
    v_mfma_f32_16x16x32_bf16 a[12:15], a[252:255], v[188:191], a[12:15]
    v_exp_f32 v242, v26
    v_mfma_f32_16x16x32_bf16 a[16:19], a[216:219], v[184:187], a[16:19]
    ds_read_b64_tr_b16 a[240:241], v216 offset:33792
    ds_read_b64_tr_b16 a[242:243], v216 offset:34304
    v_exp_f32 v243, v27
    v_add_f32 v240, 1.0, v240
    v_mfma_f32_16x16x32_bf16 a[20:23], a[216:219], v[188:191], a[20:23]
    s_add_u32 m0, s60, 147456
    s_add_u32 s61, s50, 262272
    buffer_load_dwordx4 v236, s[24:27], s61 offen offset:0 lds
    v_add_f32 v241, 1.0, v241
    v_mfma_f32_16x16x32_bf16 a[24:27], a[220:223], v[184:187], a[24:27]
    ds_read_b64_tr_b16 a[244:245], v217 offset:33792
    v_add_f32 v242, 1.0, v242
    v_mfma_f32_16x16x32_bf16 a[28:31], a[220:223], v[188:191], a[28:31]
    ds_read_b64_tr_b16 a[246:247], v217 offset:34304
    v_add_f32 v243, 1.0, v243
    s_waitcnt lgkmcnt(4)
L_back_step168:
    v_mfma_f32_16x16x32_bf16 a[0:3], a[224:227], a[144:147], a[0:3]
    ds_read_b64_tr_b16 a[248:249], v218 offset:33792
    ds_read_b64_tr_b16 a[250:251], v218 offset:34304
    v_mfma_f32_16x16x32_bf16 a[4:7], a[224:227], a[148:151], a[4:7]
    v_rcp_f32 v240, v240
    v_mfma_f32_16x16x32_bf16 a[8:11], a[228:231], a[144:147], a[8:11]
    ds_read_b64_tr_b16 a[252:253], v219 offset:33792
    ds_read_b64_tr_b16 a[254:255], v219 offset:34304
    v_rcp_f32 v241, v241
    v_mfma_f32_16x16x32_bf16 a[12:15], a[228:231], a[148:151], a[12:15]
    v_rcp_f32 v242, v242
    v_mfma_f32_16x16x32_bf16 a[16:19], a[232:235], a[144:147], a[16:19]
    ds_read_b64_tr_b16 a[216:217], v216 offset:34816
    ds_read_b64_tr_b16 a[218:219], v216 offset:35328
    v_rcp_f32 v243, v243
    v_mul_f32 v240, v56, v240
    v_mfma_f32_16x16x32_bf16 a[20:23], a[232:235], a[148:151], a[20:23]
    s_add_u32 s61, s51, 3200
    buffer_load_dwordx4 v236, s[24:27], s61 offen offset:1024 lds
    v_mul_f32 v241, v57, v241
    v_mfma_f32_16x16x32_bf16 a[24:27], a[236:239], a[144:147], a[24:27]
    ds_read_b64_tr_b16 a[220:221], v217 offset:34816
    v_mul_f32 v242, v58, v242
    v_mfma_f32_16x16x32_bf16 a[28:31], a[236:239], a[148:151], a[28:31]
    ds_read_b64_tr_b16 a[222:223], v217 offset:35328
    v_mul_f32 v243, v59, v243
    s_waitcnt lgkmcnt(4)
L_back_step169:
    v_mfma_f32_16x16x32_bf16 a[0:3], a[240:243], a[152:155], a[0:3]
    ds_read_b64_tr_b16 a[224:225], v218 offset:34816
    s_add_u32 s61, s58, 2304
    v_cvt_pk_bf16_f32 v210, v240, v241
    v_mfma_f32_16x16x32_bf16 a[4:7], a[240:243], a[156:159], a[4:7]
    ds_read_b64_tr_b16 a[226:227], v218 offset:35328
    ds_read_b64_tr_b16 a[228:229], v219 offset:34816
    v_cvt_pk_bf16_f32 v211, v242, v243
    v_mfma_f32_16x16x32_bf16 a[8:11], a[244:247], a[152:155], a[8:11]
    ds_read_b64_tr_b16 a[230:231], v219 offset:35328
    v_mfma_f32_16x16x32_bf16 a[12:15], a[244:247], a[156:159], a[12:15]
    buffer_load_dwordx4 v236, s[24:27], s61 offen offset:2048 lds
    v_exp_f32 v244, v28
    v_mfma_f32_16x16x32_bf16 a[16:19], a[248:251], a[152:155], a[16:19]
    ds_read_b64_tr_b16 a[232:233], v216 offset:35840
    ds_read_b64_tr_b16 a[234:235], v216 offset:36352
    v_exp_f32 v245, v29
    v_mfma_f32_16x16x32_bf16 a[20:23], a[248:251], a[156:159], a[20:23]
    v_exp_f32 v246, v30
    v_mfma_f32_16x16x32_bf16 a[24:27], a[252:255], a[152:155], a[24:27]
    s_waitcnt vmcnt(8)
    v_mov_b32 v3, 3
    s_mov_b64 exec, 1
    buffer_store_dword v3, v15, s[16:19], s7 offen sc1
    s_mov_b64 exec, -1
    v_exp_f32 v247, v31
    v_add_f32 v244, 1.0, v244
    v_mfma_f32_16x16x32_bf16 a[28:31], a[252:255], a[156:159], a[28:31]
    ds_read_b64_tr_b16 a[236:237], v217 offset:35840
    v_add_f32 v245, 1.0, v245
    s_waitcnt lgkmcnt(3)
L_back_step170:
    v_mfma_f32_16x16x32_bf16 a[0:3], a[216:219], a[160:163], a[0:3]
    ds_read_b64_tr_b16 a[238:239], v217 offset:36352
    ds_read_b64_tr_b16 a[240:241], v218 offset:35840
    v_add_f32 v246, 1.0, v246
    v_mfma_f32_16x16x32_bf16 a[4:7], a[216:219], a[164:167], a[4:7]
    ds_read_b64_tr_b16 a[242:243], v218 offset:36352
    s_add_u32 s61, s58, 38144
    v_add_f32 v247, 1.0, v247
    v_mfma_f32_16x16x32_bf16 a[8:11], a[220:223], a[160:163], a[8:11]
    ds_read_b64_tr_b16 a[244:245], v219 offset:35840
    ds_read_b64_tr_b16 a[246:247], v219 offset:36352
    v_mfma_f32_16x16x32_bf16 a[12:15], a[220:223], a[164:167], a[12:15]
    buffer_load_dwordx4 v236, s[24:27], s61 offen offset:3072 lds
    v_rcp_f32 v244, v244
    v_mfma_f32_16x16x32_bf16 a[16:19], a[224:227], a[160:163], a[16:19]
    ds_read_b64_tr_b16 a[248:249], v216 offset:49152
    ds_read_b64_tr_b16 a[250:251], v216 offset:49664
    v_rcp_f32 v245, v245
    v_mfma_f32_16x16x32_bf16 a[20:23], a[224:227], a[164:167], a[20:23]
    v_rcp_f32 v246, v246
    v_mfma_f32_16x16x32_bf16 a[24:27], a[228:231], a[160:163], a[24:27]
    ds_read_b64_tr_b16 a[252:253], v217 offset:49152
    ds_read_b64_tr_b16 a[254:255], v217 offset:49664
    v_rcp_f32 v247, v247
    v_mul_f32 v244, v60, v244
    v_mul_f32 v245, v61, v245
    v_mfma_f32_16x16x32_bf16 a[28:31], a[228:231], a[164:167], a[28:31]
    v_mul_f32 v246, v62, v246
    s_waitcnt lgkmcnt(4)
L_back_step171:
    v_mfma_f32_16x16x32_bf16 a[0:3], a[232:235], a[168:171], a[0:3]
    ds_read_b64_tr_b16 a[216:217], v218 offset:49152
    s_add_u32 m0, s60, 0
    v_mfma_f32_16x16x32_bf16 a[4:7], a[232:235], a[172:175], a[4:7]
    ds_read_b64_tr_b16 a[218:219], v218 offset:49664
    s_add_u32 s61, s58, 78080
    v_mul_f32 v247, v63, v247
    v_mfma_f32_16x16x32_bf16 a[8:11], a[236:239], a[168:171], a[8:11]
    ds_read_b64_tr_b16 a[220:221], v219 offset:49152
    ds_read_b64_tr_b16 a[222:223], v219 offset:49664
    v_cvt_pk_bf16_f32 v214, v244, v245
    v_mfma_f32_16x16x32_bf16 a[12:15], a[236:239], a[172:175], a[12:15]
    buffer_load_dwordx4 v236, s[24:27], s61 offen offset:0 lds
    v_cvt_pk_bf16_f32 v215, v246, v247
    v_mfma_f32_16x16x32_bf16 a[16:19], a[240:243], a[168:171], a[16:19]
    ds_read_b64_tr_b16 a[224:225], v216 offset:50176
    s_add_u32 s39, s52, 16384
    v_mfma_f32_16x16x32_bf16 a[20:23], a[240:243], a[172:175], a[20:23]
    ds_read_b64_tr_b16 a[226:227], v216 offset:50688
    ds_read_b64_tr_b16 a[228:229], v217 offset:50176
    v_mfma_f32_16x16x32_bf16 a[24:27], a[244:247], a[168:171], a[24:27]
    buffer_store_dwordx4 v[208:211], v238, s[16:19], s39 offen offset:0 sc1
    buffer_store_dwordx4 v[212:215], v238, s[16:19], s39 offen offset:1024 sc1
    v_mfma_f32_16x16x32_bf16 a[28:31], a[244:247], a[172:175], a[28:31]
    ds_read_b64_tr_b16 a[230:231], v217 offset:50688
    s_waitcnt lgkmcnt(4)
L_back_step172:
    v_mfma_f32_16x16x32_bf16 a[0:3], a[248:251], a[176:179], a[0:3]
    ds_read_b64_tr_b16 a[232:233], v218 offset:50176
    s_add_u32 s61, s58, 113920
    v_mfma_f32_16x16x32_bf16 a[4:7], a[248:251], a[180:183], a[4:7]
    ds_read_b64_tr_b16 a[234:235], v218 offset:50688
    ds_read_b64_tr_b16 a[236:237], v219 offset:50176
    v_mfma_f32_16x16x32_bf16 a[8:11], a[252:255], a[176:179], a[8:11]
    ds_read_b64_tr_b16 a[238:239], v219 offset:50688
    v_mfma_f32_16x16x32_bf16 a[12:15], a[252:255], a[180:183], a[12:15]
    buffer_load_dwordx4 v236, s[24:27], s61 offen offset:1024 lds
    v_mfma_f32_16x16x32_bf16 a[16:19], a[216:219], a[176:179], a[16:19]
    ds_read_b64_tr_b16 a[240:241], v216 offset:51200
    ds_read_b64_tr_b16 a[242:243], v216 offset:51712
    v_mfma_f32_16x16x32_bf16 a[20:23], a[216:219], a[180:183], a[20:23]
    ds_read_b64_tr_b16 a[244:245], v217 offset:51200
    v_mfma_f32_16x16x32_bf16 a[24:27], a[220:223], a[176:179], a[24:27]
    ds_read_b64_tr_b16 a[246:247], v217 offset:51712
    v_mfma_f32_16x16x32_bf16 a[28:31], a[220:223], a[180:183], a[28:31]
    ds_read_b64_tr_b16 a[248:249], v218 offset:51200
    s_waitcnt lgkmcnt(5)
L_back_step173:
    v_mfma_f32_16x16x32_bf16 a[0:3], a[224:227], a[184:187], a[0:3]
    s_add_u32 s61, s58, 149760
    ds_read_b64_tr_b16 a[250:251], v218 offset:51712
    v_mfma_f32_16x16x32_bf16 a[4:7], a[224:227], a[188:191], a[4:7]
    buffer_load_dwordx4 v236, s[24:27], s61 offen offset:2048 lds
    v_mfma_f32_16x16x32_bf16 a[8:11], a[228:231], a[184:187], a[8:11]
    ds_read_b64_tr_b16 a[252:253], v219 offset:51200
    ds_read_b64_tr_b16 a[254:255], v219 offset:51712
    v_mfma_f32_16x16x32_bf16 a[12:15], a[228:231], a[188:191], a[12:15]
    ds_read_b64_tr_b16 a[216:217], v216 offset:52224
    v_mfma_f32_16x16x32_bf16 a[16:19], a[232:235], a[184:187], a[16:19]
    ds_read_b64_tr_b16 a[218:219], v216 offset:52736
    v_mfma_f32_16x16x32_bf16 a[20:23], a[232:235], a[188:191], a[20:23]
    ds_read_b64_tr_b16 a[220:221], v217 offset:52224
    v_mfma_f32_16x16x32_bf16 a[24:27], a[236:239], a[184:187], a[24:27]
    ds_read_b64_tr_b16 a[222:223], v217 offset:52736
    v_mfma_f32_16x16x32_bf16 a[28:31], a[236:239], a[188:191], a[28:31]
    ds_read_b64_tr_b16 a[224:225], v218 offset:52224
    s_waitcnt lgkmcnt(5)
L_back_step174:
    v_mfma_f32_16x16x32_bf16 a[32:35], a[240:243], v[144:147], 0
    s_add_u32 s61, s58, 185600
    ds_read_b64_tr_b16 a[226:227], v218 offset:52736
    v_mfma_f32_16x16x32_bf16 a[36:39], a[240:243], v[148:151], 0
    buffer_load_dwordx4 v236, s[24:27], s61 offen offset:3072 lds
    v_mfma_f32_16x16x32_bf16 a[40:43], a[244:247], v[144:147], 0
    ds_read_b64_tr_b16 a[228:229], v219 offset:52224
    ds_read_b64_tr_b16 a[230:231], v219 offset:52736
    v_mfma_f32_16x16x32_bf16 a[44:47], a[244:247], v[148:151], 0
    v_mfma_f32_16x16x32_bf16 a[48:51], a[248:251], v[144:147], 0
    s_barrier
    v_mfma_f32_16x16x32_bf16 a[52:55], a[248:251], v[148:151], 0
    ds_read_b64_tr_b16 a[232:233], v220 offset:0
    ds_read_b64_tr_b16 a[234:235], v220 offset:512
    v_mfma_f32_16x16x32_bf16 a[56:59], a[252:255], v[144:147], 0
    ds_read_b64_tr_b16 a[236:237], v221 offset:0
    ds_read_b64_tr_b16 a[238:239], v221 offset:512
    v_mfma_f32_16x16x32_bf16 a[60:63], a[252:255], v[148:151], 0
    ds_read_b64_tr_b16 a[240:241], v222 offset:0
    s_waitcnt lgkmcnt(5)
L_back_step175:
    v_mfma_f32_16x16x32_bf16 a[32:35], a[216:219], v[152:155], a[32:35]
    s_add_u32 m0, s60, 16384
    s_add_u32 s61, s58, 225536
    v_mfma_f32_16x16x32_bf16 a[36:39], a[216:219], v[156:159], a[36:39]
    ds_read_b64_tr_b16 a[242:243], v222 offset:512
    ds_read_b64_tr_b16 a[244:245], v223 offset:0
    v_mfma_f32_16x16x32_bf16 a[40:43], a[220:223], v[152:155], a[40:43]
    ds_read_b64_tr_b16 a[246:247], v223 offset:512
    v_mfma_f32_16x16x32_bf16 a[44:47], a[220:223], v[156:159], a[44:47]
    buffer_load_dwordx4 v236, s[24:27], s61 offen offset:0 lds
    v_mfma_f32_16x16x32_bf16 a[48:51], a[224:227], v[152:155], a[48:51]
    ds_read_b64_tr_b16 a[248:249], v220 offset:1024
    ds_read_b64_tr_b16 a[250:251], v220 offset:1536
    v_mfma_f32_16x16x32_bf16 a[52:55], a[224:227], v[156:159], a[52:55]
    ds_read_b64_tr_b16 a[252:253], v221 offset:1024
    v_mfma_f32_16x16x32_bf16 a[56:59], a[228:231], v[152:155], a[56:59]
    ds_read_b64_tr_b16 a[254:255], v221 offset:1536
    v_mfma_f32_16x16x32_bf16 a[60:63], a[228:231], v[156:159], a[60:63]
    ds_read_b64_tr_b16 a[216:217], v222 offset:1024
    s_waitcnt lgkmcnt(5)
L_back_step176:
    v_mfma_f32_16x16x32_bf16 a[32:35], a[232:235], v[160:163], a[32:35]
    s_add_u32 s61, s58, 261376
    ds_read_b64_tr_b16 a[218:219], v222 offset:1536
    v_mfma_f32_16x16x32_bf16 a[36:39], a[232:235], v[164:167], a[36:39]
    buffer_load_dwordx4 v236, s[24:27], s61 offen offset:1024 lds
    v_mfma_f32_16x16x32_bf16 a[40:43], a[236:239], v[160:163], a[40:43]
    ds_read_b64_tr_b16 a[220:221], v223 offset:1024
    ds_read_b64_tr_b16 a[222:223], v223 offset:1536
    buffer_load_dword v2, v15, s[16:19], s38 offen sc1
    v_mfma_f32_16x16x32_bf16 a[44:47], a[236:239], v[164:167], a[44:47]
    ds_read_b64_tr_b16 a[224:225], v220 offset:2048
    v_mfma_f32_16x16x32_bf16 a[48:51], a[240:243], v[160:163], a[48:51]
    ds_read_b64_tr_b16 a[226:227], v220 offset:2560
    v_mfma_f32_16x16x32_bf16 a[52:55], a[240:243], v[164:167], a[52:55]
    ds_read_b64_tr_b16 a[228:229], v221 offset:2048
    v_mfma_f32_16x16x32_bf16 a[56:59], a[244:247], v[160:163], a[56:59]
    ds_read_b64_tr_b16 a[230:231], v221 offset:2560
    v_mfma_f32_16x16x32_bf16 a[60:63], a[244:247], v[164:167], a[60:63]
    ds_read_b64_tr_b16 a[232:233], v222 offset:2048
    s_waitcnt lgkmcnt(5)
L_back_step177:
    v_mfma_f32_16x16x32_bf16 a[32:35], a[248:251], v[168:171], a[32:35]
    s_add_u32 s61, s59, 2304
    ds_read_b64_tr_b16 a[234:235], v222 offset:2560
    v_mfma_f32_16x16x32_bf16 a[36:39], a[248:251], v[172:175], a[36:39]
    buffer_load_dwordx4 v236, s[24:27], s61 offen offset:2048 lds
    v_mfma_f32_16x16x32_bf16 a[40:43], a[252:255], v[168:171], a[40:43]
    ds_read_b64_tr_b16 a[236:237], v223 offset:2048
    ds_read_b64_tr_b16 a[238:239], v223 offset:2560
    v_mfma_f32_16x16x32_bf16 a[44:47], a[252:255], v[172:175], a[44:47]
    ds_read_b64_tr_b16 a[240:241], v220 offset:3072
    v_mfma_f32_16x16x32_bf16 a[48:51], a[216:219], v[168:171], a[48:51]
    ds_read_b64_tr_b16 a[242:243], v220 offset:3584
    v_mfma_f32_16x16x32_bf16 a[52:55], a[216:219], v[172:175], a[52:55]
    ds_read_b64_tr_b16 a[244:245], v221 offset:3072
    v_mfma_f32_16x16x32_bf16 a[56:59], a[220:223], v[168:171], a[56:59]
    ds_read_b64_tr_b16 a[246:247], v221 offset:3584
    v_mfma_f32_16x16x32_bf16 a[60:63], a[220:223], v[172:175], a[60:63]
    ds_read_b64_tr_b16 a[248:249], v222 offset:3072
    s_waitcnt lgkmcnt(5)
L_back_step178:
    v_mfma_f32_16x16x32_bf16 a[32:35], a[224:227], v[176:179], a[32:35]
    s_add_u32 s61, s50, 1280
    ds_read_b64_tr_b16 a[250:251], v222 offset:3584
    v_mfma_f32_16x16x32_bf16 a[36:39], a[224:227], v[180:183], a[36:39]
    buffer_load_dwordx4 v236, s[24:27], s61 offen offset:3072 lds
    v_mfma_f32_16x16x32_bf16 a[40:43], a[228:231], v[176:179], a[40:43]
    ds_read_b64_tr_b16 a[252:253], v223 offset:3072
    ds_read_b64_tr_b16 a[254:255], v223 offset:3584
    v_mfma_f32_16x16x32_bf16 a[44:47], a[228:231], v[180:183], a[44:47]
    ds_read_b64_tr_b16 a[216:217], v220 offset:16384
    v_mfma_f32_16x16x32_bf16 a[48:51], a[232:235], v[176:179], a[48:51]
    ds_read_b64_tr_b16 a[218:219], v220 offset:16896
    v_mfma_f32_16x16x32_bf16 a[52:55], a[232:235], v[180:183], a[52:55]
    ds_read_b64_tr_b16 a[220:221], v221 offset:16384
    v_mfma_f32_16x16x32_bf16 a[56:59], a[236:239], v[176:179], a[56:59]
    ds_read_b64_tr_b16 a[222:223], v221 offset:16896
    v_mfma_f32_16x16x32_bf16 a[60:63], a[236:239], v[180:183], a[60:63]
    ds_read_b64_tr_b16 a[224:225], v222 offset:16384
    s_waitcnt lgkmcnt(5)
L_back_step179:
    v_mfma_f32_16x16x32_bf16 a[32:35], a[240:243], v[184:187], a[32:35]
    s_add_u32 m0, s60, 32768
    s_add_u32 s61, s50, 41216
    v_mfma_f32_16x16x32_bf16 a[36:39], a[240:243], v[188:191], a[36:39]
    ds_read_b64_tr_b16 a[226:227], v222 offset:16896
    ds_read_b64_tr_b16 a[228:229], v223 offset:16384
    v_mfma_f32_16x16x32_bf16 a[40:43], a[244:247], v[184:187], a[40:43]
    ds_read_b64_tr_b16 a[230:231], v223 offset:16896
    v_mfma_f32_16x16x32_bf16 a[44:47], a[244:247], v[188:191], a[44:47]
    buffer_load_dwordx4 v236, s[24:27], s61 offen offset:0 lds
    v_mfma_f32_16x16x32_bf16 a[48:51], a[248:251], v[184:187], a[48:51]
    ds_read_b64_tr_b16 a[232:233], v220 offset:17408
    ds_read_b64_tr_b16 a[234:235], v220 offset:17920
    v_mfma_f32_16x16x32_bf16 a[52:55], a[248:251], v[188:191], a[52:55]
    ds_read_b64_tr_b16 a[236:237], v221 offset:17408
    v_mfma_f32_16x16x32_bf16 a[56:59], a[252:255], v[184:187], a[56:59]
    s_waitcnt vmcnt(9)
    v_mov_b32 v3, 4
    s_mov_b64 exec, 1
    buffer_store_dword v3, v15, s[16:19], s7 offen sc1
    s_mov_b64 exec, -1
    v_mfma_f32_16x16x32_bf16 a[60:63], a[252:255], v[188:191], a[60:63]
    ds_read_b64_tr_b16 a[238:239], v221 offset:17920
    s_waitcnt lgkmcnt(4)
L_back_step180:
    v_mfma_f32_16x16x32_bf16 a[32:35], a[216:219], a[144:147], a[32:35]
    ds_read_b64_tr_b16 a[240:241], v222 offset:17408
    s_add_u32 s61, s50, 77056
    v_mfma_f32_16x16x32_bf16 a[36:39], a[216:219], a[148:151], a[36:39]
    ds_read_b64_tr_b16 a[242:243], v222 offset:17920
    ds_read_b64_tr_b16 a[244:245], v223 offset:17408
    v_mfma_f32_16x16x32_bf16 a[40:43], a[220:223], a[144:147], a[40:43]
    ds_read_b64_tr_b16 a[246:247], v223 offset:17920
    v_mfma_f32_16x16x32_bf16 a[44:47], a[220:223], a[148:151], a[44:47]
    buffer_load_dwordx4 v236, s[24:27], s61 offen offset:1024 lds
    v_mfma_f32_16x16x32_bf16 a[48:51], a[224:227], a[144:147], a[48:51]
    ds_read_b64_tr_b16 a[248:249], v220 offset:18432
    ds_read_b64_tr_b16 a[250:251], v220 offset:18944
    v_mfma_f32_16x16x32_bf16 a[52:55], a[224:227], a[148:151], a[52:55]
    ds_read_b64_tr_b16 a[252:253], v221 offset:18432
    v_mfma_f32_16x16x32_bf16 a[56:59], a[228:231], a[144:147], a[56:59]
    ds_read_b64_tr_b16 a[254:255], v221 offset:18944
    v_mfma_f32_16x16x32_bf16 a[60:63], a[228:231], a[148:151], a[60:63]
    ds_read_b64_tr_b16 a[216:217], v222 offset:18432
    s_waitcnt lgkmcnt(5)
L_back_step181:
    v_mfma_f32_16x16x32_bf16 a[32:35], a[232:235], a[152:155], a[32:35]
    s_add_u32 s61, s50, 112896
    ds_read_b64_tr_b16 a[218:219], v222 offset:18944
    v_mfma_f32_16x16x32_bf16 a[36:39], a[232:235], a[156:159], a[36:39]
    buffer_load_dwordx4 v236, s[24:27], s61 offen offset:2048 lds
    v_mfma_f32_16x16x32_bf16 a[40:43], a[236:239], a[152:155], a[40:43]
    ds_read_b64_tr_b16 a[220:221], v223 offset:18432
    ds_read_b64_tr_b16 a[222:223], v223 offset:18944
    v_mfma_f32_16x16x32_bf16 a[44:47], a[236:239], a[156:159], a[44:47]
    ds_read_b64_tr_b16 a[224:225], v220 offset:19456
    v_mfma_f32_16x16x32_bf16 a[48:51], a[240:243], a[152:155], a[48:51]
    ds_read_b64_tr_b16 a[226:227], v220 offset:19968
    v_mfma_f32_16x16x32_bf16 a[52:55], a[240:243], a[156:159], a[52:55]
    ds_read_b64_tr_b16 a[228:229], v221 offset:19456
    v_mfma_f32_16x16x32_bf16 a[56:59], a[244:247], a[152:155], a[56:59]
    ds_read_b64_tr_b16 a[230:231], v221 offset:19968
    v_mfma_f32_16x16x32_bf16 a[60:63], a[244:247], a[156:159], a[60:63]
    ds_read_b64_tr_b16 a[232:233], v222 offset:19456
    s_waitcnt lgkmcnt(5)
L_back_step182:
    v_mfma_f32_16x16x32_bf16 a[32:35], a[248:251], a[160:163], a[32:35]
    s_add_u32 s61, s50, 148736
    ds_read_b64_tr_b16 a[234:235], v222 offset:19968
    v_mfma_f32_16x16x32_bf16 a[36:39], a[248:251], a[164:167], a[36:39]
    buffer_load_dwordx4 v236, s[24:27], s61 offen offset:3072 lds
    v_mfma_f32_16x16x32_bf16 a[40:43], a[252:255], a[160:163], a[40:43]
    ds_read_b64_tr_b16 a[236:237], v223 offset:19456
    ds_read_b64_tr_b16 a[238:239], v223 offset:19968
    v_mfma_f32_16x16x32_bf16 a[44:47], a[252:255], a[164:167], a[44:47]
    s_waitcnt vmcnt(7)
    v_readfirstlane_b32 s40, v2
    s_nop 0
    s_cmp_ge_u32 s40, 3
    s_cbranch_scc0 L_slow_6020
L_back_6021:
    s_add_u32 s43, s53, 12288
    buffer_load_dwordx4 a[192:195], v238, s[16:19], s43 offen offset:0 sc1
    v_mfma_f32_16x16x32_bf16 a[48:51], a[216:219], a[160:163], a[48:51]
    s_barrier
    v_mfma_f32_16x16x32_bf16 a[52:55], a[216:219], a[164:167], a[52:55]
    ds_read_b64_tr_b16 a[240:241], v220 offset:32768
    ds_read_b64_tr_b16 a[242:243], v220 offset:33280
    v_mfma_f32_16x16x32_bf16 a[56:59], a[220:223], a[160:163], a[56:59]
    ds_read_b64_tr_b16 a[244:245], v221 offset:32768
    ds_read_b64_tr_b16 a[246:247], v221 offset:33280
    v_mfma_f32_16x16x32_bf16 a[60:63], a[220:223], a[164:167], a[60:63]
    ds_read_b64_tr_b16 a[248:249], v222 offset:32768
    s_waitcnt lgkmcnt(5)
L_back_step183:
    v_mfma_f32_16x16x32_bf16 a[32:35], a[224:227], a[168:171], a[32:35]
    buffer_load_dwordx4 a[196:199], v238, s[16:19], s43 offen offset:1024 sc1
    v_mfma_f32_16x16x32_bf16 a[36:39], a[224:227], a[172:175], a[36:39]
    ds_read_b64_tr_b16 a[250:251], v222 offset:33280
    s_add_u32 m0, s60, 49152
    v_mfma_f32_16x16x32_bf16 a[40:43], a[228:231], a[168:171], a[40:43]
    ds_read_b64_tr_b16 a[252:253], v223 offset:32768
    ds_read_b64_tr_b16 a[254:255], v223 offset:33280
    v_mfma_f32_16x16x32_bf16 a[44:47], a[228:231], a[172:175], a[44:47]
    s_add_u32 s61, s50, 188672
    buffer_load_dwordx4 v236, s[24:27], s61 offen offset:0 lds
    v_mfma_f32_16x16x32_bf16 a[48:51], a[232:235], a[168:171], a[48:51]
    ds_read_b64_tr_b16 a[216:217], v220 offset:33792
    ds_read_b64_tr_b16 a[218:219], v220 offset:34304
    v_mfma_f32_16x16x32_bf16 a[52:55], a[232:235], a[172:175], a[52:55]
    buffer_load_dwordx4 a[200:203], v238, s[16:19], s43 offen offset:2048 sc1
    v_mfma_f32_16x16x32_bf16 a[56:59], a[236:239], a[168:171], a[56:59]
    ds_read_b64_tr_b16 a[220:221], v221 offset:33792
    ds_read_b64_tr_b16 a[222:223], v221 offset:34304
    v_mfma_f32_16x16x32_bf16 a[60:63], a[236:239], a[172:175], a[60:63]
    ds_read_b64_tr_b16 a[224:225], v222 offset:33792
    s_waitcnt lgkmcnt(5)
L_back_step184:
    v_mfma_f32_16x16x32_bf16 a[32:35], a[240:243], a[176:179], a[32:35]
    s_add_u32 s61, s50, 224512
    ds_read_b64_tr_b16 a[226:227], v222 offset:34304
    v_mfma_f32_16x16x32_bf16 a[36:39], a[240:243], a[180:183], a[36:39]
    buffer_load_dwordx4 a[204:207], v238, s[16:19], s43 offen offset:3072 sc1
    v_mfma_f32_16x16x32_bf16 a[40:43], a[244:247], a[176:179], a[40:43]
    ds_read_b64_tr_b16 a[228:229], v223 offset:33792
    ds_read_b64_tr_b16 a[230:231], v223 offset:34304
    buffer_load_dword v2, v15, s[16:19], s38 offen sc1
    v_mfma_f32_16x16x32_bf16 a[44:47], a[244:247], a[180:183], a[44:47]
    buffer_load_dwordx4 v236, s[24:27], s61 offen offset:1024 lds
    v_mfma_f32_16x16x32_bf16 a[48:51], a[248:251], a[176:179], a[48:51]
    ds_read_b64_tr_b16 a[232:233], v220 offset:34816
    ds_read_b64_tr_b16 a[234:235], v220 offset:35328
    v_mfma_f32_16x16x32_bf16 a[52:55], a[248:251], a[180:183], a[52:55]
    ds_read_b64_tr_b16 a[236:237], v221 offset:34816
    v_mfma_f32_16x16x32_bf16 a[56:59], a[252:255], a[176:179], a[56:59]
    ds_read_b64_tr_b16 a[238:239], v221 offset:35328
    v_mfma_f32_16x16x32_bf16 a[60:63], a[252:255], a[180:183], a[60:63]
    ds_read_b64_tr_b16 a[240:241], v222 offset:34816
    s_waitcnt lgkmcnt(5)
L_back_step185:
    v_mfma_f32_16x16x32_bf16 a[32:35], a[216:219], a[184:187], a[32:35]
    s_add_u32 s61, s50, 260352
    ds_read_b64_tr_b16 a[242:243], v222 offset:35328
    v_mfma_f32_16x16x32_bf16 a[36:39], a[216:219], a[188:191], a[36:39]
    buffer_load_dwordx4 v236, s[24:27], s61 offen offset:2048 lds
    v_mfma_f32_16x16x32_bf16 a[40:43], a[220:223], a[184:187], a[40:43]
    ds_read_b64_tr_b16 a[244:245], v223 offset:34816
    ds_read_b64_tr_b16 a[246:247], v223 offset:35328
    v_mfma_f32_16x16x32_bf16 a[44:47], a[220:223], a[188:191], a[44:47]
    ds_read_b64_tr_b16 a[248:249], v220 offset:35840
    v_mfma_f32_16x16x32_bf16 a[48:51], a[224:227], a[184:187], a[48:51]
    ds_read_b64_tr_b16 a[250:251], v220 offset:36352
    v_mfma_f32_16x16x32_bf16 a[52:55], a[224:227], a[188:191], a[52:55]
    ds_read_b64_tr_b16 a[252:253], v221 offset:35840
    v_mfma_f32_16x16x32_bf16 a[56:59], a[228:231], a[184:187], a[56:59]
    ds_read_b64_tr_b16 a[254:255], v221 offset:36352
    v_mfma_f32_16x16x32_bf16 a[60:63], a[228:231], a[188:191], a[60:63]
    ds_read_b64_tr_b16 a[216:217], v222 offset:35840
    s_waitcnt lgkmcnt(5)
L_back_step186:
    v_mfma_f32_16x16x32_bf16 a[0:3], a[232:235], v[192:195], a[0:3]
    s_add_u32 s61, s51, 1280
    ds_read_b64_tr_b16 a[218:219], v222 offset:36352
    v_mfma_f32_16x16x32_bf16 a[4:7], a[232:235], v[196:199], a[4:7]
    buffer_load_dwordx4 v236, s[24:27], s61 offen offset:3072 lds
    v_mfma_f32_16x16x32_bf16 a[8:11], a[236:239], v[192:195], a[8:11]
    ds_read_b64_tr_b16 a[220:221], v223 offset:35840
    ds_read_b64_tr_b16 a[222:223], v223 offset:36352
    v_mfma_f32_16x16x32_bf16 a[12:15], a[236:239], v[196:199], a[12:15]
    ds_read_b64_tr_b16 a[224:225], v220 offset:49152
    v_mfma_f32_16x16x32_bf16 a[16:19], a[240:243], v[192:195], a[16:19]
    ds_read_b64_tr_b16 a[226:227], v220 offset:49664
    v_mfma_f32_16x16x32_bf16 a[20:23], a[240:243], v[196:199], a[20:23]
    ds_read_b64_tr_b16 a[228:229], v221 offset:49152
    v_mfma_f32_16x16x32_bf16 a[24:27], a[244:247], v[192:195], a[24:27]
    ds_read_b64_tr_b16 a[230:231], v221 offset:49664
    v_mfma_f32_16x16x32_bf16 a[28:31], a[244:247], v[196:199], a[28:31]
    ds_read_b64_tr_b16 a[232:233], v222 offset:49152
    s_waitcnt lgkmcnt(5)
L_back_step187:
    v_mfma_f32_16x16x32_bf16 a[0:3], a[248:251], v[200:203], a[0:3]
    s_add_u32 m0, s60, 65536
    s_add_u32 s61, s58, 4480
    v_mfma_f32_16x16x32_bf16 a[4:7], a[248:251], v[204:207], a[4:7]
    ds_read_b64_tr_b16 a[234:235], v222 offset:49664
    ds_read_b64_tr_b16 a[236:237], v223 offset:49152
    v_mfma_f32_16x16x32_bf16 a[8:11], a[252:255], v[200:203], a[8:11]
    ds_read_b64_tr_b16 a[238:239], v223 offset:49664
    v_mfma_f32_16x16x32_bf16 a[12:15], a[252:255], v[204:207], a[12:15]
    buffer_load_dwordx4 v236, s[24:27], s61 offen offset:0 lds
    v_mfma_f32_16x16x32_bf16 a[16:19], a[216:219], v[200:203], a[16:19]
    ds_read_b64_tr_b16 a[240:241], v220 offset:50176
    ds_read_b64_tr_b16 a[242:243], v220 offset:50688
    v_mfma_f32_16x16x32_bf16 a[20:23], a[216:219], v[204:207], a[20:23]
    ds_read_b64_tr_b16 a[244:245], v221 offset:50176
    v_mfma_f32_16x16x32_bf16 a[24:27], a[220:223], v[200:203], a[24:27]
    ds_read_b64_tr_b16 a[246:247], v221 offset:50688
    v_mfma_f32_16x16x32_bf16 a[28:31], a[220:223], v[204:207], a[28:31]
    ds_read_b64_tr_b16 a[248:249], v222 offset:50176
    s_waitcnt lgkmcnt(5)
L_back_step188:
    v_mfma_f32_16x16x32_bf16 a[0:3], a[224:227], v[208:211], a[0:3]
    s_add_u32 s61, s58, 40320
    ds_read_b64_tr_b16 a[250:251], v222 offset:50688
    v_mfma_f32_16x16x32_bf16 a[4:7], a[224:227], v[212:215], a[4:7]
    buffer_load_dwordx4 v236, s[24:27], s61 offen offset:1024 lds
    v_mfma_f32_16x16x32_bf16 a[8:11], a[228:231], v[208:211], a[8:11]
    ds_read_b64_tr_b16 a[252:253], v223 offset:50176
    ds_read_b64_tr_b16 a[254:255], v223 offset:50688
    v_mfma_f32_16x16x32_bf16 a[12:15], a[228:231], v[212:215], a[12:15]
    ds_read_b64_tr_b16 a[216:217], v220 offset:51200
    v_mfma_f32_16x16x32_bf16 a[16:19], a[232:235], v[208:211], a[16:19]
    ds_read_b64_tr_b16 a[218:219], v220 offset:51712
    v_mfma_f32_16x16x32_bf16 a[20:23], a[232:235], v[212:215], a[20:23]
    ds_read_b64_tr_b16 a[220:221], v221 offset:51200
    v_mfma_f32_16x16x32_bf16 a[24:27], a[236:239], v[208:211], a[24:27]
    ds_read_b64_tr_b16 a[222:223], v221 offset:51712
    v_mfma_f32_16x16x32_bf16 a[28:31], a[236:239], v[212:215], a[28:31]
    ds_read_b64_tr_b16 a[224:225], v222 offset:51200
    s_waitcnt lgkmcnt(5)
L_back_step189:
    v_mfma_f32_16x16x32_bf16 a[32:35], a[240:243], v[192:195], a[32:35]
    s_add_u32 s61, s58, 76160
    ds_read_b64_tr_b16 a[226:227], v222 offset:51712
    v_mfma_f32_16x16x32_bf16 a[36:39], a[240:243], v[196:199], a[36:39]
    buffer_load_dwordx4 v236, s[24:27], s61 offen offset:2048 lds
    v_mfma_f32_16x16x32_bf16 a[40:43], a[244:247], v[192:195], a[40:43]
    ds_read_b64_tr_b16 a[228:229], v223 offset:51200
    ds_read_b64_tr_b16 a[230:231], v223 offset:51712
    v_mfma_f32_16x16x32_bf16 a[44:47], a[244:247], v[196:199], a[44:47]
    s_waitcnt vmcnt(6)
    v_readfirstlane_b32 s40, v2
    s_nop 0
    s_cmp_ge_u32 s40, 4
    s_cbranch_scc0 L_slow_6023
L_back_6024:
    s_add_u32 s43, s53, 16384
    buffer_load_dwordx4 a[208:211], v238, s[16:19], s43 offen offset:0 sc1
    v_mfma_f32_16x16x32_bf16 a[48:51], a[248:251], v[192:195], a[48:51]
    ds_read_b64_tr_b16 a[232:233], v220 offset:52224
    ds_read_b64_tr_b16 a[234:235], v220 offset:52736
    v_mfma_f32_16x16x32_bf16 a[52:55], a[248:251], v[196:199], a[52:55]
    ds_read_b64_tr_b16 a[236:237], v221 offset:52224
    v_mfma_f32_16x16x32_bf16 a[56:59], a[252:255], v[192:195], a[56:59]
    ds_read_b64_tr_b16 a[238:239], v221 offset:52736
    v_mfma_f32_16x16x32_bf16 a[60:63], a[252:255], v[196:199], a[60:63]
    ds_read_b64_tr_b16 a[240:241], v222 offset:52224
    s_waitcnt lgkmcnt(5)
L_back_step190:
    v_mfma_f32_16x16x32_bf16 a[32:35], a[216:219], v[200:203], a[32:35]
    buffer_load_dwordx4 a[212:215], v238, s[16:19], s43 offen offset:1024 sc1
    v_mfma_f32_16x16x32_bf16 a[36:39], a[216:219], v[204:207], a[36:39]
    ds_read_b64_tr_b16 a[242:243], v222 offset:52736
    s_add_u32 s61, s58, 112000
    v_mfma_f32_16x16x32_bf16 a[40:43], a[220:223], v[200:203], a[40:43]
    ds_read_b64_tr_b16 a[244:245], v223 offset:52224
    ds_read_b64_tr_b16 a[246:247], v223 offset:52736
    v_mfma_f32_16x16x32_bf16 a[44:47], a[220:223], v[204:207], a[44:47]
    buffer_load_dwordx4 v236, s[24:27], s61 offen offset:3072 lds
    v_mfma_f32_16x16x32_bf16 a[48:51], a[224:227], v[200:203], a[48:51]
    s_barrier
    v_mfma_f32_16x16x32_bf16 a[52:55], a[224:227], v[204:207], a[52:55]
    ds_read_b64_tr_b16 a[248:249], v224 offset:0
    ds_read_b64_tr_b16 a[250:251], v224 offset:512
    v_mfma_f32_16x16x32_bf16 a[56:59], a[228:231], v[200:203], a[56:59]
    ds_read_b64_tr_b16 a[252:253], v225 offset:0
    ds_read_b64_tr_b16 a[254:255], v225 offset:512
    v_mfma_f32_16x16x32_bf16 a[60:63], a[228:231], v[204:207], a[60:63]
    ds_read_b64_tr_b16 a[216:217], v226 offset:0
    s_waitcnt lgkmcnt(5)
L_back_step191:
    v_mfma_f32_16x16x32_bf16 a[32:35], a[232:235], v[208:211], a[32:35]
    s_add_u32 m0, s60, 81920
    s_add_u32 s61, s58, 151936
    v_mfma_f32_16x16x32_bf16 a[36:39], a[232:235], v[212:215], a[36:39]
    ds_read_b64_tr_b16 a[218:219], v226 offset:512
    ds_read_b64_tr_b16 a[220:221], v227 offset:0
    v_mfma_f32_16x16x32_bf16 a[40:43], a[236:239], v[208:211], a[40:43]
    ds_read_b64_tr_b16 a[222:223], v227 offset:512
    v_mfma_f32_16x16x32_bf16 a[44:47], a[236:239], v[212:215], a[44:47]
    buffer_load_dwordx4 v236, s[24:27], s61 offen offset:0 lds
    v_mfma_f32_16x16x32_bf16 a[48:51], a[240:243], v[208:211], a[48:51]
    ds_read_b64_tr_b16 a[224:225], v224 offset:1024
    ds_read_b64_tr_b16 a[226:227], v224 offset:1536
    v_mfma_f32_16x16x32_bf16 a[52:55], a[240:243], v[212:215], a[52:55]
    ds_read_b64_tr_b16 a[228:229], v225 offset:1024
    v_mfma_f32_16x16x32_bf16 a[56:59], a[244:247], v[208:211], a[56:59]
    ds_read_b64_tr_b16 a[230:231], v225 offset:1536
    v_mfma_f32_16x16x32_bf16 a[60:63], a[244:247], v[212:215], a[60:63]
    ds_read_b64_tr_b16 a[232:233], v226 offset:1024
    s_waitcnt lgkmcnt(5)
L_back_step192:
    v_mfma_f32_16x16x32_bf16 a[0:3], a[248:251], a[192:195], a[0:3]
    s_add_u32 s61, s58, 187776
    ds_read_b64_tr_b16 a[234:235], v226 offset:1536
    v_mfma_f32_16x16x32_bf16 a[4:7], a[248:251], a[196:199], a[4:7]
    buffer_load_dwordx4 v236, s[24:27], s61 offen offset:1024 lds
    v_mfma_f32_16x16x32_bf16 a[8:11], a[252:255], a[192:195], a[8:11]
    ds_read_b64_tr_b16 a[236:237], v227 offset:1024
    ds_read_b64_tr_b16 a[238:239], v227 offset:1536
    v_mfma_f32_16x16x32_bf16 a[12:15], a[252:255], a[196:199], a[12:15]
    ds_read_b64_tr_b16 a[240:241], v224 offset:2048
    v_mfma_f32_16x16x32_bf16 a[16:19], a[216:219], a[192:195], a[16:19]
    ds_read_b64_tr_b16 a[242:243], v224 offset:2560
    v_mfma_f32_16x16x32_bf16 a[20:23], a[216:219], a[196:199], a[20:23]
    ds_read_b64_tr_b16 a[244:245], v225 offset:2048
    v_mfma_f32_16x16x32_bf16 a[24:27], a[220:223], a[192:195], a[24:27]
    ds_read_b64_tr_b16 a[246:247], v225 offset:2560
    v_mfma_f32_16x16x32_bf16 a[28:31], a[220:223], a[196:199], a[28:31]
    ds_read_b64_tr_b16 a[248:249], v226 offset:2048
    s_waitcnt lgkmcnt(5)
L_back_step193:
    v_mfma_f32_16x16x32_bf16 a[0:3], a[224:227], a[200:203], a[0:3]
    s_add_u32 s61, s58, 223616
    ds_read_b64_tr_b16 a[250:251], v226 offset:2560
    v_mfma_f32_16x16x32_bf16 a[4:7], a[224:227], a[204:207], a[4:7]
    buffer_load_dwordx4 v236, s[24:27], s61 offen offset:2048 lds
    v_mfma_f32_16x16x32_bf16 a[8:11], a[228:231], a[200:203], a[8:11]
    ds_read_b64_tr_b16 a[252:253], v227 offset:2048
    ds_read_b64_tr_b16 a[254:255], v227 offset:2560
    v_mfma_f32_16x16x32_bf16 a[12:15], a[228:231], a[204:207], a[12:15]
    ds_read_b64_tr_b16 a[216:217], v224 offset:3072
    v_mfma_f32_16x16x32_bf16 a[16:19], a[232:235], a[200:203], a[16:19]
    ds_read_b64_tr_b16 a[218:219], v224 offset:3584
    v_mfma_f32_16x16x32_bf16 a[20:23], a[232:235], a[204:207], a[20:23]
    ds_read_b64_tr_b16 a[220:221], v225 offset:3072
    v_mfma_f32_16x16x32_bf16 a[24:27], a[236:239], a[200:203], a[24:27]
    ds_read_b64_tr_b16 a[222:223], v225 offset:3584
    v_mfma_f32_16x16x32_bf16 a[28:31], a[236:239], a[204:207], a[28:31]
    ds_read_b64_tr_b16 a[224:225], v226 offset:3072
    s_waitcnt lgkmcnt(5)
L_back_step194:
    s_waitcnt vmcnt(5)
    v_mfma_f32_16x16x32_bf16 a[0:3], a[240:243], a[208:211], a[0:3]
    s_add_u32 s61, s58, 259456
    ds_read_b64_tr_b16 a[226:227], v226 offset:3584
    s_waitcnt vmcnt(4)
    v_mfma_f32_16x16x32_bf16 a[4:7], a[240:243], a[212:215], a[4:7]
    buffer_load_dwordx4 v236, s[24:27], s61 offen offset:3072 lds
    v_mfma_f32_16x16x32_bf16 a[8:11], a[244:247], a[208:211], a[8:11]
    ds_read_b64_tr_b16 a[228:229], v227 offset:3072
    ds_read_b64_tr_b16 a[230:231], v227 offset:3584
    v_mfma_f32_16x16x32_bf16 a[12:15], a[244:247], a[212:215], a[12:15]
    ds_read_b64_tr_b16 a[232:233], v224 offset:16384
    v_mfma_f32_16x16x32_bf16 a[16:19], a[248:251], a[208:211], a[16:19]
    ds_read_b64_tr_b16 a[234:235], v224 offset:16896
    v_mfma_f32_16x16x32_bf16 a[20:23], a[248:251], a[212:215], a[20:23]
    ds_read_b64_tr_b16 a[236:237], v225 offset:16384
    v_mfma_f32_16x16x32_bf16 a[24:27], a[252:255], a[208:211], a[24:27]
    ds_read_b64_tr_b16 a[238:239], v225 offset:16896
    v_mfma_f32_16x16x32_bf16 a[28:31], a[252:255], a[212:215], a[28:31]
    ds_read_b64_tr_b16 a[240:241], v226 offset:16384
    s_waitcnt lgkmcnt(5)
L_back_step195:
    v_mfma_f32_16x16x32_bf16 a[32:35], a[216:219], a[192:195], a[32:35]
    s_add_u32 m0, s60, 98304
    s_add_u32 s61, s59, 4480
    v_mfma_f32_16x16x32_bf16 a[36:39], a[216:219], a[196:199], a[36:39]
    ds_read_b64_tr_b16 a[242:243], v226 offset:16896
    ds_read_b64_tr_b16 a[244:245], v227 offset:16384
    v_mfma_f32_16x16x32_bf16 a[40:43], a[220:223], a[192:195], a[40:43]
    ds_read_b64_tr_b16 a[246:247], v227 offset:16896
    v_mfma_f32_16x16x32_bf16 a[44:47], a[220:223], a[196:199], a[44:47]
    buffer_load_dwordx4 v236, s[24:27], s61 offen offset:0 lds
    v_mfma_f32_16x16x32_bf16 a[48:51], a[224:227], a[192:195], a[48:51]
    ds_read_b64_tr_b16 a[248:249], v224 offset:17408
    v_accvgpr_read_b32 v240, a0
    v_mfma_f32_16x16x32_bf16 a[52:55], a[224:227], a[196:199], a[52:55]
    ds_read_b64_tr_b16 a[250:251], v224 offset:17920
    v_accvgpr_read_b32 v241, a1
    v_mfma_f32_16x16x32_bf16 a[56:59], a[228:231], a[192:195], a[56:59]
    ds_read_b64_tr_b16 a[252:253], v225 offset:17408
    v_accvgpr_read_b32 v242, a2
    v_mfma_f32_16x16x32_bf16 a[60:63], a[228:231], a[196:199], a[60:63]
    ds_read_b64_tr_b16 a[254:255], v225 offset:17920
    v_accvgpr_read_b32 v243, a3
    s_waitcnt lgkmcnt(4)
L_back_step196:
    v_mfma_f32_16x16x32_bf16 a[32:35], a[232:235], a[200:203], a[32:35]
    ds_read_b64_tr_b16 a[216:217], v226 offset:17408
    s_add_u32 s61, s50, 3456
    v_cvt_pk_bf16_f32 v248, v240, v241
    v_mfma_f32_16x16x32_bf16 a[36:39], a[232:235], a[204:207], a[36:39]
    ds_read_b64_tr_b16 a[218:219], v226 offset:17920
    ds_read_b64_tr_b16 a[220:221], v227 offset:17408
    v_cvt_pk_bf16_f32 v249, v242, v243
    v_mfma_f32_16x16x32_bf16 a[40:43], a[236:239], a[200:203], a[40:43]
    ds_read_b64_tr_b16 a[222:223], v227 offset:17920
    v_accvgpr_read_b32 v240, a8
    v_mfma_f32_16x16x32_bf16 a[44:47], a[236:239], a[204:207], a[44:47]
    buffer_load_dwordx4 v236, s[24:27], s61 offen offset:1024 lds
    v_accvgpr_read_b32 v241, a9
    v_mfma_f32_16x16x32_bf16 a[48:51], a[240:243], a[200:203], a[48:51]
    ds_read_b64_tr_b16 a[224:225], v224 offset:18432
    v_accvgpr_read_b32 v242, a10
    v_mfma_f32_16x16x32_bf16 a[52:55], a[240:243], a[204:207], a[52:55]
    ds_read_b64_tr_b16 a[226:227], v224 offset:18944
    v_accvgpr_read_b32 v243, a11
    v_mfma_f32_16x16x32_bf16 a[56:59], a[244:247], a[200:203], a[56:59]
    ds_read_b64_tr_b16 a[228:229], v225 offset:18432
    v_cvt_pk_bf16_f32 v250, v240, v241
    v_mfma_f32_16x16x32_bf16 a[60:63], a[244:247], a[204:207], a[60:63]
    ds_read_b64_tr_b16 a[230:231], v225 offset:18944
    v_cvt_pk_bf16_f32 v251, v242, v243
    s_waitcnt lgkmcnt(4)
L_back_step197:
    v_mfma_f32_16x16x32_bf16 a[32:35], a[248:251], a[208:211], a[32:35]
    ds_read_b64_tr_b16 a[232:233], v226 offset:18432
    s_add_u32 s61, s50, 39296
    s_add_u32 s63, s55, 0
    v_mfma_f32_16x16x32_bf16 a[36:39], a[248:251], a[212:215], a[36:39]
    ds_read_b64_tr_b16 a[234:235], v226 offset:18944
    ds_read_b64_tr_b16 a[236:237], v227 offset:18432
    v_mfma_f32_16x16x32_bf16 a[40:43], a[252:255], a[208:211], a[40:43]
    ds_read_b64_tr_b16 a[238:239], v227 offset:18944
    v_permlane16_swap_b32 v248, v250
    v_mfma_f32_16x16x32_bf16 a[44:47], a[252:255], a[212:215], a[44:47]
    buffer_load_dwordx4 v236, s[24:27], s61 offen offset:2048 lds
    v_permlane16_swap_b32 v249, v251
    v_mfma_f32_16x16x32_bf16 a[48:51], a[216:219], a[208:211], a[48:51]
    ds_read_b64_tr_b16 a[240:241], v224 offset:19456
    ds_read_b64_tr_b16 a[242:243], v224 offset:19968
    buffer_store_dwordx4 v[248:251], v239, s[16:19], s63 offen offset:0 sc1
    v_accvgpr_read_b32 v240, a16
    v_mfma_f32_16x16x32_bf16 a[52:55], a[216:219], a[212:215], a[52:55]
    v_accvgpr_read_b32 v241, a17
    v_accvgpr_read_b32 v242, a18
    v_mfma_f32_16x16x32_bf16 a[56:59], a[220:223], a[208:211], a[56:59]
    ds_read_b64_tr_b16 a[244:245], v225 offset:19456
    v_accvgpr_read_b32 v243, a19
    v_mfma_f32_16x16x32_bf16 a[60:63], a[220:223], a[212:215], a[60:63]
    ds_read_b64_tr_b16 a[246:247], v225 offset:19968
    v_cvt_pk_bf16_f32 v252, v240, v241
    s_waitcnt lgkmcnt(4)
L_back_step198:
    v_mfma_f32_16x16x32_bf16 v[16:19], a[224:227], v[144:147], 0
    ds_read_b64_tr_b16 a[248:249], v226 offset:19456
    s_add_u32 s61, s50, 75136
    v_cvt_pk_bf16_f32 v253, v242, v243
    v_mfma_f32_16x16x32_bf16 v[20:23], a[224:227], v[148:151], 0
    ds_read_b64_tr_b16 a[250:251], v226 offset:19968
    ds_read_b64_tr_b16 a[252:253], v227 offset:19456
    v_accvgpr_read_b32 v240, a24
    v_mfma_f32_16x16x32_bf16 v[24:27], a[228:231], v[144:147], 0
    ds_read_b64_tr_b16 a[254:255], v227 offset:19968
    v_accvgpr_read_b32 v241, a25
    v_mfma_f32_16x16x32_bf16 v[28:31], a[228:231], v[148:151], 0
    buffer_load_dwordx4 v236, s[24:27], s61 offen offset:3072 lds
    v_accvgpr_read_b32 v242, a26
    v_mfma_f32_16x16x32_bf16 v[32:35], a[232:235], v[144:147], 0
    s_barrier
    v_accvgpr_read_b32 v243, a27
    v_mfma_f32_16x16x32_bf16 v[36:39], a[232:235], v[148:151], 0
    ds_read_b64_tr_b16 a[216:217], v216 offset:0
    ds_read_b64_tr_b16 a[218:219], v216 offset:512
    v_cvt_pk_bf16_f32 v254, v240, v241
    v_mfma_f32_16x16x32_bf16 v[40:43], a[236:239], v[144:147], 0
    ds_read_b64_tr_b16 a[220:221], v217 offset:0
    v_cvt_pk_bf16_f32 v255, v242, v243
    v_mfma_f32_16x16x32_bf16 v[44:47], a[236:239], v[148:151], 0
    ds_read_b64_tr_b16 a[222:223], v217 offset:512
    s_waitcnt lgkmcnt(4)
L_back_step199:
    v_mfma_f32_16x16x32_bf16 v[16:19], a[240:243], v[152:155], v[16:19]
    ds_read_b64_tr_b16 a[224:225], v218 offset:0
    ds_read_b64_tr_b16 a[226:227], v218 offset:512
    v_permlane16_swap_b32 v252, v254
    v_mfma_f32_16x16x32_bf16 v[20:23], a[240:243], v[156:159], v[20:23]
    v_permlane16_swap_b32 v253, v255
    v_mfma_f32_16x16x32_bf16 v[24:27], a[244:247], v[152:155], v[24:27]
    ds_read_b64_tr_b16 a[228:229], v219 offset:0
    ds_read_b64_tr_b16 a[230:231], v219 offset:512
    buffer_store_dwordx4 v[252:255], v239, s[16:19], s63 offen offset:1024 sc1
    v_accvgpr_read_b32 v240, a4
    v_mfma_f32_16x16x32_bf16 v[28:31], a[244:247], v[156:159], v[28:31]
    s_add_u32 m0, s60, 114688
    s_add_u32 s61, s50, 115072
    buffer_load_dwordx4 v236, s[24:27], s61 offen offset:0 lds
    v_accvgpr_read_b32 v241, a5
    v_mfma_f32_16x16x32_bf16 v[32:35], a[248:251], v[152:155], v[32:35]
    ds_read_b64_tr_b16 a[232:233], v216 offset:1024
    v_accvgpr_read_b32 v242, a6
    v_accvgpr_read_b32 v243, a7
    v_mfma_f32_16x16x32_bf16 v[36:39], a[248:251], v[156:159], v[36:39]
    ds_read_b64_tr_b16 a[234:235], v216 offset:1536
    v_cvt_pk_bf16_f32 v248, v240, v241
    v_mfma_f32_16x16x32_bf16 v[40:43], a[252:255], v[152:155], v[40:43]
    ds_read_b64_tr_b16 a[236:237], v217 offset:1024
    v_cvt_pk_bf16_f32 v249, v242, v243
    v_mfma_f32_16x16x32_bf16 v[44:47], a[252:255], v[156:159], v[44:47]
    ds_read_b64_tr_b16 a[238:239], v217 offset:1536
    v_accvgpr_read_b32 v240, a12
    s_waitcnt lgkmcnt(4)
L_back_step200:
    v_mfma_f32_16x16x32_bf16 v[16:19], a[216:219], v[160:163], v[16:19]
    ds_read_b64_tr_b16 a[240:241], v218 offset:1024
    s_add_u32 s61, s50, 150912
    v_accvgpr_read_b32 v241, a13
    v_mfma_f32_16x16x32_bf16 v[20:23], a[216:219], v[164:167], v[20:23]
    ds_read_b64_tr_b16 a[242:243], v218 offset:1536
    ds_read_b64_tr_b16 a[244:245], v219 offset:1024
    v_accvgpr_read_b32 v242, a14
    v_mfma_f32_16x16x32_bf16 v[24:27], a[220:223], v[160:163], v[24:27]
    ds_read_b64_tr_b16 a[246:247], v219 offset:1536
    v_accvgpr_read_b32 v243, a15
    v_mfma_f32_16x16x32_bf16 v[28:31], a[220:223], v[164:167], v[28:31]
    buffer_load_dwordx4 v236, s[24:27], s61 offen offset:1024 lds
    v_cvt_pk_bf16_f32 v250, v240, v241
    v_mfma_f32_16x16x32_bf16 v[32:35], a[224:227], v[160:163], v[32:35]
    ds_read_b64_tr_b16 a[248:249], v216 offset:2048
    v_cvt_pk_bf16_f32 v251, v242, v243
    v_mfma_f32_16x16x32_bf16 v[36:39], a[224:227], v[164:167], v[36:39]
    ds_read_b64_tr_b16 a[250:251], v216 offset:2560
    s_add_u32 s63, s55, 18432
    v_mfma_f32_16x16x32_bf16 v[40:43], a[228:231], v[160:163], v[40:43]
    ds_read_b64_tr_b16 a[252:253], v217 offset:2048
    ds_read_b64_tr_b16 a[254:255], v217 offset:2560
    v_mfma_f32_16x16x32_bf16 v[44:47], a[228:231], v[164:167], v[44:47]
    ds_read_b64_tr_b16 a[216:217], v218 offset:2048
    v_permlane16_swap_b32 v248, v250
    v_permlane16_swap_b32 v249, v251
    s_waitcnt lgkmcnt(5)
L_back_step201:
    v_mfma_f32_16x16x32_bf16 v[16:19], a[232:235], v[168:171], v[16:19]
    buffer_store_dwordx4 v[248:251], v239, s[16:19], s63 offen offset:0 sc1
    v_accvgpr_read_b32 v240, a20
    v_mfma_f32_16x16x32_bf16 v[20:23], a[232:235], v[172:175], v[20:23]
    ds_read_b64_tr_b16 a[218:219], v218 offset:2560
    s_add_u32 s61, s50, 186752
    v_accvgpr_read_b32 v241, a21
    v_mfma_f32_16x16x32_bf16 v[24:27], a[236:239], v[168:171], v[24:27]
    ds_read_b64_tr_b16 a[220:221], v219 offset:2048
    ds_read_b64_tr_b16 a[222:223], v219 offset:2560
    v_accvgpr_read_b32 v242, a22
    v_mfma_f32_16x16x32_bf16 v[28:31], a[236:239], v[172:175], v[28:31]
    buffer_load_dwordx4 v236, s[24:27], s61 offen offset:2048 lds
    v_accvgpr_read_b32 v243, a23
    v_mfma_f32_16x16x32_bf16 v[32:35], a[240:243], v[168:171], v[32:35]
    ds_read_b64_tr_b16 a[224:225], v216 offset:3072
    v_cvt_pk_bf16_f32 v252, v240, v241
    v_mfma_f32_16x16x32_bf16 v[36:39], a[240:243], v[172:175], v[36:39]
    ds_read_b64_tr_b16 a[226:227], v216 offset:3584
    v_cvt_pk_bf16_f32 v253, v242, v243
    v_mfma_f32_16x16x32_bf16 v[40:43], a[244:247], v[168:171], v[40:43]
    ds_read_b64_tr_b16 a[228:229], v217 offset:3072
    v_accvgpr_read_b32 v240, a28
    v_mfma_f32_16x16x32_bf16 v[44:47], a[244:247], v[172:175], v[44:47]
    ds_read_b64_tr_b16 a[230:231], v217 offset:3584
    v_accvgpr_read_b32 v241, a29
    s_waitcnt lgkmcnt(4)
L_back_step202:
    v_mfma_f32_16x16x32_bf16 v[16:19], a[248:251], v[176:179], v[16:19]
    ds_read_b64_tr_b16 a[232:233], v218 offset:3072
    s_add_u32 s61, s50, 222592
    v_accvgpr_read_b32 v242, a30
    v_mfma_f32_16x16x32_bf16 v[20:23], a[248:251], v[180:183], v[20:23]
    ds_read_b64_tr_b16 a[234:235], v218 offset:3584
    ds_read_b64_tr_b16 a[236:237], v219 offset:3072
    v_accvgpr_read_b32 v243, a31
    v_mfma_f32_16x16x32_bf16 v[24:27], a[252:255], v[176:179], v[24:27]
    ds_read_b64_tr_b16 a[238:239], v219 offset:3584
    v_cvt_pk_bf16_f32 v254, v240, v241
    v_cvt_pk_bf16_f32 v255, v242, v243
    v_mfma_f32_16x16x32_bf16 v[28:31], a[252:255], v[180:183], v[28:31]
    buffer_load_dwordx4 v236, s[24:27], s61 offen offset:3072 lds
    v_mfma_f32_16x16x32_bf16 v[32:35], a[216:219], v[176:179], v[32:35]
    ds_read_b64_tr_b16 a[240:241], v216 offset:16384
    ds_read_b64_tr_b16 a[242:243], v216 offset:16896
    v_permlane16_swap_b32 v252, v254
    v_mfma_f32_16x16x32_bf16 v[36:39], a[216:219], v[180:183], v[36:39]
    v_permlane16_swap_b32 v253, v255
    v_mfma_f32_16x16x32_bf16 v[40:43], a[220:223], v[176:179], v[40:43]
    ds_read_b64_tr_b16 a[244:245], v217 offset:16384
    ds_read_b64_tr_b16 a[246:247], v217 offset:16896
    buffer_store_dwordx4 v[252:255], v239, s[16:19], s63 offen offset:1024 sc1
    v_accvgpr_read_b32 v240, a32
    v_mfma_f32_16x16x32_bf16 v[44:47], a[220:223], v[180:183], v[44:47]
    v_accvgpr_read_b32 v241, a33
    s_waitcnt lgkmcnt(4)
L_back_step203:
    v_mfma_f32_16x16x32_bf16 v[16:19], a[224:227], v[184:187], v[16:19]
    ds_read_b64_tr_b16 a[248:249], v218 offset:16384
    s_add_u32 m0, s60, 131072
    v_accvgpr_read_b32 v242, a34
    v_mfma_f32_16x16x32_bf16 v[20:23], a[224:227], v[188:191], v[20:23]
    ds_read_b64_tr_b16 a[250:251], v218 offset:16896
    s_add_u32 s61, s50, 262528
    v_accvgpr_read_b32 v243, a35
    v_mfma_f32_16x16x32_bf16 v[24:27], a[228:231], v[184:187], v[24:27]
    ds_read_b64_tr_b16 a[252:253], v219 offset:16384
    ds_read_b64_tr_b16 a[254:255], v219 offset:16896
    v_cvt_pk_bf16_f32 v248, v240, v241
    v_mfma_f32_16x16x32_bf16 v[28:31], a[228:231], v[188:191], v[28:31]
    buffer_load_dwordx4 v236, s[24:27], s61 offen offset:0 lds
    v_cvt_pk_bf16_f32 v249, v242, v243
    v_mfma_f32_16x16x32_bf16 v[32:35], a[232:235], v[184:187], v[32:35]
    ds_read_b64_tr_b16 a[216:217], v216 offset:17408
    v_accvgpr_read_b32 v240, a40
    v_mfma_f32_16x16x32_bf16 v[36:39], a[232:235], v[188:191], v[36:39]
    ds_read_b64_tr_b16 a[218:219], v216 offset:17920
    v_accvgpr_read_b32 v241, a41
    v_accvgpr_read_b32 v242, a42
    v_mfma_f32_16x16x32_bf16 v[40:43], a[236:239], v[184:187], v[40:43]
    ds_read_b64_tr_b16 a[220:221], v217 offset:17408
    v_accvgpr_read_b32 v243, a43
    v_mfma_f32_16x16x32_bf16 v[44:47], a[236:239], v[188:191], v[44:47]
    ds_read_b64_tr_b16 a[222:223], v217 offset:17920
    v_cvt_pk_bf16_f32 v250, v240, v241
    s_waitcnt lgkmcnt(4)
L_back_step204:
    v_mfma_f32_16x16x32_bf16 v[16:19], a[240:243], v[192:195], v[16:19]
    ds_read_b64_tr_b16 a[224:225], v218 offset:17408
    s_add_u32 s61, s51, 3456
    v_cvt_pk_bf16_f32 v251, v242, v243
    v_mfma_f32_16x16x32_bf16 v[20:23], a[240:243], v[196:199], v[20:23]
    ds_read_b64_tr_b16 a[226:227], v218 offset:17920
    ds_read_b64_tr_b16 a[228:229], v219 offset:17408
    s_add_u32 s63, s55, 2048
    v_mfma_f32_16x16x32_bf16 v[24:27], a[244:247], v[192:195], v[24:27]
    ds_read_b64_tr_b16 a[230:231], v219 offset:17920
    v_mfma_f32_16x16x32_bf16 v[28:31], a[244:247], v[196:199], v[28:31]
    buffer_load_dwordx4 v236, s[24:27], s61 offen offset:1024 lds
    v_permlane16_swap_b32 v248, v250
    v_mfma_f32_16x16x32_bf16 v[32:35], a[248:251], v[192:195], v[32:35]
    ds_read_b64_tr_b16 a[232:233], v216 offset:18432
    ds_read_b64_tr_b16 a[234:235], v216 offset:18944
    v_permlane16_swap_b32 v249, v251
    v_mfma_f32_16x16x32_bf16 v[36:39], a[248:251], v[196:199], v[36:39]
    buffer_store_dwordx4 v[248:251], v239, s[16:19], s63 offen offset:0 sc1
    v_accvgpr_read_b32 v240, a48
    v_mfma_f32_16x16x32_bf16 v[40:43], a[252:255], v[192:195], v[40:43]
    ds_read_b64_tr_b16 a[236:237], v217 offset:18432
    v_accvgpr_read_b32 v241, a49
    v_mfma_f32_16x16x32_bf16 v[44:47], a[252:255], v[196:199], v[44:47]
    ds_read_b64_tr_b16 a[238:239], v217 offset:18944
    v_accvgpr_read_b32 v242, a50
    s_waitcnt lgkmcnt(4)
L_back_step205:
    v_mfma_f32_16x16x32_bf16 v[16:19], a[216:219], v[200:203], v[16:19]
    ds_read_b64_tr_b16 a[240:241], v218 offset:18432
    s_add_u32 s61, s46, s45
    v_accvgpr_read_b32 v243, a51
    v_cvt_pk_bf16_f32 v252, v240, v241
    v_mfma_f32_16x16x32_bf16 v[20:23], a[216:219], v[204:207], v[20:23]
    ds_read_b64_tr_b16 a[242:243], v218 offset:18944
    s_add_u32 s61, s61, 2048
    v_cvt_pk_bf16_f32 v253, v242, v243
    v_mfma_f32_16x16x32_bf16 v[24:27], a[220:223], v[200:203], v[24:27]
    ds_read_b64_tr_b16 a[244:245], v219 offset:18432
    ds_read_b64_tr_b16 a[246:247], v219 offset:18944
    v_accvgpr_read_b32 v240, a56
    v_mfma_f32_16x16x32_bf16 v[28:31], a[220:223], v[204:207], v[28:31]
    buffer_load_dwordx4 v237, s[24:27], s61 offen offset:2048 lds
    v_accvgpr_read_b32 v241, a57
    v_mfma_f32_16x16x32_bf16 v[32:35], a[224:227], v[200:203], v[32:35]
    ds_read_b64_tr_b16 a[248:249], v216 offset:19456
    v_accvgpr_read_b32 v242, a58
    v_mfma_f32_16x16x32_bf16 v[36:39], a[224:227], v[204:207], v[36:39]
    ds_read_b64_tr_b16 a[250:251], v216 offset:19968
    v_accvgpr_read_b32 v243, a59
    v_mfma_f32_16x16x32_bf16 v[40:43], a[228:231], v[200:203], v[40:43]
    ds_read_b64_tr_b16 a[252:253], v217 offset:19456
    v_cvt_pk_bf16_f32 v254, v240, v241
    v_mfma_f32_16x16x32_bf16 v[44:47], a[228:231], v[204:207], v[44:47]
    ds_read_b64_tr_b16 a[254:255], v217 offset:19968
    v_cvt_pk_bf16_f32 v255, v242, v243
    s_waitcnt lgkmcnt(4)
L_back_step206:
    v_mfma_f32_16x16x32_bf16 v[16:19], a[232:235], v[208:211], v[16:19]
    ds_read_b64_tr_b16 a[216:217], v218 offset:19456
    ds_read_b64_tr_b16 a[218:219], v218 offset:19968
    v_mfma_f32_16x16x32_bf16 v[20:23], a[232:235], v[212:215], v[20:23]
    v_permlane16_swap_b32 v252, v254
    v_mfma_f32_16x16x32_bf16 v[24:27], a[236:239], v[208:211], v[24:27]
    ds_read_b64_tr_b16 a[220:221], v219 offset:19456
    ds_read_b64_tr_b16 a[222:223], v219 offset:19968
    v_permlane16_swap_b32 v253, v255
    buffer_store_dwordx4 v[252:255], v239, s[16:19], s63 offen offset:1024 sc1
    v_accvgpr_read_b32 v240, a36
    v_mfma_f32_16x16x32_bf16 v[28:31], a[236:239], v[212:215], v[28:31]
    s_add_u32 s61, s46, s45
    s_add_u32 s61, s61, 74752
    buffer_load_dwordx4 v237, s[24:27], s61 offen offset:3072 lds
    v_accvgpr_read_b32 v241, a37
    v_mfma_f32_16x16x32_bf16 v[32:35], a[240:243], v[208:211], v[32:35]
    s_barrier
    v_accvgpr_read_b32 v242, a38
    v_mfma_f32_16x16x32_bf16 v[36:39], a[240:243], v[212:215], v[36:39]
    ds_read_b64_tr_b16 a[224:225], v216 offset:32768
    ds_read_b64_tr_b16 a[226:227], v216 offset:33280
    v_accvgpr_read_b32 v243, a39
    v_mfma_f32_16x16x32_bf16 v[40:43], a[244:247], v[208:211], v[40:43]
    ds_read_b64_tr_b16 a[228:229], v217 offset:32768
    v_cvt_pk_bf16_f32 v248, v240, v241
    v_mfma_f32_16x16x32_bf16 v[44:47], a[244:247], v[212:215], v[44:47]
    ds_read_b64_tr_b16 a[230:231], v217 offset:33280
    v_cvt_pk_bf16_f32 v249, v242, v243
    s_waitcnt lgkmcnt(4)
L_back_step207:
    v_mfma_f32_16x16x32_bf16 v[16:19], a[248:251], a[144:147], v[16:19]
    ds_read_b64_tr_b16 a[232:233], v218 offset:32768
    s_add_u32 m0, s60, 147456
    v_accvgpr_read_b32 v240, a44
    v_mfma_f32_16x16x32_bf16 v[20:23], a[248:251], a[148:151], v[20:23]
    ds_read_b64_tr_b16 a[234:235], v218 offset:33280
    s_add_u32 s61, s46, s45
    v_accvgpr_read_b32 v241, a45
    v_mfma_f32_16x16x32_bf16 v[24:27], a[252:255], a[144:147], v[24:27]
    ds_read_b64_tr_b16 a[236:237], v219 offset:32768
    ds_read_b64_tr_b16 a[238:239], v219 offset:33280
    v_accvgpr_read_b32 v242, a46
    v_mfma_f32_16x16x32_bf16 v[28:31], a[252:255], a[148:151], v[28:31]
    s_add_u32 s61, s61, 151552
    buffer_load_dwordx4 v237, s[24:27], s61 offen offset:0 lds
    v_accvgpr_read_b32 v243, a47
    v_mfma_f32_16x16x32_bf16 v[32:35], a[216:219], a[144:147], v[32:35]
    ds_read_b64_tr_b16 a[240:241], v216 offset:33792
    v_cvt_pk_bf16_f32 v250, v240, v241
    v_mfma_f32_16x16x32_bf16 v[36:39], a[216:219], a[148:151], v[36:39]
    ds_read_b64_tr_b16 a[242:243], v216 offset:34304
    v_cvt_pk_bf16_f32 v251, v242, v243
    v_mfma_f32_16x16x32_bf16 v[40:43], a[220:223], a[144:147], v[40:43]
    ds_read_b64_tr_b16 a[244:245], v217 offset:33792
    s_add_u32 s63, s55, 20480
    v_mfma_f32_16x16x32_bf16 v[44:47], a[220:223], a[148:151], v[44:47]
    ds_read_b64_tr_b16 a[246:247], v217 offset:34304
    v_permlane16_swap_b32 v248, v250
    s_waitcnt lgkmcnt(4)
L_back_step208:
    v_mfma_f32_16x16x32_bf16 v[16:19], a[224:227], a[152:155], v[16:19]
    ds_read_b64_tr_b16 a[248:249], v218 offset:33792
    ds_read_b64_tr_b16 a[250:251], v218 offset:34304
    v_permlane16_swap_b32 v249, v251
    v_mfma_f32_16x16x32_bf16 v[20:23], a[224:227], a[156:159], v[20:23]
    buffer_store_dwordx4 v[248:251], v239, s[16:19], s63 offen offset:0 sc1
    v_accvgpr_read_b32 v240, a52
    v_mfma_f32_16x16x32_bf16 v[24:27], a[228:231], a[152:155], v[24:27]
    ds_read_b64_tr_b16 a[252:253], v219 offset:33792
    ds_read_b64_tr_b16 a[254:255], v219 offset:34304
    v_accvgpr_read_b32 v241, a53
    v_mfma_f32_16x16x32_bf16 v[28:31], a[228:231], a[156:159], v[28:31]
    s_add_u32 s61, s46, s45
    s_add_u32 s61, s61, 224256
    buffer_load_dwordx4 v237, s[24:27], s61 offen offset:1024 lds
    v_accvgpr_read_b32 v242, a54
    v_mfma_f32_16x16x32_bf16 v[32:35], a[232:235], a[152:155], v[32:35]
    ds_read_b64_tr_b16 a[216:217], v216 offset:34816
    v_accvgpr_read_b32 v243, a55
    v_mfma_f32_16x16x32_bf16 v[36:39], a[232:235], a[156:159], v[36:39]
    ds_read_b64_tr_b16 a[218:219], v216 offset:35328
    v_cvt_pk_bf16_f32 v252, v240, v241
    v_mfma_f32_16x16x32_bf16 v[40:43], a[236:239], a[152:155], v[40:43]
    ds_read_b64_tr_b16 a[220:221], v217 offset:34816
    v_cvt_pk_bf16_f32 v253, v242, v243
    v_mfma_f32_16x16x32_bf16 v[44:47], a[236:239], a[156:159], v[44:47]
    ds_read_b64_tr_b16 a[222:223], v217 offset:35328
    v_accvgpr_read_b32 v240, a60
    s_waitcnt lgkmcnt(4)
L_back_step209:
    v_mfma_f32_16x16x32_bf16 v[16:19], a[240:243], a[160:163], v[16:19]
    ds_read_b64_tr_b16 a[224:225], v218 offset:34816
    s_add_u32 s61, s48, 2048
    v_accvgpr_read_b32 v241, a61
    v_accvgpr_read_b32 v242, a62
    v_mfma_f32_16x16x32_bf16 v[20:23], a[240:243], a[164:167], v[20:23]
    ds_read_b64_tr_b16 a[226:227], v218 offset:35328
    s_add_u32 s44, s47, 2048
    v_accvgpr_read_b32 v243, a63
    v_mfma_f32_16x16x32_bf16 v[24:27], a[244:247], a[160:163], v[24:27]
    ds_read_b64_tr_b16 a[228:229], v219 offset:34816
    ds_read_b64_tr_b16 a[230:231], v219 offset:35328
    v_cvt_pk_bf16_f32 v254, v240, v241
    v_mfma_f32_16x16x32_bf16 v[28:31], a[244:247], a[164:167], v[28:31]
    s_cmp_lt_u32 s34, 2
    s_cselect_b32 s61, s61, s44
    buffer_load_dwordx4 v237, s[24:27], s61 offen offset:2048 lds
    v_cvt_pk_bf16_f32 v255, v242, v243
    v_mfma_f32_16x16x32_bf16 v[32:35], a[248:251], a[160:163], v[32:35]
    ds_read_b64_tr_b16 a[232:233], v216 offset:35840
    ds_read_b64_tr_b16 a[234:235], v216 offset:36352
    v_mfma_f32_16x16x32_bf16 v[36:39], a[248:251], a[164:167], v[36:39]
    v_permlane16_swap_b32 v252, v254
    v_mfma_f32_16x16x32_bf16 v[40:43], a[252:255], a[160:163], v[40:43]
    ds_read_b64_tr_b16 a[236:237], v217 offset:35840
    ds_read_b64_tr_b16 a[238:239], v217 offset:36352
    v_permlane16_swap_b32 v253, v255
    v_mfma_f32_16x16x32_bf16 v[44:47], a[252:255], a[164:167], v[44:47]
    ds_read_b64_tr_b16 a[240:241], v218 offset:35840
    buffer_store_dwordx4 v[252:255], v239, s[16:19], s63 offen offset:1024 sc1
    s_waitcnt lgkmcnt(5)
L_back_step210:
    v_mfma_f32_16x16x32_bf16 v[16:19], a[216:219], a[168:171], v[16:19]
    s_add_u32 s61, s47, s45
    s_add_u32 s61, s61, 37888
    v_mfma_f32_16x16x32_bf16 v[20:23], a[216:219], a[172:175], v[20:23]
    ds_read_b64_tr_b16 a[242:243], v218 offset:36352
    ds_read_b64_tr_b16 a[244:245], v219 offset:35840
    v_mfma_f32_16x16x32_bf16 v[24:27], a[220:223], a[168:171], v[24:27]
    ds_read_b64_tr_b16 a[246:247], v219 offset:36352
    v_mfma_f32_16x16x32_bf16 v[28:31], a[220:223], a[172:175], v[28:31]
    buffer_load_dwordx4 v237, s[24:27], s61 offen offset:3072 lds
    v_mfma_f32_16x16x32_bf16 v[32:35], a[224:227], a[168:171], v[32:35]
    ds_read_b64_tr_b16 a[248:249], v216 offset:49152
    ds_read_b64_tr_b16 a[250:251], v216 offset:49664
    v_mfma_f32_16x16x32_bf16 v[36:39], a[224:227], a[172:175], v[36:39]
    ds_read_b64_tr_b16 a[252:253], v217 offset:49152
    v_mfma_f32_16x16x32_bf16 v[40:43], a[228:231], a[168:171], v[40:43]
    ds_read_b64_tr_b16 a[254:255], v217 offset:49664
    v_mfma_f32_16x16x32_bf16 v[44:47], a[228:231], a[172:175], v[44:47]
    ds_read_b64_tr_b16 a[216:217], v218 offset:49152
    s_waitcnt lgkmcnt(5)
L_back_step211:
    v_mfma_f32_16x16x32_bf16 v[16:19], a[232:235], a[176:179], v[16:19]
    s_add_u32 m0, s60, 0
    s_add_u32 s61, s47, s45
    v_mfma_f32_16x16x32_bf16 v[20:23], a[232:235], a[180:183], v[20:23]
    ds_read_b64_tr_b16 a[218:219], v218 offset:49664
    s_add_u32 s61, s61, 114688
    v_mfma_f32_16x16x32_bf16 v[24:27], a[236:239], a[176:179], v[24:27]
    ds_read_b64_tr_b16 a[220:221], v219 offset:49152
    ds_read_b64_tr_b16 a[222:223], v219 offset:49664
    v_mfma_f32_16x16x32_bf16 v[28:31], a[236:239], a[180:183], v[28:31]
    buffer_load_dwordx4 v237, s[24:27], s61 offen offset:0 lds
    v_mfma_f32_16x16x32_bf16 v[32:35], a[240:243], a[176:179], v[32:35]
    ds_read_b64_tr_b16 a[224:225], v216 offset:50176
    ds_read_b64_tr_b16 a[226:227], v216 offset:50688
    v_mfma_f32_16x16x32_bf16 v[36:39], a[240:243], a[180:183], v[36:39]
    ds_read_b64_tr_b16 a[228:229], v217 offset:50176
    v_mfma_f32_16x16x32_bf16 v[40:43], a[244:247], a[176:179], v[40:43]
    ds_read_b64_tr_b16 a[230:231], v217 offset:50688
    v_mfma_f32_16x16x32_bf16 v[44:47], a[244:247], a[180:183], v[44:47]
    ds_read_b64_tr_b16 a[232:233], v218 offset:50176
    s_waitcnt lgkmcnt(5)
L_back_step212:
    v_mfma_f32_16x16x32_bf16 v[16:19], a[248:251], a[184:187], v[16:19]
    v_mfma_f32_16x16x32_bf16 v[20:23], a[248:251], a[188:191], v[20:23]
    ds_read_b64_tr_b16 a[234:235], v218 offset:50688
    s_add_u32 s61, s47, s45
    v_mfma_f32_16x16x32_bf16 v[24:27], a[252:255], a[184:187], v[24:27]
    ds_read_b64_tr_b16 a[236:237], v219 offset:50176
    ds_read_b64_tr_b16 a[238:239], v219 offset:50688
    v_mfma_f32_16x16x32_bf16 v[28:31], a[252:255], a[188:191], v[28:31]
    s_add_u32 s61, s61, 187392
    buffer_load_dwordx4 v237, s[24:27], s61 offen offset:1024 lds
    v_mfma_f32_16x16x32_bf16 v[32:35], a[216:219], a[184:187], v[32:35]
    ds_read_b64_tr_b16 a[240:241], v216 offset:51200
    s_lshr_b32 s40, s33, 1
    v_mfma_f32_16x16x32_bf16 v[36:39], a[216:219], a[188:191], v[36:39]
    ds_read_b64_tr_b16 a[242:243], v216 offset:51712
    s_and_b32 s41, s33, 1
    v_mfma_f32_16x16x32_bf16 v[40:43], a[220:223], a[184:187], v[40:43]
    ds_read_b64_tr_b16 a[244:245], v217 offset:51200
    v_lshrrev_b32 v6, 3, v1
    v_mfma_f32_16x16x32_bf16 v[44:47], a[220:223], a[188:191], v[44:47]
    ds_read_b64_tr_b16 a[246:247], v217 offset:51712
    s_waitcnt lgkmcnt(4)
L_back_step213:
    v_mfma_f32_16x16x32_bf16 v[16:19], a[224:227], a[192:195], v[16:19]
    ds_read_b64_tr_b16 a[248:249], v218 offset:51200
    s_add_u32 s61, s47, 260096
    v_mfma_f32_16x16x32_bf16 v[20:23], a[224:227], a[196:199], v[20:23]
    ds_read_b64_tr_b16 a[250:251], v218 offset:51712
    s_add_u32 s44, s49, 2048
    v_mfma_f32_16x16x32_bf16 v[24:27], a[228:231], a[192:195], v[24:27]
    ds_read_b64_tr_b16 a[252:253], v219 offset:51200
    ds_read_b64_tr_b16 a[254:255], v219 offset:51712
    v_mfma_f32_16x16x32_bf16 v[28:31], a[228:231], a[196:199], v[28:31]
    s_cmp_lt_u32 s34, 2
    s_cselect_b32 s61, s61, s44
    buffer_load_dwordx4 v237, s[24:27], s61 offen offset:2048 lds
    v_mfma_f32_16x16x32_bf16 v[32:35], a[232:235], a[192:195], v[32:35]
    ds_read_b64_tr_b16 a[216:217], v216 offset:52224
    v_and_b32 v7, 7, v1
    v_mfma_f32_16x16x32_bf16 v[36:39], a[232:235], a[196:199], v[36:39]
    ds_read_b64_tr_b16 a[218:219], v216 offset:52736
    v_lshlrev_b32 v4, 8, v6
    v_mfma_f32_16x16x32_bf16 v[40:43], a[236:239], a[192:195], v[40:43]
    ds_read_b64_tr_b16 a[220:221], v217 offset:52224
    v_lshl_add_u32 v4, v7, 4, v4
    v_mfma_f32_16x16x32_bf16 v[44:47], a[236:239], a[196:199], v[44:47]
    ds_read_b64_tr_b16 a[222:223], v217 offset:52736
    s_waitcnt lgkmcnt(4)
L_back_step214:
    v_mfma_f32_16x16x32_bf16 v[16:19], a[240:243], a[200:203], v[16:19]
    ds_read_b64_tr_b16 a[224:225], v218 offset:52224
    v_lshlrev_b32 v5, 5, v6
    v_mfma_f32_16x16x32_bf16 v[20:23], a[240:243], a[204:207], v[20:23]
    ds_read_b64_tr_b16 a[226:227], v218 offset:52736
    v_mul_u32_u24 v10, 1152, v7
    v_mfma_f32_16x16x32_bf16 v[24:27], a[244:247], a[200:203], v[24:27]
    ds_read_b64_tr_b16 a[228:229], v219 offset:52224
    ds_read_b64_tr_b16 a[230:231], v219 offset:52736
    v_mfma_f32_16x16x32_bf16 v[28:31], a[244:247], a[204:207], v[28:31]
    v_lshl_add_u32 v10, v6, 4, v10
    v_and_b32 v8, 15, v1
    v_mfma_f32_16x16x32_bf16 v[32:35], a[248:251], a[200:203], v[32:35]
    s_waitcnt vmcnt(27)
    s_barrier
    v_mfma_f32_16x16x32_bf16 v[36:39], a[248:251], a[204:207], v[36:39]
    ds_read_b64_tr_b16 a[232:233], v220 offset:0
    ds_read_b64_tr_b16 a[234:235], v220 offset:512
    v_mfma_f32_16x16x32_bf16 v[40:43], a[252:255], a[200:203], v[40:43]
    ds_read_b64_tr_b16 a[236:237], v221 offset:0
    v_lshlrev_b32 v8, 6, v8
    v_mfma_f32_16x16x32_bf16 v[44:47], a[252:255], a[204:207], v[44:47]
    ds_read_b64_tr_b16 a[238:239], v221 offset:512
    s_waitcnt lgkmcnt(4)
L_back_step215:
    v_mfma_f32_16x16x32_bf16 v[16:19], a[216:219], a[208:211], v[16:19]
    ds_read_b64_tr_b16 a[240:241], v222 offset:0
    s_lshl_b32 s43, s32, 3
    v_mfma_f32_16x16x32_bf16 v[20:23], a[216:219], a[212:215], v[20:23]
    ds_read_b64_tr_b16 a[242:243], v222 offset:512
    s_add_u32 s43, s43, s40
    v_mfma_f32_16x16x32_bf16 v[24:27], a[220:223], a[208:211], v[24:27]
    ds_read_b64_tr_b16 a[244:245], v223 offset:0
    ds_read_b64_tr_b16 a[246:247], v223 offset:512
    v_mfma_f32_16x16x32_bf16 v[28:31], a[220:223], a[212:215], v[28:31]
    s_mul_i32 s96, s43, 18432
    s_lshl_b32 s97, s41, 7
    v_mfma_f32_16x16x32_bf16 v[32:35], a[224:227], a[208:211], v[32:35]
    ds_read_b64_tr_b16 a[248:249], v220 offset:1024
    s_add_u32 s96, s96, s97
    v_mfma_f32_16x16x32_bf16 v[36:39], a[224:227], a[212:215], v[36:39]
    ds_read_b64_tr_b16 a[250:251], v220 offset:1536
    s_add_u32 s96, s96, 9170176
    v_mfma_f32_16x16x32_bf16 v[40:43], a[228:231], a[208:211], v[40:43]
    ds_read_b64_tr_b16 a[252:253], v221 offset:1024
    s_mul_i32 s98, s32, 1179648
    v_mfma_f32_16x16x32_bf16 v[44:47], a[228:231], a[212:215], v[44:47]
    ds_read_b64_tr_b16 a[254:255], v221 offset:1536
    s_waitcnt lgkmcnt(4)
L_back_step216:
    v_mfma_f32_16x16x32_bf16 v[48:51], a[232:235], v[144:147], 0
    ds_read_b64_tr_b16 a[216:217], v222 offset:1024
    s_mul_i32 s99, s40, 18432
    v_mfma_f32_16x16x32_bf16 v[52:55], a[232:235], v[148:151], 0
    ds_read_b64_tr_b16 a[218:219], v222 offset:1536
    s_add_u32 s98, s98, s99
    v_mfma_f32_16x16x32_bf16 v[56:59], a[236:239], v[144:147], 0
    ds_read_b64_tr_b16 a[220:221], v223 offset:1024
    ds_read_b64_tr_b16 a[222:223], v223 offset:1536
    v_mfma_f32_16x16x32_bf16 v[60:63], a[236:239], v[148:151], 0
    s_add_u32 s98, s98, s97
    s_add_u32 s98, s98, 16248064
    v_mfma_f32_16x16x32_bf16 v[64:67], a[240:243], v[144:147], 0
    ds_read_b64_tr_b16 a[224:225], v220 offset:2048
    s_lshl_b32 s99, s43, 4
    v_mfma_f32_16x16x32_bf16 v[68:71], a[240:243], v[148:151], 0
    ds_read_b64_tr_b16 a[226:227], v220 offset:2560
    s_lshl_b32 s100, s41, 3
    v_mfma_f32_16x16x32_bf16 v[72:75], a[244:247], v[144:147], 0
    ds_read_b64_tr_b16 a[228:229], v221 offset:2048
    s_add_u32 s99, s99, s100
    v_cvt_pk_bf16_f32 v248, v16, v17
    v_mfma_f32_16x16x32_bf16 v[76:79], a[244:247], v[148:151], 0
    ds_read_b64_tr_b16 a[230:231], v221 offset:2560
    s_waitcnt lgkmcnt(4)
L_back_step217:
    v_mfma_f32_16x16x32_bf16 v[48:51], a[248:251], v[152:155], v[48:51]
    ds_read_b64_tr_b16 a[232:233], v222 offset:2048
    s_mul_i32 s99, s99, 1152
    v_cvt_pk_bf16_f32 v249, v18, v19
    v_mfma_f32_16x16x32_bf16 v[52:55], a[248:251], v[156:159], v[52:55]
    ds_read_b64_tr_b16 a[234:235], v222 offset:2560
    s_lshl_b32 s100, s34, 2
    v_mfma_f32_16x16x32_bf16 v[56:59], a[252:255], v[152:155], v[56:59]
    ds_read_b64_tr_b16 a[236:237], v223 offset:2048
    ds_read_b64_tr_b16 a[238:239], v223 offset:2560
    v_cvt_pk_bf16_f32 v250, v24, v25
    v_mfma_f32_16x16x32_bf16 v[60:63], a[252:255], v[156:159], v[60:63]
    s_lshr_b32 s52, 0x6510, s100
    s_and_b32 s52, s52, 15
    v_mfma_f32_16x16x32_bf16 v[64:67], a[216:219], v[152:155], v[64:67]
    ds_read_b64_tr_b16 a[240:241], v220 offset:3072
    s_lshr_b32 s53, 0x0072, s100
    v_cvt_pk_bf16_f32 v251, v26, v27
    v_mfma_f32_16x16x32_bf16 v[68:71], a[216:219], v[156:159], v[68:71]
    ds_read_b64_tr_b16 a[242:243], v220 offset:3584
    s_and_b32 s53, s53, 15
    v_mfma_f32_16x16x32_bf16 v[72:75], a[220:223], v[152:155], v[72:75]
    ds_read_b64_tr_b16 a[244:245], v221 offset:3072
    s_lshr_b32 s58, 0x4308, s100
    s_add_u32 s63, s55, 4096
    v_mfma_f32_16x16x32_bf16 v[76:79], a[220:223], v[156:159], v[76:79]
    s_waitcnt vmcnt(4)
    v_mov_b32 v3, 1
    s_mov_b64 exec, 1
    buffer_store_dword v3, v15, s[16:19], s3 offen sc1
    s_mov_b64 exec, -1
    s_waitcnt lgkmcnt(3)
L_back_step218:
    v_mfma_f32_16x16x32_bf16 v[48:51], a[224:227], v[160:163], v[48:51]
    ds_read_b64_tr_b16 a[246:247], v221 offset:3584
    ds_read_b64_tr_b16 a[248:249], v222 offset:3072
    v_mfma_f32_16x16x32_bf16 v[52:55], a[224:227], v[164:167], v[52:55]
    ds_read_b64_tr_b16 a[250:251], v222 offset:3584
    ds_read_b64_tr_b16 a[252:253], v223 offset:3072
    v_mfma_f32_16x16x32_bf16 v[56:59], a[228:231], v[160:163], v[56:59]
    ds_read_b64_tr_b16 a[254:255], v223 offset:3584
    s_and_b32 s58, s58, 15
    v_mfma_f32_16x16x32_bf16 v[60:63], a[228:231], v[164:167], v[60:63]
    v_permlane16_swap_b32 v248, v250
    v_mfma_f32_16x16x32_bf16 v[64:67], a[232:235], v[160:163], v[64:67]
    ds_read_b64_tr_b16 a[216:217], v220 offset:16384
    ds_read_b64_tr_b16 a[218:219], v220 offset:16896
    v_mfma_f32_16x16x32_bf16 v[68:71], a[232:235], v[164:167], v[68:71]
    v_permlane16_swap_b32 v249, v251
    v_mfma_f32_16x16x32_bf16 v[72:75], a[236:239], v[160:163], v[72:75]
    ds_read_b64_tr_b16 a[220:221], v221 offset:16384
    ds_read_b64_tr_b16 a[222:223], v221 offset:16896
    v_mfma_f32_16x16x32_bf16 v[76:79], a[236:239], v[164:167], v[76:79]
    ds_read_b64_tr_b16 a[224:225], v222 offset:16384
    buffer_store_dwordx4 v[248:251], v239, s[16:19], s63 offen offset:0 sc1
    v_cvt_pk_bf16_f32 v252, v32, v33
    s_waitcnt lgkmcnt(5)
L_back_step219:
    v_mfma_f32_16x16x32_bf16 v[48:51], a[240:243], v[168:171], v[48:51]
    s_movk_i32 s56, 0x3f80
    s_mov_b32 s57, 0x3f800000
    v_mfma_f32_16x16x32_bf16 v[52:55], a[240:243], v[172:175], v[52:55]
    ds_read_b64_tr_b16 a[226:227], v222 offset:16896
    s_mov_b32 s59, 0xbf317218
    v_cvt_pk_bf16_f32 v253, v34, v35
    v_mfma_f32_16x16x32_bf16 v[56:59], a[244:247], v[168:171], v[56:59]
    ds_read_b64_tr_b16 a[228:229], v223 offset:16384
    ds_read_b64_tr_b16 a[230:231], v223 offset:16896
    v_mfma_f32_16x16x32_bf16 v[60:63], a[244:247], v[172:175], v[60:63]
    s_mov_b32 s12, s82
    s_mov_b32 s13, s83
    v_cvt_pk_bf16_f32 v254, v40, v41
    v_mfma_f32_16x16x32_bf16 v[64:67], a[248:251], v[168:171], v[64:67]
    ds_read_b64_tr_b16 a[232:233], v220 offset:17408
    s_mov_b32 s14, 2359296
    v_mfma_f32_16x16x32_bf16 v[68:71], a[248:251], v[172:175], v[68:71]
    ds_read_b64_tr_b16 a[234:235], v220 offset:17920
    s_mov_b32 s15, 0x20000
    v_cvt_pk_bf16_f32 v255, v42, v43
    v_mfma_f32_16x16x32_bf16 v[72:75], a[252:255], v[168:171], v[72:75]
    ds_read_b64_tr_b16 a[236:237], v221 offset:17408
    ds_read_b64_tr_b16 a[238:239], v221 offset:17920
    v_mfma_f32_16x16x32_bf16 v[76:79], a[252:255], v[172:175], v[76:79]
    ds_read_b64_tr_b16 a[240:241], v222 offset:17408
    s_waitcnt lgkmcnt(5)
L_back_step220:
    v_mfma_f32_16x16x32_bf16 v[48:51], a[216:219], v[176:179], v[48:51]
    v_permlane16_swap_b32 v252, v254
    v_mfma_f32_16x16x32_bf16 v[52:55], a[216:219], v[180:183], v[52:55]
    ds_read_b64_tr_b16 a[242:243], v222 offset:17920
    ds_read_b64_tr_b16 a[244:245], v223 offset:17408
    v_mfma_f32_16x16x32_bf16 v[56:59], a[220:223], v[176:179], v[56:59]
    ds_read_b64_tr_b16 a[246:247], v223 offset:17920
    s_mul_i32 s97, s32, 2304
    v_mfma_f32_16x16x32_bf16 v[60:63], a[220:223], v[180:183], v[60:63]
    v_permlane16_swap_b32 v253, v255
    v_mfma_f32_16x16x32_bf16 v[64:67], a[224:227], v[176:179], v[64:67]
    ds_read_b64_tr_b16 a[248:249], v220 offset:18432
    ds_read_b64_tr_b16 a[250:251], v220 offset:18944
    v_mfma_f32_16x16x32_bf16 v[68:71], a[224:227], v[180:183], v[68:71]
    buffer_store_dwordx4 v[252:255], v239, s[16:19], s63 offen offset:1024 sc1
    v_mfma_f32_16x16x32_bf16 v[72:75], a[228:231], v[176:179], v[72:75]
    ds_read_b64_tr_b16 a[252:253], v221 offset:18432
    s_add_u32 s97, s97, 1120512
    v_cvt_pk_bf16_f32 v248, v20, v21
    v_mfma_f32_16x16x32_bf16 v[76:79], a[228:231], v[180:183], v[76:79]
    ds_read_b64_tr_b16 a[254:255], v221 offset:18944
    s_waitcnt lgkmcnt(4)
L_back_step221:
    v_mfma_f32_16x16x32_bf16 v[48:51], a[232:235], v[184:187], v[48:51]
    ds_read_b64_tr_b16 a[216:217], v222 offset:18432
    v_cvt_pk_bf16_f32 v249, v22, v23
    v_mfma_f32_16x16x32_bf16 v[52:55], a[232:235], v[188:191], v[52:55]
    ds_read_b64_tr_b16 a[218:219], v222 offset:18944
    v_cvt_pk_bf16_f32 v250, v28, v29
    v_mfma_f32_16x16x32_bf16 v[56:59], a[236:239], v[184:187], v[56:59]
    ds_read_b64_tr_b16 a[220:221], v223 offset:18432
    ds_read_b64_tr_b16 a[222:223], v223 offset:18944
    v_mfma_f32_16x16x32_bf16 v[60:63], a[236:239], v[188:191], v[60:63]
    v_cvt_pk_bf16_f32 v251, v30, v31
    s_add_u32 s63, s55, 22528
    v_mfma_f32_16x16x32_bf16 v[64:67], a[240:243], v[184:187], v[64:67]
    ds_read_b64_tr_b16 a[224:225], v220 offset:19456
    ds_read_b64_tr_b16 a[226:227], v220 offset:19968
    v_mfma_f32_16x16x32_bf16 v[68:71], a[240:243], v[188:191], v[68:71]
    v_permlane16_swap_b32 v248, v250
    v_mfma_f32_16x16x32_bf16 v[72:75], a[244:247], v[184:187], v[72:75]
    ds_read_b64_tr_b16 a[228:229], v221 offset:19456
    ds_read_b64_tr_b16 a[230:231], v221 offset:19968
    v_mfma_f32_16x16x32_bf16 v[76:79], a[244:247], v[188:191], v[76:79]
    ds_read_b64_tr_b16 a[232:233], v222 offset:19456
    s_waitcnt lgkmcnt(5)
L_back_step222:
    v_mfma_f32_16x16x32_bf16 v[48:51], a[248:251], v[192:195], v[48:51]
    v_permlane16_swap_b32 v249, v251
    v_mfma_f32_16x16x32_bf16 v[52:55], a[248:251], v[196:199], v[52:55]
    ds_read_b64_tr_b16 a[234:235], v222 offset:19968
    ds_read_b64_tr_b16 a[236:237], v223 offset:19456
    v_mfma_f32_16x16x32_bf16 v[56:59], a[252:255], v[192:195], v[56:59]
    ds_read_b64_tr_b16 a[238:239], v223 offset:19968
    v_mfma_f32_16x16x32_bf16 v[60:63], a[252:255], v[196:199], v[60:63]
    buffer_store_dwordx4 v[248:251], v239, s[16:19], s63 offen offset:0 sc1
    v_mfma_f32_16x16x32_bf16 v[64:67], a[216:219], v[192:195], v[64:67]
    s_barrier
    v_mfma_f32_16x16x32_bf16 v[68:71], a[216:219], v[196:199], v[68:71]
    ds_read_b64_tr_b16 a[240:241], v220 offset:32768
    ds_read_b64_tr_b16 a[242:243], v220 offset:33280
    v_cvt_pk_bf16_f32 v252, v36, v37
    v_mfma_f32_16x16x32_bf16 v[72:75], a[220:223], v[192:195], v[72:75]
    ds_read_b64_tr_b16 a[244:245], v221 offset:32768
    v_cvt_pk_bf16_f32 v253, v38, v39
    v_mfma_f32_16x16x32_bf16 v[76:79], a[220:223], v[196:199], v[76:79]
    ds_read_b64_tr_b16 a[246:247], v221 offset:33280
    s_waitcnt lgkmcnt(4)
L_back_step223:
    v_mfma_f32_16x16x32_bf16 v[48:51], a[224:227], v[200:203], v[48:51]
    v_mfma_f32_16x16x32_bf16 v[52:55], a[224:227], v[204:207], v[52:55]
    ds_read_b64_tr_b16 a[248:249], v222 offset:32768
    ds_read_b64_tr_b16 a[250:251], v222 offset:33280
    v_cvt_pk_bf16_f32 v254, v44, v45
    v_mfma_f32_16x16x32_bf16 v[56:59], a[228:231], v[200:203], v[56:59]
    ds_read_b64_tr_b16 a[252:253], v223 offset:32768
    ds_read_b64_tr_b16 a[254:255], v223 offset:33280
    v_mfma_f32_16x16x32_bf16 v[60:63], a[228:231], v[204:207], v[60:63]
    s_lshl_b32 s50, s52, 11
    s_add_u32 s51, s96, s50
    buffer_load_dwordx4 v[96:99], v4, s[16:19], s51 offen sc1
    v_mfma_f32_16x16x32_bf16 v[64:67], a[232:235], v[200:203], v[64:67]
    ds_read_b64_tr_b16 a[216:217], v220 offset:33792
    s_lshl_b32 s51, s52, 8
    v_cvt_pk_bf16_f32 v255, v46, v47
    v_mfma_f32_16x16x32_bf16 v[68:71], a[232:235], v[204:207], v[68:71]
    ds_read_b64_tr_b16 a[218:219], v220 offset:34304
    ds_read_b64_tr_b16 a[220:221], v221 offset:33792
    v_mfma_f32_16x16x32_bf16 v[72:75], a[236:239], v[200:203], v[72:75]
    v_permlane16_swap_b32 v252, v254
    v_mfma_f32_16x16x32_bf16 v[76:79], a[236:239], v[204:207], v[76:79]
    ds_read_b64_tr_b16 a[222:223], v221 offset:34304
    s_waitcnt lgkmcnt(4)
L_back_step224:
    v_mfma_f32_16x16x32_bf16 v[48:51], a[240:243], v[208:211], v[48:51]
    ds_read_b64_tr_b16 a[224:225], v222 offset:33792
    ds_read_b64_tr_b16 a[226:227], v222 offset:34304
    v_mfma_f32_16x16x32_bf16 v[52:55], a[240:243], v[212:215], v[52:55]
    v_permlane16_swap_b32 v253, v255
    v_mfma_f32_16x16x32_bf16 v[56:59], a[244:247], v[208:211], v[56:59]
    ds_read_b64_tr_b16 a[228:229], v223 offset:33792
    ds_read_b64_tr_b16 a[230:231], v223 offset:34304
    v_mfma_f32_16x16x32_bf16 v[60:63], a[244:247], v[212:215], v[60:63]
    buffer_store_dwordx4 v[252:255], v239, s[16:19], s63 offen offset:1024 sc1
    v_mfma_f32_16x16x32_bf16 v[64:67], a[248:251], v[208:211], v[64:67]
    ds_read_b64_tr_b16 a[232:233], v220 offset:34816
    s_add_u32 s51, s51, 11520
    buffer_load_dwordx4 v[100:103], v5, s[16:19], s51 offen
    v_mfma_f32_16x16x32_bf16 v[68:71], a[248:251], v[212:215], v[68:71]
    ds_read_b64_tr_b16 a[234:235], v220 offset:35328
    ds_read_b64_tr_b16 a[236:237], v221 offset:34816
    v_mfma_f32_16x16x32_bf16 v[72:75], a[252:255], v[208:211], v[72:75]
    ds_read_b64_tr_b16 a[238:239], v221 offset:35328
    v_mfma_f32_16x16x32_bf16 v[76:79], a[252:255], v[212:215], v[76:79]
    ds_read_b64_tr_b16 a[240:241], v222 offset:34816
    s_waitcnt lgkmcnt(5)
L_back_step225:
    v_mfma_f32_16x16x32_bf16 v[48:51], a[216:219], a[144:147], v[48:51]
    buffer_load_dwordx4 v[104:107], v5, s[16:19], s51 offen offset:16
    v_mfma_f32_16x16x32_bf16 v[52:55], a[216:219], a[148:151], v[52:55]
    ds_read_b64_tr_b16 a[242:243], v222 offset:35328
    s_lshl_b32 s50, s53, 11
    v_mfma_f32_16x16x32_bf16 v[56:59], a[220:223], a[144:147], v[56:59]
    ds_read_b64_tr_b16 a[244:245], v223 offset:34816
    ds_read_b64_tr_b16 a[246:247], v223 offset:35328
    v_mfma_f32_16x16x32_bf16 v[60:63], a[220:223], a[148:151], v[60:63]
    s_add_u32 s51, s96, s50
    ds_read_b64_tr_b16 a[248:249], v220 offset:35840
    v_mfma_f32_16x16x32_bf16 v[64:67], a[224:227], a[144:147], v[64:67]
    buffer_load_dwordx4 v[108:111], v4, s[16:19], s51 offen sc1
    v_mfma_f32_16x16x32_bf16 v[68:71], a[224:227], a[148:151], v[68:71]
    ds_read_b64_tr_b16 a[250:251], v220 offset:36352
    s_lshl_b32 s51, s53, 8
    v_mfma_f32_16x16x32_bf16 v[72:75], a[228:231], a[144:147], v[72:75]
    ds_read_b64_tr_b16 a[252:253], v221 offset:35840
    s_add_u32 s51, s51, 11520
    v_mfma_f32_16x16x32_bf16 v[76:79], a[228:231], a[148:151], v[76:79]
    ds_read_b64_tr_b16 a[254:255], v221 offset:36352
    s_waitcnt lgkmcnt(4)
L_back_step226:
    v_mfma_f32_16x16x32_bf16 v[48:51], a[232:235], a[152:155], v[48:51]
    ds_read_b64_tr_b16 a[216:217], v222 offset:35840
    ds_read_b64_tr_b16 a[218:219], v222 offset:36352
    v_mfma_f32_16x16x32_bf16 v[52:55], a[232:235], a[156:159], v[52:55]
    buffer_load_dwordx4 v[112:115], v5, s[16:19], s51 offen
    v_mfma_f32_16x16x32_bf16 v[56:59], a[236:239], a[152:155], v[56:59]
    ds_read_b64_tr_b16 a[220:221], v223 offset:35840
    ds_read_b64_tr_b16 a[222:223], v223 offset:36352
    v_mfma_f32_16x16x32_bf16 v[60:63], a[236:239], a[156:159], v[60:63]
    ds_read_b64_tr_b16 a[224:225], v220 offset:49152
    v_mfma_f32_16x16x32_bf16 v[64:67], a[240:243], a[152:155], v[64:67]
    ds_read_b64_tr_b16 a[226:227], v220 offset:49664
    v_mfma_f32_16x16x32_bf16 v[68:71], a[240:243], a[156:159], v[68:71]
    buffer_load_dwordx4 v[116:119], v5, s[16:19], s51 offen offset:16
    v_mfma_f32_16x16x32_bf16 v[72:75], a[244:247], a[152:155], v[72:75]
    ds_read_b64_tr_b16 a[228:229], v221 offset:49152
    s_lshl_b32 s50, s58, 11
    v_mfma_f32_16x16x32_bf16 v[76:79], a[244:247], a[156:159], v[76:79]
    ds_read_b64_tr_b16 a[230:231], v221 offset:49664
    s_waitcnt lgkmcnt(4)
L_back_step227:
    v_mfma_f32_16x16x32_bf16 v[48:51], a[248:251], a[160:163], v[48:51]
    ds_read_b64_tr_b16 a[232:233], v222 offset:49152
    s_add_u32 s51, s96, s50
    v_mfma_f32_16x16x32_bf16 v[52:55], a[248:251], a[164:167], v[52:55]
    ds_read_b64_tr_b16 a[234:235], v222 offset:49664
    ds_read_b64_tr_b16 a[236:237], v223 offset:49152
    v_mfma_f32_16x16x32_bf16 v[56:59], a[252:255], a[160:163], v[56:59]
    ds_read_b64_tr_b16 a[238:239], v223 offset:49664
    v_mfma_f32_16x16x32_bf16 v[60:63], a[252:255], a[164:167], v[60:63]
    buffer_load_dwordx4 v[120:123], v4, s[16:19], s51 offen sc1
    v_mfma_f32_16x16x32_bf16 v[64:67], a[216:219], a[160:163], v[64:67]
    ds_read_b64_tr_b16 a[240:241], v220 offset:50176
    s_lshl_b32 s51, s58, 8
    v_mfma_f32_16x16x32_bf16 v[68:71], a[216:219], a[164:167], v[68:71]
    ds_read_b64_tr_b16 a[242:243], v220 offset:50688
    s_add_u32 s51, s51, 11520
    v_mfma_f32_16x16x32_bf16 v[72:75], a[220:223], a[160:163], v[72:75]
    ds_read_b64_tr_b16 a[244:245], v221 offset:50176
    ds_read_b64_tr_b16 a[246:247], v221 offset:50688
    v_mfma_f32_16x16x32_bf16 v[76:79], a[220:223], a[164:167], v[76:79]
    ds_read_b64_tr_b16 a[248:249], v222 offset:50176
    s_waitcnt lgkmcnt(5)
L_back_step228:
    v_mfma_f32_16x16x32_bf16 v[48:51], a[224:227], a[168:171], v[48:51]
    buffer_load_dwordx4 v[124:127], v5, s[16:19], s51 offen
    v_mfma_f32_16x16x32_bf16 v[52:55], a[224:227], a[172:175], v[52:55]
    ds_read_b64_tr_b16 a[250:251], v222 offset:50688
    ds_read_b64_tr_b16 a[252:253], v223 offset:50176
    v_mfma_f32_16x16x32_bf16 v[56:59], a[228:231], a[168:171], v[56:59]
    ds_read_b64_tr_b16 a[254:255], v223 offset:50688
    v_mfma_f32_16x16x32_bf16 v[60:63], a[228:231], a[172:175], v[60:63]
    ds_read_b64_tr_b16 a[216:217], v220 offset:51200
    v_mfma_f32_16x16x32_bf16 v[64:67], a[232:235], a[168:171], v[64:67]
    buffer_load_dwordx4 v[128:131], v5, s[16:19], s51 offen offset:16
    v_mfma_f32_16x16x32_bf16 v[68:71], a[232:235], a[172:175], v[68:71]
    ds_read_b64_tr_b16 a[218:219], v220 offset:51712
    ds_read_b64_tr_b16 a[220:221], v221 offset:51200
    v_mfma_f32_16x16x32_bf16 v[72:75], a[236:239], a[168:171], v[72:75]
    ds_read_b64_tr_b16 a[222:223], v221 offset:51712
    v_mfma_f32_16x16x32_bf16 v[76:79], a[236:239], a[172:175], v[76:79]
    ds_read_b64_tr_b16 a[224:225], v222 offset:51200
    s_waitcnt lgkmcnt(5)
L_back_step229:
    v_mfma_f32_16x16x32_bf16 v[48:51], a[240:243], a[176:179], v[48:51]
    ds_read_b64_tr_b16 a[226:227], v222 offset:51712
    v_mfma_f32_16x16x32_bf16 v[52:55], a[240:243], a[180:183], v[52:55]
    ds_read_b64_tr_b16 a[228:229], v223 offset:51200
    v_mfma_f32_16x16x32_bf16 v[56:59], a[244:247], a[176:179], v[56:59]
    ds_read_b64_tr_b16 a[230:231], v223 offset:51712
    buffer_load_dword v9, v8, s[16:19], s4 offen sc1
    v_mfma_f32_16x16x32_bf16 v[60:63], a[244:247], a[180:183], v[60:63]
    ds_read_b64_tr_b16 a[232:233], v220 offset:52224
    v_mfma_f32_16x16x32_bf16 v[64:67], a[248:251], a[176:179], v[64:67]
    ds_read_b64_tr_b16 a[234:235], v220 offset:52736
    v_mfma_f32_16x16x32_bf16 v[68:71], a[248:251], a[180:183], v[68:71]
    ds_read_b64_tr_b16 a[236:237], v221 offset:52224
    v_mfma_f32_16x16x32_bf16 v[72:75], a[252:255], a[176:179], v[72:75]
    ds_read_b64_tr_b16 a[238:239], v221 offset:52736
    v_mfma_f32_16x16x32_bf16 v[76:79], a[252:255], a[180:183], v[76:79]
    ds_read_b64_tr_b16 a[240:241], v222 offset:52224
    s_waitcnt lgkmcnt(5)
L_back_step230:
    v_mfma_f32_16x16x32_bf16 v[48:51], a[216:219], a[184:187], v[48:51]
    ds_read_b64_tr_b16 a[242:243], v222 offset:52736
    v_mfma_f32_16x16x32_bf16 v[52:55], a[216:219], a[188:191], v[52:55]
    ds_read_b64_tr_b16 a[244:245], v223 offset:52224
    v_mfma_f32_16x16x32_bf16 v[56:59], a[220:223], a[184:187], v[56:59]
    ds_read_b64_tr_b16 a[246:247], v223 offset:52736
    v_mfma_f32_16x16x32_bf16 v[60:63], a[220:223], a[188:191], v[60:63]
    v_mfma_f32_16x16x32_bf16 v[64:67], a[224:227], a[184:187], v[64:67]
    s_waitcnt vmcnt(18)
    s_barrier
    v_mfma_f32_16x16x32_bf16 v[68:71], a[224:227], a[188:191], v[68:71]
    ds_read_b64_tr_b16 a[248:249], v224 offset:0
    ds_read_b64_tr_b16 a[250:251], v224 offset:512
    v_mfma_f32_16x16x32_bf16 v[72:75], a[228:231], a[184:187], v[72:75]
    ds_read_b64_tr_b16 a[252:253], v225 offset:0
    ds_read_b64_tr_b16 a[254:255], v225 offset:512
    v_mfma_f32_16x16x32_bf16 v[76:79], a[228:231], a[188:191], v[76:79]
    ds_read_b64_tr_b16 a[216:217], v226 offset:0
    s_waitcnt lgkmcnt(5)
L_back_step231:
    v_mfma_f32_16x16x32_bf16 v[48:51], a[232:235], a[192:195], v[48:51]
    ds_read_b64_tr_b16 a[218:219], v226 offset:512
    v_mfma_f32_16x16x32_bf16 v[52:55], a[232:235], a[196:199], v[52:55]
    ds_read_b64_tr_b16 a[220:221], v227 offset:0
    v_mfma_f32_16x16x32_bf16 v[56:59], a[236:239], a[192:195], v[56:59]
    ds_read_b64_tr_b16 a[222:223], v227 offset:512
    v_mfma_f32_16x16x32_bf16 v[60:63], a[236:239], a[196:199], v[60:63]
    ds_read_b64_tr_b16 a[224:225], v224 offset:1024
    v_mfma_f32_16x16x32_bf16 v[64:67], a[240:243], a[192:195], v[64:67]
    ds_read_b64_tr_b16 a[226:227], v224 offset:1536
    v_mfma_f32_16x16x32_bf16 v[68:71], a[240:243], a[196:199], v[68:71]
    ds_read_b64_tr_b16 a[228:229], v225 offset:1024
    v_mfma_f32_16x16x32_bf16 v[72:75], a[244:247], a[192:195], v[72:75]
    ds_read_b64_tr_b16 a[230:231], v225 offset:1536
    v_mfma_f32_16x16x32_bf16 v[76:79], a[244:247], a[196:199], v[76:79]
    ds_read_b64_tr_b16 a[232:233], v226 offset:1024
    s_waitcnt lgkmcnt(5)
L_back_step232:
    v_mfma_f32_16x16x32_bf16 v[48:51], a[248:251], a[200:203], v[48:51]
    ds_read_b64_tr_b16 a[234:235], v226 offset:1536
    v_mfma_f32_16x16x32_bf16 v[52:55], a[248:251], a[204:207], v[52:55]
    ds_read_b64_tr_b16 a[236:237], v227 offset:1024
    v_mfma_f32_16x16x32_bf16 v[56:59], a[252:255], a[200:203], v[56:59]
    ds_read_b64_tr_b16 a[238:239], v227 offset:1536
    v_mfma_f32_16x16x32_bf16 v[60:63], a[252:255], a[204:207], v[60:63]
    ds_read_b64_tr_b16 a[240:241], v232 offset:2048
    v_mfma_f32_16x16x32_bf16 v[64:67], a[216:219], a[200:203], v[64:67]
    ds_read_b64_tr_b16 a[242:243], v232 offset:2304
    v_mfma_f32_16x16x32_bf16 v[68:71], a[216:219], a[204:207], v[68:71]
    s_waitcnt vmcnt(8)
    v_mov_b32 v3, 2
    s_mov_b64 exec, 1
    buffer_store_dword v3, v15, s[16:19], s3 offen sc1
    s_mov_b64 exec, -1
    v_mfma_f32_16x16x32_bf16 v[72:75], a[220:223], a[200:203], v[72:75]
    ds_read_b64_tr_b16 a[244:245], v233 offset:2048
    ds_read_b64_tr_b16 a[246:247], v233 offset:2304
    v_mfma_f32_16x16x32_bf16 v[76:79], a[220:223], a[204:207], v[76:79]
    ds_read_b64_tr_b16 a[248:249], v232 offset:10240
    s_waitcnt lgkmcnt(5)
L_back_step233:
    v_mfma_f32_16x16x32_bf16 v[48:51], a[224:227], a[208:211], v[48:51]
    ds_read_b64_tr_b16 a[250:251], v232 offset:10496
    v_mfma_f32_16x16x32_bf16 v[52:55], a[224:227], a[212:215], v[52:55]
    ds_read_b64_tr_b16 a[252:253], v233 offset:10240
    v_mfma_f32_16x16x32_bf16 v[56:59], a[228:231], a[208:211], v[56:59]
    ds_read_b64_tr_b16 a[254:255], v233 offset:10496
    v_mfma_f32_16x16x32_bf16 v[60:63], a[228:231], a[212:215], v[60:63]
    s_waitcnt vmcnt(1)
    v_cmp_gt_u32 vcc, 1, v9
    s_nop 0
    s_cmp_eq_u64 vcc, 0
    s_cselect_b32 s60, 1, 0
    s_cselect_b32 s6, s98, 1157376
    v_mfma_f32_16x16x32_bf16 v[64:67], a[232:235], a[208:211], v[64:67]
    ds_read_b64_tr_b16 a[216:217], v232 offset:3072
    s_lshl_b32 s50, s52, 11
    v_mfma_f32_16x16x32_bf16 v[68:71], a[232:235], a[212:215], v[68:71]
    ds_read_b64_tr_b16 a[218:219], v232 offset:3328
    s_add_u32 s51, s6, s50
    buffer_load_dwordx4 v[16:19], v4, s[16:19], s51 offen sc1
    v_mfma_f32_16x16x32_bf16 v[72:75], a[236:239], a[208:211], v[72:75]
    ds_read_b64_tr_b16 a[220:221], v233 offset:3072
    s_add_u32 s51, s51, 147456
    v_mfma_f32_16x16x32_bf16 v[76:79], a[236:239], a[212:215], v[76:79]
    ds_read_b64_tr_b16 a[222:223], v233 offset:3328
    s_waitcnt lgkmcnt(4)
L_back_step234:
    v_mfma_f32_16x16x32_bf16 v[80:83], a[240:243], v[144:147], 0
    ds_read_b64_tr_b16 a[224:225], v232 offset:11264
    ds_read_b64_tr_b16 a[226:227], v232 offset:11520
    v_mfma_f32_16x16x32_bf16 v[84:87], a[240:243], v[148:151], 0
    buffer_load_dwordx4 v[20:23], v4, s[16:19], s51 offen sc1
    v_mfma_f32_16x16x32_bf16 v[88:91], a[244:247], v[144:147], 0
    ds_read_b64_tr_b16 a[228:229], v233 offset:11264
    ds_read_b64_tr_b16 a[230:231], v233 offset:11520
    v_mfma_f32_16x16x32_bf16 v[92:95], a[244:247], v[148:151], 0
    s_add_u32 s51, s51, 147456
    ds_read_b64_tr_b16 a[232:233], v232 offset:16384
    v_mfma_f32_16x16x32_bf16 v[80:83], a[248:251], v[152:155], v[80:83]
    v_cvt_pk_bf16_f32 v248, v48, v49
    v_cvt_pk_bf16_f32 v249, v50, v51
    v_mfma_f32_16x16x32_bf16 v[84:87], a[248:251], v[156:159], v[84:87]
    ds_read_b64_tr_b16 a[234:235], v232 offset:16640
    ds_read_b64_tr_b16 a[236:237], v233 offset:16384
    v_mfma_f32_16x16x32_bf16 v[88:91], a[252:255], v[152:155], v[88:91]
    buffer_load_dwordx4 v[24:27], v4, s[16:19], s51 offen sc1
    v_cvt_pk_bf16_f32 v250, v56, v57
    v_mfma_f32_16x16x32_bf16 v[92:95], a[252:255], v[156:159], v[92:95]
    ds_read_b64_tr_b16 a[238:239], v233 offset:16640
    s_waitcnt lgkmcnt(4)
L_back_step235:
    v_mfma_f32_16x16x32_bf16 v[80:83], a[216:219], v[160:163], v[80:83]
    ds_read_b64_tr_b16 a[240:241], v232 offset:24576
    s_add_u32 s51, s51, 147456
    v_cvt_pk_bf16_f32 v251, v58, v59
    v_mfma_f32_16x16x32_bf16 v[84:87], a[216:219], v[164:167], v[84:87]
    ds_read_b64_tr_b16 a[242:243], v232 offset:24832
    s_add_u32 s63, s55, 6144
    v_mfma_f32_16x16x32_bf16 v[88:91], a[220:223], v[160:163], v[88:91]
    ds_read_b64_tr_b16 a[244:245], v233 offset:24576
    ds_read_b64_tr_b16 a[246:247], v233 offset:24832
    v_mfma_f32_16x16x32_bf16 v[92:95], a[220:223], v[164:167], v[92:95]
    buffer_load_dwordx4 v[28:31], v4, s[16:19], s51 offen sc1
    v_mfma_f32_16x16x32_bf16 v[80:83], a[224:227], v[168:171], v[80:83]
    ds_read_b64_tr_b16 a[248:249], v232 offset:17408
    ds_read_b64_tr_b16 a[250:251], v232 offset:17664
    v_mfma_f32_16x16x32_bf16 v[84:87], a[224:227], v[172:175], v[84:87]
    v_permlane16_swap_b32 v248, v250
    v_mfma_f32_16x16x32_bf16 v[88:91], a[228:231], v[168:171], v[88:91]
    ds_read_b64_tr_b16 a[252:253], v233 offset:17408
    ds_read_b64_tr_b16 a[254:255], v233 offset:17664
    v_mfma_f32_16x16x32_bf16 v[92:95], a[228:231], v[172:175], v[92:95]
    ds_read_b64_tr_b16 a[216:217], v232 offset:25600
    v_permlane16_swap_b32 v249, v251
    s_waitcnt lgkmcnt(5)
L_back_step236:
    v_mfma_f32_16x16x32_bf16 v[80:83], a[232:235], v[176:179], v[80:83]
    buffer_store_dwordx4 v[248:251], v239, s[16:19], s63 offen offset:0 sc1
    v_mfma_f32_16x16x32_bf16 v[84:87], a[232:235], v[180:183], v[84:87]
    ds_read_b64_tr_b16 a[218:219], v232 offset:25856
    s_add_u32 s51, s51, 147456
    buffer_load_dwordx4 v[32:35], v4, s[16:19], s51 offen sc1
    v_cvt_pk_bf16_f32 v252, v64, v65
    v_mfma_f32_16x16x32_bf16 v[88:91], a[236:239], v[176:179], v[88:91]
    ds_read_b64_tr_b16 a[220:221], v233 offset:25600
    ds_read_b64_tr_b16 a[222:223], v233 offset:25856
    v_cvt_pk_bf16_f32 v253, v66, v67
    v_mfma_f32_16x16x32_bf16 v[92:95], a[236:239], v[180:183], v[92:95]
    s_add_u32 s51, s51, 147456
    v_cvt_pk_bf16_f32 v254, v72, v73
    v_mfma_f32_16x16x32_bf16 v[80:83], a[240:243], v[184:187], v[80:83]
    ds_read_b64_tr_b16 a[224:225], v232 offset:18432
    v_cvt_pk_bf16_f32 v255, v74, v75
    v_mfma_f32_16x16x32_bf16 v[84:87], a[240:243], v[188:191], v[84:87]
    ds_read_b64_tr_b16 a[226:227], v232 offset:18688
    ds_read_b64_tr_b16 a[228:229], v233 offset:18432
    v_mfma_f32_16x16x32_bf16 v[88:91], a[244:247], v[184:187], v[88:91]
    buffer_load_dwordx4 v[36:39], v4, s[16:19], s51 offen sc1
    v_mfma_f32_16x16x32_bf16 v[92:95], a[244:247], v[188:191], v[92:95]
    ds_read_b64_tr_b16 a[230:231], v233 offset:18688
    s_waitcnt lgkmcnt(4)
L_back_step237:
    v_mfma_f32_16x16x32_bf16 v[80:83], a[248:251], v[192:195], v[80:83]
    ds_read_b64_tr_b16 a[232:233], v232 offset:26624
    ds_read_b64_tr_b16 a[234:235], v232 offset:26880
    v_permlane16_swap_b32 v252, v254
    v_mfma_f32_16x16x32_bf16 v[84:87], a[248:251], v[196:199], v[84:87]
    v_permlane16_swap_b32 v253, v255
    v_mfma_f32_16x16x32_bf16 v[88:91], a[252:255], v[192:195], v[88:91]
    ds_read_b64_tr_b16 a[236:237], v233 offset:26624
    ds_read_b64_tr_b16 a[238:239], v233 offset:26880
    v_mfma_f32_16x16x32_bf16 v[92:95], a[252:255], v[196:199], v[92:95]
    buffer_store_dwordx4 v[252:255], v239, s[16:19], s63 offen offset:1024 sc1
    v_mfma_f32_16x16x32_bf16 v[80:83], a[216:219], v[200:203], v[80:83]
    ds_read_b64_tr_b16 a[240:241], v232 offset:19456
    s_add_u32 s51, s51, 147456
    buffer_load_dwordx4 v[40:43], v4, s[16:19], s51 offen sc1
    v_cvt_pk_bf16_f32 v248, v52, v53
    v_mfma_f32_16x16x32_bf16 v[84:87], a[216:219], v[204:207], v[84:87]
    ds_read_b64_tr_b16 a[242:243], v232 offset:19712
    s_add_u32 s51, s51, 147456
    v_mfma_f32_16x16x32_bf16 v[88:91], a[220:223], v[200:203], v[88:91]
    ds_read_b64_tr_b16 a[244:245], v233 offset:19456
    v_cvt_pk_bf16_f32 v249, v54, v55
    v_mfma_f32_16x16x32_bf16 v[92:95], a[220:223], v[204:207], v[92:95]
    ds_read_b64_tr_b16 a[246:247], v233 offset:19712
    s_waitcnt lgkmcnt(4)
L_back_step238:
    v_mfma_f32_16x16x32_bf16 v[80:83], a[224:227], v[208:211], v[80:83]
    ds_read_b64_tr_b16 a[248:249], v232 offset:27648
    ds_read_b64_tr_b16 a[250:251], v232 offset:27904
    v_cvt_pk_bf16_f32 v250, v60, v61
    v_mfma_f32_16x16x32_bf16 v[84:87], a[224:227], v[212:215], v[84:87]
    buffer_load_dwordx4 v[44:47], v4, s[16:19], s51 offen sc1
    v_mfma_f32_16x16x32_bf16 v[88:91], a[228:231], v[208:211], v[88:91]
    ds_read_b64_tr_b16 a[252:253], v233 offset:27648
    ds_read_b64_tr_b16 a[254:255], v233 offset:27904
    v_cvt_pk_bf16_f32 v251, v62, v63
    v_mfma_f32_16x16x32_bf16 v[92:95], a[228:231], v[212:215], v[92:95]
    s_add_u32 s63, s55, 24576
    v_mfma_f32_16x16x32_bf16 v[80:83], a[232:235], a[144:147], v[80:83]
    s_barrier
    v_mfma_f32_16x16x32_bf16 v[84:87], a[232:235], a[148:151], v[84:87]
    ds_read_b64_tr_b16 a[216:217], v228 offset:0
    ds_read_b64_tr_b16 a[218:219], v228 offset:256
    v_mfma_f32_16x16x32_bf16 v[88:91], a[236:239], a[144:147], v[88:91]
    ds_read_b64_tr_b16 a[220:221], v229 offset:0
    ds_read_b64_tr_b16 a[222:223], v229 offset:256
    v_mfma_f32_16x16x32_bf16 v[92:95], a[236:239], a[148:151], v[92:95]
    ds_read_b64_tr_b16 a[224:225], v228 offset:8192
    v_permlane16_swap_b32 v248, v250
    s_waitcnt lgkmcnt(5)
L_back_step239:
    v_mfma_f32_16x16x32_bf16 v[80:83], a[240:243], a[152:155], v[80:83]
    v_permlane16_swap_b32 v249, v251
    v_mfma_f32_16x16x32_bf16 v[84:87], a[240:243], a[156:159], v[84:87]
    ds_read_b64_tr_b16 a[226:227], v228 offset:8448
    ds_read_b64_tr_b16 a[228:229], v229 offset:8192
    v_mfma_f32_16x16x32_bf16 v[88:91], a[244:247], a[152:155], v[88:91]
    ds_read_b64_tr_b16 a[230:231], v229 offset:8448
    v_mfma_f32_16x16x32_bf16 v[92:95], a[244:247], a[156:159], v[92:95]
    buffer_store_dwordx4 v[248:251], v239, s[16:19], s63 offen offset:0 sc1
    v_cvt_pk_bf16_f32 v252, v68, v69
    v_mfma_f32_16x16x32_bf16 v[80:83], a[248:251], a[160:163], v[80:83]
    ds_read_b64_tr_b16 a[232:233], v228 offset:1024
    v_cvt_pk_bf16_f32 v253, v70, v71
    v_mfma_f32_16x16x32_bf16 v[84:87], a[248:251], a[164:167], v[84:87]
    ds_read_b64_tr_b16 a[234:235], v228 offset:1280
    v_cvt_pk_bf16_f32 v254, v76, v77
    v_mfma_f32_16x16x32_bf16 v[88:91], a[252:255], a[160:163], v[88:91]
    ds_read_b64_tr_b16 a[236:237], v229 offset:1024
    v_cvt_pk_bf16_f32 v255, v78, v79
    v_mfma_f32_16x16x32_bf16 v[92:95], a[252:255], a[164:167], v[92:95]
    ds_read_b64_tr_b16 a[238:239], v229 offset:1280
    s_waitcnt lgkmcnt(4)
L_back_step240:
    v_mfma_f32_16x16x32_bf16 v[80:83], a[216:219], a[168:171], v[80:83]
    ds_read_b64_tr_b16 a[240:241], v228 offset:9216
    ds_read_b64_tr_b16 a[242:243], v228 offset:9472
    v_mfma_f32_16x16x32_bf16 v[84:87], a[216:219], a[172:175], v[84:87]
    v_permlane16_swap_b32 v252, v254
    v_mfma_f32_16x16x32_bf16 v[88:91], a[220:223], a[168:171], v[88:91]
    ds_read_b64_tr_b16 a[244:245], v229 offset:9216
    ds_read_b64_tr_b16 a[246:247], v229 offset:9472
    v_mfma_f32_16x16x32_bf16 v[92:95], a[220:223], a[172:175], v[92:95]
    v_permlane16_swap_b32 v253, v255
    v_mfma_f32_16x16x32_bf16 v[80:83], a[224:227], a[176:179], v[80:83]
    ds_read_b64_tr_b16 a[248:249], v228 offset:2048
    ds_read_b64_tr_b16 a[250:251], v228 offset:2304
    v_mfma_f32_16x16x32_bf16 v[84:87], a[224:227], a[180:183], v[84:87]
    buffer_store_dwordx4 v[252:255], v239, s[16:19], s63 offen offset:1024 sc1
    v_mfma_f32_16x16x32_bf16 v[88:91], a[228:231], a[176:179], v[88:91]
    ds_read_b64_tr_b16 a[252:253], v229 offset:2048
    ds_read_b64_tr_b16 a[254:255], v229 offset:2304
    v_mfma_f32_16x16x32_bf16 v[92:95], a[228:231], a[180:183], v[92:95]
    ds_read_b64_tr_b16 a[216:217], v228 offset:10240
    s_waitcnt lgkmcnt(5)
L_back_step241:
    v_mfma_f32_16x16x32_bf16 v[80:83], a[232:235], a[184:187], v[80:83]
    ds_read_b64_tr_b16 a[218:219], v228 offset:10496
    v_mfma_f32_16x16x32_bf16 v[84:87], a[232:235], a[188:191], v[84:87]
    ds_read_b64_tr_b16 a[220:221], v229 offset:10240
    v_mfma_f32_16x16x32_bf16 v[88:91], a[236:239], a[184:187], v[88:91]
    ds_read_b64_tr_b16 a[222:223], v229 offset:10496
    v_mfma_f32_16x16x32_bf16 v[92:95], a[236:239], a[188:191], v[92:95]
    v_mfma_f32_16x16x32_bf16 v[80:83], a[240:243], a[192:195], v[80:83]
    v_mfma_f32_16x16x32_bf16 v[84:87], a[240:243], a[196:199], v[84:87]
    v_mfma_f32_16x16x32_bf16 v[88:91], a[244:247], a[192:195], v[88:91]
    v_mfma_f32_16x16x32_bf16 v[92:95], a[244:247], a[196:199], v[92:95]
    s_waitcnt lgkmcnt(0)
L_back_step242:
    v_mfma_f32_16x16x32_bf16 v[80:83], a[248:251], a[200:203], v[80:83]
    v_mfma_f32_16x16x32_bf16 v[84:87], a[248:251], a[204:207], v[84:87]
    v_mfma_f32_16x16x32_bf16 v[88:91], a[252:255], a[200:203], v[88:91]
    v_mfma_f32_16x16x32_bf16 v[92:95], a[252:255], a[204:207], v[92:95]
    v_mfma_f32_16x16x32_bf16 v[80:83], a[216:219], a[208:211], v[80:83]
    v_mfma_f32_16x16x32_bf16 v[84:87], a[216:219], a[212:215], v[84:87]
    v_mfma_f32_16x16x32_bf16 v[88:91], a[220:223], a[208:211], v[88:91]
    v_mfma_f32_16x16x32_bf16 v[92:95], a[220:223], a[212:215], v[92:95]
    s_nop 4
    v_cvt_pk_bf16_f32 v248, v80, v81
    v_cvt_pk_bf16_f32 v249, v82, v83
    v_cvt_pk_bf16_f32 v250, v88, v89
    v_cvt_pk_bf16_f32 v251, v90, v91
    s_add_u32 s63, s54, 0
    v_permlane16_swap_b32 v248, v250
    v_permlane16_swap_b32 v249, v251
    buffer_store_dwordx4 v[248:251], v239, s[16:19], s63 offen offset:0 sc1
    s_nop 1
    v_cvt_pk_bf16_f32 v248, v84, v85
    v_cvt_pk_bf16_f32 v249, v86, v87
    v_cvt_pk_bf16_f32 v250, v92, v93
    v_cvt_pk_bf16_f32 v251, v94, v95
    s_add_u32 s63, s54, 18432
    v_permlane16_swap_b32 v248, v250
    v_permlane16_swap_b32 v249, v251
    buffer_store_dwordx4 v[248:251], v239, s[16:19], s63 offen offset:0 sc1
    buffer_load_dword v9, v8, s[16:19], s4 offen sc1
    s_waitcnt vmcnt(0)
    v_mov_b32 v6, 3
    v_mov_b32 v7, 0
    s_mov_b64 exec, 1
    buffer_store_dword v6, v7, s[16:19], s3 offen sc1
    s_mov_b64 exec, -1
    s_cmp_lg_u32 s60, 0
    s_cbranch_scc1 L_fv_6027
    v_cmp_gt_u32 vcc, 1, v9
    s_nop 0
    s_cmp_eq_u64 vcc, 0
    s_cbranch_scc1 L_wok_6029
    v_and_b32 v8, 15, v1
    v_lshlrev_b32 v8, 6, v8
    s_mov_b32 s43, 0
    s_nop 3
L_poll_6030:
    buffer_load_dword v9, v8, s[16:19], s4 offen sc1
    s_add_u32 s43, s43, 1
    s_cmp_gt_u32 s43, 400000
    s_cbranch_scc1 L_polled_6031
    s_waitcnt vmcnt(0)
    v_cmp_gt_u32 vcc, 1, v9
    s_cbranch_vccnz L_poll_6030
L_polled_6031:
    s_waitcnt vmcnt(0)
L_wok_6029:
    s_lshl_b32 s50, s52, 11
    s_add_u32 s51, s98, s50
    buffer_load_dwordx4 v[16:19], v4, s[16:19], s51 offen sc1
    s_add_u32 s51, s51, 147456
    buffer_load_dwordx4 v[20:23], v4, s[16:19], s51 offen sc1
    s_add_u32 s51, s51, 147456
    buffer_load_dwordx4 v[24:27], v4, s[16:19], s51 offen sc1
    s_add_u32 s51, s51, 147456
    buffer_load_dwordx4 v[28:31], v4, s[16:19], s51 offen sc1
    s_add_u32 s51, s51, 147456
    buffer_load_dwordx4 v[32:35], v4, s[16:19], s51 offen sc1
    s_add_u32 s51, s51, 147456
    buffer_load_dwordx4 v[36:39], v4, s[16:19], s51 offen sc1
    s_add_u32 s51, s51, 147456
    buffer_load_dwordx4 v[40:43], v4, s[16:19], s51 offen sc1
    s_add_u32 s51, s51, 147456
    buffer_load_dwordx4 v[44:47], v4, s[16:19], s51 offen sc1
L_fv_6027:
    s_cmp_eq_u32 s34, 1
    s_cbranch_scc1 L_fw_6032
    s_cmp_ge_u32 s34, 2
    s_cbranch_scc1 L_fw_6033
    v_cmp_gt_u32 vcc, 3, v9
    s_nop 0
    s_cmp_eq_u64 vcc, 0
    s_cbranch_scc0 L_fst_6034
    s_lshl_b32 s50, s53, 11
    s_add_u32 s51, s98, s50
    buffer_load_dwordx4 v[144:147], v4, s[16:19], s51 offen sc1
    s_add_u32 s51, s51, 147456
    buffer_load_dwordx4 v[148:151], v4, s[16:19], s51 offen sc1
    s_add_u32 s51, s51, 147456
    buffer_load_dwordx4 v[152:155], v4, s[16:19], s51 offen sc1
    s_add_u32 s51, s51, 147456
    buffer_load_dwordx4 v[156:159], v4, s[16:19], s51 offen sc1
    s_add_u32 s51, s51, 147456
    buffer_load_dwordx4 v[160:163], v4, s[16:19], s51 offen sc1
    s_add_u32 s51, s51, 147456
    buffer_load_dwordx4 v[164:167], v4, s[16:19], s51 offen sc1
    s_add_u32 s51, s51, 147456
    buffer_load_dwordx4 v[168:171], v4, s[16:19], s51 offen sc1
    s_add_u32 s51, s51, 147456
    buffer_load_dwordx4 v[172:175], v4, s[16:19], s51 offen sc1
    s_lshl_b32 s50, s58, 11
    s_add_u32 s51, s98, s50
    buffer_load_dwordx4 v[176:179], v4, s[16:19], s51 offen sc1
    s_add_u32 s51, s51, 147456
    buffer_load_dwordx4 v[180:183], v4, s[16:19], s51 offen sc1
    s_add_u32 s51, s51, 147456
    buffer_load_dwordx4 v[184:187], v4, s[16:19], s51 offen sc1
    s_add_u32 s51, s51, 147456
    buffer_load_dwordx4 v[188:191], v4, s[16:19], s51 offen sc1
    s_add_u32 s51, s51, 147456
    buffer_load_dwordx4 v[192:195], v4, s[16:19], s51 offen sc1
    s_add_u32 s51, s51, 147456
    buffer_load_dwordx4 v[196:199], v4, s[16:19], s51 offen sc1
    s_add_u32 s51, s51, 147456
    buffer_load_dwordx4 v[200:203], v4, s[16:19], s51 offen sc1
    s_add_u32 s51, s51, 147456
    buffer_load_dwordx4 v[204:207], v4, s[16:19], s51 offen sc1
    v_pk_mul_f32 v[100:101], v[100:101], s[58:59] op_sel:[0,1] op_sel_hi:[1,1]
    v_pk_mul_f32 v[102:103], v[102:103], s[58:59] op_sel:[0,1] op_sel_hi:[1,1]
    v_pk_mul_f32 v[104:105], v[104:105], s[58:59] op_sel:[0,1] op_sel_hi:[1,1]
    v_pk_mul_f32 v[106:107], v[106:107], s[58:59] op_sel:[0,1] op_sel_hi:[1,1]
    s_waitcnt vmcnt(23)
    v_dot2_f32_bf16 v208, v16, s56, 0
    v_dot2_f32_bf16 v209, v16, s57, 0
    v_dot2_f32_bf16 v210, v17, s56, 0
    v_dot2_f32_bf16 v211, v17, s57, 0
    v_dot2_f32_bf16 v212, v18, s56, 0
    v_dot2_f32_bf16 v213, v18, s57, 0
    v_dot2_f32_bf16 v214, v19, s56, 0
    v_dot2_f32_bf16 v215, v19, s57, 0
    s_waitcnt vmcnt(22)
    v_dot2_f32_bf16 v208, v20, s56, v208
    v_dot2_f32_bf16 v209, v20, s57, v209
    v_dot2_f32_bf16 v210, v21, s56, v210
    v_dot2_f32_bf16 v211, v21, s57, v211
    v_dot2_f32_bf16 v212, v22, s56, v212
    v_dot2_f32_bf16 v213, v22, s57, v213
    v_dot2_f32_bf16 v214, v23, s56, v214
    v_dot2_f32_bf16 v215, v23, s57, v215
    s_waitcnt vmcnt(21)
    v_dot2_f32_bf16 v208, v24, s56, v208
    v_dot2_f32_bf16 v209, v24, s57, v209
    v_dot2_f32_bf16 v210, v25, s56, v210
    v_dot2_f32_bf16 v211, v25, s57, v211
    v_dot2_f32_bf16 v212, v26, s56, v212
    v_dot2_f32_bf16 v213, v26, s57, v213
    v_dot2_f32_bf16 v214, v27, s56, v214
    v_dot2_f32_bf16 v215, v27, s57, v215
    s_waitcnt vmcnt(20)
    v_dot2_f32_bf16 v208, v28, s56, v208
    v_dot2_f32_bf16 v209, v28, s57, v209
    v_dot2_f32_bf16 v210, v29, s56, v210
    v_dot2_f32_bf16 v211, v29, s57, v211
    v_dot2_f32_bf16 v212, v30, s56, v212
    v_dot2_f32_bf16 v213, v30, s57, v213
    v_dot2_f32_bf16 v214, v31, s56, v214
    v_dot2_f32_bf16 v215, v31, s57, v215
    s_waitcnt vmcnt(19)
    v_dot2_f32_bf16 v208, v32, s56, v208
    v_dot2_f32_bf16 v209, v32, s57, v209
    v_dot2_f32_bf16 v210, v33, s56, v210
    v_dot2_f32_bf16 v211, v33, s57, v211
    v_dot2_f32_bf16 v212, v34, s56, v212
    v_dot2_f32_bf16 v213, v34, s57, v213
    v_dot2_f32_bf16 v214, v35, s56, v214
    v_dot2_f32_bf16 v215, v35, s57, v215
    s_waitcnt vmcnt(18)
    v_dot2_f32_bf16 v208, v36, s56, v208
    v_dot2_f32_bf16 v209, v36, s57, v209
    v_dot2_f32_bf16 v210, v37, s56, v210
    v_dot2_f32_bf16 v211, v37, s57, v211
    v_dot2_f32_bf16 v212, v38, s56, v212
    v_dot2_f32_bf16 v213, v38, s57, v213
    v_dot2_f32_bf16 v214, v39, s56, v214
    v_dot2_f32_bf16 v215, v39, s57, v215
    s_waitcnt vmcnt(17)
    v_dot2_f32_bf16 v208, v40, s56, v208
    v_dot2_f32_bf16 v209, v40, s57, v209
    v_dot2_f32_bf16 v210, v41, s56, v210
    v_dot2_f32_bf16 v211, v41, s57, v211
    v_dot2_f32_bf16 v212, v42, s56, v212
    v_dot2_f32_bf16 v213, v42, s57, v213
    v_dot2_f32_bf16 v214, v43, s56, v214
    v_dot2_f32_bf16 v215, v43, s57, v215
    s_waitcnt vmcnt(16)
    v_dot2_f32_bf16 v208, v44, s56, v208
    v_dot2_f32_bf16 v209, v44, s57, v209
    v_dot2_f32_bf16 v210, v45, s56, v210
    v_dot2_f32_bf16 v211, v45, s57, v211
    v_dot2_f32_bf16 v212, v46, s56, v212
    v_dot2_f32_bf16 v213, v46, s57, v213
    v_dot2_f32_bf16 v214, v47, s56, v214
    v_dot2_f32_bf16 v215, v47, s57, v215
    v_lshlrev_b32 v240, 16, v96
    v_and_b32 v241, s35, v96
    v_lshlrev_b32 v242, 16, v97
    v_and_b32 v243, s35, v97
    v_lshlrev_b32 v244, 16, v98
    v_and_b32 v245, s35, v98
    v_lshlrev_b32 v246, 16, v99
    v_and_b32 v247, s35, v99
    v_pk_fma_f32 v[208:209], v[208:209], v[100:101], v[240:241]
    v_pk_fma_f32 v[210:211], v[210:211], v[102:103], v[242:243]
    v_pk_fma_f32 v[212:213], v[212:213], v[104:105], v[244:245]
    v_pk_fma_f32 v[214:215], v[214:215], v[106:107], v[246:247]
    v_cvt_pk_bf16_f32 v96, v208, v209
    v_cvt_pk_bf16_f32 v97, v210, v211
    v_cvt_pk_bf16_f32 v98, v212, v213
    v_cvt_pk_bf16_f32 v99, v214, v215
    s_lshl_b32 s50, s52, 7
    s_add_u32 s50, s50, s99
    buffer_store_dwordx4 v[96:99], v10, s[12:15], s50 offen
    v_pk_mul_f32 v[112:113], v[112:113], s[58:59] op_sel:[0,1] op_sel_hi:[1,1]
    v_pk_mul_f32 v[114:115], v[114:115], s[58:59] op_sel:[0,1] op_sel_hi:[1,1]
    v_pk_mul_f32 v[116:117], v[116:117], s[58:59] op_sel:[0,1] op_sel_hi:[1,1]
    v_pk_mul_f32 v[118:119], v[118:119], s[58:59] op_sel:[0,1] op_sel_hi:[1,1]
    s_waitcnt vmcnt(16)
    v_dot2_f32_bf16 v208, v144, s56, 0
    v_dot2_f32_bf16 v209, v144, s57, 0
    v_dot2_f32_bf16 v210, v145, s56, 0
    v_dot2_f32_bf16 v211, v145, s57, 0
    v_dot2_f32_bf16 v212, v146, s56, 0
    v_dot2_f32_bf16 v213, v146, s57, 0
    v_dot2_f32_bf16 v214, v147, s56, 0
    v_dot2_f32_bf16 v215, v147, s57, 0
    s_waitcnt vmcnt(15)
    v_dot2_f32_bf16 v208, v148, s56, v208
    v_dot2_f32_bf16 v209, v148, s57, v209
    v_dot2_f32_bf16 v210, v149, s56, v210
    v_dot2_f32_bf16 v211, v149, s57, v211
    v_dot2_f32_bf16 v212, v150, s56, v212
    v_dot2_f32_bf16 v213, v150, s57, v213
    v_dot2_f32_bf16 v214, v151, s56, v214
    v_dot2_f32_bf16 v215, v151, s57, v215
    s_waitcnt vmcnt(14)
    v_dot2_f32_bf16 v208, v152, s56, v208
    v_dot2_f32_bf16 v209, v152, s57, v209
    v_dot2_f32_bf16 v210, v153, s56, v210
    v_dot2_f32_bf16 v211, v153, s57, v211
    v_dot2_f32_bf16 v212, v154, s56, v212
    v_dot2_f32_bf16 v213, v154, s57, v213
    v_dot2_f32_bf16 v214, v155, s56, v214
    v_dot2_f32_bf16 v215, v155, s57, v215
    s_waitcnt vmcnt(13)
    v_dot2_f32_bf16 v208, v156, s56, v208
    v_dot2_f32_bf16 v209, v156, s57, v209
    v_dot2_f32_bf16 v210, v157, s56, v210
    v_dot2_f32_bf16 v211, v157, s57, v211
    v_dot2_f32_bf16 v212, v158, s56, v212
    v_dot2_f32_bf16 v213, v158, s57, v213
    v_dot2_f32_bf16 v214, v159, s56, v214
    v_dot2_f32_bf16 v215, v159, s57, v215
    s_waitcnt vmcnt(12)
    v_dot2_f32_bf16 v208, v160, s56, v208
    v_dot2_f32_bf16 v209, v160, s57, v209
    v_dot2_f32_bf16 v210, v161, s56, v210
    v_dot2_f32_bf16 v211, v161, s57, v211
    v_dot2_f32_bf16 v212, v162, s56, v212
    v_dot2_f32_bf16 v213, v162, s57, v213
    v_dot2_f32_bf16 v214, v163, s56, v214
    v_dot2_f32_bf16 v215, v163, s57, v215
    s_waitcnt vmcnt(11)
    v_dot2_f32_bf16 v208, v164, s56, v208
    v_dot2_f32_bf16 v209, v164, s57, v209
    v_dot2_f32_bf16 v210, v165, s56, v210
    v_dot2_f32_bf16 v211, v165, s57, v211
    v_dot2_f32_bf16 v212, v166, s56, v212
    v_dot2_f32_bf16 v213, v166, s57, v213
    v_dot2_f32_bf16 v214, v167, s56, v214
    v_dot2_f32_bf16 v215, v167, s57, v215
    s_waitcnt vmcnt(10)
    v_dot2_f32_bf16 v208, v168, s56, v208
    v_dot2_f32_bf16 v209, v168, s57, v209
    v_dot2_f32_bf16 v210, v169, s56, v210
    v_dot2_f32_bf16 v211, v169, s57, v211
    v_dot2_f32_bf16 v212, v170, s56, v212
    v_dot2_f32_bf16 v213, v170, s57, v213
    v_dot2_f32_bf16 v214, v171, s56, v214
    v_dot2_f32_bf16 v215, v171, s57, v215
    s_waitcnt vmcnt(9)
    v_dot2_f32_bf16 v208, v172, s56, v208
    v_dot2_f32_bf16 v209, v172, s57, v209
    v_dot2_f32_bf16 v210, v173, s56, v210
    v_dot2_f32_bf16 v211, v173, s57, v211
    v_dot2_f32_bf16 v212, v174, s56, v212
    v_dot2_f32_bf16 v213, v174, s57, v213
    v_dot2_f32_bf16 v214, v175, s56, v214
    v_dot2_f32_bf16 v215, v175, s57, v215
    v_lshlrev_b32 v240, 16, v108
    v_and_b32 v241, s35, v108
    v_lshlrev_b32 v242, 16, v109
    v_and_b32 v243, s35, v109
    v_lshlrev_b32 v244, 16, v110
    v_and_b32 v245, s35, v110
    v_lshlrev_b32 v246, 16, v111
    v_and_b32 v247, s35, v111
    v_pk_fma_f32 v[208:209], v[208:209], v[112:113], v[240:241]
    v_pk_fma_f32 v[210:211], v[210:211], v[114:115], v[242:243]
    v_pk_fma_f32 v[212:213], v[212:213], v[116:117], v[244:245]
    v_pk_fma_f32 v[214:215], v[214:215], v[118:119], v[246:247]
    v_cvt_pk_bf16_f32 v108, v208, v209
    v_cvt_pk_bf16_f32 v109, v210, v211
    v_cvt_pk_bf16_f32 v110, v212, v213
    v_cvt_pk_bf16_f32 v111, v214, v215
    s_lshl_b32 s50, s53, 7
    s_add_u32 s50, s50, s99
    buffer_store_dwordx4 v[108:111], v10, s[12:15], s50 offen
    v_pk_mul_f32 v[124:125], v[124:125], s[58:59] op_sel:[0,1] op_sel_hi:[1,1]
    v_pk_mul_f32 v[126:127], v[126:127], s[58:59] op_sel:[0,1] op_sel_hi:[1,1]
    v_pk_mul_f32 v[128:129], v[128:129], s[58:59] op_sel:[0,1] op_sel_hi:[1,1]
    v_pk_mul_f32 v[130:131], v[130:131], s[58:59] op_sel:[0,1] op_sel_hi:[1,1]
    s_waitcnt vmcnt(9)
    v_dot2_f32_bf16 v208, v176, s56, 0
    v_dot2_f32_bf16 v209, v176, s57, 0
    v_dot2_f32_bf16 v210, v177, s56, 0
    v_dot2_f32_bf16 v211, v177, s57, 0
    v_dot2_f32_bf16 v212, v178, s56, 0
    v_dot2_f32_bf16 v213, v178, s57, 0
    v_dot2_f32_bf16 v214, v179, s56, 0
    v_dot2_f32_bf16 v215, v179, s57, 0
    s_waitcnt vmcnt(8)
    v_dot2_f32_bf16 v208, v180, s56, v208
    v_dot2_f32_bf16 v209, v180, s57, v209
    v_dot2_f32_bf16 v210, v181, s56, v210
    v_dot2_f32_bf16 v211, v181, s57, v211
    v_dot2_f32_bf16 v212, v182, s56, v212
    v_dot2_f32_bf16 v213, v182, s57, v213
    v_dot2_f32_bf16 v214, v183, s56, v214
    v_dot2_f32_bf16 v215, v183, s57, v215
    s_waitcnt vmcnt(7)
    v_dot2_f32_bf16 v208, v184, s56, v208
    v_dot2_f32_bf16 v209, v184, s57, v209
    v_dot2_f32_bf16 v210, v185, s56, v210
    v_dot2_f32_bf16 v211, v185, s57, v211
    v_dot2_f32_bf16 v212, v186, s56, v212
    v_dot2_f32_bf16 v213, v186, s57, v213
    v_dot2_f32_bf16 v214, v187, s56, v214
    v_dot2_f32_bf16 v215, v187, s57, v215
    s_waitcnt vmcnt(6)
    v_dot2_f32_bf16 v208, v188, s56, v208
    v_dot2_f32_bf16 v209, v188, s57, v209
    v_dot2_f32_bf16 v210, v189, s56, v210
    v_dot2_f32_bf16 v211, v189, s57, v211
    v_dot2_f32_bf16 v212, v190, s56, v212
    v_dot2_f32_bf16 v213, v190, s57, v213
    v_dot2_f32_bf16 v214, v191, s56, v214
    v_dot2_f32_bf16 v215, v191, s57, v215
    s_waitcnt vmcnt(5)
    v_dot2_f32_bf16 v208, v192, s56, v208
    v_dot2_f32_bf16 v209, v192, s57, v209
    v_dot2_f32_bf16 v210, v193, s56, v210
    v_dot2_f32_bf16 v211, v193, s57, v211
    v_dot2_f32_bf16 v212, v194, s56, v212
    v_dot2_f32_bf16 v213, v194, s57, v213
    v_dot2_f32_bf16 v214, v195, s56, v214
    v_dot2_f32_bf16 v215, v195, s57, v215
    s_waitcnt vmcnt(4)
    v_dot2_f32_bf16 v208, v196, s56, v208
    v_dot2_f32_bf16 v209, v196, s57, v209
    v_dot2_f32_bf16 v210, v197, s56, v210
    v_dot2_f32_bf16 v211, v197, s57, v211
    v_dot2_f32_bf16 v212, v198, s56, v212
    v_dot2_f32_bf16 v213, v198, s57, v213
    v_dot2_f32_bf16 v214, v199, s56, v214
    v_dot2_f32_bf16 v215, v199, s57, v215
    s_waitcnt vmcnt(3)
    v_dot2_f32_bf16 v208, v200, s56, v208
    v_dot2_f32_bf16 v209, v200, s57, v209
    v_dot2_f32_bf16 v210, v201, s56, v210
    v_dot2_f32_bf16 v211, v201, s57, v211
    v_dot2_f32_bf16 v212, v202, s56, v212
    v_dot2_f32_bf16 v213, v202, s57, v213
    v_dot2_f32_bf16 v214, v203, s56, v214
    v_dot2_f32_bf16 v215, v203, s57, v215
    s_waitcnt vmcnt(2)
    v_dot2_f32_bf16 v208, v204, s56, v208
    v_dot2_f32_bf16 v209, v204, s57, v209
    v_dot2_f32_bf16 v210, v205, s56, v210
    v_dot2_f32_bf16 v211, v205, s57, v211
    v_dot2_f32_bf16 v212, v206, s56, v212
    v_dot2_f32_bf16 v213, v206, s57, v213
    v_dot2_f32_bf16 v214, v207, s56, v214
    v_dot2_f32_bf16 v215, v207, s57, v215
    v_lshlrev_b32 v240, 16, v120
    v_and_b32 v241, s35, v120
    v_lshlrev_b32 v242, 16, v121
    v_and_b32 v243, s35, v121
    v_lshlrev_b32 v244, 16, v122
    v_and_b32 v245, s35, v122
    v_lshlrev_b32 v246, 16, v123
    v_and_b32 v247, s35, v123
    v_pk_fma_f32 v[208:209], v[208:209], v[124:125], v[240:241]
    v_pk_fma_f32 v[210:211], v[210:211], v[126:127], v[242:243]
    v_pk_fma_f32 v[212:213], v[212:213], v[128:129], v[244:245]
    v_pk_fma_f32 v[214:215], v[214:215], v[130:131], v[246:247]
    v_cvt_pk_bf16_f32 v120, v208, v209
    v_cvt_pk_bf16_f32 v121, v210, v211
    v_cvt_pk_bf16_f32 v122, v212, v213
    v_cvt_pk_bf16_f32 v123, v214, v215
    s_lshl_b32 s50, s58, 7
    s_add_u32 s50, s50, s99
    buffer_store_dwordx4 v[120:123], v10, s[12:15], s50 offen
    s_waitcnt vmcnt(0)
    s_branch L_fin_6026
L_fst_6034:
    v_pk_mul_f32 v[100:101], v[100:101], s[58:59] op_sel:[0,1] op_sel_hi:[1,1]
    v_pk_mul_f32 v[102:103], v[102:103], s[58:59] op_sel:[0,1] op_sel_hi:[1,1]
    v_pk_mul_f32 v[104:105], v[104:105], s[58:59] op_sel:[0,1] op_sel_hi:[1,1]
    v_pk_mul_f32 v[106:107], v[106:107], s[58:59] op_sel:[0,1] op_sel_hi:[1,1]
    s_waitcnt vmcnt(7)
    v_dot2_f32_bf16 v208, v16, s56, 0
    v_dot2_f32_bf16 v209, v16, s57, 0
    v_dot2_f32_bf16 v210, v17, s56, 0
    v_dot2_f32_bf16 v211, v17, s57, 0
    v_dot2_f32_bf16 v212, v18, s56, 0
    v_dot2_f32_bf16 v213, v18, s57, 0
    v_dot2_f32_bf16 v214, v19, s56, 0
    v_dot2_f32_bf16 v215, v19, s57, 0
    s_waitcnt vmcnt(6)
    v_dot2_f32_bf16 v208, v20, s56, v208
    v_dot2_f32_bf16 v209, v20, s57, v209
    v_dot2_f32_bf16 v210, v21, s56, v210
    v_dot2_f32_bf16 v211, v21, s57, v211
    v_dot2_f32_bf16 v212, v22, s56, v212
    v_dot2_f32_bf16 v213, v22, s57, v213
    v_dot2_f32_bf16 v214, v23, s56, v214
    v_dot2_f32_bf16 v215, v23, s57, v215
    s_waitcnt vmcnt(5)
    v_dot2_f32_bf16 v208, v24, s56, v208
    v_dot2_f32_bf16 v209, v24, s57, v209
    v_dot2_f32_bf16 v210, v25, s56, v210
    v_dot2_f32_bf16 v211, v25, s57, v211
    v_dot2_f32_bf16 v212, v26, s56, v212
    v_dot2_f32_bf16 v213, v26, s57, v213
    v_dot2_f32_bf16 v214, v27, s56, v214
    v_dot2_f32_bf16 v215, v27, s57, v215
    s_waitcnt vmcnt(4)
    v_dot2_f32_bf16 v208, v28, s56, v208
    v_dot2_f32_bf16 v209, v28, s57, v209
    v_dot2_f32_bf16 v210, v29, s56, v210
    v_dot2_f32_bf16 v211, v29, s57, v211
    v_dot2_f32_bf16 v212, v30, s56, v212
    v_dot2_f32_bf16 v213, v30, s57, v213
    v_dot2_f32_bf16 v214, v31, s56, v214
    v_dot2_f32_bf16 v215, v31, s57, v215
    s_waitcnt vmcnt(3)
    v_dot2_f32_bf16 v208, v32, s56, v208
    v_dot2_f32_bf16 v209, v32, s57, v209
    v_dot2_f32_bf16 v210, v33, s56, v210
    v_dot2_f32_bf16 v211, v33, s57, v211
    v_dot2_f32_bf16 v212, v34, s56, v212
    v_dot2_f32_bf16 v213, v34, s57, v213
    v_dot2_f32_bf16 v214, v35, s56, v214
    v_dot2_f32_bf16 v215, v35, s57, v215
    s_waitcnt vmcnt(2)
    v_dot2_f32_bf16 v208, v36, s56, v208
    v_dot2_f32_bf16 v209, v36, s57, v209
    v_dot2_f32_bf16 v210, v37, s56, v210
    v_dot2_f32_bf16 v211, v37, s57, v211
    v_dot2_f32_bf16 v212, v38, s56, v212
    v_dot2_f32_bf16 v213, v38, s57, v213
    v_dot2_f32_bf16 v214, v39, s56, v214
    v_dot2_f32_bf16 v215, v39, s57, v215
    s_waitcnt vmcnt(1)
    v_dot2_f32_bf16 v208, v40, s56, v208
    v_dot2_f32_bf16 v209, v40, s57, v209
    v_dot2_f32_bf16 v210, v41, s56, v210
    v_dot2_f32_bf16 v211, v41, s57, v211
    v_dot2_f32_bf16 v212, v42, s56, v212
    v_dot2_f32_bf16 v213, v42, s57, v213
    v_dot2_f32_bf16 v214, v43, s56, v214
    v_dot2_f32_bf16 v215, v43, s57, v215
    s_waitcnt vmcnt(0)
    v_dot2_f32_bf16 v208, v44, s56, v208
    v_dot2_f32_bf16 v209, v44, s57, v209
    v_dot2_f32_bf16 v210, v45, s56, v210
    v_dot2_f32_bf16 v211, v45, s57, v211
    v_dot2_f32_bf16 v212, v46, s56, v212
    v_dot2_f32_bf16 v213, v46, s57, v213
    v_dot2_f32_bf16 v214, v47, s56, v214
    v_dot2_f32_bf16 v215, v47, s57, v215
    v_lshlrev_b32 v240, 16, v96
    v_and_b32 v241, s35, v96
    v_lshlrev_b32 v242, 16, v97
    v_and_b32 v243, s35, v97
    v_lshlrev_b32 v244, 16, v98
    v_and_b32 v245, s35, v98
    v_lshlrev_b32 v246, 16, v99
    v_and_b32 v247, s35, v99
    v_pk_fma_f32 v[208:209], v[208:209], v[100:101], v[240:241]
    v_pk_fma_f32 v[210:211], v[210:211], v[102:103], v[242:243]
    v_pk_fma_f32 v[212:213], v[212:213], v[104:105], v[244:245]
    v_pk_fma_f32 v[214:215], v[214:215], v[106:107], v[246:247]
    v_cvt_pk_bf16_f32 v96, v208, v209
    v_cvt_pk_bf16_f32 v97, v210, v211
    v_cvt_pk_bf16_f32 v98, v212, v213
    v_cvt_pk_bf16_f32 v99, v214, v215
    s_lshl_b32 s50, s52, 7
    s_add_u32 s50, s50, s99
    buffer_store_dwordx4 v[96:99], v10, s[12:15], s50 offen
    v_cmp_gt_u32 vcc, 2, v9
    s_nop 0
    s_cmp_eq_u64 vcc, 0
    s_cbranch_scc1 L_wok_6037
    v_and_b32 v8, 15, v1
    v_lshlrev_b32 v8, 6, v8
    s_mov_b32 s43, 0
    s_nop 3
L_poll_6038:
    buffer_load_dword v9, v8, s[16:19], s4 offen sc1
    s_add_u32 s43, s43, 1
    s_cmp_gt_u32 s43, 400000
    s_cbranch_scc1 L_polled_6039
    s_waitcnt vmcnt(0)
    v_cmp_gt_u32 vcc, 2, v9
    s_cbranch_vccnz L_poll_6038
L_polled_6039:
    s_waitcnt vmcnt(0)
L_wok_6037:
    v_cmp_gt_u32 vcc, 3, v9
    s_nop 0
    s_cmp_eq_u64 vcc, 0
    s_cbranch_scc0 L_fst_6035
    s_lshl_b32 s50, s53, 11
    s_add_u32 s51, s98, s50
    buffer_load_dwordx4 v[144:147], v4, s[16:19], s51 offen sc1
    s_add_u32 s51, s51, 147456
    buffer_load_dwordx4 v[148:151], v4, s[16:19], s51 offen sc1
    s_add_u32 s51, s51, 147456
    buffer_load_dwordx4 v[152:155], v4, s[16:19], s51 offen sc1
    s_add_u32 s51, s51, 147456
    buffer_load_dwordx4 v[156:159], v4, s[16:19], s51 offen sc1
    s_add_u32 s51, s51, 147456
    buffer_load_dwordx4 v[160:163], v4, s[16:19], s51 offen sc1
    s_add_u32 s51, s51, 147456
    buffer_load_dwordx4 v[164:167], v4, s[16:19], s51 offen sc1
    s_add_u32 s51, s51, 147456
    buffer_load_dwordx4 v[168:171], v4, s[16:19], s51 offen sc1
    s_add_u32 s51, s51, 147456
    buffer_load_dwordx4 v[172:175], v4, s[16:19], s51 offen sc1
    s_lshl_b32 s50, s58, 11
    s_add_u32 s51, s98, s50
    buffer_load_dwordx4 v[176:179], v4, s[16:19], s51 offen sc1
    s_add_u32 s51, s51, 147456
    buffer_load_dwordx4 v[180:183], v4, s[16:19], s51 offen sc1
    s_add_u32 s51, s51, 147456
    buffer_load_dwordx4 v[184:187], v4, s[16:19], s51 offen sc1
    s_add_u32 s51, s51, 147456
    buffer_load_dwordx4 v[188:191], v4, s[16:19], s51 offen sc1
    s_add_u32 s51, s51, 147456
    buffer_load_dwordx4 v[192:195], v4, s[16:19], s51 offen sc1
    s_add_u32 s51, s51, 147456
    buffer_load_dwordx4 v[196:199], v4, s[16:19], s51 offen sc1
    s_add_u32 s51, s51, 147456
    buffer_load_dwordx4 v[200:203], v4, s[16:19], s51 offen sc1
    s_add_u32 s51, s51, 147456
    buffer_load_dwordx4 v[204:207], v4, s[16:19], s51 offen sc1
    v_pk_mul_f32 v[112:113], v[112:113], s[58:59] op_sel:[0,1] op_sel_hi:[1,1]
    v_pk_mul_f32 v[114:115], v[114:115], s[58:59] op_sel:[0,1] op_sel_hi:[1,1]
    v_pk_mul_f32 v[116:117], v[116:117], s[58:59] op_sel:[0,1] op_sel_hi:[1,1]
    v_pk_mul_f32 v[118:119], v[118:119], s[58:59] op_sel:[0,1] op_sel_hi:[1,1]
    s_waitcnt vmcnt(15)
    v_dot2_f32_bf16 v208, v144, s56, 0
    v_dot2_f32_bf16 v209, v144, s57, 0
    v_dot2_f32_bf16 v210, v145, s56, 0
    v_dot2_f32_bf16 v211, v145, s57, 0
    v_dot2_f32_bf16 v212, v146, s56, 0
    v_dot2_f32_bf16 v213, v146, s57, 0
    v_dot2_f32_bf16 v214, v147, s56, 0
    v_dot2_f32_bf16 v215, v147, s57, 0
    s_waitcnt vmcnt(14)
    v_dot2_f32_bf16 v208, v148, s56, v208
    v_dot2_f32_bf16 v209, v148, s57, v209
    v_dot2_f32_bf16 v210, v149, s56, v210
    v_dot2_f32_bf16 v211, v149, s57, v211
    v_dot2_f32_bf16 v212, v150, s56, v212
    v_dot2_f32_bf16 v213, v150, s57, v213
    v_dot2_f32_bf16 v214, v151, s56, v214
    v_dot2_f32_bf16 v215, v151, s57, v215
    s_waitcnt vmcnt(13)
    v_dot2_f32_bf16 v208, v152, s56, v208
    v_dot2_f32_bf16 v209, v152, s57, v209
    v_dot2_f32_bf16 v210, v153, s56, v210
    v_dot2_f32_bf16 v211, v153, s57, v211
    v_dot2_f32_bf16 v212, v154, s56, v212
    v_dot2_f32_bf16 v213, v154, s57, v213
    v_dot2_f32_bf16 v214, v155, s56, v214
    v_dot2_f32_bf16 v215, v155, s57, v215
    s_waitcnt vmcnt(12)
    v_dot2_f32_bf16 v208, v156, s56, v208
    v_dot2_f32_bf16 v209, v156, s57, v209
    v_dot2_f32_bf16 v210, v157, s56, v210
    v_dot2_f32_bf16 v211, v157, s57, v211
    v_dot2_f32_bf16 v212, v158, s56, v212
    v_dot2_f32_bf16 v213, v158, s57, v213
    v_dot2_f32_bf16 v214, v159, s56, v214
    v_dot2_f32_bf16 v215, v159, s57, v215
    s_waitcnt vmcnt(11)
    v_dot2_f32_bf16 v208, v160, s56, v208
    v_dot2_f32_bf16 v209, v160, s57, v209
    v_dot2_f32_bf16 v210, v161, s56, v210
    v_dot2_f32_bf16 v211, v161, s57, v211
    v_dot2_f32_bf16 v212, v162, s56, v212
    v_dot2_f32_bf16 v213, v162, s57, v213
    v_dot2_f32_bf16 v214, v163, s56, v214
    v_dot2_f32_bf16 v215, v163, s57, v215
    s_waitcnt vmcnt(10)
    v_dot2_f32_bf16 v208, v164, s56, v208
    v_dot2_f32_bf16 v209, v164, s57, v209
    v_dot2_f32_bf16 v210, v165, s56, v210
    v_dot2_f32_bf16 v211, v165, s57, v211
    v_dot2_f32_bf16 v212, v166, s56, v212
    v_dot2_f32_bf16 v213, v166, s57, v213
    v_dot2_f32_bf16 v214, v167, s56, v214
    v_dot2_f32_bf16 v215, v167, s57, v215
    s_waitcnt vmcnt(9)
    v_dot2_f32_bf16 v208, v168, s56, v208
    v_dot2_f32_bf16 v209, v168, s57, v209
    v_dot2_f32_bf16 v210, v169, s56, v210
    v_dot2_f32_bf16 v211, v169, s57, v211
    v_dot2_f32_bf16 v212, v170, s56, v212
    v_dot2_f32_bf16 v213, v170, s57, v213
    v_dot2_f32_bf16 v214, v171, s56, v214
    v_dot2_f32_bf16 v215, v171, s57, v215
    s_waitcnt vmcnt(8)
    v_dot2_f32_bf16 v208, v172, s56, v208
    v_dot2_f32_bf16 v209, v172, s57, v209
    v_dot2_f32_bf16 v210, v173, s56, v210
    v_dot2_f32_bf16 v211, v173, s57, v211
    v_dot2_f32_bf16 v212, v174, s56, v212
    v_dot2_f32_bf16 v213, v174, s57, v213
    v_dot2_f32_bf16 v214, v175, s56, v214
    v_dot2_f32_bf16 v215, v175, s57, v215
    v_lshlrev_b32 v240, 16, v108
    v_and_b32 v241, s35, v108
    v_lshlrev_b32 v242, 16, v109
    v_and_b32 v243, s35, v109
    v_lshlrev_b32 v244, 16, v110
    v_and_b32 v245, s35, v110
    v_lshlrev_b32 v246, 16, v111
    v_and_b32 v247, s35, v111
    v_pk_fma_f32 v[208:209], v[208:209], v[112:113], v[240:241]
    v_pk_fma_f32 v[210:211], v[210:211], v[114:115], v[242:243]
    v_pk_fma_f32 v[212:213], v[212:213], v[116:117], v[244:245]
    v_pk_fma_f32 v[214:215], v[214:215], v[118:119], v[246:247]
    v_cvt_pk_bf16_f32 v108, v208, v209
    v_cvt_pk_bf16_f32 v109, v210, v211
    v_cvt_pk_bf16_f32 v110, v212, v213
    v_cvt_pk_bf16_f32 v111, v214, v215
    s_lshl_b32 s50, s53, 7
    s_add_u32 s50, s50, s99
    buffer_store_dwordx4 v[108:111], v10, s[12:15], s50 offen
    v_pk_mul_f32 v[124:125], v[124:125], s[58:59] op_sel:[0,1] op_sel_hi:[1,1]
    v_pk_mul_f32 v[126:127], v[126:127], s[58:59] op_sel:[0,1] op_sel_hi:[1,1]
    v_pk_mul_f32 v[128:129], v[128:129], s[58:59] op_sel:[0,1] op_sel_hi:[1,1]
    v_pk_mul_f32 v[130:131], v[130:131], s[58:59] op_sel:[0,1] op_sel_hi:[1,1]
    s_waitcnt vmcnt(8)
    v_dot2_f32_bf16 v208, v176, s56, 0
    v_dot2_f32_bf16 v209, v176, s57, 0
    v_dot2_f32_bf16 v210, v177, s56, 0
    v_dot2_f32_bf16 v211, v177, s57, 0
    v_dot2_f32_bf16 v212, v178, s56, 0
    v_dot2_f32_bf16 v213, v178, s57, 0
    v_dot2_f32_bf16 v214, v179, s56, 0
    v_dot2_f32_bf16 v215, v179, s57, 0
    s_waitcnt vmcnt(7)
    v_dot2_f32_bf16 v208, v180, s56, v208
    v_dot2_f32_bf16 v209, v180, s57, v209
    v_dot2_f32_bf16 v210, v181, s56, v210
    v_dot2_f32_bf16 v211, v181, s57, v211
    v_dot2_f32_bf16 v212, v182, s56, v212
    v_dot2_f32_bf16 v213, v182, s57, v213
    v_dot2_f32_bf16 v214, v183, s56, v214
    v_dot2_f32_bf16 v215, v183, s57, v215
    s_waitcnt vmcnt(6)
    v_dot2_f32_bf16 v208, v184, s56, v208
    v_dot2_f32_bf16 v209, v184, s57, v209
    v_dot2_f32_bf16 v210, v185, s56, v210
    v_dot2_f32_bf16 v211, v185, s57, v211
    v_dot2_f32_bf16 v212, v186, s56, v212
    v_dot2_f32_bf16 v213, v186, s57, v213
    v_dot2_f32_bf16 v214, v187, s56, v214
    v_dot2_f32_bf16 v215, v187, s57, v215
    s_waitcnt vmcnt(5)
    v_dot2_f32_bf16 v208, v188, s56, v208
    v_dot2_f32_bf16 v209, v188, s57, v209
    v_dot2_f32_bf16 v210, v189, s56, v210
    v_dot2_f32_bf16 v211, v189, s57, v211
    v_dot2_f32_bf16 v212, v190, s56, v212
    v_dot2_f32_bf16 v213, v190, s57, v213
    v_dot2_f32_bf16 v214, v191, s56, v214
    v_dot2_f32_bf16 v215, v191, s57, v215
    s_waitcnt vmcnt(4)
    v_dot2_f32_bf16 v208, v192, s56, v208
    v_dot2_f32_bf16 v209, v192, s57, v209
    v_dot2_f32_bf16 v210, v193, s56, v210
    v_dot2_f32_bf16 v211, v193, s57, v211
    v_dot2_f32_bf16 v212, v194, s56, v212
    v_dot2_f32_bf16 v213, v194, s57, v213
    v_dot2_f32_bf16 v214, v195, s56, v214
    v_dot2_f32_bf16 v215, v195, s57, v215
    s_waitcnt vmcnt(3)
    v_dot2_f32_bf16 v208, v196, s56, v208
    v_dot2_f32_bf16 v209, v196, s57, v209
    v_dot2_f32_bf16 v210, v197, s56, v210
    v_dot2_f32_bf16 v211, v197, s57, v211
    v_dot2_f32_bf16 v212, v198, s56, v212
    v_dot2_f32_bf16 v213, v198, s57, v213
    v_dot2_f32_bf16 v214, v199, s56, v214
    v_dot2_f32_bf16 v215, v199, s57, v215
    s_waitcnt vmcnt(2)
    v_dot2_f32_bf16 v208, v200, s56, v208
    v_dot2_f32_bf16 v209, v200, s57, v209
    v_dot2_f32_bf16 v210, v201, s56, v210
    v_dot2_f32_bf16 v211, v201, s57, v211
    v_dot2_f32_bf16 v212, v202, s56, v212
    v_dot2_f32_bf16 v213, v202, s57, v213
    v_dot2_f32_bf16 v214, v203, s56, v214
    v_dot2_f32_bf16 v215, v203, s57, v215
    s_waitcnt vmcnt(1)
    v_dot2_f32_bf16 v208, v204, s56, v208
    v_dot2_f32_bf16 v209, v204, s57, v209
    v_dot2_f32_bf16 v210, v205, s56, v210
    v_dot2_f32_bf16 v211, v205, s57, v211
    v_dot2_f32_bf16 v212, v206, s56, v212
    v_dot2_f32_bf16 v213, v206, s57, v213
    v_dot2_f32_bf16 v214, v207, s56, v214
    v_dot2_f32_bf16 v215, v207, s57, v215
    v_lshlrev_b32 v240, 16, v120
    v_and_b32 v241, s35, v120
    v_lshlrev_b32 v242, 16, v121
    v_and_b32 v243, s35, v121
    v_lshlrev_b32 v244, 16, v122
    v_and_b32 v245, s35, v122
    v_lshlrev_b32 v246, 16, v123
    v_and_b32 v247, s35, v123
    v_pk_fma_f32 v[208:209], v[208:209], v[124:125], v[240:241]
    v_pk_fma_f32 v[210:211], v[210:211], v[126:127], v[242:243]
    v_pk_fma_f32 v[212:213], v[212:213], v[128:129], v[244:245]
    v_pk_fma_f32 v[214:215], v[214:215], v[130:131], v[246:247]
    v_cvt_pk_bf16_f32 v120, v208, v209
    v_cvt_pk_bf16_f32 v121, v210, v211
    v_cvt_pk_bf16_f32 v122, v212, v213
    v_cvt_pk_bf16_f32 v123, v214, v215
    s_lshl_b32 s50, s58, 7
    s_add_u32 s50, s50, s99
    buffer_store_dwordx4 v[120:123], v10, s[12:15], s50 offen
    s_waitcnt vmcnt(0)
    s_branch L_fin_6026
L_fst_6035:
    s_lshl_b32 s50, s53, 11
    s_add_u32 s51, s98, s50
    buffer_load_dwordx4 v[144:147], v4, s[16:19], s51 offen sc1
    s_add_u32 s51, s51, 147456
    buffer_load_dwordx4 v[148:151], v4, s[16:19], s51 offen sc1
    s_add_u32 s51, s51, 147456
    buffer_load_dwordx4 v[152:155], v4, s[16:19], s51 offen sc1
    s_add_u32 s51, s51, 147456
    buffer_load_dwordx4 v[156:159], v4, s[16:19], s51 offen sc1
    s_add_u32 s51, s51, 147456
    buffer_load_dwordx4 v[160:163], v4, s[16:19], s51 offen sc1
    s_add_u32 s51, s51, 147456
    buffer_load_dwordx4 v[164:167], v4, s[16:19], s51 offen sc1
    s_add_u32 s51, s51, 147456
    buffer_load_dwordx4 v[168:171], v4, s[16:19], s51 offen sc1
    s_add_u32 s51, s51, 147456
    buffer_load_dwordx4 v[172:175], v4, s[16:19], s51 offen sc1
    v_pk_mul_f32 v[112:113], v[112:113], s[58:59] op_sel:[0,1] op_sel_hi:[1,1]
    v_pk_mul_f32 v[114:115], v[114:115], s[58:59] op_sel:[0,1] op_sel_hi:[1,1]
    v_pk_mul_f32 v[116:117], v[116:117], s[58:59] op_sel:[0,1] op_sel_hi:[1,1]
    v_pk_mul_f32 v[118:119], v[118:119], s[58:59] op_sel:[0,1] op_sel_hi:[1,1]
    s_waitcnt vmcnt(7)
    v_dot2_f32_bf16 v208, v144, s56, 0
    v_dot2_f32_bf16 v209, v144, s57, 0
    v_dot2_f32_bf16 v210, v145, s56, 0
    v_dot2_f32_bf16 v211, v145, s57, 0
    v_dot2_f32_bf16 v212, v146, s56, 0
    v_dot2_f32_bf16 v213, v146, s57, 0
    v_dot2_f32_bf16 v214, v147, s56, 0
    v_dot2_f32_bf16 v215, v147, s57, 0
    s_waitcnt vmcnt(6)
    v_dot2_f32_bf16 v208, v148, s56, v208
    v_dot2_f32_bf16 v209, v148, s57, v209
    v_dot2_f32_bf16 v210, v149, s56, v210
    v_dot2_f32_bf16 v211, v149, s57, v211
    v_dot2_f32_bf16 v212, v150, s56, v212
    v_dot2_f32_bf16 v213, v150, s57, v213
    v_dot2_f32_bf16 v214, v151, s56, v214
    v_dot2_f32_bf16 v215, v151, s57, v215
    s_waitcnt vmcnt(5)
    v_dot2_f32_bf16 v208, v152, s56, v208
    v_dot2_f32_bf16 v209, v152, s57, v209
    v_dot2_f32_bf16 v210, v153, s56, v210
    v_dot2_f32_bf16 v211, v153, s57, v211
    v_dot2_f32_bf16 v212, v154, s56, v212
    v_dot2_f32_bf16 v213, v154, s57, v213
    v_dot2_f32_bf16 v214, v155, s56, v214
    v_dot2_f32_bf16 v215, v155, s57, v215
    s_waitcnt vmcnt(4)
    v_dot2_f32_bf16 v208, v156, s56, v208
    v_dot2_f32_bf16 v209, v156, s57, v209
    v_dot2_f32_bf16 v210, v157, s56, v210
    v_dot2_f32_bf16 v211, v157, s57, v211
    v_dot2_f32_bf16 v212, v158, s56, v212
    v_dot2_f32_bf16 v213, v158, s57, v213
    v_dot2_f32_bf16 v214, v159, s56, v214
    v_dot2_f32_bf16 v215, v159, s57, v215
    s_waitcnt vmcnt(3)
    v_dot2_f32_bf16 v208, v160, s56, v208
    v_dot2_f32_bf16 v209, v160, s57, v209
    v_dot2_f32_bf16 v210, v161, s56, v210
    v_dot2_f32_bf16 v211, v161, s57, v211
    v_dot2_f32_bf16 v212, v162, s56, v212
    v_dot2_f32_bf16 v213, v162, s57, v213
    v_dot2_f32_bf16 v214, v163, s56, v214
    v_dot2_f32_bf16 v215, v163, s57, v215
    s_waitcnt vmcnt(2)
    v_dot2_f32_bf16 v208, v164, s56, v208
    v_dot2_f32_bf16 v209, v164, s57, v209
    v_dot2_f32_bf16 v210, v165, s56, v210
    v_dot2_f32_bf16 v211, v165, s57, v211
    v_dot2_f32_bf16 v212, v166, s56, v212
    v_dot2_f32_bf16 v213, v166, s57, v213
    v_dot2_f32_bf16 v214, v167, s56, v214
    v_dot2_f32_bf16 v215, v167, s57, v215
    s_waitcnt vmcnt(1)
    v_dot2_f32_bf16 v208, v168, s56, v208
    v_dot2_f32_bf16 v209, v168, s57, v209
    v_dot2_f32_bf16 v210, v169, s56, v210
    v_dot2_f32_bf16 v211, v169, s57, v211
    v_dot2_f32_bf16 v212, v170, s56, v212
    v_dot2_f32_bf16 v213, v170, s57, v213
    v_dot2_f32_bf16 v214, v171, s56, v214
    v_dot2_f32_bf16 v215, v171, s57, v215
    s_waitcnt vmcnt(0)
    v_dot2_f32_bf16 v208, v172, s56, v208
    v_dot2_f32_bf16 v209, v172, s57, v209
    v_dot2_f32_bf16 v210, v173, s56, v210
    v_dot2_f32_bf16 v211, v173, s57, v211
    v_dot2_f32_bf16 v212, v174, s56, v212
    v_dot2_f32_bf16 v213, v174, s57, v213
    v_dot2_f32_bf16 v214, v175, s56, v214
    v_dot2_f32_bf16 v215, v175, s57, v215
    v_lshlrev_b32 v240, 16, v108
    v_and_b32 v241, s35, v108
    v_lshlrev_b32 v242, 16, v109
    v_and_b32 v243, s35, v109
    v_lshlrev_b32 v244, 16, v110
    v_and_b32 v245, s35, v110
    v_lshlrev_b32 v246, 16, v111
    v_and_b32 v247, s35, v111
    v_pk_fma_f32 v[208:209], v[208:209], v[112:113], v[240:241]
    v_pk_fma_f32 v[210:211], v[210:211], v[114:115], v[242:243]
    v_pk_fma_f32 v[212:213], v[212:213], v[116:117], v[244:245]
    v_pk_fma_f32 v[214:215], v[214:215], v[118:119], v[246:247]
    v_cvt_pk_bf16_f32 v108, v208, v209
    v_cvt_pk_bf16_f32 v109, v210, v211
    v_cvt_pk_bf16_f32 v110, v212, v213
    v_cvt_pk_bf16_f32 v111, v214, v215
    s_lshl_b32 s50, s53, 7
    s_add_u32 s50, s50, s99
    buffer_store_dwordx4 v[108:111], v10, s[12:15], s50 offen
    v_cmp_gt_u32 vcc, 3, v9
    s_nop 0
    s_cmp_eq_u64 vcc, 0
    s_cbranch_scc1 L_wok_6041
    v_and_b32 v8, 15, v1
    v_lshlrev_b32 v8, 6, v8
    s_mov_b32 s43, 0
    s_nop 3
L_poll_6042:
    buffer_load_dword v9, v8, s[16:19], s4 offen sc1
    s_add_u32 s43, s43, 1
    s_cmp_gt_u32 s43, 400000
    s_cbranch_scc1 L_polled_6043
    s_waitcnt vmcnt(0)
    v_cmp_gt_u32 vcc, 3, v9
    s_cbranch_vccnz L_poll_6042
L_polled_6043:
    s_waitcnt vmcnt(0)
L_wok_6041:
    s_lshl_b32 s50, s58, 11
    s_add_u32 s51, s98, s50
    buffer_load_dwordx4 v[176:179], v4, s[16:19], s51 offen sc1
    s_add_u32 s51, s51, 147456
    buffer_load_dwordx4 v[180:183], v4, s[16:19], s51 offen sc1
    s_add_u32 s51, s51, 147456
    buffer_load_dwordx4 v[184:187], v4, s[16:19], s51 offen sc1
    s_add_u32 s51, s51, 147456
    buffer_load_dwordx4 v[188:191], v4, s[16:19], s51 offen sc1
    s_add_u32 s51, s51, 147456
    buffer_load_dwordx4 v[192:195], v4, s[16:19], s51 offen sc1
    s_add_u32 s51, s51, 147456
    buffer_load_dwordx4 v[196:199], v4, s[16:19], s51 offen sc1
    s_add_u32 s51, s51, 147456
    buffer_load_dwordx4 v[200:203], v4, s[16:19], s51 offen sc1
    s_add_u32 s51, s51, 147456
    buffer_load_dwordx4 v[204:207], v4, s[16:19], s51 offen sc1
    v_pk_mul_f32 v[124:125], v[124:125], s[58:59] op_sel:[0,1] op_sel_hi:[1,1]
    v_pk_mul_f32 v[126:127], v[126:127], s[58:59] op_sel:[0,1] op_sel_hi:[1,1]
    v_pk_mul_f32 v[128:129], v[128:129], s[58:59] op_sel:[0,1] op_sel_hi:[1,1]
    v_pk_mul_f32 v[130:131], v[130:131], s[58:59] op_sel:[0,1] op_sel_hi:[1,1]
    s_waitcnt vmcnt(7)
    v_dot2_f32_bf16 v208, v176, s56, 0
    v_dot2_f32_bf16 v209, v176, s57, 0
    v_dot2_f32_bf16 v210, v177, s56, 0
    v_dot2_f32_bf16 v211, v177, s57, 0
    v_dot2_f32_bf16 v212, v178, s56, 0
    v_dot2_f32_bf16 v213, v178, s57, 0
    v_dot2_f32_bf16 v214, v179, s56, 0
    v_dot2_f32_bf16 v215, v179, s57, 0
    s_waitcnt vmcnt(6)
    v_dot2_f32_bf16 v208, v180, s56, v208
    v_dot2_f32_bf16 v209, v180, s57, v209
    v_dot2_f32_bf16 v210, v181, s56, v210
    v_dot2_f32_bf16 v211, v181, s57, v211
    v_dot2_f32_bf16 v212, v182, s56, v212
    v_dot2_f32_bf16 v213, v182, s57, v213
    v_dot2_f32_bf16 v214, v183, s56, v214
    v_dot2_f32_bf16 v215, v183, s57, v215
    s_waitcnt vmcnt(5)
    v_dot2_f32_bf16 v208, v184, s56, v208
    v_dot2_f32_bf16 v209, v184, s57, v209
    v_dot2_f32_bf16 v210, v185, s56, v210
    v_dot2_f32_bf16 v211, v185, s57, v211
    v_dot2_f32_bf16 v212, v186, s56, v212
    v_dot2_f32_bf16 v213, v186, s57, v213
    v_dot2_f32_bf16 v214, v187, s56, v214
    v_dot2_f32_bf16 v215, v187, s57, v215
    s_waitcnt vmcnt(4)
    v_dot2_f32_bf16 v208, v188, s56, v208
    v_dot2_f32_bf16 v209, v188, s57, v209
    v_dot2_f32_bf16 v210, v189, s56, v210
    v_dot2_f32_bf16 v211, v189, s57, v211
    v_dot2_f32_bf16 v212, v190, s56, v212
    v_dot2_f32_bf16 v213, v190, s57, v213
    v_dot2_f32_bf16 v214, v191, s56, v214
    v_dot2_f32_bf16 v215, v191, s57, v215
    s_waitcnt vmcnt(3)
    v_dot2_f32_bf16 v208, v192, s56, v208
    v_dot2_f32_bf16 v209, v192, s57, v209
    v_dot2_f32_bf16 v210, v193, s56, v210
    v_dot2_f32_bf16 v211, v193, s57, v211
    v_dot2_f32_bf16 v212, v194, s56, v212
    v_dot2_f32_bf16 v213, v194, s57, v213
    v_dot2_f32_bf16 v214, v195, s56, v214
    v_dot2_f32_bf16 v215, v195, s57, v215
    s_waitcnt vmcnt(2)
    v_dot2_f32_bf16 v208, v196, s56, v208
    v_dot2_f32_bf16 v209, v196, s57, v209
    v_dot2_f32_bf16 v210, v197, s56, v210
    v_dot2_f32_bf16 v211, v197, s57, v211
    v_dot2_f32_bf16 v212, v198, s56, v212
    v_dot2_f32_bf16 v213, v198, s57, v213
    v_dot2_f32_bf16 v214, v199, s56, v214
    v_dot2_f32_bf16 v215, v199, s57, v215
    s_waitcnt vmcnt(1)
    v_dot2_f32_bf16 v208, v200, s56, v208
    v_dot2_f32_bf16 v209, v200, s57, v209
    v_dot2_f32_bf16 v210, v201, s56, v210
    v_dot2_f32_bf16 v211, v201, s57, v211
    v_dot2_f32_bf16 v212, v202, s56, v212
    v_dot2_f32_bf16 v213, v202, s57, v213
    v_dot2_f32_bf16 v214, v203, s56, v214
    v_dot2_f32_bf16 v215, v203, s57, v215
    s_waitcnt vmcnt(0)
    v_dot2_f32_bf16 v208, v204, s56, v208
    v_dot2_f32_bf16 v209, v204, s57, v209
    v_dot2_f32_bf16 v210, v205, s56, v210
    v_dot2_f32_bf16 v211, v205, s57, v211
    v_dot2_f32_bf16 v212, v206, s56, v212
    v_dot2_f32_bf16 v213, v206, s57, v213
    v_dot2_f32_bf16 v214, v207, s56, v214
    v_dot2_f32_bf16 v215, v207, s57, v215
    v_lshlrev_b32 v240, 16, v120
    v_and_b32 v241, s35, v120
    v_lshlrev_b32 v242, 16, v121
    v_and_b32 v243, s35, v121
    v_lshlrev_b32 v244, 16, v122
    v_and_b32 v245, s35, v122
    v_lshlrev_b32 v246, 16, v123
    v_and_b32 v247, s35, v123
    v_pk_fma_f32 v[208:209], v[208:209], v[124:125], v[240:241]
    v_pk_fma_f32 v[210:211], v[210:211], v[126:127], v[242:243]
    v_pk_fma_f32 v[212:213], v[212:213], v[128:129], v[244:245]
    v_pk_fma_f32 v[214:215], v[214:215], v[130:131], v[246:247]
    v_cvt_pk_bf16_f32 v120, v208, v209
    v_cvt_pk_bf16_f32 v121, v210, v211
    v_cvt_pk_bf16_f32 v122, v212, v213
    v_cvt_pk_bf16_f32 v123, v214, v215
    s_lshl_b32 s50, s58, 7
    s_add_u32 s50, s50, s99
    buffer_store_dwordx4 v[120:123], v10, s[12:15], s50 offen
    s_waitcnt vmcnt(0)
    s_branch L_fin_6026
L_fw_6032:
    v_cmp_gt_u32 vcc, 2, v9
    s_nop 0
    s_cmp_eq_u64 vcc, 0
    s_cbranch_scc0 L_fst_6044
    s_lshl_b32 s50, s53, 11
    s_add_u32 s51, s98, s50
    buffer_load_dwordx4 v[144:147], v4, s[16:19], s51 offen sc1
    s_add_u32 s51, s51, 147456
    buffer_load_dwordx4 v[148:151], v4, s[16:19], s51 offen sc1
    s_add_u32 s51, s51, 147456
    buffer_load_dwordx4 v[152:155], v4, s[16:19], s51 offen sc1
    s_add_u32 s51, s51, 147456
    buffer_load_dwordx4 v[156:159], v4, s[16:19], s51 offen sc1
    s_add_u32 s51, s51, 147456
    buffer_load_dwordx4 v[160:163], v4, s[16:19], s51 offen sc1
    s_add_u32 s51, s51, 147456
    buffer_load_dwordx4 v[164:167], v4, s[16:19], s51 offen sc1
    s_add_u32 s51, s51, 147456
    buffer_load_dwordx4 v[168:171], v4, s[16:19], s51 offen sc1
    s_add_u32 s51, s51, 147456
    buffer_load_dwordx4 v[172:175], v4, s[16:19], s51 offen sc1
    v_pk_mul_f32 v[100:101], v[100:101], s[58:59] op_sel:[0,1] op_sel_hi:[1,1]
    v_pk_mul_f32 v[102:103], v[102:103], s[58:59] op_sel:[0,1] op_sel_hi:[1,1]
    v_pk_mul_f32 v[104:105], v[104:105], s[58:59] op_sel:[0,1] op_sel_hi:[1,1]
    v_pk_mul_f32 v[106:107], v[106:107], s[58:59] op_sel:[0,1] op_sel_hi:[1,1]
    s_waitcnt vmcnt(15)
    v_dot2_f32_bf16 v208, v16, s56, 0
    v_dot2_f32_bf16 v209, v16, s57, 0
    v_dot2_f32_bf16 v210, v17, s56, 0
    v_dot2_f32_bf16 v211, v17, s57, 0
    v_dot2_f32_bf16 v212, v18, s56, 0
    v_dot2_f32_bf16 v213, v18, s57, 0
    v_dot2_f32_bf16 v214, v19, s56, 0
    v_dot2_f32_bf16 v215, v19, s57, 0
    s_waitcnt vmcnt(14)
    v_dot2_f32_bf16 v208, v20, s56, v208
    v_dot2_f32_bf16 v209, v20, s57, v209
    v_dot2_f32_bf16 v210, v21, s56, v210
    v_dot2_f32_bf16 v211, v21, s57, v211
    v_dot2_f32_bf16 v212, v22, s56, v212
    v_dot2_f32_bf16 v213, v22, s57, v213
    v_dot2_f32_bf16 v214, v23, s56, v214
    v_dot2_f32_bf16 v215, v23, s57, v215
    s_waitcnt vmcnt(13)
    v_dot2_f32_bf16 v208, v24, s56, v208
    v_dot2_f32_bf16 v209, v24, s57, v209
    v_dot2_f32_bf16 v210, v25, s56, v210
    v_dot2_f32_bf16 v211, v25, s57, v211
    v_dot2_f32_bf16 v212, v26, s56, v212
    v_dot2_f32_bf16 v213, v26, s57, v213
    v_dot2_f32_bf16 v214, v27, s56, v214
    v_dot2_f32_bf16 v215, v27, s57, v215
    s_waitcnt vmcnt(12)
    v_dot2_f32_bf16 v208, v28, s56, v208
    v_dot2_f32_bf16 v209, v28, s57, v209
    v_dot2_f32_bf16 v210, v29, s56, v210
    v_dot2_f32_bf16 v211, v29, s57, v211
    v_dot2_f32_bf16 v212, v30, s56, v212
    v_dot2_f32_bf16 v213, v30, s57, v213
    v_dot2_f32_bf16 v214, v31, s56, v214
    v_dot2_f32_bf16 v215, v31, s57, v215
    s_waitcnt vmcnt(11)
    v_dot2_f32_bf16 v208, v32, s56, v208
    v_dot2_f32_bf16 v209, v32, s57, v209
    v_dot2_f32_bf16 v210, v33, s56, v210
    v_dot2_f32_bf16 v211, v33, s57, v211
    v_dot2_f32_bf16 v212, v34, s56, v212
    v_dot2_f32_bf16 v213, v34, s57, v213
    v_dot2_f32_bf16 v214, v35, s56, v214
    v_dot2_f32_bf16 v215, v35, s57, v215
    s_waitcnt vmcnt(10)
    v_dot2_f32_bf16 v208, v36, s56, v208
    v_dot2_f32_bf16 v209, v36, s57, v209
    v_dot2_f32_bf16 v210, v37, s56, v210
    v_dot2_f32_bf16 v211, v37, s57, v211
    v_dot2_f32_bf16 v212, v38, s56, v212
    v_dot2_f32_bf16 v213, v38, s57, v213
    v_dot2_f32_bf16 v214, v39, s56, v214
    v_dot2_f32_bf16 v215, v39, s57, v215
    s_waitcnt vmcnt(9)
    v_dot2_f32_bf16 v208, v40, s56, v208
    v_dot2_f32_bf16 v209, v40, s57, v209
    v_dot2_f32_bf16 v210, v41, s56, v210
    v_dot2_f32_bf16 v211, v41, s57, v211
    v_dot2_f32_bf16 v212, v42, s56, v212
    v_dot2_f32_bf16 v213, v42, s57, v213
    v_dot2_f32_bf16 v214, v43, s56, v214
    v_dot2_f32_bf16 v215, v43, s57, v215
    s_waitcnt vmcnt(8)
    v_dot2_f32_bf16 v208, v44, s56, v208
    v_dot2_f32_bf16 v209, v44, s57, v209
    v_dot2_f32_bf16 v210, v45, s56, v210
    v_dot2_f32_bf16 v211, v45, s57, v211
    v_dot2_f32_bf16 v212, v46, s56, v212
    v_dot2_f32_bf16 v213, v46, s57, v213
    v_dot2_f32_bf16 v214, v47, s56, v214
    v_dot2_f32_bf16 v215, v47, s57, v215
    v_lshlrev_b32 v240, 16, v96
    v_and_b32 v241, s35, v96
    v_lshlrev_b32 v242, 16, v97
    v_and_b32 v243, s35, v97
    v_lshlrev_b32 v244, 16, v98
    v_and_b32 v245, s35, v98
    v_lshlrev_b32 v246, 16, v99
    v_and_b32 v247, s35, v99
    v_pk_fma_f32 v[208:209], v[208:209], v[100:101], v[240:241]
    v_pk_fma_f32 v[210:211], v[210:211], v[102:103], v[242:243]
    v_pk_fma_f32 v[212:213], v[212:213], v[104:105], v[244:245]
    v_pk_fma_f32 v[214:215], v[214:215], v[106:107], v[246:247]
    v_cvt_pk_bf16_f32 v96, v208, v209
    v_cvt_pk_bf16_f32 v97, v210, v211
    v_cvt_pk_bf16_f32 v98, v212, v213
    v_cvt_pk_bf16_f32 v99, v214, v215
    s_lshl_b32 s50, s52, 7
    s_add_u32 s50, s50, s99
    buffer_store_dwordx4 v[96:99], v10, s[12:15], s50 offen
    v_pk_mul_f32 v[112:113], v[112:113], s[58:59] op_sel:[0,1] op_sel_hi:[1,1]
    v_pk_mul_f32 v[114:115], v[114:115], s[58:59] op_sel:[0,1] op_sel_hi:[1,1]
    v_pk_mul_f32 v[116:117], v[116:117], s[58:59] op_sel:[0,1] op_sel_hi:[1,1]
    v_pk_mul_f32 v[118:119], v[118:119], s[58:59] op_sel:[0,1] op_sel_hi:[1,1]
    s_waitcnt vmcnt(8)
    v_dot2_f32_bf16 v208, v144, s56, 0
    v_dot2_f32_bf16 v209, v144, s57, 0
    v_dot2_f32_bf16 v210, v145, s56, 0
    v_dot2_f32_bf16 v211, v145, s57, 0
    v_dot2_f32_bf16 v212, v146, s56, 0
    v_dot2_f32_bf16 v213, v146, s57, 0
    v_dot2_f32_bf16 v214, v147, s56, 0
    v_dot2_f32_bf16 v215, v147, s57, 0
    s_waitcnt vmcnt(7)
    v_dot2_f32_bf16 v208, v148, s56, v208
    v_dot2_f32_bf16 v209, v148, s57, v209
    v_dot2_f32_bf16 v210, v149, s56, v210
    v_dot2_f32_bf16 v211, v149, s57, v211
    v_dot2_f32_bf16 v212, v150, s56, v212
    v_dot2_f32_bf16 v213, v150, s57, v213
    v_dot2_f32_bf16 v214, v151, s56, v214
    v_dot2_f32_bf16 v215, v151, s57, v215
    s_waitcnt vmcnt(6)
    v_dot2_f32_bf16 v208, v152, s56, v208
    v_dot2_f32_bf16 v209, v152, s57, v209
    v_dot2_f32_bf16 v210, v153, s56, v210
    v_dot2_f32_bf16 v211, v153, s57, v211
    v_dot2_f32_bf16 v212, v154, s56, v212
    v_dot2_f32_bf16 v213, v154, s57, v213
    v_dot2_f32_bf16 v214, v155, s56, v214
    v_dot2_f32_bf16 v215, v155, s57, v215
    s_waitcnt vmcnt(5)
    v_dot2_f32_bf16 v208, v156, s56, v208
    v_dot2_f32_bf16 v209, v156, s57, v209
    v_dot2_f32_bf16 v210, v157, s56, v210
    v_dot2_f32_bf16 v211, v157, s57, v211
    v_dot2_f32_bf16 v212, v158, s56, v212
    v_dot2_f32_bf16 v213, v158, s57, v213
    v_dot2_f32_bf16 v214, v159, s56, v214
    v_dot2_f32_bf16 v215, v159, s57, v215
    s_waitcnt vmcnt(4)
    v_dot2_f32_bf16 v208, v160, s56, v208
    v_dot2_f32_bf16 v209, v160, s57, v209
    v_dot2_f32_bf16 v210, v161, s56, v210
    v_dot2_f32_bf16 v211, v161, s57, v211
    v_dot2_f32_bf16 v212, v162, s56, v212
    v_dot2_f32_bf16 v213, v162, s57, v213
    v_dot2_f32_bf16 v214, v163, s56, v214
    v_dot2_f32_bf16 v215, v163, s57, v215
    s_waitcnt vmcnt(3)
    v_dot2_f32_bf16 v208, v164, s56, v208
    v_dot2_f32_bf16 v209, v164, s57, v209
    v_dot2_f32_bf16 v210, v165, s56, v210
    v_dot2_f32_bf16 v211, v165, s57, v211
    v_dot2_f32_bf16 v212, v166, s56, v212
    v_dot2_f32_bf16 v213, v166, s57, v213
    v_dot2_f32_bf16 v214, v167, s56, v214
    v_dot2_f32_bf16 v215, v167, s57, v215
    s_waitcnt vmcnt(2)
    v_dot2_f32_bf16 v208, v168, s56, v208
    v_dot2_f32_bf16 v209, v168, s57, v209
    v_dot2_f32_bf16 v210, v169, s56, v210
    v_dot2_f32_bf16 v211, v169, s57, v211
    v_dot2_f32_bf16 v212, v170, s56, v212
    v_dot2_f32_bf16 v213, v170, s57, v213
    v_dot2_f32_bf16 v214, v171, s56, v214
    v_dot2_f32_bf16 v215, v171, s57, v215
    s_waitcnt vmcnt(1)
    v_dot2_f32_bf16 v208, v172, s56, v208
    v_dot2_f32_bf16 v209, v172, s57, v209
    v_dot2_f32_bf16 v210, v173, s56, v210
    v_dot2_f32_bf16 v211, v173, s57, v211
    v_dot2_f32_bf16 v212, v174, s56, v212
    v_dot2_f32_bf16 v213, v174, s57, v213
    v_dot2_f32_bf16 v214, v175, s56, v214
    v_dot2_f32_bf16 v215, v175, s57, v215
    v_lshlrev_b32 v240, 16, v108
    v_and_b32 v241, s35, v108
    v_lshlrev_b32 v242, 16, v109
    v_and_b32 v243, s35, v109
    v_lshlrev_b32 v244, 16, v110
    v_and_b32 v245, s35, v110
    v_lshlrev_b32 v246, 16, v111
    v_and_b32 v247, s35, v111
    v_pk_fma_f32 v[208:209], v[208:209], v[112:113], v[240:241]
    v_pk_fma_f32 v[210:211], v[210:211], v[114:115], v[242:243]
    v_pk_fma_f32 v[212:213], v[212:213], v[116:117], v[244:245]
    v_pk_fma_f32 v[214:215], v[214:215], v[118:119], v[246:247]
    v_cvt_pk_bf16_f32 v108, v208, v209
    v_cvt_pk_bf16_f32 v109, v210, v211
    v_cvt_pk_bf16_f32 v110, v212, v213
    v_cvt_pk_bf16_f32 v111, v214, v215
    s_lshl_b32 s50, s53, 7
    s_add_u32 s50, s50, s99
    buffer_store_dwordx4 v[108:111], v10, s[12:15], s50 offen
    s_waitcnt vmcnt(0)
    s_branch L_fin_6026
L_fst_6044:
    v_pk_mul_f32 v[100:101], v[100:101], s[58:59] op_sel:[0,1] op_sel_hi:[1,1]
    v_pk_mul_f32 v[102:103], v[102:103], s[58:59] op_sel:[0,1] op_sel_hi:[1,1]
    v_pk_mul_f32 v[104:105], v[104:105], s[58:59] op_sel:[0,1] op_sel_hi:[1,1]
    v_pk_mul_f32 v[106:107], v[106:107], s[58:59] op_sel:[0,1] op_sel_hi:[1,1]
    s_waitcnt vmcnt(7)
    v_dot2_f32_bf16 v208, v16, s56, 0
    v_dot2_f32_bf16 v209, v16, s57, 0
    v_dot2_f32_bf16 v210, v17, s56, 0
    v_dot2_f32_bf16 v211, v17, s57, 0
    v_dot2_f32_bf16 v212, v18, s56, 0
    v_dot2_f32_bf16 v213, v18, s57, 0
    v_dot2_f32_bf16 v214, v19, s56, 0
    v_dot2_f32_bf16 v215, v19, s57, 0
    s_waitcnt vmcnt(6)
    v_dot2_f32_bf16 v208, v20, s56, v208
    v_dot2_f32_bf16 v209, v20, s57, v209
    v_dot2_f32_bf16 v210, v21, s56, v210
    v_dot2_f32_bf16 v211, v21, s57, v211
    v_dot2_f32_bf16 v212, v22, s56, v212
    v_dot2_f32_bf16 v213, v22, s57, v213
    v_dot2_f32_bf16 v214, v23, s56, v214
    v_dot2_f32_bf16 v215, v23, s57, v215
    s_waitcnt vmcnt(5)
    v_dot2_f32_bf16 v208, v24, s56, v208
    v_dot2_f32_bf16 v209, v24, s57, v209
    v_dot2_f32_bf16 v210, v25, s56, v210
    v_dot2_f32_bf16 v211, v25, s57, v211
    v_dot2_f32_bf16 v212, v26, s56, v212
    v_dot2_f32_bf16 v213, v26, s57, v213
    v_dot2_f32_bf16 v214, v27, s56, v214
    v_dot2_f32_bf16 v215, v27, s57, v215
    s_waitcnt vmcnt(4)
    v_dot2_f32_bf16 v208, v28, s56, v208
    v_dot2_f32_bf16 v209, v28, s57, v209
    v_dot2_f32_bf16 v210, v29, s56, v210
    v_dot2_f32_bf16 v211, v29, s57, v211
    v_dot2_f32_bf16 v212, v30, s56, v212
    v_dot2_f32_bf16 v213, v30, s57, v213
    v_dot2_f32_bf16 v214, v31, s56, v214
    v_dot2_f32_bf16 v215, v31, s57, v215
    s_waitcnt vmcnt(3)
    v_dot2_f32_bf16 v208, v32, s56, v208
    v_dot2_f32_bf16 v209, v32, s57, v209
    v_dot2_f32_bf16 v210, v33, s56, v210
    v_dot2_f32_bf16 v211, v33, s57, v211
    v_dot2_f32_bf16 v212, v34, s56, v212
    v_dot2_f32_bf16 v213, v34, s57, v213
    v_dot2_f32_bf16 v214, v35, s56, v214
    v_dot2_f32_bf16 v215, v35, s57, v215
    s_waitcnt vmcnt(2)
    v_dot2_f32_bf16 v208, v36, s56, v208
    v_dot2_f32_bf16 v209, v36, s57, v209
    v_dot2_f32_bf16 v210, v37, s56, v210
    v_dot2_f32_bf16 v211, v37, s57, v211
    v_dot2_f32_bf16 v212, v38, s56, v212
    v_dot2_f32_bf16 v213, v38, s57, v213
    v_dot2_f32_bf16 v214, v39, s56, v214
    v_dot2_f32_bf16 v215, v39, s57, v215
    s_waitcnt vmcnt(1)
    v_dot2_f32_bf16 v208, v40, s56, v208
    v_dot2_f32_bf16 v209, v40, s57, v209
    v_dot2_f32_bf16 v210, v41, s56, v210
    v_dot2_f32_bf16 v211, v41, s57, v211
    v_dot2_f32_bf16 v212, v42, s56, v212
    v_dot2_f32_bf16 v213, v42, s57, v213
    v_dot2_f32_bf16 v214, v43, s56, v214
    v_dot2_f32_bf16 v215, v43, s57, v215
    s_waitcnt vmcnt(0)
    v_dot2_f32_bf16 v208, v44, s56, v208
    v_dot2_f32_bf16 v209, v44, s57, v209
    v_dot2_f32_bf16 v210, v45, s56, v210
    v_dot2_f32_bf16 v211, v45, s57, v211
    v_dot2_f32_bf16 v212, v46, s56, v212
    v_dot2_f32_bf16 v213, v46, s57, v213
    v_dot2_f32_bf16 v214, v47, s56, v214
    v_dot2_f32_bf16 v215, v47, s57, v215
    v_lshlrev_b32 v240, 16, v96
    v_and_b32 v241, s35, v96
    v_lshlrev_b32 v242, 16, v97
    v_and_b32 v243, s35, v97
    v_lshlrev_b32 v244, 16, v98
    v_and_b32 v245, s35, v98
    v_lshlrev_b32 v246, 16, v99
    v_and_b32 v247, s35, v99
    v_pk_fma_f32 v[208:209], v[208:209], v[100:101], v[240:241]
    v_pk_fma_f32 v[210:211], v[210:211], v[102:103], v[242:243]
    v_pk_fma_f32 v[212:213], v[212:213], v[104:105], v[244:245]
    v_pk_fma_f32 v[214:215], v[214:215], v[106:107], v[246:247]
    v_cvt_pk_bf16_f32 v96, v208, v209
    v_cvt_pk_bf16_f32 v97, v210, v211
    v_cvt_pk_bf16_f32 v98, v212, v213
    v_cvt_pk_bf16_f32 v99, v214, v215
    s_lshl_b32 s50, s52, 7
    s_add_u32 s50, s50, s99
    buffer_store_dwordx4 v[96:99], v10, s[12:15], s50 offen
    v_cmp_gt_u32 vcc, 2, v9
    s_nop 0
    s_cmp_eq_u64 vcc, 0
    s_cbranch_scc1 L_wok_6047
    v_and_b32 v8, 15, v1
    v_lshlrev_b32 v8, 6, v8
    s_mov_b32 s43, 0
    s_nop 3
L_poll_6048:
    buffer_load_dword v9, v8, s[16:19], s4 offen sc1
    s_add_u32 s43, s43, 1
    s_cmp_gt_u32 s43, 400000
    s_cbranch_scc1 L_polled_6049
    s_waitcnt vmcnt(0)
    v_cmp_gt_u32 vcc, 2, v9
    s_cbranch_vccnz L_poll_6048
L_polled_6049:
    s_waitcnt vmcnt(0)
L_wok_6047:
    s_lshl_b32 s50, s53, 11
    s_add_u32 s51, s98, s50
    buffer_load_dwordx4 v[144:147], v4, s[16:19], s51 offen sc1
    s_add_u32 s51, s51, 147456
    buffer_load_dwordx4 v[148:151], v4, s[16:19], s51 offen sc1
    s_add_u32 s51, s51, 147456
    buffer_load_dwordx4 v[152:155], v4, s[16:19], s51 offen sc1
    s_add_u32 s51, s51, 147456
    buffer_load_dwordx4 v[156:159], v4, s[16:19], s51 offen sc1
    s_add_u32 s51, s51, 147456
    buffer_load_dwordx4 v[160:163], v4, s[16:19], s51 offen sc1
    s_add_u32 s51, s51, 147456
    buffer_load_dwordx4 v[164:167], v4, s[16:19], s51 offen sc1
    s_add_u32 s51, s51, 147456
    buffer_load_dwordx4 v[168:171], v4, s[16:19], s51 offen sc1
    s_add_u32 s51, s51, 147456
    buffer_load_dwordx4 v[172:175], v4, s[16:19], s51 offen sc1
    v_pk_mul_f32 v[112:113], v[112:113], s[58:59] op_sel:[0,1] op_sel_hi:[1,1]
    v_pk_mul_f32 v[114:115], v[114:115], s[58:59] op_sel:[0,1] op_sel_hi:[1,1]
    v_pk_mul_f32 v[116:117], v[116:117], s[58:59] op_sel:[0,1] op_sel_hi:[1,1]
    v_pk_mul_f32 v[118:119], v[118:119], s[58:59] op_sel:[0,1] op_sel_hi:[1,1]
    s_waitcnt vmcnt(7)
    v_dot2_f32_bf16 v208, v144, s56, 0
    v_dot2_f32_bf16 v209, v144, s57, 0
    v_dot2_f32_bf16 v210, v145, s56, 0
    v_dot2_f32_bf16 v211, v145, s57, 0
    v_dot2_f32_bf16 v212, v146, s56, 0
    v_dot2_f32_bf16 v213, v146, s57, 0
    v_dot2_f32_bf16 v214, v147, s56, 0
    v_dot2_f32_bf16 v215, v147, s57, 0
    s_waitcnt vmcnt(6)
    v_dot2_f32_bf16 v208, v148, s56, v208
    v_dot2_f32_bf16 v209, v148, s57, v209
    v_dot2_f32_bf16 v210, v149, s56, v210
    v_dot2_f32_bf16 v211, v149, s57, v211
    v_dot2_f32_bf16 v212, v150, s56, v212
    v_dot2_f32_bf16 v213, v150, s57, v213
    v_dot2_f32_bf16 v214, v151, s56, v214
    v_dot2_f32_bf16 v215, v151, s57, v215
    s_waitcnt vmcnt(5)
    v_dot2_f32_bf16 v208, v152, s56, v208
    v_dot2_f32_bf16 v209, v152, s57, v209
    v_dot2_f32_bf16 v210, v153, s56, v210
    v_dot2_f32_bf16 v211, v153, s57, v211
    v_dot2_f32_bf16 v212, v154, s56, v212
    v_dot2_f32_bf16 v213, v154, s57, v213
    v_dot2_f32_bf16 v214, v155, s56, v214
    v_dot2_f32_bf16 v215, v155, s57, v215
    s_waitcnt vmcnt(4)
    v_dot2_f32_bf16 v208, v156, s56, v208
    v_dot2_f32_bf16 v209, v156, s57, v209
    v_dot2_f32_bf16 v210, v157, s56, v210
    v_dot2_f32_bf16 v211, v157, s57, v211
    v_dot2_f32_bf16 v212, v158, s56, v212
    v_dot2_f32_bf16 v213, v158, s57, v213
    v_dot2_f32_bf16 v214, v159, s56, v214
    v_dot2_f32_bf16 v215, v159, s57, v215
    s_waitcnt vmcnt(3)
    v_dot2_f32_bf16 v208, v160, s56, v208
    v_dot2_f32_bf16 v209, v160, s57, v209
    v_dot2_f32_bf16 v210, v161, s56, v210
    v_dot2_f32_bf16 v211, v161, s57, v211
    v_dot2_f32_bf16 v212, v162, s56, v212
    v_dot2_f32_bf16 v213, v162, s57, v213
    v_dot2_f32_bf16 v214, v163, s56, v214
    v_dot2_f32_bf16 v215, v163, s57, v215
    s_waitcnt vmcnt(2)
    v_dot2_f32_bf16 v208, v164, s56, v208
    v_dot2_f32_bf16 v209, v164, s57, v209
    v_dot2_f32_bf16 v210, v165, s56, v210
    v_dot2_f32_bf16 v211, v165, s57, v211
    v_dot2_f32_bf16 v212, v166, s56, v212
    v_dot2_f32_bf16 v213, v166, s57, v213
    v_dot2_f32_bf16 v214, v167, s56, v214
    v_dot2_f32_bf16 v215, v167, s57, v215
    s_waitcnt vmcnt(1)
    v_dot2_f32_bf16 v208, v168, s56, v208
    v_dot2_f32_bf16 v209, v168, s57, v209
    v_dot2_f32_bf16 v210, v169, s56, v210
    v_dot2_f32_bf16 v211, v169, s57, v211
    v_dot2_f32_bf16 v212, v170, s56, v212
    v_dot2_f32_bf16 v213, v170, s57, v213
    v_dot2_f32_bf16 v214, v171, s56, v214
    v_dot2_f32_bf16 v215, v171, s57, v215
    s_waitcnt vmcnt(0)
    v_dot2_f32_bf16 v208, v172, s56, v208
    v_dot2_f32_bf16 v209, v172, s57, v209
    v_dot2_f32_bf16 v210, v173, s56, v210
    v_dot2_f32_bf16 v211, v173, s57, v211
    v_dot2_f32_bf16 v212, v174, s56, v212
    v_dot2_f32_bf16 v213, v174, s57, v213
    v_dot2_f32_bf16 v214, v175, s56, v214
    v_dot2_f32_bf16 v215, v175, s57, v215
    v_lshlrev_b32 v240, 16, v108
    v_and_b32 v241, s35, v108
    v_lshlrev_b32 v242, 16, v109
    v_and_b32 v243, s35, v109
    v_lshlrev_b32 v244, 16, v110
    v_and_b32 v245, s35, v110
    v_lshlrev_b32 v246, 16, v111
    v_and_b32 v247, s35, v111
    v_pk_fma_f32 v[208:209], v[208:209], v[112:113], v[240:241]
    v_pk_fma_f32 v[210:211], v[210:211], v[114:115], v[242:243]
    v_pk_fma_f32 v[212:213], v[212:213], v[116:117], v[244:245]
    v_pk_fma_f32 v[214:215], v[214:215], v[118:119], v[246:247]
    v_cvt_pk_bf16_f32 v108, v208, v209
    v_cvt_pk_bf16_f32 v109, v210, v211
    v_cvt_pk_bf16_f32 v110, v212, v213
    v_cvt_pk_bf16_f32 v111, v214, v215
    s_lshl_b32 s50, s53, 7
    s_add_u32 s50, s50, s99
    buffer_store_dwordx4 v[108:111], v10, s[12:15], s50 offen
    s_waitcnt vmcnt(0)
    s_branch L_fin_6026
L_fw_6033:
    v_cmp_gt_u32 vcc, 3, v9
    s_nop 0
    s_cmp_eq_u64 vcc, 0
    s_cbranch_scc0 L_fst_6050
    s_lshl_b32 s50, s58, 11
    s_add_u32 s51, s98, s50
    buffer_load_dwordx4 v[176:179], v4, s[16:19], s51 offen sc1
    s_add_u32 s51, s51, 147456
    buffer_load_dwordx4 v[180:183], v4, s[16:19], s51 offen sc1
    s_add_u32 s51, s51, 147456
    buffer_load_dwordx4 v[184:187], v4, s[16:19], s51 offen sc1
    s_add_u32 s51, s51, 147456
    buffer_load_dwordx4 v[188:191], v4, s[16:19], s51 offen sc1
    s_add_u32 s51, s51, 147456
    buffer_load_dwordx4 v[192:195], v4, s[16:19], s51 offen sc1
    s_add_u32 s51, s51, 147456
    buffer_load_dwordx4 v[196:199], v4, s[16:19], s51 offen sc1
    s_add_u32 s51, s51, 147456
    buffer_load_dwordx4 v[200:203], v4, s[16:19], s51 offen sc1
    s_add_u32 s51, s51, 147456
    buffer_load_dwordx4 v[204:207], v4, s[16:19], s51 offen sc1
    v_pk_mul_f32 v[100:101], v[100:101], s[58:59] op_sel:[0,1] op_sel_hi:[1,1]
    v_pk_mul_f32 v[102:103], v[102:103], s[58:59] op_sel:[0,1] op_sel_hi:[1,1]
    v_pk_mul_f32 v[104:105], v[104:105], s[58:59] op_sel:[0,1] op_sel_hi:[1,1]
    v_pk_mul_f32 v[106:107], v[106:107], s[58:59] op_sel:[0,1] op_sel_hi:[1,1]
    s_waitcnt vmcnt(15)
    v_dot2_f32_bf16 v208, v16, s56, 0
    v_dot2_f32_bf16 v209, v16, s57, 0
    v_dot2_f32_bf16 v210, v17, s56, 0
    v_dot2_f32_bf16 v211, v17, s57, 0
    v_dot2_f32_bf16 v212, v18, s56, 0
    v_dot2_f32_bf16 v213, v18, s57, 0
    v_dot2_f32_bf16 v214, v19, s56, 0
    v_dot2_f32_bf16 v215, v19, s57, 0
    s_waitcnt vmcnt(14)
    v_dot2_f32_bf16 v208, v20, s56, v208
    v_dot2_f32_bf16 v209, v20, s57, v209
    v_dot2_f32_bf16 v210, v21, s56, v210
    v_dot2_f32_bf16 v211, v21, s57, v211
    v_dot2_f32_bf16 v212, v22, s56, v212
    v_dot2_f32_bf16 v213, v22, s57, v213
    v_dot2_f32_bf16 v214, v23, s56, v214
    v_dot2_f32_bf16 v215, v23, s57, v215
    s_waitcnt vmcnt(13)
    v_dot2_f32_bf16 v208, v24, s56, v208
    v_dot2_f32_bf16 v209, v24, s57, v209
    v_dot2_f32_bf16 v210, v25, s56, v210
    v_dot2_f32_bf16 v211, v25, s57, v211
    v_dot2_f32_bf16 v212, v26, s56, v212
    v_dot2_f32_bf16 v213, v26, s57, v213
    v_dot2_f32_bf16 v214, v27, s56, v214
    v_dot2_f32_bf16 v215, v27, s57, v215
    s_waitcnt vmcnt(12)
    v_dot2_f32_bf16 v208, v28, s56, v208
    v_dot2_f32_bf16 v209, v28, s57, v209
    v_dot2_f32_bf16 v210, v29, s56, v210
    v_dot2_f32_bf16 v211, v29, s57, v211
    v_dot2_f32_bf16 v212, v30, s56, v212
    v_dot2_f32_bf16 v213, v30, s57, v213
    v_dot2_f32_bf16 v214, v31, s56, v214
    v_dot2_f32_bf16 v215, v31, s57, v215
    s_waitcnt vmcnt(11)
    v_dot2_f32_bf16 v208, v32, s56, v208
    v_dot2_f32_bf16 v209, v32, s57, v209
    v_dot2_f32_bf16 v210, v33, s56, v210
    v_dot2_f32_bf16 v211, v33, s57, v211
    v_dot2_f32_bf16 v212, v34, s56, v212
    v_dot2_f32_bf16 v213, v34, s57, v213
    v_dot2_f32_bf16 v214, v35, s56, v214
    v_dot2_f32_bf16 v215, v35, s57, v215
    s_waitcnt vmcnt(10)
    v_dot2_f32_bf16 v208, v36, s56, v208
    v_dot2_f32_bf16 v209, v36, s57, v209
    v_dot2_f32_bf16 v210, v37, s56, v210
    v_dot2_f32_bf16 v211, v37, s57, v211
    v_dot2_f32_bf16 v212, v38, s56, v212
    v_dot2_f32_bf16 v213, v38, s57, v213
    v_dot2_f32_bf16 v214, v39, s56, v214
    v_dot2_f32_bf16 v215, v39, s57, v215
    s_waitcnt vmcnt(9)
    v_dot2_f32_bf16 v208, v40, s56, v208
    v_dot2_f32_bf16 v209, v40, s57, v209
    v_dot2_f32_bf16 v210, v41, s56, v210
    v_dot2_f32_bf16 v211, v41, s57, v211
    v_dot2_f32_bf16 v212, v42, s56, v212
    v_dot2_f32_bf16 v213, v42, s57, v213
    v_dot2_f32_bf16 v214, v43, s56, v214
    v_dot2_f32_bf16 v215, v43, s57, v215
    s_waitcnt vmcnt(8)
    v_dot2_f32_bf16 v208, v44, s56, v208
    v_dot2_f32_bf16 v209, v44, s57, v209
    v_dot2_f32_bf16 v210, v45, s56, v210
    v_dot2_f32_bf16 v211, v45, s57, v211
    v_dot2_f32_bf16 v212, v46, s56, v212
    v_dot2_f32_bf16 v213, v46, s57, v213
    v_dot2_f32_bf16 v214, v47, s56, v214
    v_dot2_f32_bf16 v215, v47, s57, v215
    v_lshlrev_b32 v240, 16, v96
    v_and_b32 v241, s35, v96
    v_lshlrev_b32 v242, 16, v97
    v_and_b32 v243, s35, v97
    v_lshlrev_b32 v244, 16, v98
    v_and_b32 v245, s35, v98
    v_lshlrev_b32 v246, 16, v99
    v_and_b32 v247, s35, v99
    v_pk_fma_f32 v[208:209], v[208:209], v[100:101], v[240:241]
    v_pk_fma_f32 v[210:211], v[210:211], v[102:103], v[242:243]
    v_pk_fma_f32 v[212:213], v[212:213], v[104:105], v[244:245]
    v_pk_fma_f32 v[214:215], v[214:215], v[106:107], v[246:247]
    v_cvt_pk_bf16_f32 v96, v208, v209
    v_cvt_pk_bf16_f32 v97, v210, v211
    v_cvt_pk_bf16_f32 v98, v212, v213
    v_cvt_pk_bf16_f32 v99, v214, v215
    s_lshl_b32 s50, s52, 7
    s_add_u32 s50, s50, s99
    buffer_store_dwordx4 v[96:99], v10, s[12:15], s50 offen
    v_pk_mul_f32 v[124:125], v[124:125], s[58:59] op_sel:[0,1] op_sel_hi:[1,1]
    v_pk_mul_f32 v[126:127], v[126:127], s[58:59] op_sel:[0,1] op_sel_hi:[1,1]
    v_pk_mul_f32 v[128:129], v[128:129], s[58:59] op_sel:[0,1] op_sel_hi:[1,1]
    v_pk_mul_f32 v[130:131], v[130:131], s[58:59] op_sel:[0,1] op_sel_hi:[1,1]
    s_waitcnt vmcnt(8)
    v_dot2_f32_bf16 v208, v176, s56, 0
    v_dot2_f32_bf16 v209, v176, s57, 0
    v_dot2_f32_bf16 v210, v177, s56, 0
    v_dot2_f32_bf16 v211, v177, s57, 0
    v_dot2_f32_bf16 v212, v178, s56, 0
    v_dot2_f32_bf16 v213, v178, s57, 0
    v_dot2_f32_bf16 v214, v179, s56, 0
    v_dot2_f32_bf16 v215, v179, s57, 0
    s_waitcnt vmcnt(7)
    v_dot2_f32_bf16 v208, v180, s56, v208
    v_dot2_f32_bf16 v209, v180, s57, v209
    v_dot2_f32_bf16 v210, v181, s56, v210
    v_dot2_f32_bf16 v211, v181, s57, v211
    v_dot2_f32_bf16 v212, v182, s56, v212
    v_dot2_f32_bf16 v213, v182, s57, v213
    v_dot2_f32_bf16 v214, v183, s56, v214
    v_dot2_f32_bf16 v215, v183, s57, v215
    s_waitcnt vmcnt(6)
    v_dot2_f32_bf16 v208, v184, s56, v208
    v_dot2_f32_bf16 v209, v184, s57, v209
    v_dot2_f32_bf16 v210, v185, s56, v210
    v_dot2_f32_bf16 v211, v185, s57, v211
    v_dot2_f32_bf16 v212, v186, s56, v212
    v_dot2_f32_bf16 v213, v186, s57, v213
    v_dot2_f32_bf16 v214, v187, s56, v214
    v_dot2_f32_bf16 v215, v187, s57, v215
    s_waitcnt vmcnt(5)
    v_dot2_f32_bf16 v208, v188, s56, v208
    v_dot2_f32_bf16 v209, v188, s57, v209
    v_dot2_f32_bf16 v210, v189, s56, v210
    v_dot2_f32_bf16 v211, v189, s57, v211
    v_dot2_f32_bf16 v212, v190, s56, v212
    v_dot2_f32_bf16 v213, v190, s57, v213
    v_dot2_f32_bf16 v214, v191, s56, v214
    v_dot2_f32_bf16 v215, v191, s57, v215
    s_waitcnt vmcnt(4)
    v_dot2_f32_bf16 v208, v192, s56, v208
    v_dot2_f32_bf16 v209, v192, s57, v209
    v_dot2_f32_bf16 v210, v193, s56, v210
    v_dot2_f32_bf16 v211, v193, s57, v211
    v_dot2_f32_bf16 v212, v194, s56, v212
    v_dot2_f32_bf16 v213, v194, s57, v213
    v_dot2_f32_bf16 v214, v195, s56, v214
    v_dot2_f32_bf16 v215, v195, s57, v215
    s_waitcnt vmcnt(3)
    v_dot2_f32_bf16 v208, v196, s56, v208
    v_dot2_f32_bf16 v209, v196, s57, v209
    v_dot2_f32_bf16 v210, v197, s56, v210
    v_dot2_f32_bf16 v211, v197, s57, v211
    v_dot2_f32_bf16 v212, v198, s56, v212
    v_dot2_f32_bf16 v213, v198, s57, v213
    v_dot2_f32_bf16 v214, v199, s56, v214
    v_dot2_f32_bf16 v215, v199, s57, v215
    s_waitcnt vmcnt(2)
    v_dot2_f32_bf16 v208, v200, s56, v208
    v_dot2_f32_bf16 v209, v200, s57, v209
    v_dot2_f32_bf16 v210, v201, s56, v210
    v_dot2_f32_bf16 v211, v201, s57, v211
    v_dot2_f32_bf16 v212, v202, s56, v212
    v_dot2_f32_bf16 v213, v202, s57, v213
    v_dot2_f32_bf16 v214, v203, s56, v214
    v_dot2_f32_bf16 v215, v203, s57, v215
    s_waitcnt vmcnt(1)
    v_dot2_f32_bf16 v208, v204, s56, v208
    v_dot2_f32_bf16 v209, v204, s57, v209
    v_dot2_f32_bf16 v210, v205, s56, v210
    v_dot2_f32_bf16 v211, v205, s57, v211
    v_dot2_f32_bf16 v212, v206, s56, v212
    v_dot2_f32_bf16 v213, v206, s57, v213
    v_dot2_f32_bf16 v214, v207, s56, v214
    v_dot2_f32_bf16 v215, v207, s57, v215
    v_lshlrev_b32 v240, 16, v120
    v_and_b32 v241, s35, v120
    v_lshlrev_b32 v242, 16, v121
    v_and_b32 v243, s35, v121
    v_lshlrev_b32 v244, 16, v122
    v_and_b32 v245, s35, v122
    v_lshlrev_b32 v246, 16, v123
    v_and_b32 v247, s35, v123
    v_pk_fma_f32 v[208:209], v[208:209], v[124:125], v[240:241]
    v_pk_fma_f32 v[210:211], v[210:211], v[126:127], v[242:243]
    v_pk_fma_f32 v[212:213], v[212:213], v[128:129], v[244:245]
    v_pk_fma_f32 v[214:215], v[214:215], v[130:131], v[246:247]
    v_cvt_pk_bf16_f32 v120, v208, v209
    v_cvt_pk_bf16_f32 v121, v210, v211
    v_cvt_pk_bf16_f32 v122, v212, v213
    v_cvt_pk_bf16_f32 v123, v214, v215
    s_lshl_b32 s50, s58, 7
    s_add_u32 s50, s50, s99
    buffer_store_dwordx4 v[120:123], v10, s[12:15], s50 offen
    s_waitcnt vmcnt(0)
    s_branch L_fin_6026
L_fst_6050:
    v_pk_mul_f32 v[100:101], v[100:101], s[58:59] op_sel:[0,1] op_sel_hi:[1,1]
    v_pk_mul_f32 v[102:103], v[102:103], s[58:59] op_sel:[0,1] op_sel_hi:[1,1]
    v_pk_mul_f32 v[104:105], v[104:105], s[58:59] op_sel:[0,1] op_sel_hi:[1,1]
    v_pk_mul_f32 v[106:107], v[106:107], s[58:59] op_sel:[0,1] op_sel_hi:[1,1]
    s_waitcnt vmcnt(7)
    v_dot2_f32_bf16 v208, v16, s56, 0
    v_dot2_f32_bf16 v209, v16, s57, 0
    v_dot2_f32_bf16 v210, v17, s56, 0
    v_dot2_f32_bf16 v211, v17, s57, 0
    v_dot2_f32_bf16 v212, v18, s56, 0
    v_dot2_f32_bf16 v213, v18, s57, 0
    v_dot2_f32_bf16 v214, v19, s56, 0
    v_dot2_f32_bf16 v215, v19, s57, 0
    s_waitcnt vmcnt(6)
    v_dot2_f32_bf16 v208, v20, s56, v208
    v_dot2_f32_bf16 v209, v20, s57, v209
    v_dot2_f32_bf16 v210, v21, s56, v210
    v_dot2_f32_bf16 v211, v21, s57, v211
    v_dot2_f32_bf16 v212, v22, s56, v212
    v_dot2_f32_bf16 v213, v22, s57, v213
    v_dot2_f32_bf16 v214, v23, s56, v214
    v_dot2_f32_bf16 v215, v23, s57, v215
    s_waitcnt vmcnt(5)
    v_dot2_f32_bf16 v208, v24, s56, v208
    v_dot2_f32_bf16 v209, v24, s57, v209
    v_dot2_f32_bf16 v210, v25, s56, v210
    v_dot2_f32_bf16 v211, v25, s57, v211
    v_dot2_f32_bf16 v212, v26, s56, v212
    v_dot2_f32_bf16 v213, v26, s57, v213
    v_dot2_f32_bf16 v214, v27, s56, v214
    v_dot2_f32_bf16 v215, v27, s57, v215
    s_waitcnt vmcnt(4)
    v_dot2_f32_bf16 v208, v28, s56, v208
    v_dot2_f32_bf16 v209, v28, s57, v209
    v_dot2_f32_bf16 v210, v29, s56, v210
    v_dot2_f32_bf16 v211, v29, s57, v211
    v_dot2_f32_bf16 v212, v30, s56, v212
    v_dot2_f32_bf16 v213, v30, s57, v213
    v_dot2_f32_bf16 v214, v31, s56, v214
    v_dot2_f32_bf16 v215, v31, s57, v215
    s_waitcnt vmcnt(3)
    v_dot2_f32_bf16 v208, v32, s56, v208
    v_dot2_f32_bf16 v209, v32, s57, v209
    v_dot2_f32_bf16 v210, v33, s56, v210
    v_dot2_f32_bf16 v211, v33, s57, v211
    v_dot2_f32_bf16 v212, v34, s56, v212
    v_dot2_f32_bf16 v213, v34, s57, v213
    v_dot2_f32_bf16 v214, v35, s56, v214
    v_dot2_f32_bf16 v215, v35, s57, v215
    s_waitcnt vmcnt(2)
    v_dot2_f32_bf16 v208, v36, s56, v208
    v_dot2_f32_bf16 v209, v36, s57, v209
    v_dot2_f32_bf16 v210, v37, s56, v210
    v_dot2_f32_bf16 v211, v37, s57, v211
    v_dot2_f32_bf16 v212, v38, s56, v212
    v_dot2_f32_bf16 v213, v38, s57, v213
    v_dot2_f32_bf16 v214, v39, s56, v214
    v_dot2_f32_bf16 v215, v39, s57, v215
    s_waitcnt vmcnt(1)
    v_dot2_f32_bf16 v208, v40, s56, v208
    v_dot2_f32_bf16 v209, v40, s57, v209
    v_dot2_f32_bf16 v210, v41, s56, v210
    v_dot2_f32_bf16 v211, v41, s57, v211
    v_dot2_f32_bf16 v212, v42, s56, v212
    v_dot2_f32_bf16 v213, v42, s57, v213
    v_dot2_f32_bf16 v214, v43, s56, v214
    v_dot2_f32_bf16 v215, v43, s57, v215
    s_waitcnt vmcnt(0)
    v_dot2_f32_bf16 v208, v44, s56, v208
    v_dot2_f32_bf16 v209, v44, s57, v209
    v_dot2_f32_bf16 v210, v45, s56, v210
    v_dot2_f32_bf16 v211, v45, s57, v211
    v_dot2_f32_bf16 v212, v46, s56, v212
    v_dot2_f32_bf16 v213, v46, s57, v213
    v_dot2_f32_bf16 v214, v47, s56, v214
    v_dot2_f32_bf16 v215, v47, s57, v215
    v_lshlrev_b32 v240, 16, v96
    v_and_b32 v241, s35, v96
    v_lshlrev_b32 v242, 16, v97
    v_and_b32 v243, s35, v97
    v_lshlrev_b32 v244, 16, v98
    v_and_b32 v245, s35, v98
    v_lshlrev_b32 v246, 16, v99
    v_and_b32 v247, s35, v99
    v_pk_fma_f32 v[208:209], v[208:209], v[100:101], v[240:241]
    v_pk_fma_f32 v[210:211], v[210:211], v[102:103], v[242:243]
    v_pk_fma_f32 v[212:213], v[212:213], v[104:105], v[244:245]
    v_pk_fma_f32 v[214:215], v[214:215], v[106:107], v[246:247]
    v_cvt_pk_bf16_f32 v96, v208, v209
    v_cvt_pk_bf16_f32 v97, v210, v211
    v_cvt_pk_bf16_f32 v98, v212, v213
    v_cvt_pk_bf16_f32 v99, v214, v215
    s_lshl_b32 s50, s52, 7
    s_add_u32 s50, s50, s99
    buffer_store_dwordx4 v[96:99], v10, s[12:15], s50 offen
    v_cmp_gt_u32 vcc, 3, v9
    s_nop 0
    s_cmp_eq_u64 vcc, 0
    s_cbranch_scc1 L_wok_6053
    v_and_b32 v8, 15, v1
    v_lshlrev_b32 v8, 6, v8
    s_mov_b32 s43, 0
    s_nop 3
L_poll_6054:
    buffer_load_dword v9, v8, s[16:19], s4 offen sc1
    s_add_u32 s43, s43, 1
    s_cmp_gt_u32 s43, 400000
    s_cbranch_scc1 L_polled_6055
    s_waitcnt vmcnt(0)
    v_cmp_gt_u32 vcc, 3, v9
    s_cbranch_vccnz L_poll_6054
L_polled_6055:
    s_waitcnt vmcnt(0)
L_wok_6053:
    s_lshl_b32 s50, s58, 11
    s_add_u32 s51, s98, s50
    buffer_load_dwordx4 v[176:179], v4, s[16:19], s51 offen sc1
    s_add_u32 s51, s51, 147456
    buffer_load_dwordx4 v[180:183], v4, s[16:19], s51 offen sc1
    s_add_u32 s51, s51, 147456
    buffer_load_dwordx4 v[184:187], v4, s[16:19], s51 offen sc1
    s_add_u32 s51, s51, 147456
    buffer_load_dwordx4 v[188:191], v4, s[16:19], s51 offen sc1
    s_add_u32 s51, s51, 147456
    buffer_load_dwordx4 v[192:195], v4, s[16:19], s51 offen sc1
    s_add_u32 s51, s51, 147456
    buffer_load_dwordx4 v[196:199], v4, s[16:19], s51 offen sc1
    s_add_u32 s51, s51, 147456
    buffer_load_dwordx4 v[200:203], v4, s[16:19], s51 offen sc1
    s_add_u32 s51, s51, 147456
    buffer_load_dwordx4 v[204:207], v4, s[16:19], s51 offen sc1
    v_pk_mul_f32 v[124:125], v[124:125], s[58:59] op_sel:[0,1] op_sel_hi:[1,1]
    v_pk_mul_f32 v[126:127], v[126:127], s[58:59] op_sel:[0,1] op_sel_hi:[1,1]
    v_pk_mul_f32 v[128:129], v[128:129], s[58:59] op_sel:[0,1] op_sel_hi:[1,1]
    v_pk_mul_f32 v[130:131], v[130:131], s[58:59] op_sel:[0,1] op_sel_hi:[1,1]
    s_waitcnt vmcnt(7)
    v_dot2_f32_bf16 v208, v176, s56, 0
    v_dot2_f32_bf16 v209, v176, s57, 0
    v_dot2_f32_bf16 v210, v177, s56, 0
    v_dot2_f32_bf16 v211, v177, s57, 0
    v_dot2_f32_bf16 v212, v178, s56, 0
    v_dot2_f32_bf16 v213, v178, s57, 0
    v_dot2_f32_bf16 v214, v179, s56, 0
    v_dot2_f32_bf16 v215, v179, s57, 0
    s_waitcnt vmcnt(6)
    v_dot2_f32_bf16 v208, v180, s56, v208
    v_dot2_f32_bf16 v209, v180, s57, v209
    v_dot2_f32_bf16 v210, v181, s56, v210
    v_dot2_f32_bf16 v211, v181, s57, v211
    v_dot2_f32_bf16 v212, v182, s56, v212
    v_dot2_f32_bf16 v213, v182, s57, v213
    v_dot2_f32_bf16 v214, v183, s56, v214
    v_dot2_f32_bf16 v215, v183, s57, v215
    s_waitcnt vmcnt(5)
    v_dot2_f32_bf16 v208, v184, s56, v208
    v_dot2_f32_bf16 v209, v184, s57, v209
    v_dot2_f32_bf16 v210, v185, s56, v210
    v_dot2_f32_bf16 v211, v185, s57, v211
    v_dot2_f32_bf16 v212, v186, s56, v212
    v_dot2_f32_bf16 v213, v186, s57, v213
    v_dot2_f32_bf16 v214, v187, s56, v214
    v_dot2_f32_bf16 v215, v187, s57, v215
    s_waitcnt vmcnt(4)
    v_dot2_f32_bf16 v208, v188, s56, v208
    v_dot2_f32_bf16 v209, v188, s57, v209
    v_dot2_f32_bf16 v210, v189, s56, v210
    v_dot2_f32_bf16 v211, v189, s57, v211
    v_dot2_f32_bf16 v212, v190, s56, v212
    v_dot2_f32_bf16 v213, v190, s57, v213
    v_dot2_f32_bf16 v214, v191, s56, v214
    v_dot2_f32_bf16 v215, v191, s57, v215
    s_waitcnt vmcnt(3)
    v_dot2_f32_bf16 v208, v192, s56, v208
    v_dot2_f32_bf16 v209, v192, s57, v209
    v_dot2_f32_bf16 v210, v193, s56, v210
    v_dot2_f32_bf16 v211, v193, s57, v211
    v_dot2_f32_bf16 v212, v194, s56, v212
    v_dot2_f32_bf16 v213, v194, s57, v213
    v_dot2_f32_bf16 v214, v195, s56, v214
    v_dot2_f32_bf16 v215, v195, s57, v215
    s_waitcnt vmcnt(2)
    v_dot2_f32_bf16 v208, v196, s56, v208
    v_dot2_f32_bf16 v209, v196, s57, v209
    v_dot2_f32_bf16 v210, v197, s56, v210
    v_dot2_f32_bf16 v211, v197, s57, v211
    v_dot2_f32_bf16 v212, v198, s56, v212
    v_dot2_f32_bf16 v213, v198, s57, v213
    v_dot2_f32_bf16 v214, v199, s56, v214
    v_dot2_f32_bf16 v215, v199, s57, v215
    s_waitcnt vmcnt(1)
    v_dot2_f32_bf16 v208, v200, s56, v208
    v_dot2_f32_bf16 v209, v200, s57, v209
    v_dot2_f32_bf16 v210, v201, s56, v210
    v_dot2_f32_bf16 v211, v201, s57, v211
    v_dot2_f32_bf16 v212, v202, s56, v212
    v_dot2_f32_bf16 v213, v202, s57, v213
    v_dot2_f32_bf16 v214, v203, s56, v214
    v_dot2_f32_bf16 v215, v203, s57, v215
    s_waitcnt vmcnt(0)
    v_dot2_f32_bf16 v208, v204, s56, v208
    v_dot2_f32_bf16 v209, v204, s57, v209
    v_dot2_f32_bf16 v210, v205, s56, v210
    v_dot2_f32_bf16 v211, v205, s57, v211
    v_dot2_f32_bf16 v212, v206, s56, v212
    v_dot2_f32_bf16 v213, v206, s57, v213
    v_dot2_f32_bf16 v214, v207, s56, v214
    v_dot2_f32_bf16 v215, v207, s57, v215
    v_lshlrev_b32 v240, 16, v120
    v_and_b32 v241, s35, v120
    v_lshlrev_b32 v242, 16, v121
    v_and_b32 v243, s35, v121
    v_lshlrev_b32 v244, 16, v122
    v_and_b32 v245, s35, v122
    v_lshlrev_b32 v246, 16, v123
    v_and_b32 v247, s35, v123
    v_pk_fma_f32 v[208:209], v[208:209], v[124:125], v[240:241]
    v_pk_fma_f32 v[210:211], v[210:211], v[126:127], v[242:243]
    v_pk_fma_f32 v[212:213], v[212:213], v[128:129], v[244:245]
    v_pk_fma_f32 v[214:215], v[214:215], v[130:131], v[246:247]
    v_cvt_pk_bf16_f32 v120, v208, v209
    v_cvt_pk_bf16_f32 v121, v210, v211
    v_cvt_pk_bf16_f32 v122, v212, v213
    v_cvt_pk_bf16_f32 v123, v214, v215
    s_lshl_b32 s50, s58, 7
    s_add_u32 s50, s50, s99
    buffer_store_dwordx4 v[120:123], v10, s[12:15], s50 offen
    s_waitcnt vmcnt(0)
    s_branch L_fin_6026
L_fin_6026:
L_end_k1_kernel:
    s_endpgm
L_pslow_6006:
    s_mov_b32 s41, 0
L_pagain_6007:
    buffer_load_dword v3, v2, s[16:19], s101 offen sc1
    s_add_u32 s41, s41, 1
    s_cmp_gt_u32 s41, 400000
    s_cbranch_scc1 L_back_ok_6005
    s_waitcnt vmcnt(0)
    v_cmp_gt_u32 vcc, 1, v3
    s_nop 1
    s_cbranch_vccnz L_pagain_6007
    s_branch L_back_ok_6005
L_stslow_6009:
    s_mov_b32 s100, 0
L_stagain_6010:
    buffer_load_dwordx4 v[32:35], v238, s[16:19], s97 offen sc1
    buffer_load_dwordx4 v[36:39], v238, s[16:19], s97 offen offset:1024 sc1
    s_add_u32 s100, s100, 1
    s_cmp_gt_u32 s100, 400000
    s_cbranch_scc1 L_back_st_6008
    s_waitcnt vmcnt(0)
    v_and_b32 v44, v34, v38
    v_cmp_eq_u32 vcc, 0, v44
    s_nop 1
    s_cbranch_vccnz L_stagain_6010
    s_branch L_back_st_6008
L_pslow_6012:
    s_mov_b32 s40, 0
L_pagain_6013:
    buffer_load_dword v11, v10, s[16:19], s101 offen sc1
    s_add_u32 s40, s40, 1
    s_cmp_gt_u32 s40, 400000
    s_cbranch_scc1 L_back_ok_6011
    s_waitcnt vmcnt(0)
    v_cmp_gt_u32 vcc, 1, v11
    s_nop 1
    s_cbranch_vccnz L_pagain_6013
    s_branch L_back_ok_6011
L_slow_6014:
    s_mov_b32 s44, 0
L_again_6016:
    buffer_load_dword v2, v15, s[16:19], s38 offen sc1
    s_add_u32 s44, s44, 1
    s_cmp_gt_u32 s44, 400000
    s_cbranch_scc1 L_back_6015
    s_waitcnt vmcnt(0)
    v_readfirstlane_b32 s40, v2
    s_nop 1
    s_cmp_ge_u32 s40, 1
    s_cbranch_scc0 L_again_6016
    s_branch L_back_6015
L_slow_6017:
    s_mov_b32 s44, 0
L_again_6019:
    buffer_load_dword v2, v15, s[16:19], s38 offen sc1
    s_add_u32 s44, s44, 1
    s_cmp_gt_u32 s44, 400000
    s_cbranch_scc1 L_back_6018
    s_waitcnt vmcnt(0)
    v_readfirstlane_b32 s40, v2
    s_nop 1
    s_cmp_ge_u32 s40, 2
    s_cbranch_scc0 L_again_6019
    s_branch L_back_6018
L_slow_6020:
    s_mov_b32 s44, 0
L_again_6022:
    buffer_load_dword v2, v15, s[16:19], s38 offen sc1
    s_add_u32 s44, s44, 1
    s_cmp_gt_u32 s44, 400000
    s_cbranch_scc1 L_back_6021
    s_waitcnt vmcnt(0)
    v_readfirstlane_b32 s40, v2
    s_nop 1
    s_cmp_ge_u32 s40, 3
    s_cbranch_scc0 L_again_6022
    s_branch L_back_6021
L_slow_6023:
    s_mov_b32 s44, 0
L_again_6025:
    buffer_load_dword v2, v15, s[16:19], s38 offen sc1
    s_add_u32 s44, s44, 1
    s_cmp_gt_u32 s44, 400000
    s_cbranch_scc1 L_back_6024
    s_waitcnt vmcnt(0)
    v_readfirstlane_b32 s40, v2
    s_nop 1
    s_cmp_ge_u32 s40, 4
    s_cbranch_scc0 L_again_6025
    s_branch L_back_6024
L_k1_end:

.section .rodata,"a"
.p2align 6
.amdhsa_kernel k0_kernel
  .amdhsa_next_free_vgpr 128
  .amdhsa_next_free_sgpr 102
  .amdhsa_accum_offset 128
  .amdhsa_group_segment_fixed_size 0
  .amdhsa_kernarg_size 96
  .amdhsa_user_sgpr_count 2
  .amdhsa_user_sgpr_kernarg_segment_ptr 1
  .amdhsa_system_sgpr_workgroup_id_x 1
  .amdhsa_float_denorm_mode_32 3
.end_amdhsa_kernel
.p2align 6
.amdhsa_kernel k1_kernel
  .amdhsa_next_free_vgpr 512
  .amdhsa_next_free_sgpr 102
  .amdhsa_accum_offset 256
  .amdhsa_group_segment_fixed_size 0
  .amdhsa_kernarg_size 96
  .amdhsa_user_sgpr_count 2
  .amdhsa_user_sgpr_kernarg_segment_ptr 1
  .amdhsa_system_sgpr_workgroup_id_x 1
  .amdhsa_float_denorm_mode_32 3
.end_amdhsa_kernel
```
